```python
import torch

def _softmax(x, axis=-1):
    return torch.softmax(x, dim=axis)
def _gelu(x):
    return torch.nn.functional.gelu(x, approximate="tanh")
def _silu(x):
    return torch.nn.functional.silu(x)
def _sigmoid(x):
    return torch.sigmoid(x)
def _layernorm(x, axis=-1, eps=1e-5):
    m = x.mean(dim=axis, keepdim=True)
    v = x.var(dim=axis, keepdim=True, unbiased=False)
    return (x - m) / torch.sqrt(v + eps)
def _scatter_add(tgt, idx, src, axis=0):
    return tgt.clone().index_add_(axis, idx, src)
def _segment_sum(src, seg, n):
    out = torch.zeros((n,) + src.shape[1:], dtype=src.dtype)
    return out.index_add_(0, seg, src)
def _pad(x, pw):
    flat = tuple(v for pair in reversed(pw) for v in pair)
    return torch.nn.functional.pad(x, flat)

kernel_name = 'concat_heads__gqa_block_cached__mha_block_cached__near_ridge'

def setup_inputs():

    _w = (lambda a: (lambda t: t.to(torch.bfloat16) if t.is_floating_point() else t)(torch.as_tensor(a)))
    def _A_setup():
        B, Sq, D = 16, 160, 640
        Hq, Hkv, Sk, Dh = 32, 32, 512, 192
        assert Hq % Hkv == 0, (Hq, Hkv)
        return {
            "x": _w((lambda *s: torch.randn(*s, dtype=torch.bfloat16) * 0.8)(B, Sq, D)),
            "k_cache": _w((lambda *s: torch.randn(*s, dtype=torch.bfloat16) * 0.8)(B, Hkv, Sk, Dh)),
            "v_cache": _w((lambda *s: torch.randn(*s, dtype=torch.bfloat16) * 0.05)(B, Hkv, Sk, Dh)),
            "wq": _w((lambda *s: torch.randn(*s, dtype=torch.bfloat16) * 0.8)(D, Hq * Dh) * (D ** -0.5)),
            "wo": _w((lambda *s: torch.randn(*s, dtype=torch.bfloat16) * 0.05)(Hq * Dh, D) * ((Hq * Dh) ** -0.5)),
        }
    _A_in = _A_setup()

    def _B_setup():
        B, Sq, D = 16, 160, 640
        H, Sk, Dh = 32, 512, 192
        return {
            "x": _w((lambda *s: torch.randn(*s, dtype=torch.bfloat16) * 0.8)(B, Sq, D)),
            "k_cache": _w((lambda *s: torch.randn(*s, dtype=torch.bfloat16) * 0.8)(B, H, Sk, Dh)),
            "v_cache": _w((lambda *s: torch.randn(*s, dtype=torch.bfloat16) * 0.05)(B, H, Sk, Dh)),
            "wq": _w((lambda *s: torch.randn(*s, dtype=torch.bfloat16) * 0.8)(D, H * Dh) * (D ** -0.5)),
            "wo": _w((lambda *s: torch.randn(*s, dtype=torch.bfloat16) * 0.05)(H * Dh, D) * ((H * Dh) ** -0.5)),
        }
    _B_in = _B_setup()

    return {
        "A_x": _A_in["x"],
        "A_k_cache": _A_in["k_cache"],
        "A_v_cache": _A_in["v_cache"],
        "A_wq": _A_in["wq"],
        "A_wo": _A_in["wo"],
        "B_x": _B_in["x"],
        "B_k_cache": _B_in["k_cache"],
        "B_v_cache": _B_in["v_cache"],
        "B_wq": _B_in["wq"],
        "B_wo": _B_in["wo"],
    }

def reference(A_x, A_k_cache, A_v_cache, A_wq, A_wo, B_x, B_k_cache, B_v_cache, B_wq, B_wo):
    def _A_ref(x, k_cache, v_cache, wq, wo):
        B, Sq, D = x.shape
        Hq, Dh = 32, 192
        Hkv = k_cache.shape[1]
        rep = Hq // Hkv
        q = (lambda x, *d: x.permute(*d))((x @ wq).reshape(B, Sq, Hq, Dh), 0, 2, 1, 3)
        k = (lambda x, n, axis: torch.repeat_interleave(x, n, dim=axis))(k_cache, rep, axis=1)
        v = (lambda x, n, axis: torch.repeat_interleave(x, n, dim=axis))(v_cache, rep, axis=1)
        scores = torch.einsum("bhqd,bhkd->bhqk", q, k) * (Dh ** -0.5)
        p = _softmax(scores, axis=-1)
        o = torch.einsum("bhqk,bhkd->bhqd", p, v)
        return (lambda x, *d: x.permute(*d))(o, 0, 2, 1, 3).reshape(B, Sq, Hq * Dh) @ wo

    def _B_ref(x, k_cache, v_cache, wq, wo):
        B, Sq, D = x.shape
        H, Dh = 32, 192
        q = (lambda x, *d: x.permute(*d))((x @ wq).reshape(B, Sq, H, Dh), 0, 2, 1, 3)
        scores = torch.einsum("bhqd,bhkd->bhqk", q, k_cache) * (Dh ** -0.5)
        p = _softmax(scores, axis=-1)
        o = torch.einsum("bhqk,bhkd->bhqd", p, v_cache)
        return (lambda x, *d: x.permute(*d))(o, 0, 2, 1, 3).reshape(B, Sq, H * Dh) @ wo

    a = _A_ref(A_x, A_k_cache, A_v_cache, A_wq, A_wo)
    b = _B_ref(B_x, B_k_cache, B_v_cache, B_wq, B_wo)
    return torch.concatenate([a, b], axis=-1)
```

```asm
; @launch grid=(256,1,1) block=(256,1,1) lds=163840
.amdgcn_target "amdgcn-amd-amdhsa--gfx950"
.text
.globl concat_heads__gqa_block_cached__mha_block_cached__near_ridge_kernel
.p2align 8
.type concat_heads__gqa_block_cached__mha_block_cached__near_ridge_kernel,@function
concat_heads__gqa_block_cached__mha_block_cached__near_ridge_kernel:
    s_cmp_ge_u32 s2, 256
    s_cbranch_scc1 L_end
    s_load_dwordx16 s[52:67], s[0:1], 0
    s_load_dwordx8 s[68:75], s[0:1], 64
    s_load_dwordx2 s[88:89], s[0:1], 96
    s_getpc_b64 s[12:13]
    s_mov_b32 s14, L_end - . - 16
    s_mov_b32 s15, 0x20000
    v_lshrrev_b32 v18, 6, v0
    v_and_b32 v19, 63, v0
    v_lshlrev_b32 v18, 7, v18
    v_lshl_add_u32 v18, v19, 14, v18
    s_lshr_b32 s42, s2, 3
    s_lshl_b32 s42, s42, 9

    buffer_load_dword a255, v18, s[12:15], s42 offen
    v_lshrrev_b32 v16, 6, v0
    v_and_b32 v17, 63, v0
    s_bfe_u32 s44, s2, 0x10002
    v_readfirstlane_b32 s24, v16
    s_lshr_b32 s85, s2, 7
    s_and_b32 s84, s2, 1
    s_bfe_u32 s45, s2, 0x10001
    s_lshl_b32 s45, s45, 2
    s_bfe_u32 s46, s2, 0x20003
    s_add_u32 s45, s45, s46
    s_lshl_b32 s42, s44, 3
    s_add_u32 s42, s42, s45
    s_lshl_b32 s80, s42, 3
    s_lshl_b32 s45, s45, 1
    s_lshr_b32 s46, s24, 1
    s_add_u32 s45, s45, s46
    s_mul_i32 s48, s46, 24576
    s_and_b32 s47, s24, 1
    s_mul_i32 s27, s47, 3072
    s_add_u32 s27, s27, s48
    s_add_u32 s40, s27, 147456
    s_mul_i32 s25, s24, 3072
    s_mul_i32 s26, s24, 10240
    s_lshr_b32 s46, s2, 5
    s_lshl_b32 s43, s84, 3
    s_add_u32 s46, s46, s43
    s_lshl_b32 s41, 1, s43

    s_mov_b32 s28, 1
    s_mov_b32 s32, 0
    v_lshrrev_b32 v18, 3, v17
    v_and_b32 v19, 7, v17
    v_lshrrev_b32 v20, 4, v17
    v_mul_u32_u24 v21, 1280, v18
    v_xor_b32 v22, v19, v20
    v_lshl_add_u32 v9, v22, 4, v21
    v_xor_b32 v22, 4, v22
    v_lshl_add_u32 v10, v22, 4, v21
    s_lshr_b32 s42, s24, 1
    s_lshl_b32 s42, s42, 2
    s_lshl_b32 s43, s47, 4
    s_add_u32 s42, s42, s43
    s_mul_i32 s43, s47, 3072

    v_add_u32 v26, 0, v18
    v_mul_u32_u24 v21, 43, v26
    v_lshrrev_b32 v21, 7, v21
    v_mul_u32_u24 v22, 3, v21
    v_sub_u32 v22, v26, v22
    v_and_b32 v23, 6, v21
    v_add_u32 v23, s47, v23
    v_xor_b32 v23, v23, v19
    v_lshlrev_b32 v23, 4, v23
    v_lshl_add_u32 v24, v18, 7, v23
    v_add_u32 v11, s43, v24
    v_and_b32 v24, 3, v21
    v_lshrrev_b32 v25, 2, v21
    v_lshl_add_u32 v24, v25, 3, v24
    v_add_u32 v24, s42, v24
    v_mul_u32_u24 v24, 12288, v24
    v_lshl_add_u32 v24, v22, 7, v24
    v_add_u32 v24, v24, v23
    v_subrev_u32 v6, 0, v24

    v_add_u32 v26, 8, v18
    v_mul_u32_u24 v21, 43, v26
    v_lshrrev_b32 v21, 7, v21
    v_mul_u32_u24 v22, 3, v21
    v_sub_u32 v22, v26, v22
    v_and_b32 v23, 6, v21
    v_add_u32 v23, s47, v23
    v_xor_b32 v23, v23, v19
    v_lshlrev_b32 v23, 4, v23
    v_lshl_add_u32 v24, v18, 7, v23
    v_add_u32 v12, s43, v24
    v_and_b32 v24, 3, v21
    v_lshrrev_b32 v25, 2, v21
    v_lshl_add_u32 v24, v25, 3, v24
    v_add_u32 v24, s42, v24
    v_mul_u32_u24 v24, 12288, v24
    v_lshl_add_u32 v24, v22, 7, v24
    v_add_u32 v24, v24, v23
    v_subrev_u32 v7, 1024, v24

    v_add_u32 v26, 16, v18
    v_mul_u32_u24 v21, 43, v26
    v_lshrrev_b32 v21, 7, v21
    v_mul_u32_u24 v22, 3, v21
    v_sub_u32 v22, v26, v22
    v_and_b32 v23, 6, v21
    v_add_u32 v23, s47, v23
    v_xor_b32 v23, v23, v19
    v_lshlrev_b32 v23, 4, v23
    v_lshl_add_u32 v24, v18, 7, v23
    v_add_u32 v13, s43, v24
    v_and_b32 v24, 3, v21
    v_lshrrev_b32 v25, 2, v21
    v_lshl_add_u32 v24, v25, 3, v24
    v_add_u32 v24, s42, v24
    v_mul_u32_u24 v24, 12288, v24
    v_lshl_add_u32 v24, v22, 7, v24
    v_add_u32 v24, v24, v23
    v_subrev_u32 v8, 2048, v24

    s_add_u32 s32, s32, s46
    s_waitcnt lgkmcnt(0)
    s_cmp_eq_u32 s44, 0
    s_cselect_b64 s[90:91], s[52:53], s[62:63]
    s_cselect_b64 s[92:93], s[54:55], s[64:65]
    s_cselect_b64 s[94:95], s[56:57], s[66:67]
    s_cselect_b64 s[96:97], s[58:59], s[68:69]
    s_cselect_b64 s[98:99], s[60:61], s[70:71]
    s_mul_i32 s42, s45, 204800
    s_mul_i32 s43, s47, 102400
    s_add_u32 s42, s42, s43
    s_add_u32 s4, s90, s42
    s_addc_u32 s5, s91, 0
    s_mov_b32 s6, 102400
    s_mov_b32 s7, 0x20000
    s_mul_i32 s42, s32, 384
    s_add_u32 s8, s96, s42
    s_addc_u32 s9, s97, 0
    s_mov_b32 s10, 7852416
    s_mov_b32 s11, 0x20000

    s_bfe_u32 s29, s2, 0x20003
    s_lshl_b32 s29, s29, 2
    s_add_u32 s29, s29, s24
    s_mul_i32 s29, s29, 12288
    v_mul_u32_u24 v31, 43, v17
    v_lshrrev_b32 v31, 7, v31
    v_mul_u32_u24 v31, 196224, v31
    v_lshl_add_u32 v31, v17, 7, v31
    s_mov_b64 exec, 0xffffff
    buffer_load_dword a255, v31, s[8:11], s29 offen
    s_mov_b64 exec, -1
    s_mov_b64 s[50:51], s[72:73]
    s_mov_b64 s[68:69], s[74:75]
    s_mov_b32 s70, 256
    s_mov_b32 s71, 0x20000
    s_lshl_b32 s42, s45, 5
    s_add_u32 s42, s42, s46
    s_mul_i32 s42, s42, 196608
    s_add_u32 s12, s92, s42
    s_addc_u32 s13, s93, 0
    s_mov_b32 s14, 196608
    s_mov_b32 s15, 0x20000
    s_add_u32 s16, s94, s42
    s_addc_u32 s17, s95, 0
    s_mov_b32 s18, 196608
    s_mov_b32 s19, 0x20000
    s_lshl_b32 s42, s44, 4
    s_add_u32 s42, s42, s45
    s_lshl_b32 s42, s42, 5
    s_add_u32 s42, s42, s46
    s_mul_i32 s42, s42, 61440
    s_lshl_b32 s29, s84, 3
    s_lshr_b32 s34, s2, 5
    s_add_u32 s29, s29, s34
    s_mul_i32 s29, s29, 6400
    v_lshlrev_b32 v30, 7, v17
    s_mov_b32 exec_hi, 0x3ffff
    buffer_load_dword a255, v30, s[4:7], s29 offen
    s_mov_b32 exec_hi, -1
    s_mul_i32 s43, s47, 5120
    s_add_u32 s42, s42, s43
    s_add_u32 s20, s88, s42
    s_addc_u32 s21, s89, 0
    s_mov_b32 s22, 0
    s_mov_b32 s23, 0x20000
    s_add_u32 s64, s88, 62914560
    s_addc_u32 s65, s89, 0
    s_mov_b32 s66, 71467008
    s_mov_b32 s67, 0x20000
    s_lshr_b32 s43, s2, 5
    s_add_u32 s42, s80, s43
    s_lshl_b32 s42, s42, 1
    s_add_u32 s42, s42, s84
    s_lshl_b32 s42, s42, 7
    s_add_u32 s42, s42, 71303168
    s_mov_b32 s87, s42
    s_mov_b32 s38, 0x3dd53b95
    s_mov_b32 s39, s38
    s_and_b32 s45, s2, 3
    s_add_u32 m0, s26, 0
    s_mov_b32 s32, 0
    buffer_load_dwordx4 v9, s[4:7], s32 offen lds
    s_xor_b32 s45, s45, s85
    s_lshl_b32 s45, s45, 2
    s_bfe_u32 s43, s2, 0x20005
    s_add_u32 s45, s45, s43
    s_bfe_u32 s46, s2, 0x20003
    s_lshr_b32 s79, s24, 1
    s_mul_i32 s76, s24, 5120
    s_mul_i32 s42, s45, 409600
    s_mul_i32 s43, s47, 204800
    s_add_u32 s42, s42, s43
    s_mul_i32 s43, s44, 1280
    s_add_u32 s42, s42, s43
    s_mul_i32 s43, s46, 320
    s_add_u32 s42, s42, s43
    s_mul_i32 s43, s79, 160
    s_add_u32 s42, s42, s43
    s_add_u32 s60, s50, s42
    s_addc_u32 s61, s51, 0
    s_mov_b32 s62, 202400
    s_mov_b32 s63, 0x20000
    s_mov_b32 s33, 9216
    buffer_load_dwordx4 v10, s[4:7], s33 offen offset:1024 lds
    s_mul_i32 s42, s46, 320
    s_mul_i32 s43, s24, 20480
    s_add_u32 s42, s42, s43
    s_add_u32 s52, s98, s42
    s_addc_u32 s53, s99, 0
    s_mov_b32 s54, 7801920
    s_mov_b32 s55, 0x20000
    s_lshl_b32 s42, s44, 4
    s_add_u32 s45, s45, s42
    s_mul_i32 s42, s45, 1966080
    s_add_u32 s42, s42, s76
    s_add_u32 s56, s88, s42
    s_addc_u32 s57, s89, 0
    s_mov_b32 s58, 1950720
    s_mov_b32 s59, 0x20000
    s_lshr_b32 s42, s45, 1
    s_lshl_b32 s81, s42, 3
    s_lshl_b32 s42, s45, 2
    s_add_u32 s42, s42, s46
    s_lshl_b32 s42, s42, 1
    s_mov_b32 s32, 18432
    buffer_load_dwordx4 v9, s[4:7], s32 offen offset:2048 lds
    s_add_u32 s42, s42, s85
    s_lshl_b32 s42, s42, 2
    s_add_u32 s82, s42, s24
    s_xor_b32 s83, s82, 4
    s_mov_b64 s[72:73], s[98:99]
    s_mov_b32 s74, 7864320
    s_mov_b32 s75, 0x20000
    s_lshr_b32 s42, s2, 3
    s_bfe_u32 s43, s2, 0x10001
    s_lshl_b32 s43, s43, 5
    s_add_u32 s42, s42, s43
    s_lshl_b32 s43, s84, 6
    s_add_u32 s42, s42, s43
    s_lshl_b32 s42, s42, 2
    s_add_u32 s42, s42, s24
    s_mul_i32 s49, s42, 7680
    buffer_load_dword a255, off, s[12:15], 0 sc1
    buffer_load_dword a255, off, s[16:19], 0 sc1
    v_and_b32 v21, 15, v17
    v_lshrrev_b32 v22, 1, v21
    s_mov_b32 s33, 27648
    buffer_load_dwordx4 v10, s[4:7], s33 offen offset:3072 lds
    v_xor_b32 v22, v22, v20
    v_lshlrev_b32 v22, 4, v22
    v_lshl_add_u32 v22, v21, 7, v22
    v_add_u32 v4, s26, v22
    v_xor_b32 v22, 64, v22
    v_add_u32 v5, s26, v22
    v_and_b32 v22, 6, v21
    v_lshrrev_b32 v23, 3, v21
    v_add_u32 v22, v22, v23
    v_and_b32 v23, 1, v20
    v_lshlrev_b32 v23, 1, v23
    v_lshrrev_b32 v24, 1, v20
    v_add_u32 v23, v23, v24
    v_xor_b32 v22, v22, v23
    v_lshlrev_b32 v22, 4, v22
    v_mul_u32_u24 v23, 384, v21
    v_add_u32 v23, s48, v23
    v_add_u32 v14, v23, v22
    v_xor_b32 v22, 64, v22
    v_add_u32 v15, v23, v22
    s_add_u32 m0, s26, 4096
    s_mov_b32 s32, 40960
    buffer_load_dwordx4 v9, s[4:7], s32 offen lds
    v_lshrrev_b32 v21, 2, v17
    v_and_b32 v22, 6, v21
    v_lshrrev_b32 v23, 3, v21
    v_add_u32 v22, v22, v23
    v_bfe_u32 v23, v17, 1, 1
    v_xor_b32 v22, v22, v23
    v_lshlrev_b32 v22, 4, v22
    v_mul_u32_u24 v23, 384, v21
    v_and_b32 v24, 1, v17
    v_lshl_add_u32 v23, v24, 3, v23
    v_add_u32 v23, 98304, v23
    v_xor_b32 v24, 0, v22
    v_add_u32 v0, v23, v24
    v_xor_b32 v24, 32, v22
    v_add_u32 v1, v23, v24
    v_xor_b32 v24, 64, v22
    v_add_u32 v2, v23, v24
    v_xor_b32 v24, 96, v22
    v_add_u32 v3, v23, v24
    v_and_b32 v19, 3, v17
    s_mov_b32 s33, 50176
    buffer_load_dwordx4 v10, s[4:7], s33 offen offset:1024 lds
    v_add_u32 v26, 0, v21
    v_mul_u32_u24 v22, 205, v26
    v_lshrrev_b32 v22, 10, v22
    v_mul_u32_u24 v23, 5, v22
    v_sub_u32 v23, v26, v23
    v_bfe_u32 v24, v22, 2, 1
    v_lshlrev_b32 v24, 1, v24
    v_xor_b32 v24, v24, v19
    v_lshlrev_b32 v24, 4, v24
    v_lshl_add_u32 v24, v23, 6, v24
    v_mul_u32_u24 v25, 1280, v22
    v_add_u32 v25, v25, v24
    v_subrev_u32 v25, 0, v25
    v_accvgpr_write_b32 a240, v25
    v_add_u32 v26, 16, v21
    v_mul_u32_u24 v22, 205, v26
    v_lshrrev_b32 v22, 10, v22
    v_mul_u32_u24 v23, 5, v22
    v_sub_u32 v23, v26, v23
    v_bfe_u32 v24, v22, 2, 1
    s_mov_b32 s32, 59392
    buffer_load_dwordx4 v9, s[4:7], s32 offen offset:2048 lds
    v_lshlrev_b32 v24, 1, v24
    v_xor_b32 v24, v24, v19
    v_lshlrev_b32 v24, 4, v24
    v_lshl_add_u32 v24, v23, 6, v24
    v_mul_u32_u24 v25, 1280, v22
    v_add_u32 v25, v25, v24
    v_subrev_u32 v25, 1024, v25
    v_accvgpr_write_b32 a241, v25
    v_add_u32 v26, 32, v21
    v_mul_u32_u24 v22, 205, v26
    v_lshrrev_b32 v22, 10, v22
    v_mul_u32_u24 v23, 5, v22
    v_sub_u32 v23, v26, v23
    v_bfe_u32 v24, v22, 2, 1
    v_lshlrev_b32 v24, 1, v24
    v_xor_b32 v24, v24, v19
    v_lshlrev_b32 v24, 4, v24
    v_lshl_add_u32 v24, v23, 6, v24
    v_mul_u32_u24 v25, 1280, v22
    v_add_u32 v25, v25, v24
    s_mov_b32 s33, 68608
    buffer_load_dwordx4 v10, s[4:7], s33 offen offset:3072 lds
    v_subrev_u32 v25, 2048, v25
    v_accvgpr_write_b32 a242, v25
    v_add_u32 v26, 48, v21
    v_mul_u32_u24 v22, 205, v26
    v_lshrrev_b32 v22, 10, v22
    v_mul_u32_u24 v23, 5, v22
    v_sub_u32 v23, v26, v23
    v_bfe_u32 v24, v22, 2, 1
    v_lshlrev_b32 v24, 1, v24
    v_xor_b32 v24, v24, v19
    v_lshlrev_b32 v24, 4, v24
    v_lshl_add_u32 v24, v23, 6, v24
    v_mul_u32_u24 v25, 1280, v22
    v_add_u32 v25, v25, v24
    v_subrev_u32 v25, 3072, v25
    v_accvgpr_write_b32 a243, v25
    v_add_u32 v26, 64, v21
    v_mul_u32_u24 v22, 205, v26
    v_lshrrev_b32 v22, 10, v22
    v_mul_u32_u24 v23, 5, v22
    s_add_u32 m0, s26, 8192
    s_mov_b32 s32, 81920
    buffer_load_dwordx4 v9, s[4:7], s32 offen lds
    v_sub_u32 v23, v26, v23
    v_bfe_u32 v24, v22, 2, 1
    v_lshlrev_b32 v24, 1, v24
    v_xor_b32 v24, v24, v19
    v_lshlrev_b32 v24, 4, v24
    v_lshl_add_u32 v24, v23, 6, v24
    v_mul_u32_u24 v25, 1280, v22
    v_add_u32 v25, v25, v24
    v_subrev_u32 v25, 0, v25
    v_accvgpr_write_b32 a244, v25
    v_lshlrev_b32 v25, 4, v17
    v_accvgpr_write_b32 a245, v25
    s_mul_i32 s42, s47, 5120
    v_add_u32 v25, s42, v25
    v_accvgpr_write_b32 a246, v25
    v_mul_u32_u24 v26, 320, v21
    v_lshl_add_u32 v26, v19, 3, v26
    v_add_u32 v26, 20480, v26
    v_bfe_u32 v22, v21, 2, 1
    v_xor_b32 v22, s79, v22
    s_mov_b32 s33, 91136
    buffer_load_dwordx4 v10, s[4:7], s33 offen offset:1024 lds
    s_lshl_b32 s42, s79, 7
    s_mul_i32 s43, s79, 192
    v_lshl_add_u32 v23, v22, 5, v26
    v_add_u32 v25, s42, v23
    v_accvgpr_write_b32 a247, v25
    v_xor_b32 v22, 1, v22
    v_lshl_add_u32 v23, v22, 5, v26
    v_add_u32 v25, s43, v23
    v_accvgpr_write_b32 a248, v25
    s_bfe_u32 s42, s2, 0x10001
    s_lshl_b32 s42, s42, 2
    s_bfe_u32 s43, s2, 0x20003
    s_add_u32 s42, s42, s43
    s_lshl_b32 s42, s42, 2
    s_add_u32 s42, s42, s24
    s_add_u32 s42, s42, 128
    s_mul_i32 s42, s42, 12288
    v_mul_u32_u24 v22, 43, v17
    v_lshrrev_b32 v22, 7, v22
    v_mul_u32_u24 v22, 392832, v22
    s_add_u32 m0, s25, 98304
    s_mov_b32 s30, 0
    buffer_load_dwordx4 v6, s[8:11], s30 offen lds
    v_lshl_add_u32 v22, v17, 7, v22
    v_add_u32 v25, s42, v22
    v_accvgpr_write_b32 a249, v25
    v_accvgpr_write_b32 a250, v14
    v_lshlrev_b32 v25, 7, v17
    v_accvgpr_write_b32 a251, v25
    buffer_load_dwordx4 v7, s[8:11], s30 offen offset:1024 lds
    buffer_load_dwordx4 v8, s[8:11], s30 offen offset:2048 lds
    s_add_u32 m0, s25, 110592
    s_mov_b32 s31, 393216
    buffer_load_dwordx4 v6, s[8:11], s31 offen lds
    buffer_load_dwordx4 v7, s[8:11], s31 offen offset:1024 lds
    buffer_load_dwordx4 v8, s[8:11], s31 offen offset:2048 lds
    s_add_u32 m0, s26, 122880
    s_mov_b32 s32, 128
    buffer_load_dwordx4 v9, s[4:7], s32 offen lds
    s_mov_b32 s33, 9344
    buffer_load_dwordx4 v10, s[4:7], s33 offen offset:1024 lds
    s_mov_b32 s32, 18560
    buffer_load_dwordx4 v9, s[4:7], s32 offen offset:2048 lds
    s_mov_b32 s33, 27776
    buffer_load_dwordx4 v10, s[4:7], s33 offen offset:3072 lds
    s_add_u32 m0, s26, 126976
    s_mov_b32 s32, 41088
    buffer_load_dwordx4 v9, s[4:7], s32 offen lds
    s_mov_b32 s33, 50304
    buffer_load_dwordx4 v10, s[4:7], s33 offen offset:1024 lds
    s_mov_b32 s32, 59520
    buffer_load_dwordx4 v9, s[4:7], s32 offen offset:2048 lds
    s_mov_b32 s33, 68736
    buffer_load_dwordx4 v10, s[4:7], s33 offen offset:3072 lds
    s_add_u32 m0, s26, 131072
    s_mov_b32 s32, 82048
    buffer_load_dwordx4 v9, s[4:7], s32 offen lds
    s_mov_b32 s33, 91264
    buffer_load_dwordx4 v10, s[4:7], s33 offen offset:1024 lds
    s_waitcnt vmcnt(10)
    s_barrier
    s_add_u32 m0, s25, 49152
    s_mov_b32 s30, 786432
    ds_read_b128 a[0:3], v4 offset:0
    ds_read_b128 a[20:23], v5 offset:0
    ds_read_b128 a[4:7], v4 offset:2048
    ds_read_b128 a[24:27], v5 offset:2048
    buffer_load_dwordx4 v6, s[8:11], s30 offen lds
    ds_read_b128 a[8:11], v4 offset:4096
    ds_read_b128 a[28:31], v5 offset:4096
    ds_read_b128 a[12:15], v4 offset:6144
    ds_read_b128 a[32:35], v5 offset:6144
    buffer_load_dwordx4 v7, s[8:11], s30 offen offset:1024 lds
    ds_read_b128 a[16:19], v4 offset:8192
    ds_read_b128 a[36:39], v5 offset:8192
    ds_read_b64_tr_b16 a[80:81], v0 offset:0
    ds_read_b64_tr_b16 a[82:83], v0 offset:6144
    buffer_load_dwordx4 v8, s[8:11], s30 offen offset:2048 lds
    s_add_u32 m0, s25, 61440
    s_mov_b32 s31, 1179648
    ds_read_b64_tr_b16 a[84:85], v0 offset:12288
    ds_read_b64_tr_b16 a[86:87], v0 offset:18432
    ds_read_b64_tr_b16 a[88:89], v1 offset:0
    ds_read_b64_tr_b16 a[90:91], v1 offset:6144
    buffer_load_dwordx4 v6, s[8:11], s31 offen lds
    ds_read_b64_tr_b16 a[92:93], v1 offset:12288
    ds_read_b64_tr_b16 a[94:95], v1 offset:18432
    ds_read_b64_tr_b16 a[96:97], v2 offset:0
    ds_read_b64_tr_b16 a[98:99], v2 offset:6144
    buffer_load_dwordx4 v7, s[8:11], s31 offen offset:1024 lds
    ds_read_b64_tr_b16 a[100:101], v2 offset:12288
    ds_read_b64_tr_b16 a[102:103], v2 offset:18432
    buffer_load_dwordx4 v8, s[8:11], s31 offen offset:2048 lds
    s_waitcnt lgkmcnt(0)
.p2align 3
L_qp:
    v_mfma_f32_16x16x32_bf16 v[16:19], a[80:83], a[0:3], 0
    s_add_u32 m0, s26, 0
    ds_read_b64_tr_b16 a[104:105], v3 offset:0
    v_accvgpr_read_b32 v14, a245
    v_mfma_f32_16x16x32_bf16 v[16:19], a[84:87], a[20:23], v[16:19]
    s_mov_b32 s32, 256
    buffer_load_dwordx4 v9, s[4:7], s32 offen lds
    v_mfma_f32_16x16x32_bf16 v[20:23], a[84:87], a[24:27], 0
    s_mov_b32 s33, 9472
    ds_read_b64_tr_b16 a[106:107], v3 offset:6144
    v_add_u32 v4, 0x1e000, v4
    v_mfma_f32_16x16x32_bf16 v[20:23], a[80:83], a[4:7], v[20:23]
    ds_read_b64_tr_b16 a[108:109], v3 offset:12288
    v_add_u32 v5, 0x1e000, v5
    v_mfma_f32_16x16x32_bf16 v[24:27], a[80:83], a[8:11], 0
    ds_read_b64_tr_b16 a[110:111], v3 offset:18432
    v_accvgpr_write_b32 a128, v64
    v_mfma_f32_16x16x32_bf16 v[24:27], a[84:87], a[28:31], v[24:27]
    buffer_load_dwordx4 v10, s[4:7], s33 offen offset:1024 lds
    v_mfma_f32_16x16x32_bf16 v[28:31], a[84:87], a[32:35], 0
    s_mov_b32 s32, 18688
    ds_read_b64_tr_b16 a[112:113], v0 offset:128
    v_accvgpr_write_b32 a129, v65
    v_mfma_f32_16x16x32_bf16 v[28:31], a[80:83], a[12:15], v[28:31]
    ds_read_b64_tr_b16 a[114:115], v0 offset:6272
    v_accvgpr_write_b32 a130, v66
    v_mfma_f32_16x16x32_bf16 v[32:35], a[80:83], a[16:19], 0
    ds_read_b64_tr_b16 a[116:117], v0 offset:12416
    v_accvgpr_write_b32 a131, v67
    v_mfma_f32_16x16x32_bf16 v[32:35], a[84:87], a[36:39], v[32:35]
    buffer_load_dwordx4 v9, s[4:7], s32 offen offset:2048 lds
    v_mfma_f32_16x16x32_bf16 v[136:139], a[88:91], a[0:3], 0
    s_mov_b32 s33, 27904
    ds_read_b64_tr_b16 a[118:119], v0 offset:18560
    v_accvgpr_write_b32 a132, v68
    v_mfma_f32_16x16x32_bf16 v[136:139], a[92:95], a[20:23], v[136:139]
    ds_read_b64_tr_b16 a[120:121], v1 offset:128
    v_accvgpr_write_b32 a133, v69
    v_mfma_f32_16x16x32_bf16 v[140:143], a[92:95], a[24:27], 0
    ds_read_b64_tr_b16 a[122:123], v1 offset:6272
    v_accvgpr_write_b32 a134, v70
    v_mfma_f32_16x16x32_bf16 v[140:143], a[88:91], a[4:7], v[140:143]
    buffer_load_dwordx4 v10, s[4:7], s33 offen offset:3072 lds
    v_mfma_f32_16x16x32_bf16 v[144:147], a[88:91], a[8:11], 0
    s_add_u32 m0, s26, 4096
    ds_read_b64_tr_b16 a[124:125], v1 offset:12416
    v_accvgpr_write_b32 a135, v71
    v_mfma_f32_16x16x32_bf16 v[144:147], a[92:95], a[28:31], v[144:147]
    s_mov_b32 s32, 41216
    ds_read_b64_tr_b16 a[126:127], v1 offset:18560
    v_accvgpr_write_b32 a136, v72
    v_mfma_f32_16x16x32_bf16 v[148:151], a[92:95], a[32:35], 0
    v_accvgpr_write_b32 a137, v73
    v_accvgpr_write_b32 a138, v74
    v_mfma_f32_16x16x32_bf16 v[148:151], a[88:91], a[12:15], v[148:151]
    buffer_load_dwordx4 v9, s[4:7], s32 offen lds
    v_mfma_f32_16x16x32_bf16 v[152:155], a[88:91], a[16:19], 0
    s_mov_b32 s33, 50432
    v_accvgpr_write_b32 a139, v75
    v_accvgpr_write_b32 a140, v176
    v_mfma_f32_16x16x32_bf16 v[152:155], a[92:95], a[36:39], v[152:155]
    v_accvgpr_write_b32 a141, v177
    v_accvgpr_write_b32 a142, v178
    v_mfma_f32_16x16x32_bf16 v[36:39], a[96:99], a[0:3], 0
    v_accvgpr_write_b32 a143, v179
    v_accvgpr_write_b32 a144, v180
    v_mfma_f32_16x16x32_bf16 v[36:39], a[100:103], a[20:23], v[36:39]
    buffer_load_dwordx4 v10, s[4:7], s33 offen offset:1024 lds
    v_mfma_f32_16x16x32_bf16 v[40:43], a[100:103], a[24:27], 0
    s_mov_b32 s32, 59648
    v_accvgpr_write_b32 a145, v181
    v_accvgpr_write_b32 a146, v182
    v_mfma_f32_16x16x32_bf16 v[40:43], a[96:99], a[4:7], v[40:43]
    v_accvgpr_write_b32 a147, v183
    v_accvgpr_write_b32 a148, v184
    v_mfma_f32_16x16x32_bf16 v[44:47], a[96:99], a[8:11], 0
    v_accvgpr_write_b32 a149, v185
    v_accvgpr_write_b32 a150, v186
    v_mfma_f32_16x16x32_bf16 v[44:47], a[100:103], a[28:31], v[44:47]
    buffer_load_dwordx4 v9, s[4:7], s32 offen offset:2048 lds
    v_mfma_f32_16x16x32_bf16 v[48:51], a[100:103], a[32:35], 0
    s_mov_b32 s33, 68864
    v_accvgpr_write_b32 a151, v187
    v_accvgpr_write_b32 a152, v188
    v_mfma_f32_16x16x32_bf16 v[48:51], a[96:99], a[12:15], v[48:51]
    v_accvgpr_write_b32 a153, v189
    v_accvgpr_write_b32 a154, v190
    v_mfma_f32_16x16x32_bf16 v[52:55], a[96:99], a[16:19], 0
    v_accvgpr_write_b32 a155, v191
    v_accvgpr_write_b32 a156, v192
    v_mfma_f32_16x16x32_bf16 v[52:55], a[100:103], a[36:39], v[52:55]
    s_waitcnt lgkmcnt(0)
    buffer_load_dwordx4 v10, s[4:7], s33 offen offset:3072 lds
    v_mfma_f32_16x16x32_bf16 v[156:159], a[104:107], a[0:3], 0
    s_add_u32 m0, s26, 8192
    ds_read_b64_tr_b16 a[80:81], v2 offset:128
    v_accvgpr_read_b32 v15, a251
    v_mfma_f32_16x16x32_bf16 v[156:159], a[108:111], a[20:23], v[156:159]
    s_mov_b32 s32, 82176
    ds_read_b64_tr_b16 a[82:83], v2 offset:6272
    v_accvgpr_write_b32 a157, v193
    v_mfma_f32_16x16x32_bf16 v[160:163], a[108:111], a[24:27], 0
    ds_read_b64_tr_b16 a[84:85], v2 offset:12416
    v_accvgpr_write_b32 a158, v194
    v_mfma_f32_16x16x32_bf16 v[160:163], a[104:107], a[4:7], v[160:163]
    buffer_load_dwordx4 v9, s[4:7], s32 offen lds
    v_mfma_f32_16x16x32_bf16 v[164:167], a[104:107], a[8:11], 0
    s_mov_b32 s33, 91392
    ds_read_b64_tr_b16 a[86:87], v2 offset:18560
    v_accvgpr_write_b32 a159, v195
    v_mfma_f32_16x16x32_bf16 v[164:167], a[108:111], a[28:31], v[164:167]
    ds_read_b64_tr_b16 a[88:89], v3 offset:128
    v_accvgpr_write_b32 a160, v76
    v_mfma_f32_16x16x32_bf16 v[168:171], a[108:111], a[32:35], 0
    ds_read_b64_tr_b16 a[90:91], v3 offset:6272
    v_accvgpr_write_b32 a161, v77
    v_mfma_f32_16x16x32_bf16 v[168:171], a[104:107], a[12:15], v[168:171]
    buffer_load_dwordx4 v10, s[4:7], s33 offen offset:1024 lds
    v_mfma_f32_16x16x32_bf16 v[172:175], a[104:107], a[16:19], 0
    s_add_u32 m0, s25, 73728
    ds_read_b64_tr_b16 a[92:93], v3 offset:12416
    v_accvgpr_write_b32 a162, v78
    v_mfma_f32_16x16x32_bf16 v[172:175], a[108:111], a[36:39], v[172:175]
    s_mov_b32 s30, 1572864
    ds_read_b64_tr_b16 a[94:95], v3 offset:18560
    v_accvgpr_write_b32 a163, v79
    v_mfma_f32_16x16x32_bf16 v[56:59], a[112:115], a[0:3], 0
    ds_read_b64_tr_b16 a[96:97], v0 offset:256
    v_accvgpr_write_b32 a164, v80
    v_mfma_f32_16x16x32_bf16 v[56:59], a[116:119], a[20:23], v[56:59]
    buffer_load_dwordx4 v6, s[8:11], s30 offen lds
    v_mfma_f32_16x16x32_bf16 v[60:63], a[116:119], a[24:27], 0
    ds_read_b64_tr_b16 a[98:99], v0 offset:6400
    v_accvgpr_write_b32 a165, v81
    v_mfma_f32_16x16x32_bf16 v[60:63], a[112:115], a[4:7], v[60:63]
    ds_read_b64_tr_b16 a[100:101], v0 offset:12544
    v_accvgpr_write_b32 a166, v82
    v_mfma_f32_16x16x32_bf16 v[64:67], a[112:115], a[8:11], 0
    s_cmp_lg_u32 s28, 1
    s_cbranch_scc1 L_x1ok
    s_waitcnt vmcnt(17)
L_x1ok:
    ds_read_b64_tr_b16 a[102:103], v0 offset:18688
    v_accvgpr_write_b32 a167, v83
    v_mfma_f32_16x16x32_bf16 v[64:67], a[116:119], a[28:31], v[64:67]
    buffer_load_dwordx4 v7, s[8:11], s30 offen offset:1024 lds
    v_mfma_f32_16x16x32_bf16 v[68:71], a[116:119], a[32:35], 0
    ds_read_b128 a[40:43], v4 offset:0
    v_accvgpr_write_b32 a168, v84
    v_mfma_f32_16x16x32_bf16 v[68:71], a[112:115], a[12:15], v[68:71]
    ds_read_b128 a[60:63], v5 offset:0
    v_accvgpr_write_b32 a169, v85
    v_mfma_f32_16x16x32_bf16 v[72:75], a[112:115], a[16:19], 0
    ds_read_b128 a[44:47], v4 offset:2048
    v_accvgpr_write_b32 a170, v86
    v_mfma_f32_16x16x32_bf16 v[72:75], a[116:119], a[36:39], v[72:75]
    buffer_load_dwordx4 v8, s[8:11], s30 offen offset:2048 lds
    v_mfma_f32_16x16x32_bf16 v[176:179], a[120:123], a[0:3], 0
    s_add_u32 m0, s25, 86016
    ds_read_b128 a[64:67], v5 offset:2048
    v_accvgpr_write_b32 a171, v87
    v_mfma_f32_16x16x32_bf16 v[176:179], a[124:127], a[20:23], v[176:179]
    s_mov_b32 s31, 1966080
    ds_read_b128 a[48:51], v4 offset:4096
    v_accvgpr_write_b32 a172, v88
    v_mfma_f32_16x16x32_bf16 v[180:183], a[124:127], a[24:27], 0
    v_accvgpr_write_b32 a173, v89
    v_accvgpr_write_b32 a174, v90
    v_mfma_f32_16x16x32_bf16 v[180:183], a[120:123], a[4:7], v[180:183]
    buffer_load_dwordx4 v6, s[8:11], s31 offen lds
    v_mfma_f32_16x16x32_bf16 v[184:187], a[120:123], a[8:11], 0
    v_accvgpr_write_b32 a175, v91
    v_accvgpr_write_b32 a176, v92
    v_mfma_f32_16x16x32_bf16 v[184:187], a[124:127], a[28:31], v[184:187]
    v_accvgpr_write_b32 a177, v93
    v_accvgpr_write_b32 a178, v94
    v_mfma_f32_16x16x32_bf16 v[188:191], a[124:127], a[32:35], 0
    v_accvgpr_write_b32 a179, v95
    v_accvgpr_write_b32 a180, v196
    v_mfma_f32_16x16x32_bf16 v[188:191], a[120:123], a[12:15], v[188:191]
    buffer_load_dwordx4 v7, s[8:11], s31 offen offset:1024 lds
    v_mfma_f32_16x16x32_bf16 v[192:195], a[120:123], a[16:19], 0
    v_accvgpr_write_b32 a181, v197
    v_accvgpr_write_b32 a182, v198
    v_mfma_f32_16x16x32_bf16 v[192:195], a[124:127], a[36:39], v[192:195]
    s_waitcnt lgkmcnt(0)
    v_accvgpr_write_b32 a183, v199
    v_accvgpr_write_b32 a184, v200
    v_mfma_f32_16x16x32_bf16 v[76:79], a[80:83], a[0:3], 0
    ds_read_b64_tr_b16 a[104:105], v1 offset:256
    v_accvgpr_write_b32 a185, v201
    v_mfma_f32_16x16x32_bf16 v[76:79], a[84:87], a[20:23], v[76:79]
    buffer_load_dwordx4 v8, s[8:11], s31 offen offset:2048 lds
    v_mfma_f32_16x16x32_bf16 v[80:83], a[84:87], a[24:27], 0
    s_lshl_b32 s35, s28, 2
    ds_read_b64_tr_b16 a[106:107], v1 offset:6400
    v_accvgpr_write_b32 a186, v202
    v_mfma_f32_16x16x32_bf16 v[80:83], a[80:83], a[4:7], v[80:83]
    s_add_u32 s35, s35, s24
    ds_read_b64_tr_b16 a[108:109], v1 offset:12544
    v_accvgpr_write_b32 a187, v203
    v_mfma_f32_16x16x32_bf16 v[84:87], a[80:83], a[8:11], 0
    s_add_u32 s34, s49, 0
    ds_read_b64_tr_b16 a[110:111], v1 offset:18688
    v_accvgpr_write_b32 a188, v204
    v_mfma_f32_16x16x32_bf16 v[84:87], a[84:87], a[28:31], v[84:87]
    s_cmp_eq_u32 s35, 4
    s_cselect_b32 s35, s34, 1879048192
    ds_read_b64_tr_b16 a[112:113], v2 offset:256
    v_accvgpr_write_b32 a189, v205
    v_mfma_f32_16x16x32_bf16 v[88:91], a[84:87], a[32:35], 0
    buffer_load_dword a255, v15, s[72:75], s35 offen
    v_mfma_f32_16x16x32_bf16 v[88:91], a[80:83], a[12:15], v[88:91]
    ds_read_b64_tr_b16 a[114:115], v2 offset:6400
    v_accvgpr_write_b32 a190, v206
    v_mfma_f32_16x16x32_bf16 v[92:95], a[80:83], a[16:19], 0
    s_mov_b32 s29, 0
    buffer_store_dwordx4 a[128:131], v14, s[20:23], s29 offen sc1
    v_mfma_f32_16x16x32_bf16 v[92:95], a[84:87], a[36:39], v[92:95]
    ds_read_b64_tr_b16 a[116:117], v2 offset:12544
    v_accvgpr_write_b32 a191, v207
    v_mfma_f32_16x16x32_bf16 v[196:199], a[88:91], a[0:3], 0
    ds_read_b64_tr_b16 a[118:119], v2 offset:18688
    v_accvgpr_write_b32 a192, v208
    v_mfma_f32_16x16x32_bf16 v[196:199], a[92:95], a[20:23], v[196:199]
    ds_read_b64_tr_b16 a[120:121], v3 offset:256
    v_accvgpr_write_b32 a193, v209
    v_mfma_f32_16x16x32_bf16 v[200:203], a[92:95], a[24:27], 0
    ds_read_b64_tr_b16 a[122:123], v3 offset:6400
    v_accvgpr_write_b32 a194, v210
    v_mfma_f32_16x16x32_bf16 v[200:203], a[88:91], a[4:7], v[200:203]
    ds_read_b64_tr_b16 a[124:125], v3 offset:12544
    v_accvgpr_write_b32 a195, v211
    v_mfma_f32_16x16x32_bf16 v[204:207], a[88:91], a[8:11], 0
    ds_read_b64_tr_b16 a[126:127], v3 offset:18688
    v_accvgpr_write_b32 a196, v212
    v_accvgpr_write_b32 a197, v213
    v_mfma_f32_16x16x32_bf16 v[204:207], a[92:95], a[28:31], v[204:207]
    ds_read_b128 a[68:71], v5 offset:4096
    v_add_u32 v0, 0xffff4000, v0
    v_accvgpr_write_b32 a198, v214
    v_mfma_f32_16x16x32_bf16 v[208:211], a[92:95], a[32:35], 0
    ds_read_b128 a[52:55], v4 offset:6144
    v_add_u32 v1, 0xffff4000, v1
    v_accvgpr_write_b32 a199, v215
    v_mfma_f32_16x16x32_bf16 v[208:211], a[88:91], a[12:15], v[208:211]
    ds_read_b128 a[72:75], v5 offset:6144
    v_add_u32 v2, 0xffff4000, v2
    v_mfma_f32_16x16x32_bf16 v[212:215], a[88:91], a[16:19], 0
    ds_read_b128 a[56:59], v4 offset:8192
    v_add_u32 v3, 0xffff4000, v3
    v_mfma_f32_16x16x32_bf16 v[212:215], a[92:95], a[36:39], v[212:215]
    ds_read_b128 a[76:79], v5 offset:8192
    v_accvgpr_write_b32 a200, v96
    v_accvgpr_write_b32 a201, v97
    v_accvgpr_write_b32 a202, v98
    v_accvgpr_write_b32 a203, v99
    v_mfma_f32_16x16x32_bf16 v[96:99], a[96:99], a[0:3], 0
    v_accvgpr_write_b32 a204, v100
    v_accvgpr_write_b32 a205, v101
    v_mfma_f32_16x16x32_bf16 v[96:99], a[100:103], a[20:23], v[96:99]
    v_accvgpr_write_b32 a206, v102
    v_accvgpr_write_b32 a207, v103
    v_mfma_f32_16x16x32_bf16 v[100:103], a[100:103], a[24:27], 0
    v_accvgpr_write_b32 a208, v104
    v_accvgpr_write_b32 a209, v105
    v_mfma_f32_16x16x32_bf16 v[100:103], a[96:99], a[4:7], v[100:103]
    v_accvgpr_write_b32 a210, v106
    v_accvgpr_write_b32 a211, v107
    v_mfma_f32_16x16x32_bf16 v[104:107], a[96:99], a[8:11], 0
    v_accvgpr_write_b32 a212, v108
    v_accvgpr_write_b32 a213, v109
    v_mfma_f32_16x16x32_bf16 v[104:107], a[100:103], a[28:31], v[104:107]
    v_accvgpr_write_b32 a214, v110
    v_accvgpr_write_b32 a215, v111
    v_mfma_f32_16x16x32_bf16 v[108:111], a[100:103], a[32:35], 0
    v_accvgpr_write_b32 a216, v112
    v_accvgpr_write_b32 a217, v113
    v_mfma_f32_16x16x32_bf16 v[108:111], a[96:99], a[12:15], v[108:111]
    v_accvgpr_write_b32 a218, v114
    v_accvgpr_write_b32 a219, v115
    v_mfma_f32_16x16x32_bf16 v[112:115], a[96:99], a[16:19], 0
    s_waitcnt vmcnt(18) lgkmcnt(0)
    v_accvgpr_write_b32 a220, v116
    v_accvgpr_write_b32 a221, v117
    v_mfma_f32_16x16x32_bf16 v[112:115], a[100:103], a[36:39], v[112:115]

    s_barrier
    v_mfma_f32_16x16x32_bf16 v[216:219], a[104:107], a[0:3], 0
    s_add_u32 m0, s26, 122880
    ds_read_b64_tr_b16 a[80:81], v0 offset:0
    v_accvgpr_write_b32 a222, v118
    v_mfma_f32_16x16x32_bf16 v[216:219], a[108:111], a[20:23], v[216:219]
    s_mov_b32 s32, 384
    buffer_load_dwordx4 v9, s[4:7], s32 offen lds
    v_mfma_f32_16x16x32_bf16 v[220:223], a[108:111], a[24:27], 0
    s_mov_b32 s33, 9600
    ds_read_b64_tr_b16 a[82:83], v0 offset:6144
    v_accvgpr_write_b32 a223, v119
    v_mfma_f32_16x16x32_bf16 v[220:223], a[104:107], a[4:7], v[220:223]
    s_mov_b32 s29, 1024
    buffer_store_dwordx4 a[132:135], v14, s[20:23], s29 offen sc1
    v_mfma_f32_16x16x32_bf16 v[224:227], a[104:107], a[8:11], 0
    ds_read_b64_tr_b16 a[84:85], v0 offset:12288
    v_accvgpr_write_b32 a224, v120
    v_mfma_f32_16x16x32_bf16 v[224:227], a[108:111], a[28:31], v[224:227]
    ds_read_b64_tr_b16 a[86:87], v0 offset:18432
    v_accvgpr_write_b32 a225, v121
    v_mfma_f32_16x16x32_bf16 v[228:231], a[108:111], a[32:35], 0
    ds_read_b64_tr_b16 a[88:89], v1 offset:0
    v_accvgpr_write_b32 a226, v122
    v_mfma_f32_16x16x32_bf16 v[228:231], a[104:107], a[12:15], v[228:231]
    buffer_load_dwordx4 v10, s[4:7], s33 offen offset:1024 lds
    v_mfma_f32_16x16x32_bf16 v[232:235], a[104:107], a[16:19], 0
    s_mov_b32 s32, 18816
    ds_read_b64_tr_b16 a[90:91], v1 offset:6144
    v_accvgpr_write_b32 a227, v123
    v_mfma_f32_16x16x32_bf16 v[232:235], a[108:111], a[36:39], v[232:235]
    ds_read_b64_tr_b16 a[92:93], v1 offset:12288
    v_accvgpr_write_b32 a228, v124
    v_mfma_f32_16x16x32_bf16 v[116:119], a[112:115], a[0:3], 0
    ds_read_b64_tr_b16 a[94:95], v1 offset:18432
    v_accvgpr_write_b32 a229, v125
    v_mfma_f32_16x16x32_bf16 v[116:119], a[116:119], a[20:23], v[116:119]
    ds_read_b64_tr_b16 a[96:97], v2 offset:0
    v_accvgpr_write_b32 a230, v126
    v_mfma_f32_16x16x32_bf16 v[120:123], a[116:119], a[24:27], 0
    ds_read_b64_tr_b16 a[98:99], v2 offset:6144
    v_accvgpr_write_b32 a231, v127
    v_mfma_f32_16x16x32_bf16 v[120:123], a[112:115], a[4:7], v[120:123]
    buffer_load_dwordx4 v9, s[4:7], s32 offen offset:2048 lds
    v_mfma_f32_16x16x32_bf16 v[124:127], a[112:115], a[8:11], 0
    s_mov_b32 s33, 28032
    ds_read_b64_tr_b16 a[100:101], v2 offset:12288
    v_accvgpr_write_b32 a232, v128
    v_mfma_f32_16x16x32_bf16 v[124:127], a[116:119], a[28:31], v[124:127]
    ds_read_b64_tr_b16 a[102:103], v2 offset:18432
    v_accvgpr_write_b32 a233, v129
    v_accvgpr_write_b32 a234, v130
    v_accvgpr_write_b32 a235, v131
    v_mfma_f32_16x16x32_bf16 v[128:131], a[116:119], a[32:35], 0
    v_accvgpr_write_b32 a236, v132
    v_accvgpr_write_b32 a237, v133
    v_mfma_f32_16x16x32_bf16 v[128:131], a[112:115], a[12:15], v[128:131]
    v_accvgpr_write_b32 a238, v134
    v_accvgpr_write_b32 a239, v135
    v_mfma_f32_16x16x32_bf16 v[132:135], a[112:115], a[16:19], 0
    v_mfma_f32_16x16x32_bf16 v[132:135], a[116:119], a[36:39], v[132:135]
    buffer_load_dwordx4 v10, s[4:7], s33 offen offset:3072 lds
    v_mfma_f32_16x16x32_bf16 v[236:239], a[120:123], a[0:3], 0
    s_add_u32 m0, s26, 126976
    v_mfma_f32_16x16x32_bf16 v[236:239], a[124:127], a[20:23], v[236:239]
    s_mov_b32 s32, 41344
    v_mfma_f32_16x16x32_bf16 v[240:243], a[124:127], a[24:27], 0
    v_mfma_f32_16x16x32_bf16 v[240:243], a[120:123], a[4:7], v[240:243]
    v_mfma_f32_16x16x32_bf16 v[244:247], a[120:123], a[8:11], 0
    v_mfma_f32_16x16x32_bf16 v[244:247], a[124:127], a[28:31], v[244:247]
    buffer_load_dwordx4 v9, s[4:7], s32 offen lds
    v_mfma_f32_16x16x32_bf16 v[248:251], a[124:127], a[32:35], 0
    s_mov_b32 s33, 50560
    v_mfma_f32_16x16x32_bf16 v[248:251], a[120:123], a[12:15], v[248:251]
    v_mfma_f32_16x16x32_bf16 v[252:255], a[120:123], a[16:19], 0
    v_mfma_f32_16x16x32_bf16 v[252:255], a[124:127], a[36:39], v[252:255]
    s_waitcnt lgkmcnt(0)
    v_mfma_f32_16x16x32_bf16 v[16:19], a[80:83], a[40:43], v[16:19]
    ds_read_b64_tr_b16 a[104:105], v3 offset:0
    v_mfma_f32_16x16x32_bf16 v[16:19], a[84:87], a[60:63], v[16:19]
    buffer_load_dwordx4 v10, s[4:7], s33 offen offset:1024 lds
    v_mfma_f32_16x16x32_bf16 v[20:23], a[84:87], a[64:67], v[20:23]
    s_mov_b32 s32, 59776
    ds_read_b64_tr_b16 a[106:107], v3 offset:6144
    v_add_u32 v4, 0xfffe2000, v4
    v_mfma_f32_16x16x32_bf16 v[20:23], a[80:83], a[44:47], v[20:23]
    s_mov_b32 s29, 2048
    buffer_store_dwordx4 a[136:139], v14, s[20:23], s29 offen sc1
    v_mfma_f32_16x16x32_bf16 v[24:27], a[80:83], a[48:51], v[24:27]
    ds_read_b64_tr_b16 a[108:109], v3 offset:12288
    v_add_u32 v5, 0xfffe2000, v5
    v_mfma_f32_16x16x32_bf16 v[24:27], a[84:87], a[68:71], v[24:27]
    ds_read_b64_tr_b16 a[110:111], v3 offset:18432
    v_mfma_f32_16x16x32_bf16 v[28:31], a[84:87], a[72:75], v[28:31]
    ds_read_b64_tr_b16 a[112:113], v0 offset:128
    v_mfma_f32_16x16x32_bf16 v[28:31], a[80:83], a[52:55], v[28:31]
    buffer_load_dwordx4 v9, s[4:7], s32 offen offset:2048 lds
    v_mfma_f32_16x16x32_bf16 v[32:35], a[80:83], a[56:59], v[32:35]
    s_mov_b32 s33, 68992
    ds_read_b64_tr_b16 a[114:115], v0 offset:6272
    v_mfma_f32_16x16x32_bf16 v[32:35], a[84:87], a[76:79], v[32:35]
    ds_read_b64_tr_b16 a[116:117], v0 offset:12416
    v_mfma_f32_16x16x32_bf16 v[152:155], a[92:95], a[76:79], v[152:155]
    ds_read_b64_tr_b16 a[118:119], v0 offset:18560
    v_mfma_f32_16x16x32_bf16 v[152:155], a[88:91], a[56:59], v[152:155]
    ds_read_b64_tr_b16 a[120:121], v1 offset:128
    v_mfma_f32_16x16x32_bf16 v[148:151], a[88:91], a[52:55], v[148:151]
    ds_read_b64_tr_b16 a[122:123], v1 offset:6272
    v_mfma_f32_16x16x32_bf16 v[148:151], a[92:95], a[72:75], v[148:151]
    buffer_load_dwordx4 v10, s[4:7], s33 offen offset:3072 lds
    v_mfma_f32_16x16x32_bf16 v[144:147], a[92:95], a[68:71], v[144:147]
    s_add_u32 m0, s26, 131072
    ds_read_b64_tr_b16 a[124:125], v1 offset:12416
    v_mfma_f32_16x16x32_bf16 v[144:147], a[88:91], a[48:51], v[144:147]
    s_mov_b32 s32, 82304
    ds_read_b64_tr_b16 a[126:127], v1 offset:18560
    v_mfma_f32_16x16x32_bf16 v[140:143], a[88:91], a[44:47], v[140:143]
    v_mfma_f32_16x16x32_bf16 v[140:143], a[92:95], a[64:67], v[140:143]
    v_mfma_f32_16x16x32_bf16 v[136:139], a[92:95], a[60:63], v[136:139]
    v_mfma_f32_16x16x32_bf16 v[136:139], a[88:91], a[40:43], v[136:139]
    buffer_load_dwordx4 v9, s[4:7], s32 offen lds
    v_mfma_f32_16x16x32_bf16 v[36:39], a[96:99], a[40:43], v[36:39]
    s_mov_b32 s33, 91520
    v_mfma_f32_16x16x32_bf16 v[36:39], a[100:103], a[60:63], v[36:39]
    v_mfma_f32_16x16x32_bf16 v[40:43], a[100:103], a[64:67], v[40:43]
    v_mfma_f32_16x16x32_bf16 v[40:43], a[96:99], a[44:47], v[40:43]
    v_mfma_f32_16x16x32_bf16 v[44:47], a[96:99], a[48:51], v[44:47]
    v_mfma_f32_16x16x32_bf16 v[44:47], a[100:103], a[68:71], v[44:47]
    buffer_load_dwordx4 v10, s[4:7], s33 offen offset:1024 lds
    v_mfma_f32_16x16x32_bf16 v[48:51], a[100:103], a[72:75], v[48:51]
    s_add_u32 m0, s25, 98304
    v_mfma_f32_16x16x32_bf16 v[48:51], a[96:99], a[52:55], v[48:51]
    s_mov_b32 s30, 2359296
    v_mfma_f32_16x16x32_bf16 v[52:55], a[96:99], a[56:59], v[52:55]
    s_mov_b32 s29, 3072
    buffer_store_dwordx4 a[140:143], v14, s[20:23], s29 offen sc1
    v_mfma_f32_16x16x32_bf16 v[52:55], a[100:103], a[76:79], v[52:55]
    s_waitcnt lgkmcnt(0)
    v_mfma_f32_16x16x32_bf16 v[156:159], a[104:107], a[40:43], v[156:159]
    ds_read_b64_tr_b16 a[80:81], v2 offset:128
    v_mfma_f32_16x16x32_bf16 v[156:159], a[108:111], a[60:63], v[156:159]
    buffer_load_dwordx4 v6, s[8:11], s30 offen lds
    v_mfma_f32_16x16x32_bf16 v[160:163], a[108:111], a[64:67], v[160:163]
    ds_read_b64_tr_b16 a[82:83], v2 offset:6272
    v_mfma_f32_16x16x32_bf16 v[160:163], a[104:107], a[44:47], v[160:163]
    ds_read_b64_tr_b16 a[84:85], v2 offset:12416
    v_mfma_f32_16x16x32_bf16 v[164:167], a[104:107], a[48:51], v[164:167]
    ds_read_b64_tr_b16 a[86:87], v2 offset:18560
    v_mfma_f32_16x16x32_bf16 v[164:167], a[108:111], a[68:71], v[164:167]
    ds_read_b64_tr_b16 a[88:89], v3 offset:128
    v_mfma_f32_16x16x32_bf16 v[168:171], a[108:111], a[72:75], v[168:171]
    ds_read_b64_tr_b16 a[90:91], v3 offset:6272
    v_mfma_f32_16x16x32_bf16 v[168:171], a[104:107], a[52:55], v[168:171]
    buffer_load_dwordx4 v7, s[8:11], s30 offen offset:1024 lds
    v_mfma_f32_16x16x32_bf16 v[172:175], a[104:107], a[56:59], v[172:175]
    ds_read_b64_tr_b16 a[92:93], v3 offset:12416
    v_mfma_f32_16x16x32_bf16 v[172:175], a[108:111], a[76:79], v[172:175]
    ds_read_b64_tr_b16 a[94:95], v3 offset:18560
    v_mfma_f32_16x16x32_bf16 v[72:75], a[116:119], a[76:79], v[72:75]
    ds_read_b64_tr_b16 a[96:97], v0 offset:256
    v_mfma_f32_16x16x32_bf16 v[72:75], a[112:115], a[56:59], v[72:75]
    ds_read_b64_tr_b16 a[98:99], v0 offset:6400
    v_mfma_f32_16x16x32_bf16 v[68:71], a[112:115], a[52:55], v[68:71]
    s_waitcnt vmcnt(23)
    ds_read_b64_tr_b16 a[100:101], v0 offset:12544
    v_mfma_f32_16x16x32_bf16 v[68:71], a[116:119], a[72:75], v[68:71]
    buffer_load_dwordx4 v8, s[8:11], s30 offen offset:2048 lds
    v_mfma_f32_16x16x32_bf16 v[64:67], a[116:119], a[68:71], v[64:67]
    s_add_u32 m0, s25, 110592
    ds_read_b64_tr_b16 a[102:103], v0 offset:18688
    v_mfma_f32_16x16x32_bf16 v[64:67], a[112:115], a[48:51], v[64:67]
    s_mov_b32 s31, 2752512
    ds_read_b128 a[0:3], v4 offset:0
    v_mfma_f32_16x16x32_bf16 v[60:63], a[112:115], a[44:47], v[60:63]
    ds_read_b128 a[20:23], v5 offset:0
    v_mfma_f32_16x16x32_bf16 v[60:63], a[116:119], a[64:67], v[60:63]
    ds_read_b128 a[4:7], v4 offset:2048
    v_mfma_f32_16x16x32_bf16 v[56:59], a[116:119], a[60:63], v[56:59]
    ds_read_b128 a[24:27], v5 offset:2048
    v_mfma_f32_16x16x32_bf16 v[56:59], a[112:115], a[40:43], v[56:59]
    buffer_load_dwordx4 v6, s[8:11], s31 offen lds
    v_mfma_f32_16x16x32_bf16 v[176:179], a[120:123], a[40:43], v[176:179]
    ds_read_b128 a[8:11], v4 offset:4096
    v_mfma_f32_16x16x32_bf16 v[176:179], a[124:127], a[60:63], v[176:179]
    v_mfma_f32_16x16x32_bf16 v[180:183], a[124:127], a[64:67], v[180:183]
    v_mfma_f32_16x16x32_bf16 v[180:183], a[120:123], a[44:47], v[180:183]
    v_mfma_f32_16x16x32_bf16 v[184:187], a[120:123], a[48:51], v[184:187]
    v_mfma_f32_16x16x32_bf16 v[184:187], a[124:127], a[68:71], v[184:187]
    buffer_load_dwordx4 v7, s[8:11], s31 offen offset:1024 lds
    v_mfma_f32_16x16x32_bf16 v[188:191], a[124:127], a[72:75], v[188:191]
    v_mfma_f32_16x16x32_bf16 v[188:191], a[120:123], a[52:55], v[188:191]
    s_mov_b32 s29, 4096
    buffer_store_dwordx4 a[144:147], v14, s[20:23], s29 offen sc1
    v_mfma_f32_16x16x32_bf16 v[192:195], a[120:123], a[56:59], v[192:195]
    v_mfma_f32_16x16x32_bf16 v[192:195], a[124:127], a[76:79], v[192:195]
    s_waitcnt lgkmcnt(0)
    v_mfma_f32_16x16x32_bf16 v[76:79], a[80:83], a[40:43], v[76:79]
    ds_read_b64_tr_b16 a[104:105], v1 offset:256
    v_mfma_f32_16x16x32_bf16 v[76:79], a[84:87], a[60:63], v[76:79]
    buffer_load_dwordx4 v8, s[8:11], s31 offen offset:2048 lds
    v_mfma_f32_16x16x32_bf16 v[80:83], a[84:87], a[64:67], v[80:83]
    s_lshl_b32 s35, s28, 2
    ds_read_b64_tr_b16 a[106:107], v1 offset:6400
    v_mfma_f32_16x16x32_bf16 v[80:83], a[80:83], a[44:47], v[80:83]
    s_add_u32 s35, s35, s24
    ds_read_b64_tr_b16 a[108:109], v1 offset:12544
    v_mfma_f32_16x16x32_bf16 v[84:87], a[80:83], a[48:51], v[84:87]
    s_add_u32 s34, s49, 0
    ds_read_b64_tr_b16 a[110:111], v1 offset:18688
    v_mfma_f32_16x16x32_bf16 v[84:87], a[84:87], a[68:71], v[84:87]
    s_cmp_eq_u32 s35, 5
    s_cselect_b32 s35, s34, 1879048192
    ds_read_b64_tr_b16 a[112:113], v2 offset:256
    v_mfma_f32_16x16x32_bf16 v[88:91], a[84:87], a[72:75], v[88:91]
    ds_read_b64_tr_b16 a[114:115], v2 offset:6400
    v_mfma_f32_16x16x32_bf16 v[88:91], a[80:83], a[52:55], v[88:91]
    buffer_load_dword a255, v15, s[72:75], s35 offen
    v_mfma_f32_16x16x32_bf16 v[92:95], a[80:83], a[56:59], v[92:95]
    ds_read_b64_tr_b16 a[116:117], v2 offset:12544
    v_mfma_f32_16x16x32_bf16 v[92:95], a[84:87], a[76:79], v[92:95]
    ds_read_b64_tr_b16 a[118:119], v2 offset:18688
    v_mfma_f32_16x16x32_bf16 v[212:215], a[92:95], a[76:79], v[212:215]
    ds_read_b64_tr_b16 a[120:121], v3 offset:256
    v_mfma_f32_16x16x32_bf16 v[212:215], a[88:91], a[56:59], v[212:215]
    ds_read_b64_tr_b16 a[122:123], v3 offset:6400
    v_mfma_f32_16x16x32_bf16 v[208:211], a[88:91], a[52:55], v[208:211]
    ds_read_b64_tr_b16 a[124:125], v3 offset:12544
    v_mfma_f32_16x16x32_bf16 v[208:211], a[92:95], a[72:75], v[208:211]
    ds_read_b64_tr_b16 a[126:127], v3 offset:18688
    v_mfma_f32_16x16x32_bf16 v[204:207], a[92:95], a[68:71], v[204:207]
    ds_read_b128 a[28:31], v5 offset:4096
    v_add_u32 v0, 0x6000, v0
    v_mfma_f32_16x16x32_bf16 v[204:207], a[88:91], a[48:51], v[204:207]
    ds_read_b128 a[12:15], v4 offset:6144
    v_add_u32 v1, 0x6000, v1
    v_mfma_f32_16x16x32_bf16 v[200:203], a[88:91], a[44:47], v[200:203]
    ds_read_b128 a[32:35], v5 offset:6144
    v_add_u32 v2, 0x6000, v2
    v_mfma_f32_16x16x32_bf16 v[200:203], a[92:95], a[64:67], v[200:203]
    ds_read_b128 a[16:19], v4 offset:8192
    v_add_u32 v3, 0x6000, v3
    v_mfma_f32_16x16x32_bf16 v[196:199], a[92:95], a[60:63], v[196:199]
    ds_read_b128 a[36:39], v5 offset:8192
    v_mfma_f32_16x16x32_bf16 v[196:199], a[88:91], a[40:43], v[196:199]
    v_mfma_f32_16x16x32_bf16 v[96:99], a[96:99], a[40:43], v[96:99]
    v_mfma_f32_16x16x32_bf16 v[96:99], a[100:103], a[60:63], v[96:99]
    s_mov_b32 s29, 20480
    buffer_store_dwordx4 a[148:151], v14, s[20:23], s29 offen sc1
    v_mfma_f32_16x16x32_bf16 v[100:103], a[100:103], a[64:67], v[100:103]
    v_mfma_f32_16x16x32_bf16 v[100:103], a[96:99], a[44:47], v[100:103]
    v_mfma_f32_16x16x32_bf16 v[104:107], a[96:99], a[48:51], v[104:107]
    v_mfma_f32_16x16x32_bf16 v[104:107], a[100:103], a[68:71], v[104:107]
    v_mfma_f32_16x16x32_bf16 v[108:111], a[100:103], a[72:75], v[108:111]
    v_mfma_f32_16x16x32_bf16 v[108:111], a[96:99], a[52:55], v[108:111]
    v_mfma_f32_16x16x32_bf16 v[112:115], a[96:99], a[56:59], v[112:115]
    s_waitcnt vmcnt(24) lgkmcnt(0)
    v_mfma_f32_16x16x32_bf16 v[112:115], a[100:103], a[76:79], v[112:115]

    s_barrier
    v_mfma_f32_16x16x32_bf16 v[216:219], a[104:107], a[40:43], v[216:219]
    s_add_u32 m0, s26, 0
    ds_read_b64_tr_b16 a[80:81], v0 offset:0
    v_mfma_f32_16x16x32_bf16 v[216:219], a[108:111], a[60:63], v[216:219]
    s_mov_b32 s32, 512
    buffer_load_dwordx4 v9, s[4:7], s32 offen lds
    v_mfma_f32_16x16x32_bf16 v[220:223], a[108:111], a[64:67], v[220:223]
    s_mov_b32 s33, 9728
    ds_read_b64_tr_b16 a[82:83], v0 offset:6144
    v_mfma_f32_16x16x32_bf16 v[220:223], a[104:107], a[44:47], v[220:223]
    ds_read_b64_tr_b16 a[84:85], v0 offset:12288
    v_mfma_f32_16x16x32_bf16 v[224:227], a[104:107], a[48:51], v[224:227]
    ds_read_b64_tr_b16 a[86:87], v0 offset:18432
    v_mfma_f32_16x16x32_bf16 v[224:227], a[108:111], a[68:71], v[224:227]
    ds_read_b64_tr_b16 a[88:89], v1 offset:0
    v_mfma_f32_16x16x32_bf16 v[228:231], a[108:111], a[72:75], v[228:231]
    ds_read_b64_tr_b16 a[90:91], v1 offset:6144
    v_mfma_f32_16x16x32_bf16 v[228:231], a[104:107], a[52:55], v[228:231]
    buffer_load_dwordx4 v10, s[4:7], s33 offen offset:1024 lds
    v_mfma_f32_16x16x32_bf16 v[232:235], a[104:107], a[56:59], v[232:235]
    s_mov_b32 s32, 18944
    ds_read_b64_tr_b16 a[92:93], v1 offset:12288
    v_mfma_f32_16x16x32_bf16 v[232:235], a[108:111], a[76:79], v[232:235]
    ds_read_b64_tr_b16 a[94:95], v1 offset:18432
    v_mfma_f32_16x16x32_bf16 v[132:135], a[116:119], a[76:79], v[132:135]
    ds_read_b64_tr_b16 a[96:97], v2 offset:0
    v_mfma_f32_16x16x32_bf16 v[132:135], a[112:115], a[56:59], v[132:135]
    ds_read_b64_tr_b16 a[98:99], v2 offset:6144
    v_mfma_f32_16x16x32_bf16 v[128:131], a[112:115], a[52:55], v[128:131]
    ds_read_b64_tr_b16 a[100:101], v2 offset:12288
    v_mfma_f32_16x16x32_bf16 v[128:131], a[116:119], a[72:75], v[128:131]
    buffer_load_dwordx4 v9, s[4:7], s32 offen offset:2048 lds
    v_mfma_f32_16x16x32_bf16 v[124:127], a[116:119], a[68:71], v[124:127]
    s_mov_b32 s33, 28160
    ds_read_b64_tr_b16 a[102:103], v2 offset:18432
    v_mfma_f32_16x16x32_bf16 v[124:127], a[112:115], a[48:51], v[124:127]
    v_mfma_f32_16x16x32_bf16 v[120:123], a[112:115], a[44:47], v[120:123]
    v_mfma_f32_16x16x32_bf16 v[120:123], a[116:119], a[64:67], v[120:123]
    v_mfma_f32_16x16x32_bf16 v[116:119], a[116:119], a[60:63], v[116:119]
    v_mfma_f32_16x16x32_bf16 v[116:119], a[112:115], a[40:43], v[116:119]
    buffer_load_dwordx4 v10, s[4:7], s33 offen offset:3072 lds
    v_mfma_f32_16x16x32_bf16 v[236:239], a[120:123], a[40:43], v[236:239]
    s_add_u32 m0, s26, 4096
    v_mfma_f32_16x16x32_bf16 v[236:239], a[124:127], a[60:63], v[236:239]
    s_mov_b32 s32, 41472
    v_mfma_f32_16x16x32_bf16 v[240:243], a[124:127], a[64:67], v[240:243]
    s_mov_b32 s29, 21504
    buffer_store_dwordx4 a[152:155], v14, s[20:23], s29 offen sc1
    v_mfma_f32_16x16x32_bf16 v[240:243], a[120:123], a[44:47], v[240:243]
    v_mfma_f32_16x16x32_bf16 v[244:247], a[120:123], a[48:51], v[244:247]
    v_mfma_f32_16x16x32_bf16 v[244:247], a[124:127], a[68:71], v[244:247]
    buffer_load_dwordx4 v9, s[4:7], s32 offen lds
    v_mfma_f32_16x16x32_bf16 v[248:251], a[124:127], a[72:75], v[248:251]
    s_mov_b32 s33, 50688
    v_mfma_f32_16x16x32_bf16 v[248:251], a[120:123], a[52:55], v[248:251]
    v_mfma_f32_16x16x32_bf16 v[252:255], a[120:123], a[56:59], v[252:255]
    v_mfma_f32_16x16x32_bf16 v[252:255], a[124:127], a[76:79], v[252:255]
    s_waitcnt lgkmcnt(0)
    v_mfma_f32_16x16x32_bf16 v[16:19], a[80:83], a[0:3], v[16:19]
    ds_read_b64_tr_b16 a[104:105], v3 offset:0
    v_mfma_f32_16x16x32_bf16 v[16:19], a[84:87], a[20:23], v[16:19]
    buffer_load_dwordx4 v10, s[4:7], s33 offen offset:1024 lds
    v_mfma_f32_16x16x32_bf16 v[20:23], a[84:87], a[24:27], v[20:23]
    s_mov_b32 s32, 59904
    ds_read_b64_tr_b16 a[106:107], v3 offset:6144
    v_add_u32 v4, 0x1e000, v4
    v_mfma_f32_16x16x32_bf16 v[20:23], a[80:83], a[4:7], v[20:23]
    ds_read_b64_tr_b16 a[108:109], v3 offset:12288
    v_add_u32 v5, 0x1e000, v5
    v_mfma_f32_16x16x32_bf16 v[24:27], a[80:83], a[8:11], v[24:27]
    ds_read_b64_tr_b16 a[110:111], v3 offset:18432
    v_mfma_f32_16x16x32_bf16 v[24:27], a[84:87], a[28:31], v[24:27]
    ds_read_b64_tr_b16 a[112:113], v0 offset:128
    v_mfma_f32_16x16x32_bf16 v[28:31], a[84:87], a[32:35], v[28:31]
    ds_read_b64_tr_b16 a[114:115], v0 offset:6272
    v_mfma_f32_16x16x32_bf16 v[28:31], a[80:83], a[12:15], v[28:31]
    buffer_load_dwordx4 v9, s[4:7], s32 offen offset:2048 lds
    v_mfma_f32_16x16x32_bf16 v[32:35], a[80:83], a[16:19], v[32:35]
    s_mov_b32 s33, 69120
    ds_read_b64_tr_b16 a[116:117], v0 offset:12416
    v_mfma_f32_16x16x32_bf16 v[32:35], a[84:87], a[36:39], v[32:35]
    ds_read_b64_tr_b16 a[118:119], v0 offset:18560
    v_mfma_f32_16x16x32_bf16 v[152:155], a[92:95], a[36:39], v[152:155]
    ds_read_b64_tr_b16 a[120:121], v1 offset:128
    v_mfma_f32_16x16x32_bf16 v[152:155], a[88:91], a[16:19], v[152:155]
    ds_read_b64_tr_b16 a[122:123], v1 offset:6272
    v_mfma_f32_16x16x32_bf16 v[148:151], a[88:91], a[12:15], v[148:151]
    ds_read_b64_tr_b16 a[124:125], v1 offset:12416
    v_mfma_f32_16x16x32_bf16 v[148:151], a[92:95], a[32:35], v[148:151]
    buffer_load_dwordx4 v10, s[4:7], s33 offen offset:3072 lds
    v_mfma_f32_16x16x32_bf16 v[144:147], a[92:95], a[28:31], v[144:147]
    s_add_u32 m0, s26, 8192
    ds_read_b64_tr_b16 a[126:127], v1 offset:18560
    v_mfma_f32_16x16x32_bf16 v[144:147], a[88:91], a[8:11], v[144:147]
    s_mov_b32 s32, 82432
    v_mfma_f32_16x16x32_bf16 v[140:143], a[88:91], a[4:7], v[140:143]
    s_mov_b32 s29, 22528
    buffer_store_dwordx4 a[156:159], v14, s[20:23], s29 offen sc1
    v_mfma_f32_16x16x32_bf16 v[140:143], a[92:95], a[24:27], v[140:143]
    v_mfma_f32_16x16x32_bf16 v[136:139], a[92:95], a[20:23], v[136:139]
    v_mfma_f32_16x16x32_bf16 v[136:139], a[88:91], a[0:3], v[136:139]
    buffer_load_dwordx4 v9, s[4:7], s32 offen lds
    v_mfma_f32_16x16x32_bf16 v[36:39], a[96:99], a[0:3], v[36:39]
    s_mov_b32 s33, 91648
    v_mfma_f32_16x16x32_bf16 v[36:39], a[100:103], a[20:23], v[36:39]
    v_mfma_f32_16x16x32_bf16 v[40:43], a[100:103], a[24:27], v[40:43]
    v_mfma_f32_16x16x32_bf16 v[40:43], a[96:99], a[4:7], v[40:43]
    v_mfma_f32_16x16x32_bf16 v[44:47], a[96:99], a[8:11], v[44:47]
    v_mfma_f32_16x16x32_bf16 v[44:47], a[100:103], a[28:31], v[44:47]
    buffer_load_dwordx4 v10, s[4:7], s33 offen offset:1024 lds
    v_mfma_f32_16x16x32_bf16 v[48:51], a[100:103], a[32:35], v[48:51]
    s_add_u32 m0, s25, 49152
    v_mfma_f32_16x16x32_bf16 v[48:51], a[96:99], a[12:15], v[48:51]
    s_mov_b32 s30, 3145728
    v_mfma_f32_16x16x32_bf16 v[52:55], a[96:99], a[16:19], v[52:55]
    v_mfma_f32_16x16x32_bf16 v[52:55], a[100:103], a[36:39], v[52:55]
    s_waitcnt lgkmcnt(0)
    v_mfma_f32_16x16x32_bf16 v[156:159], a[104:107], a[0:3], v[156:159]
    ds_read_b64_tr_b16 a[80:81], v2 offset:128
    v_mfma_f32_16x16x32_bf16 v[156:159], a[108:111], a[20:23], v[156:159]
    buffer_load_dwordx4 v6, s[8:11], s30 offen lds
    v_mfma_f32_16x16x32_bf16 v[160:163], a[108:111], a[24:27], v[160:163]
    ds_read_b64_tr_b16 a[82:83], v2 offset:6272
    v_mfma_f32_16x16x32_bf16 v[160:163], a[104:107], a[4:7], v[160:163]
    ds_read_b64_tr_b16 a[84:85], v2 offset:12416
    v_mfma_f32_16x16x32_bf16 v[164:167], a[104:107], a[8:11], v[164:167]
    ds_read_b64_tr_b16 a[86:87], v2 offset:18560
    v_mfma_f32_16x16x32_bf16 v[164:167], a[108:111], a[28:31], v[164:167]
    ds_read_b64_tr_b16 a[88:89], v3 offset:128
    v_mfma_f32_16x16x32_bf16 v[168:171], a[108:111], a[32:35], v[168:171]
    ds_read_b64_tr_b16 a[90:91], v3 offset:6272
    v_mfma_f32_16x16x32_bf16 v[168:171], a[104:107], a[12:15], v[168:171]
    buffer_load_dwordx4 v7, s[8:11], s30 offen offset:1024 lds
    v_mfma_f32_16x16x32_bf16 v[172:175], a[104:107], a[16:19], v[172:175]
    ds_read_b64_tr_b16 a[92:93], v3 offset:12416
    v_mfma_f32_16x16x32_bf16 v[172:175], a[108:111], a[36:39], v[172:175]
    ds_read_b64_tr_b16 a[94:95], v3 offset:18560
    v_mfma_f32_16x16x32_bf16 v[72:75], a[116:119], a[36:39], v[72:75]
    ds_read_b64_tr_b16 a[96:97], v0 offset:256
    v_mfma_f32_16x16x32_bf16 v[72:75], a[112:115], a[16:19], v[72:75]
    ds_read_b64_tr_b16 a[98:99], v0 offset:6400
    v_mfma_f32_16x16x32_bf16 v[68:71], a[112:115], a[12:15], v[68:71]
    s_waitcnt vmcnt(24)
    ds_read_b64_tr_b16 a[100:101], v0 offset:12544
    v_mfma_f32_16x16x32_bf16 v[68:71], a[116:119], a[32:35], v[68:71]
    buffer_load_dwordx4 v8, s[8:11], s30 offen offset:2048 lds
    v_mfma_f32_16x16x32_bf16 v[64:67], a[116:119], a[28:31], v[64:67]
    s_add_u32 m0, s25, 61440
    ds_read_b64_tr_b16 a[102:103], v0 offset:18688
    v_mfma_f32_16x16x32_bf16 v[64:67], a[112:115], a[8:11], v[64:67]
    s_mov_b32 s31, 3538944
    ds_read_b128 a[40:43], v4 offset:0
    v_mfma_f32_16x16x32_bf16 v[60:63], a[112:115], a[4:7], v[60:63]
    s_mov_b32 s29, 23552
    buffer_store_dwordx4 a[160:163], v14, s[20:23], s29 offen sc1
    v_mfma_f32_16x16x32_bf16 v[60:63], a[116:119], a[24:27], v[60:63]
    ds_read_b128 a[60:63], v5 offset:0
    v_mfma_f32_16x16x32_bf16 v[56:59], a[116:119], a[20:23], v[56:59]
    ds_read_b128 a[44:47], v4 offset:2048
    v_mfma_f32_16x16x32_bf16 v[56:59], a[112:115], a[0:3], v[56:59]
    buffer_load_dwordx4 v6, s[8:11], s31 offen lds
    v_mfma_f32_16x16x32_bf16 v[176:179], a[120:123], a[0:3], v[176:179]
    ds_read_b128 a[64:67], v5 offset:2048
    v_mfma_f32_16x16x32_bf16 v[176:179], a[124:127], a[20:23], v[176:179]
    ds_read_b128 a[48:51], v4 offset:4096
    v_mfma_f32_16x16x32_bf16 v[180:183], a[124:127], a[24:27], v[180:183]
    v_mfma_f32_16x16x32_bf16 v[180:183], a[120:123], a[4:7], v[180:183]
    v_mfma_f32_16x16x32_bf16 v[184:187], a[120:123], a[8:11], v[184:187]
    v_mfma_f32_16x16x32_bf16 v[184:187], a[124:127], a[28:31], v[184:187]
    buffer_load_dwordx4 v7, s[8:11], s31 offen offset:1024 lds
    v_mfma_f32_16x16x32_bf16 v[188:191], a[124:127], a[32:35], v[188:191]
    v_mfma_f32_16x16x32_bf16 v[188:191], a[120:123], a[12:15], v[188:191]
    v_mfma_f32_16x16x32_bf16 v[192:195], a[120:123], a[16:19], v[192:195]
    v_mfma_f32_16x16x32_bf16 v[192:195], a[124:127], a[36:39], v[192:195]
    s_waitcnt lgkmcnt(0)
    v_mfma_f32_16x16x32_bf16 v[76:79], a[80:83], a[0:3], v[76:79]
    ds_read_b64_tr_b16 a[104:105], v1 offset:256
    v_mfma_f32_16x16x32_bf16 v[76:79], a[84:87], a[20:23], v[76:79]
    buffer_load_dwordx4 v8, s[8:11], s31 offen offset:2048 lds
    v_mfma_f32_16x16x32_bf16 v[80:83], a[84:87], a[24:27], v[80:83]
    s_lshl_b32 s35, s28, 2
    ds_read_b64_tr_b16 a[106:107], v1 offset:6400
    v_mfma_f32_16x16x32_bf16 v[80:83], a[80:83], a[4:7], v[80:83]
    s_add_u32 s35, s35, s24
    ds_read_b64_tr_b16 a[108:109], v1 offset:12544
    v_mfma_f32_16x16x32_bf16 v[84:87], a[80:83], a[8:11], v[84:87]
    s_add_u32 s34, s49, 0
    ds_read_b64_tr_b16 a[110:111], v1 offset:18688
    v_mfma_f32_16x16x32_bf16 v[84:87], a[84:87], a[28:31], v[84:87]
    s_cmp_eq_u32 s35, 6
    s_cselect_b32 s35, s34, 1879048192
    ds_read_b64_tr_b16 a[112:113], v2 offset:256
    v_mfma_f32_16x16x32_bf16 v[88:91], a[84:87], a[32:35], v[88:91]
    ds_read_b64_tr_b16 a[114:115], v2 offset:6400
    v_mfma_f32_16x16x32_bf16 v[88:91], a[80:83], a[12:15], v[88:91]
    buffer_load_dword a255, v15, s[72:75], s35 offen
    v_mfma_f32_16x16x32_bf16 v[92:95], a[80:83], a[16:19], v[92:95]
    ds_read_b64_tr_b16 a[116:117], v2 offset:12544
    v_mfma_f32_16x16x32_bf16 v[92:95], a[84:87], a[36:39], v[92:95]
    s_mov_b32 s29, 24576
    buffer_store_dwordx4 a[164:167], v14, s[20:23], s29 offen sc1
    v_mfma_f32_16x16x32_bf16 v[212:215], a[92:95], a[36:39], v[212:215]
    ds_read_b64_tr_b16 a[118:119], v2 offset:18688
    v_mfma_f32_16x16x32_bf16 v[212:215], a[88:91], a[16:19], v[212:215]
    ds_read_b64_tr_b16 a[120:121], v3 offset:256
    v_mfma_f32_16x16x32_bf16 v[208:211], a[88:91], a[12:15], v[208:211]
    ds_read_b64_tr_b16 a[122:123], v3 offset:6400
    v_mfma_f32_16x16x32_bf16 v[208:211], a[92:95], a[32:35], v[208:211]
    ds_read_b64_tr_b16 a[124:125], v3 offset:12544
    v_mfma_f32_16x16x32_bf16 v[204:207], a[92:95], a[28:31], v[204:207]
    ds_read_b64_tr_b16 a[126:127], v3 offset:18688
    v_mfma_f32_16x16x32_bf16 v[204:207], a[88:91], a[8:11], v[204:207]
    ds_read_b128 a[68:71], v5 offset:4096
    v_add_u32 v0, 0x6000, v0
    v_mfma_f32_16x16x32_bf16 v[200:203], a[88:91], a[4:7], v[200:203]
    ds_read_b128 a[52:55], v4 offset:6144
    v_add_u32 v1, 0x6000, v1
    v_mfma_f32_16x16x32_bf16 v[200:203], a[92:95], a[24:27], v[200:203]
    ds_read_b128 a[72:75], v5 offset:6144
    v_add_u32 v2, 0x6000, v2
    v_mfma_f32_16x16x32_bf16 v[196:199], a[92:95], a[20:23], v[196:199]
    ds_read_b128 a[56:59], v4 offset:8192
    v_add_u32 v3, 0x6000, v3
    v_mfma_f32_16x16x32_bf16 v[196:199], a[88:91], a[0:3], v[196:199]
    ds_read_b128 a[76:79], v5 offset:8192
    v_mfma_f32_16x16x32_bf16 v[96:99], a[96:99], a[0:3], v[96:99]
    v_mfma_f32_16x16x32_bf16 v[96:99], a[100:103], a[20:23], v[96:99]
    v_mfma_f32_16x16x32_bf16 v[100:103], a[100:103], a[24:27], v[100:103]
    v_mfma_f32_16x16x32_bf16 v[100:103], a[96:99], a[4:7], v[100:103]
    v_mfma_f32_16x16x32_bf16 v[104:107], a[96:99], a[8:11], v[104:107]
    v_mfma_f32_16x16x32_bf16 v[104:107], a[100:103], a[28:31], v[104:107]
    v_mfma_f32_16x16x32_bf16 v[108:111], a[100:103], a[32:35], v[108:111]
    v_mfma_f32_16x16x32_bf16 v[108:111], a[96:99], a[12:15], v[108:111]
    v_mfma_f32_16x16x32_bf16 v[112:115], a[96:99], a[16:19], v[112:115]
    s_waitcnt vmcnt(23) lgkmcnt(0)
    v_mfma_f32_16x16x32_bf16 v[112:115], a[100:103], a[36:39], v[112:115]

    s_barrier
    v_mfma_f32_16x16x32_bf16 v[216:219], a[104:107], a[0:3], v[216:219]
    s_add_u32 m0, s26, 122880
    ds_read_b64_tr_b16 a[80:81], v0 offset:0
    v_mfma_f32_16x16x32_bf16 v[216:219], a[108:111], a[20:23], v[216:219]
    s_mov_b32 s32, 640
    buffer_load_dwordx4 v9, s[4:7], s32 offen lds
    v_mfma_f32_16x16x32_bf16 v[220:223], a[108:111], a[24:27], v[220:223]
    s_mov_b32 s33, 9856
    ds_read_b64_tr_b16 a[82:83], v0 offset:6144
    v_mfma_f32_16x16x32_bf16 v[220:223], a[104:107], a[4:7], v[220:223]
    ds_read_b64_tr_b16 a[84:85], v0 offset:12288
    v_mfma_f32_16x16x32_bf16 v[224:227], a[104:107], a[8:11], v[224:227]
    ds_read_b64_tr_b16 a[86:87], v0 offset:18432
    v_mfma_f32_16x16x32_bf16 v[224:227], a[108:111], a[28:31], v[224:227]
    ds_read_b64_tr_b16 a[88:89], v1 offset:0
    v_mfma_f32_16x16x32_bf16 v[228:231], a[108:111], a[32:35], v[228:231]
    ds_read_b64_tr_b16 a[90:91], v1 offset:6144
    v_mfma_f32_16x16x32_bf16 v[228:231], a[104:107], a[12:15], v[228:231]
    buffer_load_dwordx4 v10, s[4:7], s33 offen offset:1024 lds
    v_mfma_f32_16x16x32_bf16 v[232:235], a[104:107], a[16:19], v[232:235]
    s_mov_b32 s32, 19072
    ds_read_b64_tr_b16 a[92:93], v1 offset:12288
    v_mfma_f32_16x16x32_bf16 v[232:235], a[108:111], a[36:39], v[232:235]
    s_mov_b32 s29, 10240
    buffer_store_dwordx4 a[168:171], v14, s[20:23], s29 offen sc1
    v_mfma_f32_16x16x32_bf16 v[132:135], a[116:119], a[36:39], v[132:135]
    ds_read_b64_tr_b16 a[94:95], v1 offset:18432
    v_mfma_f32_16x16x32_bf16 v[132:135], a[112:115], a[16:19], v[132:135]
    ds_read_b64_tr_b16 a[96:97], v2 offset:0
    v_mfma_f32_16x16x32_bf16 v[128:131], a[112:115], a[12:15], v[128:131]
    ds_read_b64_tr_b16 a[98:99], v2 offset:6144
    v_mfma_f32_16x16x32_bf16 v[128:131], a[116:119], a[32:35], v[128:131]
    buffer_load_dwordx4 v9, s[4:7], s32 offen offset:2048 lds
    v_mfma_f32_16x16x32_bf16 v[124:127], a[116:119], a[28:31], v[124:127]
    s_mov_b32 s33, 28288
    ds_read_b64_tr_b16 a[100:101], v2 offset:12288
    v_mfma_f32_16x16x32_bf16 v[124:127], a[112:115], a[8:11], v[124:127]
    ds_read_b64_tr_b16 a[102:103], v2 offset:18432
    v_mfma_f32_16x16x32_bf16 v[120:123], a[112:115], a[4:7], v[120:123]
    v_mfma_f32_16x16x32_bf16 v[120:123], a[116:119], a[24:27], v[120:123]
    v_mfma_f32_16x16x32_bf16 v[116:119], a[116:119], a[20:23], v[116:119]
    v_mfma_f32_16x16x32_bf16 v[116:119], a[112:115], a[0:3], v[116:119]
    buffer_load_dwordx4 v10, s[4:7], s33 offen offset:3072 lds
    v_mfma_f32_16x16x32_bf16 v[236:239], a[120:123], a[0:3], v[236:239]
    s_add_u32 m0, s26, 126976
    v_mfma_f32_16x16x32_bf16 v[236:239], a[124:127], a[20:23], v[236:239]
    s_mov_b32 s32, 41600
    v_mfma_f32_16x16x32_bf16 v[240:243], a[124:127], a[24:27], v[240:243]
    v_mfma_f32_16x16x32_bf16 v[240:243], a[120:123], a[4:7], v[240:243]
    v_mfma_f32_16x16x32_bf16 v[244:247], a[120:123], a[8:11], v[244:247]
    v_mfma_f32_16x16x32_bf16 v[244:247], a[124:127], a[28:31], v[244:247]
    buffer_load_dwordx4 v9, s[4:7], s32 offen lds
    v_mfma_f32_16x16x32_bf16 v[248:251], a[124:127], a[32:35], v[248:251]
    s_mov_b32 s33, 50816
    v_mfma_f32_16x16x32_bf16 v[248:251], a[120:123], a[12:15], v[248:251]
    v_mfma_f32_16x16x32_bf16 v[252:255], a[120:123], a[16:19], v[252:255]
    v_mfma_f32_16x16x32_bf16 v[252:255], a[124:127], a[36:39], v[252:255]
    s_waitcnt lgkmcnt(0)
    v_mfma_f32_16x16x32_bf16 v[16:19], a[80:83], a[40:43], v[16:19]
    ds_read_b64_tr_b16 a[104:105], v3 offset:0
    v_mfma_f32_16x16x32_bf16 v[16:19], a[84:87], a[60:63], v[16:19]
    buffer_load_dwordx4 v10, s[4:7], s33 offen offset:1024 lds
    v_mfma_f32_16x16x32_bf16 v[20:23], a[84:87], a[64:67], v[20:23]
    s_mov_b32 s32, 60032
    ds_read_b64_tr_b16 a[106:107], v3 offset:6144
    v_add_u32 v4, 0xfffe2000, v4
    v_mfma_f32_16x16x32_bf16 v[20:23], a[80:83], a[44:47], v[20:23]
    s_mov_b32 s29, 11264
    buffer_store_dwordx4 a[172:175], v14, s[20:23], s29 offen sc1
    v_mfma_f32_16x16x32_bf16 v[24:27], a[80:83], a[48:51], v[24:27]
    ds_read_b64_tr_b16 a[108:109], v3 offset:12288
    v_add_u32 v5, 0xfffe2000, v5
    v_mfma_f32_16x16x32_bf16 v[24:27], a[84:87], a[68:71], v[24:27]
    ds_read_b64_tr_b16 a[110:111], v3 offset:18432
    v_mfma_f32_16x16x32_bf16 v[28:31], a[84:87], a[72:75], v[28:31]
    ds_read_b64_tr_b16 a[112:113], v0 offset:128
    v_mfma_f32_16x16x32_bf16 v[28:31], a[80:83], a[52:55], v[28:31]
    buffer_load_dwordx4 v9, s[4:7], s32 offen offset:2048 lds
    v_mfma_f32_16x16x32_bf16 v[32:35], a[80:83], a[56:59], v[32:35]
    s_mov_b32 s33, 69248
    ds_read_b64_tr_b16 a[114:115], v0 offset:6272
    v_mfma_f32_16x16x32_bf16 v[32:35], a[84:87], a[76:79], v[32:35]
    ds_read_b64_tr_b16 a[116:117], v0 offset:12416
    v_mfma_f32_16x16x32_bf16 v[152:155], a[92:95], a[76:79], v[152:155]
    ds_read_b64_tr_b16 a[118:119], v0 offset:18560
    v_mfma_f32_16x16x32_bf16 v[152:155], a[88:91], a[56:59], v[152:155]
    ds_read_b64_tr_b16 a[120:121], v1 offset:128
    v_mfma_f32_16x16x32_bf16 v[148:151], a[88:91], a[52:55], v[148:151]
    ds_read_b64_tr_b16 a[122:123], v1 offset:6272
    v_mfma_f32_16x16x32_bf16 v[148:151], a[92:95], a[72:75], v[148:151]
    buffer_load_dwordx4 v10, s[4:7], s33 offen offset:3072 lds
    v_mfma_f32_16x16x32_bf16 v[144:147], a[92:95], a[68:71], v[144:147]
    s_add_u32 m0, s26, 131072
    ds_read_b64_tr_b16 a[124:125], v1 offset:12416
    v_mfma_f32_16x16x32_bf16 v[144:147], a[88:91], a[48:51], v[144:147]
    s_mov_b32 s32, 82560
    ds_read_b64_tr_b16 a[126:127], v1 offset:18560
    v_mfma_f32_16x16x32_bf16 v[140:143], a[88:91], a[44:47], v[140:143]
    v_mfma_f32_16x16x32_bf16 v[140:143], a[92:95], a[64:67], v[140:143]
    v_mfma_f32_16x16x32_bf16 v[136:139], a[92:95], a[60:63], v[136:139]
    v_mfma_f32_16x16x32_bf16 v[136:139], a[88:91], a[40:43], v[136:139]
    buffer_load_dwordx4 v9, s[4:7], s32 offen lds
    v_mfma_f32_16x16x32_bf16 v[36:39], a[96:99], a[40:43], v[36:39]
    s_mov_b32 s33, 91776
    v_mfma_f32_16x16x32_bf16 v[36:39], a[100:103], a[60:63], v[36:39]
    v_mfma_f32_16x16x32_bf16 v[40:43], a[100:103], a[64:67], v[40:43]
    v_mfma_f32_16x16x32_bf16 v[40:43], a[96:99], a[44:47], v[40:43]
    v_mfma_f32_16x16x32_bf16 v[44:47], a[96:99], a[48:51], v[44:47]
    v_mfma_f32_16x16x32_bf16 v[44:47], a[100:103], a[68:71], v[44:47]
    buffer_load_dwordx4 v10, s[4:7], s33 offen offset:1024 lds
    v_mfma_f32_16x16x32_bf16 v[48:51], a[100:103], a[72:75], v[48:51]
    s_add_u32 m0, s25, 73728
    v_mfma_f32_16x16x32_bf16 v[48:51], a[96:99], a[52:55], v[48:51]
    s_mov_b32 s30, 3932160
    v_mfma_f32_16x16x32_bf16 v[52:55], a[96:99], a[56:59], v[52:55]
    v_mfma_f32_16x16x32_bf16 v[52:55], a[100:103], a[76:79], v[52:55]
    s_waitcnt lgkmcnt(0)
    v_mfma_f32_16x16x32_bf16 v[156:159], a[104:107], a[40:43], v[156:159]
    ds_read_b64_tr_b16 a[80:81], v2 offset:128
    v_mfma_f32_16x16x32_bf16 v[156:159], a[108:111], a[60:63], v[156:159]
    buffer_load_dwordx4 v6, s[8:11], s30 offen lds
    v_mfma_f32_16x16x32_bf16 v[160:163], a[108:111], a[64:67], v[160:163]
    ds_read_b64_tr_b16 a[82:83], v2 offset:6272
    v_mfma_f32_16x16x32_bf16 v[160:163], a[104:107], a[44:47], v[160:163]
    s_mov_b32 s29, 12288
    buffer_store_dwordx4 a[176:179], v14, s[20:23], s29 offen sc1
    v_mfma_f32_16x16x32_bf16 v[164:167], a[104:107], a[48:51], v[164:167]
    ds_read_b64_tr_b16 a[84:85], v2 offset:12416
    v_mfma_f32_16x16x32_bf16 v[164:167], a[108:111], a[68:71], v[164:167]
    ds_read_b64_tr_b16 a[86:87], v2 offset:18560
    v_mfma_f32_16x16x32_bf16 v[168:171], a[108:111], a[72:75], v[168:171]
    ds_read_b64_tr_b16 a[88:89], v3 offset:128
    v_mfma_f32_16x16x32_bf16 v[168:171], a[104:107], a[52:55], v[168:171]
    buffer_load_dwordx4 v7, s[8:11], s30 offen offset:1024 lds
    v_mfma_f32_16x16x32_bf16 v[172:175], a[104:107], a[56:59], v[172:175]
    ds_read_b64_tr_b16 a[90:91], v3 offset:6272
    v_mfma_f32_16x16x32_bf16 v[172:175], a[108:111], a[76:79], v[172:175]
    ds_read_b64_tr_b16 a[92:93], v3 offset:12416
    v_mfma_f32_16x16x32_bf16 v[72:75], a[116:119], a[76:79], v[72:75]
    ds_read_b64_tr_b16 a[94:95], v3 offset:18560
    v_mfma_f32_16x16x32_bf16 v[72:75], a[112:115], a[56:59], v[72:75]
    ds_read_b64_tr_b16 a[96:97], v0 offset:256
    v_mfma_f32_16x16x32_bf16 v[68:71], a[112:115], a[52:55], v[68:71]
    ds_read_b64_tr_b16 a[98:99], v0 offset:6400
    v_mfma_f32_16x16x32_bf16 v[68:71], a[116:119], a[72:75], v[68:71]
    s_waitcnt vmcnt(24)
    buffer_load_dwordx4 v8, s[8:11], s30 offen offset:2048 lds
    v_mfma_f32_16x16x32_bf16 v[64:67], a[116:119], a[68:71], v[64:67]
    s_add_u32 m0, s25, 86016
    ds_read_b64_tr_b16 a[100:101], v0 offset:12544
    v_mfma_f32_16x16x32_bf16 v[64:67], a[112:115], a[48:51], v[64:67]
    s_mov_b32 s31, 4325376
    ds_read_b64_tr_b16 a[102:103], v0 offset:18688
    v_mfma_f32_16x16x32_bf16 v[60:63], a[112:115], a[44:47], v[60:63]
    ds_read_b128 a[0:3], v4 offset:0
    v_mfma_f32_16x16x32_bf16 v[60:63], a[116:119], a[64:67], v[60:63]
    ds_read_b128 a[20:23], v5 offset:0
    v_mfma_f32_16x16x32_bf16 v[56:59], a[116:119], a[60:63], v[56:59]
    ds_read_b128 a[4:7], v4 offset:2048
    v_mfma_f32_16x16x32_bf16 v[56:59], a[112:115], a[40:43], v[56:59]
    buffer_load_dwordx4 v6, s[8:11], s31 offen lds
    v_mfma_f32_16x16x32_bf16 v[176:179], a[120:123], a[40:43], v[176:179]
    ds_read_b128 a[24:27], v5 offset:2048
    v_mfma_f32_16x16x32_bf16 v[176:179], a[124:127], a[60:63], v[176:179]
    ds_read_b128 a[8:11], v4 offset:4096
    v_mfma_f32_16x16x32_bf16 v[180:183], a[124:127], a[64:67], v[180:183]
    v_mfma_f32_16x16x32_bf16 v[180:183], a[120:123], a[44:47], v[180:183]
    v_mfma_f32_16x16x32_bf16 v[184:187], a[120:123], a[48:51], v[184:187]
    v_mfma_f32_16x16x32_bf16 v[184:187], a[124:127], a[68:71], v[184:187]
    buffer_load_dwordx4 v7, s[8:11], s31 offen offset:1024 lds
    v_mfma_f32_16x16x32_bf16 v[188:191], a[124:127], a[72:75], v[188:191]
    v_mfma_f32_16x16x32_bf16 v[188:191], a[120:123], a[52:55], v[188:191]
    s_mov_b32 s29, 13312
    buffer_store_dwordx4 a[180:183], v14, s[20:23], s29 offen sc1
    v_mfma_f32_16x16x32_bf16 v[192:195], a[120:123], a[56:59], v[192:195]
    v_mfma_f32_16x16x32_bf16 v[192:195], a[124:127], a[76:79], v[192:195]
    s_waitcnt lgkmcnt(0)
    v_mfma_f32_16x16x32_bf16 v[76:79], a[80:83], a[40:43], v[76:79]
    ds_read_b64_tr_b16 a[104:105], v1 offset:256
    v_mfma_f32_16x16x32_bf16 v[76:79], a[84:87], a[60:63], v[76:79]
    buffer_load_dwordx4 v8, s[8:11], s31 offen offset:2048 lds
    v_mfma_f32_16x16x32_bf16 v[80:83], a[84:87], a[64:67], v[80:83]
    s_lshl_b32 s35, s28, 2
    ds_read_b64_tr_b16 a[106:107], v1 offset:6400
    v_mfma_f32_16x16x32_bf16 v[80:83], a[80:83], a[44:47], v[80:83]
    s_add_u32 s35, s35, s24
    ds_read_b64_tr_b16 a[108:109], v1 offset:12544
    v_mfma_f32_16x16x32_bf16 v[84:87], a[80:83], a[48:51], v[84:87]
    s_add_u32 s34, s49, 0
    ds_read_b64_tr_b16 a[110:111], v1 offset:18688
    v_mfma_f32_16x16x32_bf16 v[84:87], a[84:87], a[68:71], v[84:87]
    s_cmp_eq_u32 s35, 7
    s_cselect_b32 s35, s34, 1879048192
    ds_read_b64_tr_b16 a[112:113], v2 offset:256
    v_mfma_f32_16x16x32_bf16 v[88:91], a[84:87], a[72:75], v[88:91]
    ds_read_b64_tr_b16 a[114:115], v2 offset:6400
    v_mfma_f32_16x16x32_bf16 v[88:91], a[80:83], a[52:55], v[88:91]
    buffer_load_dword a255, v15, s[72:75], s35 offen
    v_mfma_f32_16x16x32_bf16 v[92:95], a[80:83], a[56:59], v[92:95]
    ds_read_b64_tr_b16 a[116:117], v2 offset:12544
    v_mfma_f32_16x16x32_bf16 v[92:95], a[84:87], a[76:79], v[92:95]
    ds_read_b64_tr_b16 a[118:119], v2 offset:18688
    v_mfma_f32_16x16x32_bf16 v[212:215], a[92:95], a[76:79], v[212:215]
    ds_read_b64_tr_b16 a[120:121], v3 offset:256
    v_mfma_f32_16x16x32_bf16 v[212:215], a[88:91], a[56:59], v[212:215]
    ds_read_b64_tr_b16 a[122:123], v3 offset:6400
    v_mfma_f32_16x16x32_bf16 v[208:211], a[88:91], a[52:55], v[208:211]
    ds_read_b64_tr_b16 a[124:125], v3 offset:12544
    v_mfma_f32_16x16x32_bf16 v[208:211], a[92:95], a[72:75], v[208:211]
    ds_read_b64_tr_b16 a[126:127], v3 offset:18688
    v_mfma_f32_16x16x32_bf16 v[204:207], a[92:95], a[68:71], v[204:207]
    ds_read_b128 a[28:31], v5 offset:4096
    v_add_u32 v0, 0xffff4000, v0
    v_mfma_f32_16x16x32_bf16 v[204:207], a[88:91], a[48:51], v[204:207]
    ds_read_b128 a[12:15], v4 offset:6144
    v_add_u32 v1, 0xffff4000, v1
    v_mfma_f32_16x16x32_bf16 v[200:203], a[88:91], a[44:47], v[200:203]
    ds_read_b128 a[32:35], v5 offset:6144
    v_add_u32 v2, 0xffff4000, v2
    v_mfma_f32_16x16x32_bf16 v[200:203], a[92:95], a[64:67], v[200:203]
    ds_read_b128 a[16:19], v4 offset:8192
    v_add_u32 v3, 0xffff4000, v3
    v_mfma_f32_16x16x32_bf16 v[196:199], a[92:95], a[60:63], v[196:199]
    ds_read_b128 a[36:39], v5 offset:8192
    v_mfma_f32_16x16x32_bf16 v[196:199], a[88:91], a[40:43], v[196:199]
    v_mfma_f32_16x16x32_bf16 v[96:99], a[96:99], a[40:43], v[96:99]
    v_mfma_f32_16x16x32_bf16 v[96:99], a[100:103], a[60:63], v[96:99]
    v_mfma_f32_16x16x32_bf16 v[100:103], a[100:103], a[64:67], v[100:103]
    v_mfma_f32_16x16x32_bf16 v[100:103], a[96:99], a[44:47], v[100:103]
    v_mfma_f32_16x16x32_bf16 v[104:107], a[96:99], a[48:51], v[104:107]
    s_mov_b32 s29, 14336
    buffer_store_dwordx4 a[184:187], v14, s[20:23], s29 offen sc1
    v_mfma_f32_16x16x32_bf16 v[104:107], a[100:103], a[68:71], v[104:107]
    v_mfma_f32_16x16x32_bf16 v[108:111], a[100:103], a[72:75], v[108:111]
    v_mfma_f32_16x16x32_bf16 v[108:111], a[96:99], a[52:55], v[108:111]
    v_mfma_f32_16x16x32_bf16 v[112:115], a[96:99], a[56:59], v[112:115]
    s_waitcnt vmcnt(24) lgkmcnt(0)
    v_mfma_f32_16x16x32_bf16 v[112:115], a[100:103], a[76:79], v[112:115]

    s_barrier
    v_mfma_f32_16x16x32_bf16 v[216:219], a[104:107], a[40:43], v[216:219]
    s_add_u32 m0, s26, 0
    ds_read_b64_tr_b16 a[80:81], v0 offset:0
    v_mfma_f32_16x16x32_bf16 v[216:219], a[108:111], a[60:63], v[216:219]
    s_mov_b32 s32, 768
    buffer_load_dwordx4 v9, s[4:7], s32 offen lds
    v_mfma_f32_16x16x32_bf16 v[220:223], a[108:111], a[64:67], v[220:223]
    s_mov_b32 s33, 9984
    ds_read_b64_tr_b16 a[82:83], v0 offset:6144
    v_mfma_f32_16x16x32_bf16 v[220:223], a[104:107], a[44:47], v[220:223]
    ds_read_b64_tr_b16 a[84:85], v0 offset:12288
    v_mfma_f32_16x16x32_bf16 v[224:227], a[104:107], a[48:51], v[224:227]
    ds_read_b64_tr_b16 a[86:87], v0 offset:18432
    v_mfma_f32_16x16x32_bf16 v[224:227], a[108:111], a[68:71], v[224:227]
    ds_read_b64_tr_b16 a[88:89], v1 offset:0
    v_mfma_f32_16x16x32_bf16 v[228:231], a[108:111], a[72:75], v[228:231]
    ds_read_b64_tr_b16 a[90:91], v1 offset:6144
    v_mfma_f32_16x16x32_bf16 v[228:231], a[104:107], a[52:55], v[228:231]
    buffer_load_dwordx4 v10, s[4:7], s33 offen offset:1024 lds
    v_mfma_f32_16x16x32_bf16 v[232:235], a[104:107], a[56:59], v[232:235]
    s_mov_b32 s32, 19200
    ds_read_b64_tr_b16 a[92:93], v1 offset:12288
    v_mfma_f32_16x16x32_bf16 v[232:235], a[108:111], a[76:79], v[232:235]
    ds_read_b64_tr_b16 a[94:95], v1 offset:18432
    v_mfma_f32_16x16x32_bf16 v[132:135], a[116:119], a[76:79], v[132:135]
    ds_read_b64_tr_b16 a[96:97], v2 offset:0
    v_mfma_f32_16x16x32_bf16 v[132:135], a[112:115], a[56:59], v[132:135]
    ds_read_b64_tr_b16 a[98:99], v2 offset:6144
    v_mfma_f32_16x16x32_bf16 v[128:131], a[112:115], a[52:55], v[128:131]
    ds_read_b64_tr_b16 a[100:101], v2 offset:12288
    v_mfma_f32_16x16x32_bf16 v[128:131], a[116:119], a[72:75], v[128:131]
    buffer_load_dwordx4 v9, s[4:7], s32 offen offset:2048 lds
    v_mfma_f32_16x16x32_bf16 v[124:127], a[116:119], a[68:71], v[124:127]
    s_mov_b32 s33, 28416
    ds_read_b64_tr_b16 a[102:103], v2 offset:18432
    v_mfma_f32_16x16x32_bf16 v[124:127], a[112:115], a[48:51], v[124:127]
    v_mfma_f32_16x16x32_bf16 v[120:123], a[112:115], a[44:47], v[120:123]
    v_mfma_f32_16x16x32_bf16 v[120:123], a[116:119], a[64:67], v[120:123]
    v_mfma_f32_16x16x32_bf16 v[116:119], a[116:119], a[60:63], v[116:119]
    v_mfma_f32_16x16x32_bf16 v[116:119], a[112:115], a[40:43], v[116:119]
    buffer_load_dwordx4 v10, s[4:7], s33 offen offset:3072 lds
    v_mfma_f32_16x16x32_bf16 v[236:239], a[120:123], a[40:43], v[236:239]
    s_add_u32 m0, s26, 4096
    v_mfma_f32_16x16x32_bf16 v[236:239], a[124:127], a[60:63], v[236:239]
    s_mov_b32 s32, 41728
    v_mfma_f32_16x16x32_bf16 v[240:243], a[124:127], a[64:67], v[240:243]
    s_mov_b32 s29, 30720
    buffer_store_dwordx4 a[188:191], v14, s[20:23], s29 offen sc1
    v_mfma_f32_16x16x32_bf16 v[240:243], a[120:123], a[44:47], v[240:243]
    v_mfma_f32_16x16x32_bf16 v[244:247], a[120:123], a[48:51], v[244:247]
    v_mfma_f32_16x16x32_bf16 v[244:247], a[124:127], a[68:71], v[244:247]
    buffer_load_dwordx4 v9, s[4:7], s32 offen lds
    v_mfma_f32_16x16x32_bf16 v[248:251], a[124:127], a[72:75], v[248:251]
    s_mov_b32 s33, 50944
    v_mfma_f32_16x16x32_bf16 v[248:251], a[120:123], a[52:55], v[248:251]
    v_mfma_f32_16x16x32_bf16 v[252:255], a[120:123], a[56:59], v[252:255]
    v_mfma_f32_16x16x32_bf16 v[252:255], a[124:127], a[76:79], v[252:255]
    s_waitcnt lgkmcnt(0)
    v_mfma_f32_16x16x32_bf16 v[16:19], a[80:83], a[0:3], v[16:19]
    ds_read_b64_tr_b16 a[104:105], v3 offset:0
    v_mfma_f32_16x16x32_bf16 v[16:19], a[84:87], a[20:23], v[16:19]
    buffer_load_dwordx4 v10, s[4:7], s33 offen offset:1024 lds
    v_mfma_f32_16x16x32_bf16 v[20:23], a[84:87], a[24:27], v[20:23]
    s_mov_b32 s32, 60160
    ds_read_b64_tr_b16 a[106:107], v3 offset:6144
    v_add_u32 v4, 0x1e000, v4
    v_mfma_f32_16x16x32_bf16 v[20:23], a[80:83], a[4:7], v[20:23]
    ds_read_b64_tr_b16 a[108:109], v3 offset:12288
    v_add_u32 v5, 0x1e000, v5
    v_mfma_f32_16x16x32_bf16 v[24:27], a[80:83], a[8:11], v[24:27]
    ds_read_b64_tr_b16 a[110:111], v3 offset:18432
    v_mfma_f32_16x16x32_bf16 v[24:27], a[84:87], a[28:31], v[24:27]
    ds_read_b64_tr_b16 a[112:113], v0 offset:128
    v_mfma_f32_16x16x32_bf16 v[28:31], a[84:87], a[32:35], v[28:31]
    ds_read_b64_tr_b16 a[114:115], v0 offset:6272
    v_mfma_f32_16x16x32_bf16 v[28:31], a[80:83], a[12:15], v[28:31]
    buffer_load_dwordx4 v9, s[4:7], s32 offen offset:2048 lds
    v_mfma_f32_16x16x32_bf16 v[32:35], a[80:83], a[16:19], v[32:35]
    s_mov_b32 s33, 69376
    ds_read_b64_tr_b16 a[116:117], v0 offset:12416
    v_mfma_f32_16x16x32_bf16 v[32:35], a[84:87], a[36:39], v[32:35]
    ds_read_b64_tr_b16 a[118:119], v0 offset:18560
    v_mfma_f32_16x16x32_bf16 v[152:155], a[92:95], a[36:39], v[152:155]
    ds_read_b64_tr_b16 a[120:121], v1 offset:128
    v_mfma_f32_16x16x32_bf16 v[152:155], a[88:91], a[16:19], v[152:155]
    ds_read_b64_tr_b16 a[122:123], v1 offset:6272
    v_mfma_f32_16x16x32_bf16 v[148:151], a[88:91], a[12:15], v[148:151]
    ds_read_b64_tr_b16 a[124:125], v1 offset:12416
    v_mfma_f32_16x16x32_bf16 v[148:151], a[92:95], a[32:35], v[148:151]
    buffer_load_dwordx4 v10, s[4:7], s33 offen offset:3072 lds
    v_mfma_f32_16x16x32_bf16 v[144:147], a[92:95], a[28:31], v[144:147]
    s_add_u32 m0, s26, 8192
    ds_read_b64_tr_b16 a[126:127], v1 offset:18560
    v_mfma_f32_16x16x32_bf16 v[144:147], a[88:91], a[8:11], v[144:147]
    s_mov_b32 s32, 82688
    v_mfma_f32_16x16x32_bf16 v[140:143], a[88:91], a[4:7], v[140:143]
    v_mfma_f32_16x16x32_bf16 v[140:143], a[92:95], a[24:27], v[140:143]
    v_mfma_f32_16x16x32_bf16 v[136:139], a[92:95], a[20:23], v[136:139]
    v_mfma_f32_16x16x32_bf16 v[136:139], a[88:91], a[0:3], v[136:139]
    buffer_load_dwordx4 v9, s[4:7], s32 offen lds
    v_mfma_f32_16x16x32_bf16 v[36:39], a[96:99], a[0:3], v[36:39]
    s_mov_b32 s33, 91904
    v_mfma_f32_16x16x32_bf16 v[36:39], a[100:103], a[20:23], v[36:39]
    s_mov_b32 s29, 31744
    buffer_store_dwordx4 a[192:195], v14, s[20:23], s29 offen sc1
    v_mfma_f32_16x16x32_bf16 v[40:43], a[100:103], a[24:27], v[40:43]
    v_mfma_f32_16x16x32_bf16 v[40:43], a[96:99], a[4:7], v[40:43]
    v_mfma_f32_16x16x32_bf16 v[44:47], a[96:99], a[8:11], v[44:47]
    v_mfma_f32_16x16x32_bf16 v[44:47], a[100:103], a[28:31], v[44:47]
    buffer_load_dwordx4 v10, s[4:7], s33 offen offset:1024 lds
    v_mfma_f32_16x16x32_bf16 v[48:51], a[100:103], a[32:35], v[48:51]
    s_add_u32 m0, s25, 98304
    v_mfma_f32_16x16x32_bf16 v[48:51], a[96:99], a[12:15], v[48:51]
    s_mov_b32 s30, 4718592
    v_mfma_f32_16x16x32_bf16 v[52:55], a[96:99], a[16:19], v[52:55]
    v_mfma_f32_16x16x32_bf16 v[52:55], a[100:103], a[36:39], v[52:55]
    s_waitcnt lgkmcnt(0)
    v_mfma_f32_16x16x32_bf16 v[156:159], a[104:107], a[0:3], v[156:159]
    ds_read_b64_tr_b16 a[80:81], v2 offset:128
    v_mfma_f32_16x16x32_bf16 v[156:159], a[108:111], a[20:23], v[156:159]
    buffer_load_dwordx4 v6, s[8:11], s30 offen lds
    v_mfma_f32_16x16x32_bf16 v[160:163], a[108:111], a[24:27], v[160:163]
    ds_read_b64_tr_b16 a[82:83], v2 offset:6272
    v_mfma_f32_16x16x32_bf16 v[160:163], a[104:107], a[4:7], v[160:163]
    ds_read_b64_tr_b16 a[84:85], v2 offset:12416
    v_mfma_f32_16x16x32_bf16 v[164:167], a[104:107], a[8:11], v[164:167]
    ds_read_b64_tr_b16 a[86:87], v2 offset:18560
    v_mfma_f32_16x16x32_bf16 v[164:167], a[108:111], a[28:31], v[164:167]
    ds_read_b64_tr_b16 a[88:89], v3 offset:128
    v_mfma_f32_16x16x32_bf16 v[168:171], a[108:111], a[32:35], v[168:171]
    ds_read_b64_tr_b16 a[90:91], v3 offset:6272
    v_mfma_f32_16x16x32_bf16 v[168:171], a[104:107], a[12:15], v[168:171]
    buffer_load_dwordx4 v7, s[8:11], s30 offen offset:1024 lds
    v_mfma_f32_16x16x32_bf16 v[172:175], a[104:107], a[16:19], v[172:175]
    ds_read_b64_tr_b16 a[92:93], v3 offset:12416
    v_mfma_f32_16x16x32_bf16 v[172:175], a[108:111], a[36:39], v[172:175]
    ds_read_b64_tr_b16 a[94:95], v3 offset:18560
    v_mfma_f32_16x16x32_bf16 v[72:75], a[116:119], a[36:39], v[72:75]
    ds_read_b64_tr_b16 a[96:97], v0 offset:256
    v_mfma_f32_16x16x32_bf16 v[72:75], a[112:115], a[16:19], v[72:75]
    ds_read_b64_tr_b16 a[98:99], v0 offset:6400
    v_mfma_f32_16x16x32_bf16 v[68:71], a[112:115], a[12:15], v[68:71]
    s_waitcnt vmcnt(24)
    ds_read_b64_tr_b16 a[100:101], v0 offset:12544
    v_mfma_f32_16x16x32_bf16 v[68:71], a[116:119], a[32:35], v[68:71]
    buffer_load_dwordx4 v8, s[8:11], s30 offen offset:2048 lds
    v_mfma_f32_16x16x32_bf16 v[64:67], a[116:119], a[28:31], v[64:67]
    s_add_u32 m0, s25, 110592
    ds_read_b64_tr_b16 a[102:103], v0 offset:18688
    v_mfma_f32_16x16x32_bf16 v[64:67], a[112:115], a[8:11], v[64:67]
    s_mov_b32 s31, 5111808
    ds_read_b128 a[40:43], v4 offset:0
    v_mfma_f32_16x16x32_bf16 v[60:63], a[112:115], a[4:7], v[60:63]
    s_mov_b32 s29, 32768
    buffer_store_dwordx4 a[196:199], v14, s[20:23], s29 offen sc1
    v_mfma_f32_16x16x32_bf16 v[60:63], a[116:119], a[24:27], v[60:63]
    ds_read_b128 a[60:63], v5 offset:0
    v_mfma_f32_16x16x32_bf16 v[56:59], a[116:119], a[20:23], v[56:59]
    ds_read_b128 a[44:47], v4 offset:2048
    v_mfma_f32_16x16x32_bf16 v[56:59], a[112:115], a[0:3], v[56:59]
    buffer_load_dwordx4 v6, s[8:11], s31 offen lds
    v_mfma_f32_16x16x32_bf16 v[176:179], a[120:123], a[0:3], v[176:179]
    ds_read_b128 a[64:67], v5 offset:2048
    v_mfma_f32_16x16x32_bf16 v[176:179], a[124:127], a[20:23], v[176:179]
    ds_read_b128 a[48:51], v4 offset:4096
    v_mfma_f32_16x16x32_bf16 v[180:183], a[124:127], a[24:27], v[180:183]
    v_mfma_f32_16x16x32_bf16 v[180:183], a[120:123], a[4:7], v[180:183]
    v_mfma_f32_16x16x32_bf16 v[184:187], a[120:123], a[8:11], v[184:187]
    v_mfma_f32_16x16x32_bf16 v[184:187], a[124:127], a[28:31], v[184:187]
    buffer_load_dwordx4 v7, s[8:11], s31 offen offset:1024 lds
    v_mfma_f32_16x16x32_bf16 v[188:191], a[124:127], a[32:35], v[188:191]
    v_mfma_f32_16x16x32_bf16 v[188:191], a[120:123], a[12:15], v[188:191]
    v_mfma_f32_16x16x32_bf16 v[192:195], a[120:123], a[16:19], v[192:195]
    v_mfma_f32_16x16x32_bf16 v[192:195], a[124:127], a[36:39], v[192:195]
    s_waitcnt lgkmcnt(0)
    v_mfma_f32_16x16x32_bf16 v[76:79], a[80:83], a[0:3], v[76:79]
    ds_read_b64_tr_b16 a[104:105], v1 offset:256
    v_mfma_f32_16x16x32_bf16 v[76:79], a[84:87], a[20:23], v[76:79]
    buffer_load_dwordx4 v8, s[8:11], s31 offen offset:2048 lds
    v_mfma_f32_16x16x32_bf16 v[80:83], a[84:87], a[24:27], v[80:83]
    s_lshl_b32 s35, s28, 2
    ds_read_b64_tr_b16 a[106:107], v1 offset:6400
    v_mfma_f32_16x16x32_bf16 v[80:83], a[80:83], a[4:7], v[80:83]
    s_add_u32 s35, s35, s24
    ds_read_b64_tr_b16 a[108:109], v1 offset:12544
    v_mfma_f32_16x16x32_bf16 v[84:87], a[80:83], a[8:11], v[84:87]
    s_add_u32 s34, s49, 3932160
    ds_read_b64_tr_b16 a[110:111], v1 offset:18688
    v_mfma_f32_16x16x32_bf16 v[84:87], a[84:87], a[28:31], v[84:87]
    s_cmp_eq_u32 s35, 4
    s_cselect_b32 s35, s34, 1879048192
    ds_read_b64_tr_b16 a[112:113], v2 offset:256
    v_mfma_f32_16x16x32_bf16 v[88:91], a[84:87], a[32:35], v[88:91]
    ds_read_b64_tr_b16 a[114:115], v2 offset:6400
    v_mfma_f32_16x16x32_bf16 v[88:91], a[80:83], a[12:15], v[88:91]
    buffer_load_dword a255, v15, s[72:75], s35 offen
    v_mfma_f32_16x16x32_bf16 v[92:95], a[80:83], a[16:19], v[92:95]
    ds_read_b64_tr_b16 a[116:117], v2 offset:12544
    v_mfma_f32_16x16x32_bf16 v[92:95], a[84:87], a[36:39], v[92:95]
    ds_read_b64_tr_b16 a[118:119], v2 offset:18688
    v_mfma_f32_16x16x32_bf16 v[212:215], a[92:95], a[36:39], v[212:215]
    ds_read_b64_tr_b16 a[120:121], v3 offset:256
    v_mfma_f32_16x16x32_bf16 v[212:215], a[88:91], a[16:19], v[212:215]
    ds_read_b64_tr_b16 a[122:123], v3 offset:6400
    v_mfma_f32_16x16x32_bf16 v[208:211], a[88:91], a[12:15], v[208:211]
    s_mov_b32 s29, 33792
    buffer_store_dwordx4 a[200:203], v14, s[20:23], s29 offen sc1
    v_mfma_f32_16x16x32_bf16 v[208:211], a[92:95], a[32:35], v[208:211]
    ds_read_b64_tr_b16 a[124:125], v3 offset:12544
    v_mfma_f32_16x16x32_bf16 v[204:207], a[92:95], a[28:31], v[204:207]
    ds_read_b64_tr_b16 a[126:127], v3 offset:18688
    v_mfma_f32_16x16x32_bf16 v[204:207], a[88:91], a[8:11], v[204:207]
    ds_read_b128 a[68:71], v5 offset:4096
    v_add_u32 v0, 0x6000, v0
    v_mfma_f32_16x16x32_bf16 v[200:203], a[88:91], a[4:7], v[200:203]
    ds_read_b128 a[52:55], v4 offset:6144
    v_add_u32 v1, 0x6000, v1
    v_mfma_f32_16x16x32_bf16 v[200:203], a[92:95], a[24:27], v[200:203]
    ds_read_b128 a[72:75], v5 offset:6144
    v_add_u32 v2, 0x6000, v2
    v_mfma_f32_16x16x32_bf16 v[196:199], a[92:95], a[20:23], v[196:199]
    ds_read_b128 a[56:59], v4 offset:8192
    v_add_u32 v3, 0x6000, v3
    v_mfma_f32_16x16x32_bf16 v[196:199], a[88:91], a[0:3], v[196:199]
    ds_read_b128 a[76:79], v5 offset:8192
    v_mfma_f32_16x16x32_bf16 v[96:99], a[96:99], a[0:3], v[96:99]
    v_mfma_f32_16x16x32_bf16 v[96:99], a[100:103], a[20:23], v[96:99]
    v_mfma_f32_16x16x32_bf16 v[100:103], a[100:103], a[24:27], v[100:103]
    v_mfma_f32_16x16x32_bf16 v[100:103], a[96:99], a[4:7], v[100:103]
    v_mfma_f32_16x16x32_bf16 v[104:107], a[96:99], a[8:11], v[104:107]
    v_mfma_f32_16x16x32_bf16 v[104:107], a[100:103], a[28:31], v[104:107]
    v_mfma_f32_16x16x32_bf16 v[108:111], a[100:103], a[32:35], v[108:111]
    v_mfma_f32_16x16x32_bf16 v[108:111], a[96:99], a[12:15], v[108:111]
    v_mfma_f32_16x16x32_bf16 v[112:115], a[96:99], a[16:19], v[112:115]
    s_waitcnt vmcnt(23) lgkmcnt(0)
    v_mfma_f32_16x16x32_bf16 v[112:115], a[100:103], a[36:39], v[112:115]

    s_barrier
    v_mfma_f32_16x16x32_bf16 v[216:219], a[104:107], a[0:3], v[216:219]
    s_add_u32 m0, s26, 122880
    ds_read_b64_tr_b16 a[80:81], v0 offset:0
    v_mfma_f32_16x16x32_bf16 v[216:219], a[108:111], a[20:23], v[216:219]
    s_mov_b32 s32, 896
    buffer_load_dwordx4 v9, s[4:7], s32 offen lds
    v_mfma_f32_16x16x32_bf16 v[220:223], a[108:111], a[24:27], v[220:223]
    s_mov_b32 s33, 10112
    ds_read_b64_tr_b16 a[82:83], v0 offset:6144
    v_mfma_f32_16x16x32_bf16 v[220:223], a[104:107], a[4:7], v[220:223]
    ds_read_b64_tr_b16 a[84:85], v0 offset:12288
    v_mfma_f32_16x16x32_bf16 v[224:227], a[104:107], a[8:11], v[224:227]
    ds_read_b64_tr_b16 a[86:87], v0 offset:18432
    v_mfma_f32_16x16x32_bf16 v[224:227], a[108:111], a[28:31], v[224:227]
    ds_read_b64_tr_b16 a[88:89], v1 offset:0
    v_mfma_f32_16x16x32_bf16 v[228:231], a[108:111], a[32:35], v[228:231]
    ds_read_b64_tr_b16 a[90:91], v1 offset:6144
    v_mfma_f32_16x16x32_bf16 v[228:231], a[104:107], a[12:15], v[228:231]
    buffer_load_dwordx4 v10, s[4:7], s33 offen offset:1024 lds
    v_mfma_f32_16x16x32_bf16 v[232:235], a[104:107], a[16:19], v[232:235]
    s_mov_b32 s32, 19328
    ds_read_b64_tr_b16 a[92:93], v1 offset:12288
    v_mfma_f32_16x16x32_bf16 v[232:235], a[108:111], a[36:39], v[232:235]
    s_mov_b32 s29, 34816
    buffer_store_dwordx4 a[204:207], v14, s[20:23], s29 offen sc1
    v_mfma_f32_16x16x32_bf16 v[132:135], a[116:119], a[36:39], v[132:135]
    ds_read_b64_tr_b16 a[94:95], v1 offset:18432
    v_mfma_f32_16x16x32_bf16 v[132:135], a[112:115], a[16:19], v[132:135]
    ds_read_b64_tr_b16 a[96:97], v2 offset:0
    v_mfma_f32_16x16x32_bf16 v[128:131], a[112:115], a[12:15], v[128:131]
    ds_read_b64_tr_b16 a[98:99], v2 offset:6144
    v_mfma_f32_16x16x32_bf16 v[128:131], a[116:119], a[32:35], v[128:131]
    buffer_load_dwordx4 v9, s[4:7], s32 offen offset:2048 lds
    v_mfma_f32_16x16x32_bf16 v[124:127], a[116:119], a[28:31], v[124:127]
    s_mov_b32 s33, 28544
    ds_read_b64_tr_b16 a[100:101], v2 offset:12288
    v_mfma_f32_16x16x32_bf16 v[124:127], a[112:115], a[8:11], v[124:127]
    ds_read_b64_tr_b16 a[102:103], v2 offset:18432
    v_mfma_f32_16x16x32_bf16 v[120:123], a[112:115], a[4:7], v[120:123]
    v_mfma_f32_16x16x32_bf16 v[120:123], a[116:119], a[24:27], v[120:123]
    v_mfma_f32_16x16x32_bf16 v[116:119], a[116:119], a[20:23], v[116:119]
    v_mfma_f32_16x16x32_bf16 v[116:119], a[112:115], a[0:3], v[116:119]
    buffer_load_dwordx4 v10, s[4:7], s33 offen offset:3072 lds
    v_mfma_f32_16x16x32_bf16 v[236:239], a[120:123], a[0:3], v[236:239]
    s_add_u32 m0, s26, 126976
    v_mfma_f32_16x16x32_bf16 v[236:239], a[124:127], a[20:23], v[236:239]
    s_mov_b32 s32, 41856
    v_mfma_f32_16x16x32_bf16 v[240:243], a[124:127], a[24:27], v[240:243]
    v_mfma_f32_16x16x32_bf16 v[240:243], a[120:123], a[4:7], v[240:243]
    v_mfma_f32_16x16x32_bf16 v[244:247], a[120:123], a[8:11], v[244:247]
    v_mfma_f32_16x16x32_bf16 v[244:247], a[124:127], a[28:31], v[244:247]
    buffer_load_dwordx4 v9, s[4:7], s32 offen lds
    v_mfma_f32_16x16x32_bf16 v[248:251], a[124:127], a[32:35], v[248:251]
    s_mov_b32 s33, 51072
    v_mfma_f32_16x16x32_bf16 v[248:251], a[120:123], a[12:15], v[248:251]
    v_mfma_f32_16x16x32_bf16 v[252:255], a[120:123], a[16:19], v[252:255]
    v_mfma_f32_16x16x32_bf16 v[252:255], a[124:127], a[36:39], v[252:255]
    s_waitcnt lgkmcnt(0)
    v_mfma_f32_16x16x32_bf16 v[16:19], a[80:83], a[40:43], v[16:19]
    ds_read_b64_tr_b16 a[104:105], v3 offset:0
    v_mfma_f32_16x16x32_bf16 v[16:19], a[84:87], a[60:63], v[16:19]
    buffer_load_dwordx4 v10, s[4:7], s33 offen offset:1024 lds
    v_mfma_f32_16x16x32_bf16 v[20:23], a[84:87], a[64:67], v[20:23]
    s_mov_b32 s32, 60288
    ds_read_b64_tr_b16 a[106:107], v3 offset:6144
    v_add_u32 v4, 0xfffe2000, v4
    v_mfma_f32_16x16x32_bf16 v[20:23], a[80:83], a[44:47], v[20:23]
    ds_read_b64_tr_b16 a[108:109], v3 offset:12288
    v_add_u32 v5, 0xfffe2000, v5
    v_mfma_f32_16x16x32_bf16 v[24:27], a[80:83], a[48:51], v[24:27]
    ds_read_b64_tr_b16 a[110:111], v3 offset:18432
    v_mfma_f32_16x16x32_bf16 v[24:27], a[84:87], a[68:71], v[24:27]
    ds_read_b64_tr_b16 a[112:113], v0 offset:128
    v_mfma_f32_16x16x32_bf16 v[28:31], a[84:87], a[72:75], v[28:31]
    ds_read_b64_tr_b16 a[114:115], v0 offset:6272
    v_mfma_f32_16x16x32_bf16 v[28:31], a[80:83], a[52:55], v[28:31]
    buffer_load_dwordx4 v9, s[4:7], s32 offen offset:2048 lds
    v_mfma_f32_16x16x32_bf16 v[32:35], a[80:83], a[56:59], v[32:35]
    s_mov_b32 s33, 69504
    ds_read_b64_tr_b16 a[116:117], v0 offset:12416
    v_mfma_f32_16x16x32_bf16 v[32:35], a[84:87], a[76:79], v[32:35]
    s_mov_b32 s29, 40960
    buffer_store_dwordx4 a[208:211], v14, s[20:23], s29 offen sc1
    v_mfma_f32_16x16x32_bf16 v[152:155], a[92:95], a[76:79], v[152:155]
    ds_read_b64_tr_b16 a[118:119], v0 offset:18560
    v_mfma_f32_16x16x32_bf16 v[152:155], a[88:91], a[56:59], v[152:155]
    ds_read_b64_tr_b16 a[120:121], v1 offset:128
    v_mfma_f32_16x16x32_bf16 v[148:151], a[88:91], a[52:55], v[148:151]
    ds_read_b64_tr_b16 a[122:123], v1 offset:6272
    v_mfma_f32_16x16x32_bf16 v[148:151], a[92:95], a[72:75], v[148:151]
    buffer_load_dwordx4 v10, s[4:7], s33 offen offset:3072 lds
    v_mfma_f32_16x16x32_bf16 v[144:147], a[92:95], a[68:71], v[144:147]
    s_add_u32 m0, s26, 131072
    ds_read_b64_tr_b16 a[124:125], v1 offset:12416
    v_mfma_f32_16x16x32_bf16 v[144:147], a[88:91], a[48:51], v[144:147]
    s_mov_b32 s32, 82816
    ds_read_b64_tr_b16 a[126:127], v1 offset:18560
    v_mfma_f32_16x16x32_bf16 v[140:143], a[88:91], a[44:47], v[140:143]
    v_mfma_f32_16x16x32_bf16 v[140:143], a[92:95], a[64:67], v[140:143]
    v_mfma_f32_16x16x32_bf16 v[136:139], a[92:95], a[60:63], v[136:139]
    v_mfma_f32_16x16x32_bf16 v[136:139], a[88:91], a[40:43], v[136:139]
    buffer_load_dwordx4 v9, s[4:7], s32 offen lds
    v_mfma_f32_16x16x32_bf16 v[36:39], a[96:99], a[40:43], v[36:39]
    s_mov_b32 s33, 92032
    v_mfma_f32_16x16x32_bf16 v[36:39], a[100:103], a[60:63], v[36:39]
    v_mfma_f32_16x16x32_bf16 v[40:43], a[100:103], a[64:67], v[40:43]
    v_mfma_f32_16x16x32_bf16 v[40:43], a[96:99], a[44:47], v[40:43]
    v_mfma_f32_16x16x32_bf16 v[44:47], a[96:99], a[48:51], v[44:47]
    v_mfma_f32_16x16x32_bf16 v[44:47], a[100:103], a[68:71], v[44:47]
    buffer_load_dwordx4 v10, s[4:7], s33 offen offset:1024 lds
    v_mfma_f32_16x16x32_bf16 v[48:51], a[100:103], a[72:75], v[48:51]
    s_add_u32 m0, s25, 49152
    v_mfma_f32_16x16x32_bf16 v[48:51], a[96:99], a[52:55], v[48:51]
    s_mov_b32 s30, 5505024
    v_mfma_f32_16x16x32_bf16 v[52:55], a[96:99], a[56:59], v[52:55]
    v_mfma_f32_16x16x32_bf16 v[52:55], a[100:103], a[76:79], v[52:55]
    s_waitcnt lgkmcnt(0)
    v_mfma_f32_16x16x32_bf16 v[156:159], a[104:107], a[40:43], v[156:159]
    ds_read_b64_tr_b16 a[80:81], v2 offset:128
    v_mfma_f32_16x16x32_bf16 v[156:159], a[108:111], a[60:63], v[156:159]
    buffer_load_dwordx4 v6, s[8:11], s30 offen lds
    v_mfma_f32_16x16x32_bf16 v[160:163], a[108:111], a[64:67], v[160:163]
    ds_read_b64_tr_b16 a[82:83], v2 offset:6272
    v_mfma_f32_16x16x32_bf16 v[160:163], a[104:107], a[44:47], v[160:163]
    s_mov_b32 s29, 41984
    buffer_store_dwordx4 a[212:215], v14, s[20:23], s29 offen sc1
    v_mfma_f32_16x16x32_bf16 v[164:167], a[104:107], a[48:51], v[164:167]
    ds_read_b64_tr_b16 a[84:85], v2 offset:12416
    v_mfma_f32_16x16x32_bf16 v[164:167], a[108:111], a[68:71], v[164:167]
    ds_read_b64_tr_b16 a[86:87], v2 offset:18560
    v_mfma_f32_16x16x32_bf16 v[168:171], a[108:111], a[72:75], v[168:171]
    ds_read_b64_tr_b16 a[88:89], v3 offset:128
    v_mfma_f32_16x16x32_bf16 v[168:171], a[104:107], a[52:55], v[168:171]
    buffer_load_dwordx4 v7, s[8:11], s30 offen offset:1024 lds
    v_mfma_f32_16x16x32_bf16 v[172:175], a[104:107], a[56:59], v[172:175]
    ds_read_b64_tr_b16 a[90:91], v3 offset:6272
    v_mfma_f32_16x16x32_bf16 v[172:175], a[108:111], a[76:79], v[172:175]
    ds_read_b64_tr_b16 a[92:93], v3 offset:12416
    v_mfma_f32_16x16x32_bf16 v[72:75], a[116:119], a[76:79], v[72:75]
    ds_read_b64_tr_b16 a[94:95], v3 offset:18560
    v_mfma_f32_16x16x32_bf16 v[72:75], a[112:115], a[56:59], v[72:75]
    ds_read_b64_tr_b16 a[96:97], v0 offset:256
    v_mfma_f32_16x16x32_bf16 v[68:71], a[112:115], a[52:55], v[68:71]
    ds_read_b64_tr_b16 a[98:99], v0 offset:6400
    v_mfma_f32_16x16x32_bf16 v[68:71], a[116:119], a[72:75], v[68:71]
    s_waitcnt vmcnt(24)
    buffer_load_dwordx4 v8, s[8:11], s30 offen offset:2048 lds
    v_mfma_f32_16x16x32_bf16 v[64:67], a[116:119], a[68:71], v[64:67]
    s_add_u32 m0, s25, 61440
    ds_read_b64_tr_b16 a[100:101], v0 offset:12544
    v_mfma_f32_16x16x32_bf16 v[64:67], a[112:115], a[48:51], v[64:67]
    s_mov_b32 s31, 5898240
    ds_read_b64_tr_b16 a[102:103], v0 offset:18688
    v_mfma_f32_16x16x32_bf16 v[60:63], a[112:115], a[44:47], v[60:63]
    ds_read_b128 a[0:3], v4 offset:0
    v_mfma_f32_16x16x32_bf16 v[60:63], a[116:119], a[64:67], v[60:63]
    ds_read_b128 a[20:23], v5 offset:0
    v_mfma_f32_16x16x32_bf16 v[56:59], a[116:119], a[60:63], v[56:59]
    ds_read_b128 a[4:7], v4 offset:2048
    v_mfma_f32_16x16x32_bf16 v[56:59], a[112:115], a[40:43], v[56:59]
    buffer_load_dwordx4 v6, s[8:11], s31 offen lds
    v_mfma_f32_16x16x32_bf16 v[176:179], a[120:123], a[40:43], v[176:179]
    ds_read_b128 a[24:27], v5 offset:2048
    v_mfma_f32_16x16x32_bf16 v[176:179], a[124:127], a[60:63], v[176:179]
    ds_read_b128 a[8:11], v4 offset:4096
    v_mfma_f32_16x16x32_bf16 v[180:183], a[124:127], a[64:67], v[180:183]
    v_mfma_f32_16x16x32_bf16 v[180:183], a[120:123], a[44:47], v[180:183]
    v_mfma_f32_16x16x32_bf16 v[184:187], a[120:123], a[48:51], v[184:187]
    v_mfma_f32_16x16x32_bf16 v[184:187], a[124:127], a[68:71], v[184:187]
    buffer_load_dwordx4 v7, s[8:11], s31 offen offset:1024 lds
    v_mfma_f32_16x16x32_bf16 v[188:191], a[124:127], a[72:75], v[188:191]
    v_mfma_f32_16x16x32_bf16 v[188:191], a[120:123], a[52:55], v[188:191]
    v_mfma_f32_16x16x32_bf16 v[192:195], a[120:123], a[56:59], v[192:195]
    v_mfma_f32_16x16x32_bf16 v[192:195], a[124:127], a[76:79], v[192:195]
    s_waitcnt lgkmcnt(0)
    v_mfma_f32_16x16x32_bf16 v[76:79], a[80:83], a[40:43], v[76:79]
    ds_read_b64_tr_b16 a[104:105], v1 offset:256
    v_mfma_f32_16x16x32_bf16 v[76:79], a[84:87], a[60:63], v[76:79]
    buffer_load_dwordx4 v8, s[8:11], s31 offen offset:2048 lds
    v_mfma_f32_16x16x32_bf16 v[80:83], a[84:87], a[64:67], v[80:83]
    s_lshl_b32 s35, s28, 2
    ds_read_b64_tr_b16 a[106:107], v1 offset:6400
    v_mfma_f32_16x16x32_bf16 v[80:83], a[80:83], a[44:47], v[80:83]
    s_add_u32 s35, s35, s24
    ds_read_b64_tr_b16 a[108:109], v1 offset:12544
    v_mfma_f32_16x16x32_bf16 v[84:87], a[80:83], a[48:51], v[84:87]
    s_add_u32 s34, s49, 3932160
    ds_read_b64_tr_b16 a[110:111], v1 offset:18688
    v_mfma_f32_16x16x32_bf16 v[84:87], a[84:87], a[68:71], v[84:87]
    s_cmp_eq_u32 s35, 5
    s_cselect_b32 s35, s34, 1879048192
    ds_read_b64_tr_b16 a[112:113], v2 offset:256
    v_mfma_f32_16x16x32_bf16 v[88:91], a[84:87], a[72:75], v[88:91]
    ds_read_b64_tr_b16 a[114:115], v2 offset:6400
    v_mfma_f32_16x16x32_bf16 v[88:91], a[80:83], a[52:55], v[88:91]
    buffer_load_dword a255, v15, s[72:75], s35 offen
    v_mfma_f32_16x16x32_bf16 v[92:95], a[80:83], a[56:59], v[92:95]
    ds_read_b64_tr_b16 a[116:117], v2 offset:12544
    v_mfma_f32_16x16x32_bf16 v[92:95], a[84:87], a[76:79], v[92:95]
    s_mov_b32 s29, 43008
    buffer_store_dwordx4 a[216:219], v14, s[20:23], s29 offen sc1
    v_mfma_f32_16x16x32_bf16 v[212:215], a[92:95], a[76:79], v[212:215]
    ds_read_b64_tr_b16 a[118:119], v2 offset:18688
    v_mfma_f32_16x16x32_bf16 v[212:215], a[88:91], a[56:59], v[212:215]
    ds_read_b64_tr_b16 a[120:121], v3 offset:256
    v_mfma_f32_16x16x32_bf16 v[208:211], a[88:91], a[52:55], v[208:211]
    ds_read_b64_tr_b16 a[122:123], v3 offset:6400
    v_mfma_f32_16x16x32_bf16 v[208:211], a[92:95], a[72:75], v[208:211]
    ds_read_b64_tr_b16 a[124:125], v3 offset:12544
    v_mfma_f32_16x16x32_bf16 v[204:207], a[92:95], a[68:71], v[204:207]
    ds_read_b64_tr_b16 a[126:127], v3 offset:18688
    v_mfma_f32_16x16x32_bf16 v[204:207], a[88:91], a[48:51], v[204:207]
    ds_read_b128 a[28:31], v5 offset:4096
    v_add_u32 v0, 0x6000, v0
    v_mfma_f32_16x16x32_bf16 v[200:203], a[88:91], a[44:47], v[200:203]
    ds_read_b128 a[12:15], v4 offset:6144
    v_add_u32 v1, 0x6000, v1
    v_mfma_f32_16x16x32_bf16 v[200:203], a[92:95], a[64:67], v[200:203]
    ds_read_b128 a[32:35], v5 offset:6144
    v_add_u32 v2, 0x6000, v2
    v_mfma_f32_16x16x32_bf16 v[196:199], a[92:95], a[60:63], v[196:199]
    ds_read_b128 a[16:19], v4 offset:8192
    v_add_u32 v3, 0x6000, v3
    v_mfma_f32_16x16x32_bf16 v[196:199], a[88:91], a[40:43], v[196:199]
    ds_read_b128 a[36:39], v5 offset:8192
    v_mfma_f32_16x16x32_bf16 v[96:99], a[96:99], a[40:43], v[96:99]
    v_mfma_f32_16x16x32_bf16 v[96:99], a[100:103], a[60:63], v[96:99]
    v_mfma_f32_16x16x32_bf16 v[100:103], a[100:103], a[64:67], v[100:103]
    v_mfma_f32_16x16x32_bf16 v[100:103], a[96:99], a[44:47], v[100:103]
    v_mfma_f32_16x16x32_bf16 v[104:107], a[96:99], a[48:51], v[104:107]
    v_mfma_f32_16x16x32_bf16 v[104:107], a[100:103], a[68:71], v[104:107]
    v_mfma_f32_16x16x32_bf16 v[108:111], a[100:103], a[72:75], v[108:111]
    v_mfma_f32_16x16x32_bf16 v[108:111], a[96:99], a[52:55], v[108:111]
    s_mov_b32 s29, 44032
    buffer_store_dwordx4 a[220:223], v14, s[20:23], s29 offen sc1
    v_mfma_f32_16x16x32_bf16 v[112:115], a[96:99], a[56:59], v[112:115]
    s_waitcnt vmcnt(24) lgkmcnt(0)
    v_mfma_f32_16x16x32_bf16 v[112:115], a[100:103], a[76:79], v[112:115]

    s_barrier
    v_mfma_f32_16x16x32_bf16 v[216:219], a[104:107], a[40:43], v[216:219]
    s_add_u32 m0, s26, 0
    ds_read_b64_tr_b16 a[80:81], v0 offset:0
    v_mfma_f32_16x16x32_bf16 v[216:219], a[108:111], a[60:63], v[216:219]
    s_mov_b32 s32, 1024
    buffer_load_dwordx4 v9, s[4:7], s32 offen lds
    v_mfma_f32_16x16x32_bf16 v[220:223], a[108:111], a[64:67], v[220:223]
    s_mov_b32 s33, 10240
    ds_read_b64_tr_b16 a[82:83], v0 offset:6144
    v_mfma_f32_16x16x32_bf16 v[220:223], a[104:107], a[44:47], v[220:223]
    ds_read_b64_tr_b16 a[84:85], v0 offset:12288
    v_mfma_f32_16x16x32_bf16 v[224:227], a[104:107], a[48:51], v[224:227]
    ds_read_b64_tr_b16 a[86:87], v0 offset:18432
    v_mfma_f32_16x16x32_bf16 v[224:227], a[108:111], a[68:71], v[224:227]
    ds_read_b64_tr_b16 a[88:89], v1 offset:0
    v_mfma_f32_16x16x32_bf16 v[228:231], a[108:111], a[72:75], v[228:231]
    ds_read_b64_tr_b16 a[90:91], v1 offset:6144
    v_mfma_f32_16x16x32_bf16 v[228:231], a[104:107], a[52:55], v[228:231]
    buffer_load_dwordx4 v10, s[4:7], s33 offen offset:1024 lds
    v_mfma_f32_16x16x32_bf16 v[232:235], a[104:107], a[56:59], v[232:235]
    s_mov_b32 s32, 19456
    ds_read_b64_tr_b16 a[92:93], v1 offset:12288
    v_mfma_f32_16x16x32_bf16 v[232:235], a[108:111], a[76:79], v[232:235]
    ds_read_b64_tr_b16 a[94:95], v1 offset:18432
    v_mfma_f32_16x16x32_bf16 v[132:135], a[116:119], a[76:79], v[132:135]
    ds_read_b64_tr_b16 a[96:97], v2 offset:0
    v_mfma_f32_16x16x32_bf16 v[132:135], a[112:115], a[56:59], v[132:135]
    ds_read_b64_tr_b16 a[98:99], v2 offset:6144
    v_mfma_f32_16x16x32_bf16 v[128:131], a[112:115], a[52:55], v[128:131]
    ds_read_b64_tr_b16 a[100:101], v2 offset:12288
    v_mfma_f32_16x16x32_bf16 v[128:131], a[116:119], a[72:75], v[128:131]
    buffer_load_dwordx4 v9, s[4:7], s32 offen offset:2048 lds
    v_mfma_f32_16x16x32_bf16 v[124:127], a[116:119], a[68:71], v[124:127]
    s_mov_b32 s33, 28672
    ds_read_b64_tr_b16 a[102:103], v2 offset:18432
    v_mfma_f32_16x16x32_bf16 v[124:127], a[112:115], a[48:51], v[124:127]
    v_mfma_f32_16x16x32_bf16 v[120:123], a[112:115], a[44:47], v[120:123]
    v_mfma_f32_16x16x32_bf16 v[120:123], a[116:119], a[64:67], v[120:123]
    v_mfma_f32_16x16x32_bf16 v[116:119], a[116:119], a[60:63], v[116:119]
    v_mfma_f32_16x16x32_bf16 v[116:119], a[112:115], a[40:43], v[116:119]
    buffer_load_dwordx4 v10, s[4:7], s33 offen offset:3072 lds
    v_mfma_f32_16x16x32_bf16 v[236:239], a[120:123], a[40:43], v[236:239]
    s_add_u32 m0, s26, 4096
    v_mfma_f32_16x16x32_bf16 v[236:239], a[124:127], a[60:63], v[236:239]
    s_mov_b32 s32, 41984
    v_mfma_f32_16x16x32_bf16 v[240:243], a[124:127], a[64:67], v[240:243]
    v_mfma_f32_16x16x32_bf16 v[240:243], a[120:123], a[44:47], v[240:243]
    v_mfma_f32_16x16x32_bf16 v[244:247], a[120:123], a[48:51], v[244:247]
    v_mfma_f32_16x16x32_bf16 v[244:247], a[124:127], a[68:71], v[244:247]
    buffer_load_dwordx4 v9, s[4:7], s32 offen lds
    v_mfma_f32_16x16x32_bf16 v[248:251], a[124:127], a[72:75], v[248:251]
    s_mov_b32 s33, 51200
    v_mfma_f32_16x16x32_bf16 v[248:251], a[120:123], a[52:55], v[248:251]
    s_mov_b32 s29, 45056
    buffer_store_dwordx4 a[224:227], v14, s[20:23], s29 offen sc1
    v_mfma_f32_16x16x32_bf16 v[252:255], a[120:123], a[56:59], v[252:255]
    v_mfma_f32_16x16x32_bf16 v[252:255], a[124:127], a[76:79], v[252:255]
    s_waitcnt lgkmcnt(0)
    v_mfma_f32_16x16x32_bf16 v[16:19], a[80:83], a[0:3], v[16:19]
    ds_read_b64_tr_b16 a[104:105], v3 offset:0
    v_mfma_f32_16x16x32_bf16 v[16:19], a[84:87], a[20:23], v[16:19]
    buffer_load_dwordx4 v10, s[4:7], s33 offen offset:1024 lds
    v_mfma_f32_16x16x32_bf16 v[20:23], a[84:87], a[24:27], v[20:23]
    s_mov_b32 s32, 60416
    ds_read_b64_tr_b16 a[106:107], v3 offset:6144
    v_add_u32 v4, 0x1e000, v4
    v_mfma_f32_16x16x32_bf16 v[20:23], a[80:83], a[4:7], v[20:23]
    ds_read_b64_tr_b16 a[108:109], v3 offset:12288
    v_add_u32 v5, 0x1e000, v5
    v_mfma_f32_16x16x32_bf16 v[24:27], a[80:83], a[8:11], v[24:27]
    ds_read_b64_tr_b16 a[110:111], v3 offset:18432
    v_mfma_f32_16x16x32_bf16 v[24:27], a[84:87], a[28:31], v[24:27]
    ds_read_b64_tr_b16 a[112:113], v0 offset:128
    v_mfma_f32_16x16x32_bf16 v[28:31], a[84:87], a[32:35], v[28:31]
    ds_read_b64_tr_b16 a[114:115], v0 offset:6272
    v_mfma_f32_16x16x32_bf16 v[28:31], a[80:83], a[12:15], v[28:31]
    buffer_load_dwordx4 v9, s[4:7], s32 offen offset:2048 lds
    v_mfma_f32_16x16x32_bf16 v[32:35], a[80:83], a[16:19], v[32:35]
    s_mov_b32 s33, 69632
    ds_read_b64_tr_b16 a[116:117], v0 offset:12416
    v_mfma_f32_16x16x32_bf16 v[32:35], a[84:87], a[36:39], v[32:35]
    ds_read_b64_tr_b16 a[118:119], v0 offset:18560
    v_mfma_f32_16x16x32_bf16 v[152:155], a[92:95], a[36:39], v[152:155]
    ds_read_b64_tr_b16 a[120:121], v1 offset:128
    v_mfma_f32_16x16x32_bf16 v[152:155], a[88:91], a[16:19], v[152:155]
    ds_read_b64_tr_b16 a[122:123], v1 offset:6272
    v_mfma_f32_16x16x32_bf16 v[148:151], a[88:91], a[12:15], v[148:151]
    ds_read_b64_tr_b16 a[124:125], v1 offset:12416
    v_mfma_f32_16x16x32_bf16 v[148:151], a[92:95], a[32:35], v[148:151]
    buffer_load_dwordx4 v10, s[4:7], s33 offen offset:3072 lds
    v_mfma_f32_16x16x32_bf16 v[144:147], a[92:95], a[28:31], v[144:147]
    s_add_u32 m0, s26, 8192
    ds_read_b64_tr_b16 a[126:127], v1 offset:18560
    v_mfma_f32_16x16x32_bf16 v[144:147], a[88:91], a[8:11], v[144:147]
    s_mov_b32 s32, 82944
    v_mfma_f32_16x16x32_bf16 v[140:143], a[88:91], a[4:7], v[140:143]
    v_mfma_f32_16x16x32_bf16 v[140:143], a[92:95], a[24:27], v[140:143]
    v_mfma_f32_16x16x32_bf16 v[136:139], a[92:95], a[20:23], v[136:139]
    v_mfma_f32_16x16x32_bf16 v[136:139], a[88:91], a[0:3], v[136:139]
    buffer_load_dwordx4 v9, s[4:7], s32 offen lds
    v_mfma_f32_16x16x32_bf16 v[36:39], a[96:99], a[0:3], v[36:39]
    s_mov_b32 s33, 92160
    v_mfma_f32_16x16x32_bf16 v[36:39], a[100:103], a[20:23], v[36:39]
    s_mov_b32 s29, 51200
    buffer_store_dwordx4 a[228:231], v14, s[20:23], s29 offen sc1
    v_mfma_f32_16x16x32_bf16 v[40:43], a[100:103], a[24:27], v[40:43]
    v_mfma_f32_16x16x32_bf16 v[40:43], a[96:99], a[4:7], v[40:43]
    v_mfma_f32_16x16x32_bf16 v[44:47], a[96:99], a[8:11], v[44:47]
    v_mfma_f32_16x16x32_bf16 v[44:47], a[100:103], a[28:31], v[44:47]
    buffer_load_dwordx4 v10, s[4:7], s33 offen offset:1024 lds
    v_mfma_f32_16x16x32_bf16 v[48:51], a[100:103], a[32:35], v[48:51]
    s_add_u32 m0, s25, 73728
    v_mfma_f32_16x16x32_bf16 v[48:51], a[96:99], a[12:15], v[48:51]
    s_mov_b32 s30, 6291456
    v_mfma_f32_16x16x32_bf16 v[52:55], a[96:99], a[16:19], v[52:55]
    v_mfma_f32_16x16x32_bf16 v[52:55], a[100:103], a[36:39], v[52:55]
    s_waitcnt lgkmcnt(0)
    v_mfma_f32_16x16x32_bf16 v[156:159], a[104:107], a[0:3], v[156:159]
    ds_read_b64_tr_b16 a[80:81], v2 offset:128
    v_mfma_f32_16x16x32_bf16 v[156:159], a[108:111], a[20:23], v[156:159]
    buffer_load_dwordx4 v6, s[8:11], s30 offen lds
    v_mfma_f32_16x16x32_bf16 v[160:163], a[108:111], a[24:27], v[160:163]
    ds_read_b64_tr_b16 a[82:83], v2 offset:6272
    v_mfma_f32_16x16x32_bf16 v[160:163], a[104:107], a[4:7], v[160:163]
    ds_read_b64_tr_b16 a[84:85], v2 offset:12416
    v_mfma_f32_16x16x32_bf16 v[164:167], a[104:107], a[8:11], v[164:167]
    ds_read_b64_tr_b16 a[86:87], v2 offset:18560
    v_mfma_f32_16x16x32_bf16 v[164:167], a[108:111], a[28:31], v[164:167]
    ds_read_b64_tr_b16 a[88:89], v3 offset:128
    v_mfma_f32_16x16x32_bf16 v[168:171], a[108:111], a[32:35], v[168:171]
    ds_read_b64_tr_b16 a[90:91], v3 offset:6272
    v_mfma_f32_16x16x32_bf16 v[168:171], a[104:107], a[12:15], v[168:171]
    buffer_load_dwordx4 v7, s[8:11], s30 offen offset:1024 lds
    v_mfma_f32_16x16x32_bf16 v[172:175], a[104:107], a[16:19], v[172:175]
    ds_read_b64_tr_b16 a[92:93], v3 offset:12416
    v_mfma_f32_16x16x32_bf16 v[172:175], a[108:111], a[36:39], v[172:175]
    ds_read_b64_tr_b16 a[94:95], v3 offset:18560
    v_mfma_f32_16x16x32_bf16 v[72:75], a[116:119], a[36:39], v[72:75]
    ds_read_b64_tr_b16 a[96:97], v0 offset:256
    v_mfma_f32_16x16x32_bf16 v[72:75], a[112:115], a[16:19], v[72:75]
    ds_read_b64_tr_b16 a[98:99], v0 offset:6400
    v_mfma_f32_16x16x32_bf16 v[68:71], a[112:115], a[12:15], v[68:71]
    s_waitcnt vmcnt(24)
    ds_read_b64_tr_b16 a[100:101], v0 offset:12544
    v_mfma_f32_16x16x32_bf16 v[68:71], a[116:119], a[32:35], v[68:71]
    buffer_load_dwordx4 v8, s[8:11], s30 offen offset:2048 lds
    v_mfma_f32_16x16x32_bf16 v[64:67], a[116:119], a[28:31], v[64:67]
    s_add_u32 m0, s25, 86016
    ds_read_b64_tr_b16 a[102:103], v0 offset:18688
    v_mfma_f32_16x16x32_bf16 v[64:67], a[112:115], a[8:11], v[64:67]
    s_mov_b32 s31, 6684672
    ds_read_b128 a[40:43], v4 offset:0
    v_mfma_f32_16x16x32_bf16 v[60:63], a[112:115], a[4:7], v[60:63]
    ds_read_b128 a[60:63], v5 offset:0
    v_mfma_f32_16x16x32_bf16 v[60:63], a[116:119], a[24:27], v[60:63]
    ds_read_b128 a[44:47], v4 offset:2048
    v_mfma_f32_16x16x32_bf16 v[56:59], a[116:119], a[20:23], v[56:59]
    ds_read_b128 a[64:67], v5 offset:2048
    v_mfma_f32_16x16x32_bf16 v[56:59], a[112:115], a[0:3], v[56:59]
    buffer_load_dwordx4 v6, s[8:11], s31 offen lds
    v_mfma_f32_16x16x32_bf16 v[176:179], a[120:123], a[0:3], v[176:179]
    ds_read_b128 a[48:51], v4 offset:4096
    v_mfma_f32_16x16x32_bf16 v[176:179], a[124:127], a[20:23], v[176:179]
    s_mov_b32 s29, 52224
    buffer_store_dwordx4 a[232:235], v14, s[20:23], s29 offen sc1
    v_mfma_f32_16x16x32_bf16 v[180:183], a[124:127], a[24:27], v[180:183]
    v_mfma_f32_16x16x32_bf16 v[180:183], a[120:123], a[4:7], v[180:183]
    v_mfma_f32_16x16x32_bf16 v[184:187], a[120:123], a[8:11], v[184:187]
    v_mfma_f32_16x16x32_bf16 v[184:187], a[124:127], a[28:31], v[184:187]
    buffer_load_dwordx4 v7, s[8:11], s31 offen offset:1024 lds
    v_mfma_f32_16x16x32_bf16 v[188:191], a[124:127], a[32:35], v[188:191]
    v_mfma_f32_16x16x32_bf16 v[188:191], a[120:123], a[12:15], v[188:191]
    v_mfma_f32_16x16x32_bf16 v[192:195], a[120:123], a[16:19], v[192:195]
    v_mfma_f32_16x16x32_bf16 v[192:195], a[124:127], a[36:39], v[192:195]
    s_waitcnt lgkmcnt(0)
    v_mfma_f32_16x16x32_bf16 v[76:79], a[80:83], a[0:3], v[76:79]
    ds_read_b64_tr_b16 a[104:105], v1 offset:256
    v_mfma_f32_16x16x32_bf16 v[76:79], a[84:87], a[20:23], v[76:79]
    buffer_load_dwordx4 v8, s[8:11], s31 offen offset:2048 lds
    v_mfma_f32_16x16x32_bf16 v[80:83], a[84:87], a[24:27], v[80:83]
    s_lshl_b32 s35, s28, 2
    ds_read_b64_tr_b16 a[106:107], v1 offset:6400
    v_mfma_f32_16x16x32_bf16 v[80:83], a[80:83], a[4:7], v[80:83]
    s_add_u32 s35, s35, s24
    ds_read_b64_tr_b16 a[108:109], v1 offset:12544
    v_mfma_f32_16x16x32_bf16 v[84:87], a[80:83], a[8:11], v[84:87]
    s_add_u32 s34, s49, 3932160
    ds_read_b64_tr_b16 a[110:111], v1 offset:18688
    v_mfma_f32_16x16x32_bf16 v[84:87], a[84:87], a[28:31], v[84:87]
    s_cmp_eq_u32 s35, 6
    s_cselect_b32 s35, s34, 1879048192
    ds_read_b64_tr_b16 a[112:113], v2 offset:256
    v_mfma_f32_16x16x32_bf16 v[88:91], a[84:87], a[32:35], v[88:91]
    ds_read_b64_tr_b16 a[114:115], v2 offset:6400
    v_mfma_f32_16x16x32_bf16 v[88:91], a[80:83], a[12:15], v[88:91]
    buffer_load_dword a255, v15, s[72:75], s35 offen
    v_mfma_f32_16x16x32_bf16 v[92:95], a[80:83], a[16:19], v[92:95]
    ds_read_b64_tr_b16 a[116:117], v2 offset:12544
    v_mfma_f32_16x16x32_bf16 v[92:95], a[84:87], a[36:39], v[92:95]
    ds_read_b64_tr_b16 a[118:119], v2 offset:18688
    v_mfma_f32_16x16x32_bf16 v[212:215], a[92:95], a[36:39], v[212:215]
    ds_read_b64_tr_b16 a[120:121], v3 offset:256
    v_mfma_f32_16x16x32_bf16 v[212:215], a[88:91], a[16:19], v[212:215]
    ds_read_b64_tr_b16 a[122:123], v3 offset:6400
    v_mfma_f32_16x16x32_bf16 v[208:211], a[88:91], a[12:15], v[208:211]
    ds_read_b64_tr_b16 a[124:125], v3 offset:12544
    v_mfma_f32_16x16x32_bf16 v[208:211], a[92:95], a[32:35], v[208:211]
    ds_read_b64_tr_b16 a[126:127], v3 offset:18688
    v_mfma_f32_16x16x32_bf16 v[204:207], a[92:95], a[28:31], v[204:207]
    ds_read_b128 a[68:71], v5 offset:4096
    v_add_u32 v0, 0xffff4000, v0
    v_mfma_f32_16x16x32_bf16 v[204:207], a[88:91], a[8:11], v[204:207]
    s_mov_b32 s29, 53248
    buffer_store_dwordx4 a[236:239], v14, s[20:23], s29 offen sc1
    v_mfma_f32_16x16x32_bf16 v[200:203], a[88:91], a[4:7], v[200:203]
    ds_read_b128 a[52:55], v4 offset:6144
    v_add_u32 v1, 0xffff4000, v1
    v_mfma_f32_16x16x32_bf16 v[200:203], a[92:95], a[24:27], v[200:203]
    ds_read_b128 a[72:75], v5 offset:6144
    v_add_u32 v2, 0xffff4000, v2
    v_mfma_f32_16x16x32_bf16 v[196:199], a[92:95], a[20:23], v[196:199]
    ds_read_b128 a[56:59], v4 offset:8192
    v_add_u32 v3, 0xffff4000, v3
    v_mfma_f32_16x16x32_bf16 v[196:199], a[88:91], a[0:3], v[196:199]
    ds_read_b128 a[76:79], v5 offset:8192
    v_mfma_f32_16x16x32_bf16 v[96:99], a[96:99], a[0:3], v[96:99]
    v_mfma_f32_16x16x32_bf16 v[96:99], a[100:103], a[20:23], v[96:99]
    v_mfma_f32_16x16x32_bf16 v[100:103], a[100:103], a[24:27], v[100:103]
    v_mfma_f32_16x16x32_bf16 v[100:103], a[96:99], a[4:7], v[100:103]
    v_mfma_f32_16x16x32_bf16 v[104:107], a[96:99], a[8:11], v[104:107]
    v_mfma_f32_16x16x32_bf16 v[104:107], a[100:103], a[28:31], v[104:107]
    v_mfma_f32_16x16x32_bf16 v[108:111], a[100:103], a[32:35], v[108:111]
    v_mfma_f32_16x16x32_bf16 v[108:111], a[96:99], a[12:15], v[108:111]
    v_mfma_f32_16x16x32_bf16 v[112:115], a[96:99], a[16:19], v[112:115]
    s_waitcnt vmcnt(24) lgkmcnt(0)
    v_mfma_f32_16x16x32_bf16 v[112:115], a[100:103], a[36:39], v[112:115]

    s_barrier
    v_mfma_f32_16x16x32_bf16 v[216:219], a[104:107], a[0:3], v[216:219]
    s_add_u32 m0, s26, 122880
    ds_read_b64_tr_b16 a[80:81], v0 offset:0
    v_mfma_f32_16x16x32_bf16 v[216:219], a[108:111], a[20:23], v[216:219]
    s_mov_b32 s32, 1152
    buffer_load_dwordx4 v9, s[4:7], s32 offen lds
    v_mfma_f32_16x16x32_bf16 v[220:223], a[108:111], a[24:27], v[220:223]
    s_mov_b32 s33, 10368
    ds_read_b64_tr_b16 a[82:83], v0 offset:6144
    v_mfma_f32_16x16x32_bf16 v[220:223], a[104:107], a[4:7], v[220:223]
    ds_read_b64_tr_b16 a[84:85], v0 offset:12288
    v_mfma_f32_16x16x32_bf16 v[224:227], a[104:107], a[8:11], v[224:227]
    ds_read_b64_tr_b16 a[86:87], v0 offset:18432
    v_mfma_f32_16x16x32_bf16 v[224:227], a[108:111], a[28:31], v[224:227]
    ds_read_b64_tr_b16 a[88:89], v1 offset:0
    v_mfma_f32_16x16x32_bf16 v[228:231], a[108:111], a[32:35], v[228:231]
    ds_read_b64_tr_b16 a[90:91], v1 offset:6144
    v_mfma_f32_16x16x32_bf16 v[228:231], a[104:107], a[12:15], v[228:231]
    buffer_load_dwordx4 v10, s[4:7], s33 offen offset:1024 lds
    v_mfma_f32_16x16x32_bf16 v[232:235], a[104:107], a[16:19], v[232:235]
    s_mov_b32 s32, 19584
    ds_read_b64_tr_b16 a[92:93], v1 offset:12288
    v_mfma_f32_16x16x32_bf16 v[232:235], a[108:111], a[36:39], v[232:235]
    ds_read_b64_tr_b16 a[94:95], v1 offset:18432
    v_mfma_f32_16x16x32_bf16 v[132:135], a[116:119], a[36:39], v[132:135]
    ds_read_b64_tr_b16 a[96:97], v2 offset:0
    v_mfma_f32_16x16x32_bf16 v[132:135], a[112:115], a[16:19], v[132:135]
    ds_read_b64_tr_b16 a[98:99], v2 offset:6144
    v_mfma_f32_16x16x32_bf16 v[128:131], a[112:115], a[12:15], v[128:131]
    ds_read_b64_tr_b16 a[100:101], v2 offset:12288
    v_mfma_f32_16x16x32_bf16 v[128:131], a[116:119], a[32:35], v[128:131]
    buffer_load_dwordx4 v9, s[4:7], s32 offen offset:2048 lds
    v_mfma_f32_16x16x32_bf16 v[124:127], a[116:119], a[28:31], v[124:127]
    s_mov_b32 s33, 28800
    ds_read_b64_tr_b16 a[102:103], v2 offset:18432
    v_mfma_f32_16x16x32_bf16 v[124:127], a[112:115], a[8:11], v[124:127]
    v_mfma_f32_16x16x32_bf16 v[120:123], a[112:115], a[4:7], v[120:123]
    v_mfma_f32_16x16x32_bf16 v[120:123], a[116:119], a[24:27], v[120:123]
    v_mfma_f32_16x16x32_bf16 v[116:119], a[116:119], a[20:23], v[116:119]
    v_mfma_f32_16x16x32_bf16 v[116:119], a[112:115], a[0:3], v[116:119]
    buffer_load_dwordx4 v10, s[4:7], s33 offen offset:3072 lds
    v_mfma_f32_16x16x32_bf16 v[236:239], a[120:123], a[0:3], v[236:239]
    s_add_u32 m0, s26, 126976
    v_mfma_f32_16x16x32_bf16 v[236:239], a[124:127], a[20:23], v[236:239]
    s_mov_b32 s32, 42112
    v_mfma_f32_16x16x32_bf16 v[240:243], a[124:127], a[24:27], v[240:243]
    v_mfma_f32_16x16x32_bf16 v[240:243], a[120:123], a[4:7], v[240:243]
    v_mfma_f32_16x16x32_bf16 v[244:247], a[120:123], a[8:11], v[244:247]
    v_mfma_f32_16x16x32_bf16 v[244:247], a[124:127], a[28:31], v[244:247]
    buffer_load_dwordx4 v9, s[4:7], s32 offen lds
    v_mfma_f32_16x16x32_bf16 v[248:251], a[124:127], a[32:35], v[248:251]
    s_mov_b32 s33, 51328
    v_mfma_f32_16x16x32_bf16 v[248:251], a[120:123], a[12:15], v[248:251]
    v_mfma_f32_16x16x32_bf16 v[252:255], a[120:123], a[16:19], v[252:255]
    v_mfma_f32_16x16x32_bf16 v[252:255], a[124:127], a[36:39], v[252:255]
    s_waitcnt lgkmcnt(0)
    v_mfma_f32_16x16x32_bf16 v[16:19], a[80:83], a[40:43], v[16:19]
    ds_read_b64_tr_b16 a[104:105], v3 offset:0
    v_mfma_f32_16x16x32_bf16 v[16:19], a[84:87], a[60:63], v[16:19]
    buffer_load_dwordx4 v10, s[4:7], s33 offen offset:1024 lds
    v_mfma_f32_16x16x32_bf16 v[20:23], a[84:87], a[64:67], v[20:23]
    s_mov_b32 s32, 60544
    ds_read_b64_tr_b16 a[106:107], v3 offset:6144
    v_add_u32 v4, 0xfffe2000, v4
    v_mfma_f32_16x16x32_bf16 v[20:23], a[80:83], a[44:47], v[20:23]
    ds_read_b64_tr_b16 a[108:109], v3 offset:12288
    v_add_u32 v5, 0xfffe2000, v5
    v_mfma_f32_16x16x32_bf16 v[24:27], a[80:83], a[48:51], v[24:27]
    ds_read_b64_tr_b16 a[110:111], v3 offset:18432
    v_mfma_f32_16x16x32_bf16 v[24:27], a[84:87], a[68:71], v[24:27]
    ds_read_b64_tr_b16 a[112:113], v0 offset:128
    v_mfma_f32_16x16x32_bf16 v[28:31], a[84:87], a[72:75], v[28:31]
    ds_read_b64_tr_b16 a[114:115], v0 offset:6272
    v_mfma_f32_16x16x32_bf16 v[28:31], a[80:83], a[52:55], v[28:31]
    buffer_load_dwordx4 v9, s[4:7], s32 offen offset:2048 lds
    v_mfma_f32_16x16x32_bf16 v[32:35], a[80:83], a[56:59], v[32:35]
    s_mov_b32 s33, 69760
    ds_read_b64_tr_b16 a[116:117], v0 offset:12416
    v_mfma_f32_16x16x32_bf16 v[32:35], a[84:87], a[76:79], v[32:35]
    ds_read_b64_tr_b16 a[118:119], v0 offset:18560
    v_mfma_f32_16x16x32_bf16 v[152:155], a[92:95], a[76:79], v[152:155]
    ds_read_b64_tr_b16 a[120:121], v1 offset:128
    v_mfma_f32_16x16x32_bf16 v[152:155], a[88:91], a[56:59], v[152:155]
    ds_read_b64_tr_b16 a[122:123], v1 offset:6272
    v_mfma_f32_16x16x32_bf16 v[148:151], a[88:91], a[52:55], v[148:151]
    ds_read_b64_tr_b16 a[124:125], v1 offset:12416
    v_mfma_f32_16x16x32_bf16 v[148:151], a[92:95], a[72:75], v[148:151]
    buffer_load_dwordx4 v10, s[4:7], s33 offen offset:3072 lds
    v_mfma_f32_16x16x32_bf16 v[144:147], a[92:95], a[68:71], v[144:147]
    s_add_u32 m0, s26, 131072
    ds_read_b64_tr_b16 a[126:127], v1 offset:18560
    v_mfma_f32_16x16x32_bf16 v[144:147], a[88:91], a[48:51], v[144:147]
    s_mov_b32 s32, 83072
    v_mfma_f32_16x16x32_bf16 v[140:143], a[88:91], a[44:47], v[140:143]
    v_mfma_f32_16x16x32_bf16 v[140:143], a[92:95], a[64:67], v[140:143]
    v_mfma_f32_16x16x32_bf16 v[136:139], a[92:95], a[60:63], v[136:139]
    v_mfma_f32_16x16x32_bf16 v[136:139], a[88:91], a[40:43], v[136:139]
    buffer_load_dwordx4 v9, s[4:7], s32 offen lds
    v_mfma_f32_16x16x32_bf16 v[36:39], a[96:99], a[40:43], v[36:39]
    s_mov_b32 s33, 92288
    v_mfma_f32_16x16x32_bf16 v[36:39], a[100:103], a[60:63], v[36:39]
    v_mfma_f32_16x16x32_bf16 v[40:43], a[100:103], a[64:67], v[40:43]
    v_mfma_f32_16x16x32_bf16 v[40:43], a[96:99], a[44:47], v[40:43]
    v_mfma_f32_16x16x32_bf16 v[44:47], a[96:99], a[48:51], v[44:47]
    v_mfma_f32_16x16x32_bf16 v[44:47], a[100:103], a[68:71], v[44:47]
    buffer_load_dwordx4 v10, s[4:7], s33 offen offset:1024 lds
    v_mfma_f32_16x16x32_bf16 v[48:51], a[100:103], a[72:75], v[48:51]
    s_add_u32 m0, s25, 98304
    v_mfma_f32_16x16x32_bf16 v[48:51], a[96:99], a[52:55], v[48:51]
    s_mov_b32 s30, 7077888
    v_mfma_f32_16x16x32_bf16 v[52:55], a[96:99], a[56:59], v[52:55]
    v_mfma_f32_16x16x32_bf16 v[52:55], a[100:103], a[76:79], v[52:55]
    s_waitcnt lgkmcnt(0)
    v_mfma_f32_16x16x32_bf16 v[156:159], a[104:107], a[40:43], v[156:159]
    ds_read_b64_tr_b16 a[80:81], v2 offset:128
    v_mfma_f32_16x16x32_bf16 v[156:159], a[108:111], a[60:63], v[156:159]
    buffer_load_dwordx4 v6, s[8:11], s30 offen lds
    v_mfma_f32_16x16x32_bf16 v[160:163], a[108:111], a[64:67], v[160:163]
    ds_read_b64_tr_b16 a[82:83], v2 offset:6272
    v_mfma_f32_16x16x32_bf16 v[160:163], a[104:107], a[44:47], v[160:163]
    ds_read_b64_tr_b16 a[84:85], v2 offset:12416
    v_mfma_f32_16x16x32_bf16 v[164:167], a[104:107], a[48:51], v[164:167]
    ds_read_b64_tr_b16 a[86:87], v2 offset:18560
    v_mfma_f32_16x16x32_bf16 v[164:167], a[108:111], a[68:71], v[164:167]
    ds_read_b64_tr_b16 a[88:89], v3 offset:128
    v_mfma_f32_16x16x32_bf16 v[168:171], a[108:111], a[72:75], v[168:171]
    ds_read_b64_tr_b16 a[90:91], v3 offset:6272
    v_mfma_f32_16x16x32_bf16 v[168:171], a[104:107], a[52:55], v[168:171]
    buffer_load_dwordx4 v7, s[8:11], s30 offen offset:1024 lds
    v_mfma_f32_16x16x32_bf16 v[172:175], a[104:107], a[56:59], v[172:175]
    ds_read_b64_tr_b16 a[92:93], v3 offset:12416
    v_mfma_f32_16x16x32_bf16 v[172:175], a[108:111], a[76:79], v[172:175]
    ds_read_b64_tr_b16 a[94:95], v3 offset:18560
    v_mfma_f32_16x16x32_bf16 v[72:75], a[116:119], a[76:79], v[72:75]
    ds_read_b64_tr_b16 a[96:97], v0 offset:256
    v_mfma_f32_16x16x32_bf16 v[72:75], a[112:115], a[56:59], v[72:75]
    ds_read_b64_tr_b16 a[98:99], v0 offset:6400
    v_mfma_f32_16x16x32_bf16 v[68:71], a[112:115], a[52:55], v[68:71]
    s_waitcnt vmcnt(21)
    ds_read_b64_tr_b16 a[100:101], v0 offset:12544
    v_mfma_f32_16x16x32_bf16 v[68:71], a[116:119], a[72:75], v[68:71]
    buffer_load_dwordx4 v8, s[8:11], s30 offen offset:2048 lds
    v_mfma_f32_16x16x32_bf16 v[64:67], a[116:119], a[68:71], v[64:67]
    s_add_u32 m0, s25, 110592
    ds_read_b64_tr_b16 a[102:103], v0 offset:18688
    v_mfma_f32_16x16x32_bf16 v[64:67], a[112:115], a[48:51], v[64:67]
    s_mov_b32 s31, 7471104
    ds_read_b128 a[0:3], v4 offset:0
    v_mfma_f32_16x16x32_bf16 v[60:63], a[112:115], a[44:47], v[60:63]
    ds_read_b128 a[20:23], v5 offset:0
    v_mfma_f32_16x16x32_bf16 v[60:63], a[116:119], a[64:67], v[60:63]
    ds_read_b128 a[4:7], v4 offset:2048
    v_mfma_f32_16x16x32_bf16 v[56:59], a[116:119], a[60:63], v[56:59]
    ds_read_b128 a[24:27], v5 offset:2048
    v_mfma_f32_16x16x32_bf16 v[56:59], a[112:115], a[40:43], v[56:59]
    buffer_load_dwordx4 v6, s[8:11], s31 offen lds
    v_mfma_f32_16x16x32_bf16 v[176:179], a[120:123], a[40:43], v[176:179]
    ds_read_b128 a[8:11], v4 offset:4096
    v_mfma_f32_16x16x32_bf16 v[176:179], a[124:127], a[60:63], v[176:179]
    v_mfma_f32_16x16x32_bf16 v[180:183], a[124:127], a[64:67], v[180:183]
    v_mfma_f32_16x16x32_bf16 v[180:183], a[120:123], a[44:47], v[180:183]
    v_mfma_f32_16x16x32_bf16 v[184:187], a[120:123], a[48:51], v[184:187]
    v_mfma_f32_16x16x32_bf16 v[184:187], a[124:127], a[68:71], v[184:187]
    buffer_load_dwordx4 v7, s[8:11], s31 offen offset:1024 lds
    v_mfma_f32_16x16x32_bf16 v[188:191], a[124:127], a[72:75], v[188:191]
    v_mfma_f32_16x16x32_bf16 v[188:191], a[120:123], a[52:55], v[188:191]
    v_mfma_f32_16x16x32_bf16 v[192:195], a[120:123], a[56:59], v[192:195]
    v_mfma_f32_16x16x32_bf16 v[192:195], a[124:127], a[76:79], v[192:195]
    s_waitcnt lgkmcnt(0)
    v_mfma_f32_16x16x32_bf16 v[76:79], a[80:83], a[40:43], v[76:79]
    ds_read_b64_tr_b16 a[104:105], v1 offset:256
    v_mfma_f32_16x16x32_bf16 v[76:79], a[84:87], a[60:63], v[76:79]
    buffer_load_dwordx4 v8, s[8:11], s31 offen offset:2048 lds
    v_mfma_f32_16x16x32_bf16 v[80:83], a[84:87], a[64:67], v[80:83]
    s_lshl_b32 s35, s28, 2
    ds_read_b64_tr_b16 a[106:107], v1 offset:6400
    v_mfma_f32_16x16x32_bf16 v[80:83], a[80:83], a[44:47], v[80:83]
    s_add_u32 s35, s35, s24
    ds_read_b64_tr_b16 a[108:109], v1 offset:12544
    v_mfma_f32_16x16x32_bf16 v[84:87], a[80:83], a[48:51], v[84:87]
    s_add_u32 s34, s49, 3932160
    ds_read_b64_tr_b16 a[110:111], v1 offset:18688
    v_mfma_f32_16x16x32_bf16 v[84:87], a[84:87], a[68:71], v[84:87]
    s_cmp_eq_u32 s35, 7
    s_cselect_b32 s35, s34, 1879048192
    ds_read_b64_tr_b16 a[112:113], v2 offset:256
    v_mfma_f32_16x16x32_bf16 v[88:91], a[84:87], a[72:75], v[88:91]
    ds_read_b64_tr_b16 a[114:115], v2 offset:6400
    v_mfma_f32_16x16x32_bf16 v[88:91], a[80:83], a[52:55], v[88:91]
    buffer_load_dword a255, v15, s[72:75], s35 offen
    v_mfma_f32_16x16x32_bf16 v[92:95], a[80:83], a[56:59], v[92:95]
    ds_read_b64_tr_b16 a[116:117], v2 offset:12544
    v_mfma_f32_16x16x32_bf16 v[92:95], a[84:87], a[76:79], v[92:95]
    ds_read_b64_tr_b16 a[118:119], v2 offset:18688
    v_mfma_f32_16x16x32_bf16 v[212:215], a[92:95], a[76:79], v[212:215]
    ds_read_b64_tr_b16 a[120:121], v3 offset:256
    v_mfma_f32_16x16x32_bf16 v[212:215], a[88:91], a[56:59], v[212:215]
    ds_read_b64_tr_b16 a[122:123], v3 offset:6400
    v_mfma_f32_16x16x32_bf16 v[208:211], a[88:91], a[52:55], v[208:211]
    ds_read_b64_tr_b16 a[124:125], v3 offset:12544
    v_mfma_f32_16x16x32_bf16 v[208:211], a[92:95], a[72:75], v[208:211]
    ds_read_b64_tr_b16 a[126:127], v3 offset:18688
    v_mfma_f32_16x16x32_bf16 v[204:207], a[92:95], a[68:71], v[204:207]
    ds_read_b128 a[28:31], v5 offset:4096
    v_add_u32 v0, 0x6000, v0
    v_mfma_f32_16x16x32_bf16 v[204:207], a[88:91], a[48:51], v[204:207]
    ds_read_b128 a[12:15], v4 offset:6144
    v_add_u32 v1, 0x6000, v1
    v_mfma_f32_16x16x32_bf16 v[200:203], a[88:91], a[44:47], v[200:203]
    ds_read_b128 a[32:35], v5 offset:6144
    v_add_u32 v2, 0x6000, v2
    v_mfma_f32_16x16x32_bf16 v[200:203], a[92:95], a[64:67], v[200:203]
    ds_read_b128 a[16:19], v4 offset:8192
    v_add_u32 v3, 0x6000, v3
    v_mfma_f32_16x16x32_bf16 v[196:199], a[92:95], a[60:63], v[196:199]
    ds_read_b128 a[36:39], v5 offset:8192
    v_mfma_f32_16x16x32_bf16 v[196:199], a[88:91], a[40:43], v[196:199]
    v_mfma_f32_16x16x32_bf16 v[96:99], a[96:99], a[40:43], v[96:99]
    v_mfma_f32_16x16x32_bf16 v[96:99], a[100:103], a[60:63], v[96:99]
    v_mfma_f32_16x16x32_bf16 v[100:103], a[100:103], a[64:67], v[100:103]
    v_mfma_f32_16x16x32_bf16 v[100:103], a[96:99], a[44:47], v[100:103]
    v_mfma_f32_16x16x32_bf16 v[104:107], a[96:99], a[48:51], v[104:107]
    v_mfma_f32_16x16x32_bf16 v[104:107], a[100:103], a[68:71], v[104:107]
    v_mfma_f32_16x16x32_bf16 v[108:111], a[100:103], a[72:75], v[108:111]
    v_mfma_f32_16x16x32_bf16 v[108:111], a[96:99], a[52:55], v[108:111]
    v_mfma_f32_16x16x32_bf16 v[112:115], a[96:99], a[56:59], v[112:115]
    s_waitcnt vmcnt(17) lgkmcnt(0)
    v_mfma_f32_16x16x32_bf16 v[112:115], a[100:103], a[76:79], v[112:115]

    s_barrier
    s_cmp_lg_u32 s28, 3
    s_cbranch_scc1 L_nosig
    s_cmp_lg_u32 s24, 0
    s_cbranch_scc1 L_sig1
    v_accvgpr_write_b32 a254, s41
    s_mov_b64 exec, 1
    buffer_atomic_add a254, off, s[68:71], s80 sc1
    s_mov_b64 exec, -1
    L_sig1:
    s_add_u32 s80, s80, 128
L_nosig:
    v_mfma_f32_16x16x32_bf16 v[216:219], a[104:107], a[40:43], v[216:219]
    s_add_u32 m0, s27, 0
    ds_read_b64_tr_b16 a[80:81], v0 offset:0
    v_mfma_f32_16x16x32_bf16 v[216:219], a[108:111], a[60:63], v[216:219]
    s_mov_b32 s30, 0
    ds_read_b64_tr_b16 a[82:83], v0 offset:6144
    v_mfma_f32_16x16x32_bf16 v[220:223], a[108:111], a[64:67], v[220:223]
    buffer_load_dwordx4 v11, s[12:15], s30 offen nt lds
    v_mfma_f32_16x16x32_bf16 v[220:223], a[104:107], a[44:47], v[220:223]
    ds_read_b64_tr_b16 a[84:85], v0 offset:12288
    v_mfma_f32_16x16x32_bf16 v[224:227], a[104:107], a[48:51], v[224:227]
    ds_read_b64_tr_b16 a[86:87], v0 offset:18432
    v_mfma_f32_16x16x32_bf16 v[224:227], a[108:111], a[68:71], v[224:227]
    ds_read_b64_tr_b16 a[88:89], v1 offset:0
    v_mfma_f32_16x16x32_bf16 v[228:231], a[108:111], a[72:75], v[228:231]
    ds_read_b64_tr_b16 a[90:91], v1 offset:6144
    v_mfma_f32_16x16x32_bf16 v[228:231], a[104:107], a[52:55], v[228:231]
    ds_read_b64_tr_b16 a[92:93], v1 offset:12288
    v_mfma_f32_16x16x32_bf16 v[232:235], a[104:107], a[56:59], v[232:235]
    ds_read_b64_tr_b16 a[94:95], v1 offset:18432
    v_mfma_f32_16x16x32_bf16 v[232:235], a[108:111], a[76:79], v[232:235]
    ds_read_b64_tr_b16 a[96:97], v2 offset:0
    v_mfma_f32_16x16x32_bf16 v[132:135], a[116:119], a[76:79], v[132:135]
    ds_read_b64_tr_b16 a[98:99], v2 offset:6144
    v_mfma_f32_16x16x32_bf16 v[132:135], a[112:115], a[56:59], v[132:135]
    ds_read_b64_tr_b16 a[100:101], v2 offset:12288
    v_mfma_f32_16x16x32_bf16 v[128:131], a[112:115], a[52:55], v[128:131]
    ds_read_b64_tr_b16 a[102:103], v2 offset:18432
    v_mfma_f32_16x16x32_bf16 v[128:131], a[116:119], a[72:75], v[128:131]
    v_mfma_f32_16x16x32_bf16 v[124:127], a[116:119], a[68:71], v[124:127]
    v_mfma_f32_16x16x32_bf16 v[124:127], a[112:115], a[48:51], v[124:127]
    buffer_load_dwordx4 v12, s[12:15], s30 offen offset:1024 nt lds
    v_mfma_f32_16x16x32_bf16 v[120:123], a[112:115], a[44:47], v[120:123]
    v_mfma_f32_16x16x32_bf16 v[120:123], a[116:119], a[64:67], v[120:123]
    v_mfma_f32_16x16x32_bf16 v[116:119], a[116:119], a[60:63], v[116:119]
    v_mfma_f32_16x16x32_bf16 v[116:119], a[112:115], a[40:43], v[116:119]
    v_mfma_f32_16x16x32_bf16 v[236:239], a[120:123], a[40:43], v[236:239]
    v_mfma_f32_16x16x32_bf16 v[236:239], a[124:127], a[60:63], v[236:239]
    v_mfma_f32_16x16x32_bf16 v[240:243], a[124:127], a[64:67], v[240:243]
    v_mfma_f32_16x16x32_bf16 v[240:243], a[120:123], a[44:47], v[240:243]
    v_mfma_f32_16x16x32_bf16 v[244:247], a[120:123], a[48:51], v[244:247]
    v_mfma_f32_16x16x32_bf16 v[244:247], a[124:127], a[68:71], v[244:247]
    v_mfma_f32_16x16x32_bf16 v[248:251], a[124:127], a[72:75], v[248:251]
    v_mfma_f32_16x16x32_bf16 v[248:251], a[120:123], a[52:55], v[248:251]
    v_mfma_f32_16x16x32_bf16 v[252:255], a[120:123], a[56:59], v[252:255]
    buffer_load_dwordx4 v13, s[12:15], s30 offen offset:2048 nt lds
    v_mfma_f32_16x16x32_bf16 v[252:255], a[124:127], a[76:79], v[252:255]
    s_waitcnt lgkmcnt(0)
    v_mfma_f32_16x16x32_bf16 v[16:19], a[80:83], a[0:3], v[16:19]
    s_add_u32 m0, s27, 6144
    ds_read_b64_tr_b16 a[104:105], v3 offset:0
    v_mfma_f32_16x16x32_bf16 v[16:19], a[84:87], a[20:23], v[16:19]
    s_mov_b32 s31, 6144
    ds_read_b64_tr_b16 a[106:107], v3 offset:6144
    v_mfma_f32_16x16x32_bf16 v[20:23], a[84:87], a[24:27], v[20:23]
    ds_read_b64_tr_b16 a[108:109], v3 offset:12288
    v_add_u32 v4, 0x1e000, v4
    v_mfma_f32_16x16x32_bf16 v[20:23], a[80:83], a[4:7], v[20:23]
    ds_read_b64_tr_b16 a[110:111], v3 offset:18432
    v_add_u32 v5, 0x1e000, v5
    v_mfma_f32_16x16x32_bf16 v[24:27], a[80:83], a[8:11], v[24:27]
    ds_read_b64_tr_b16 a[112:113], v0 offset:128
    v_mfma_f32_16x16x32_bf16 v[24:27], a[84:87], a[28:31], v[24:27]
    ds_read_b64_tr_b16 a[114:115], v0 offset:6272
    v_mfma_f32_16x16x32_bf16 v[28:31], a[84:87], a[32:35], v[28:31]
    ds_read_b64_tr_b16 a[116:117], v0 offset:12416
    v_mfma_f32_16x16x32_bf16 v[28:31], a[80:83], a[12:15], v[28:31]
    ds_read_b64_tr_b16 a[118:119], v0 offset:18560
    v_mfma_f32_16x16x32_bf16 v[32:35], a[80:83], a[16:19], v[32:35]
    ds_read_b64_tr_b16 a[120:121], v1 offset:128
    v_mfma_f32_16x16x32_bf16 v[32:35], a[84:87], a[36:39], v[32:35]
    ds_read_b64_tr_b16 a[122:123], v1 offset:6272
    v_mfma_f32_16x16x32_bf16 v[152:155], a[92:95], a[36:39], v[152:155]
    ds_read_b64_tr_b16 a[124:125], v1 offset:12416
    v_mfma_f32_16x16x32_bf16 v[152:155], a[88:91], a[16:19], v[152:155]
    buffer_load_dwordx4 v11, s[12:15], s31 offen nt lds
    v_mfma_f32_16x16x32_bf16 v[148:151], a[88:91], a[12:15], v[148:151]
    ds_read_b64_tr_b16 a[126:127], v1 offset:18560
    v_mfma_f32_16x16x32_bf16 v[148:151], a[92:95], a[32:35], v[148:151]
    v_mfma_f32_16x16x32_bf16 v[144:147], a[92:95], a[28:31], v[144:147]
    v_mfma_f32_16x16x32_bf16 v[144:147], a[88:91], a[8:11], v[144:147]
    v_mfma_f32_16x16x32_bf16 v[140:143], a[88:91], a[4:7], v[140:143]
    v_mfma_f32_16x16x32_bf16 v[140:143], a[92:95], a[24:27], v[140:143]
    v_mfma_f32_16x16x32_bf16 v[136:139], a[92:95], a[20:23], v[136:139]
    v_mfma_f32_16x16x32_bf16 v[136:139], a[88:91], a[0:3], v[136:139]
    v_mfma_f32_16x16x32_bf16 v[36:39], a[96:99], a[0:3], v[36:39]
    v_mfma_f32_16x16x32_bf16 v[36:39], a[100:103], a[20:23], v[36:39]
    v_mfma_f32_16x16x32_bf16 v[40:43], a[100:103], a[24:27], v[40:43]
    v_mfma_f32_16x16x32_bf16 v[40:43], a[96:99], a[4:7], v[40:43]
    v_mfma_f32_16x16x32_bf16 v[44:47], a[96:99], a[8:11], v[44:47]
    buffer_load_dwordx4 v12, s[12:15], s31 offen offset:1024 nt lds
    v_mfma_f32_16x16x32_bf16 v[44:47], a[100:103], a[28:31], v[44:47]
    v_mfma_f32_16x16x32_bf16 v[48:51], a[100:103], a[32:35], v[48:51]
    v_mfma_f32_16x16x32_bf16 v[48:51], a[96:99], a[12:15], v[48:51]
    v_mfma_f32_16x16x32_bf16 v[52:55], a[96:99], a[16:19], v[52:55]
    v_mfma_f32_16x16x32_bf16 v[52:55], a[100:103], a[36:39], v[52:55]
    s_waitcnt lgkmcnt(0)
    v_mfma_f32_16x16x32_bf16 v[156:159], a[104:107], a[0:3], v[156:159]
    ds_read_b64_tr_b16 a[80:81], v2 offset:128
    v_mfma_f32_16x16x32_bf16 v[156:159], a[108:111], a[20:23], v[156:159]
    ds_read_b64_tr_b16 a[82:83], v2 offset:6272
    v_mfma_f32_16x16x32_bf16 v[160:163], a[108:111], a[24:27], v[160:163]
    ds_read_b64_tr_b16 a[84:85], v2 offset:12416
    v_mfma_f32_16x16x32_bf16 v[160:163], a[104:107], a[4:7], v[160:163]
    ds_read_b64_tr_b16 a[86:87], v2 offset:18560
    v_mfma_f32_16x16x32_bf16 v[164:167], a[104:107], a[8:11], v[164:167]
    ds_read_b64_tr_b16 a[88:89], v3 offset:128
    v_mfma_f32_16x16x32_bf16 v[164:167], a[108:111], a[28:31], v[164:167]
    ds_read_b64_tr_b16 a[90:91], v3 offset:6272
    v_mfma_f32_16x16x32_bf16 v[168:171], a[108:111], a[32:35], v[168:171]
    ds_read_b64_tr_b16 a[92:93], v3 offset:12416
    v_mfma_f32_16x16x32_bf16 v[168:171], a[104:107], a[12:15], v[168:171]
    buffer_load_dwordx4 v13, s[12:15], s31 offen offset:2048 nt lds
    v_mfma_f32_16x16x32_bf16 v[172:175], a[104:107], a[16:19], v[172:175]
    s_add_u32 m0, s27, 12288
    ds_read_b64_tr_b16 a[94:95], v3 offset:18560
    v_mfma_f32_16x16x32_bf16 v[172:175], a[108:111], a[36:39], v[172:175]
    s_mov_b32 s30, 12288
    ds_read_b64_tr_b16 a[96:97], v0 offset:256
    v_mfma_f32_16x16x32_bf16 v[72:75], a[116:119], a[36:39], v[72:75]
    s_waitcnt vmcnt(13)
    ds_read_b64_tr_b16 a[98:99], v0 offset:6400
    v_mfma_f32_16x16x32_bf16 v[72:75], a[112:115], a[16:19], v[72:75]
    ds_read_b64_tr_b16 a[100:101], v0 offset:12544
    v_mfma_f32_16x16x32_bf16 v[68:71], a[112:115], a[12:15], v[68:71]
    ds_read_b64_tr_b16 a[102:103], v0 offset:18688
    v_mfma_f32_16x16x32_bf16 v[68:71], a[116:119], a[32:35], v[68:71]
    ds_read_b128 a[40:43], v4 offset:0
    v_mfma_f32_16x16x32_bf16 v[64:67], a[116:119], a[28:31], v[64:67]
    ds_read_b128 a[60:63], v5 offset:0
    v_mfma_f32_16x16x32_bf16 v[64:67], a[112:115], a[8:11], v[64:67]
    ds_read_b128 a[44:47], v4 offset:2048
    v_mfma_f32_16x16x32_bf16 v[60:63], a[112:115], a[4:7], v[60:63]
    ds_read_b128 a[64:67], v5 offset:2048
    v_mfma_f32_16x16x32_bf16 v[60:63], a[116:119], a[24:27], v[60:63]
    ds_read_b128 a[48:51], v4 offset:4096
    v_mfma_f32_16x16x32_bf16 v[56:59], a[116:119], a[20:23], v[56:59]
    v_mfma_f32_16x16x32_bf16 v[56:59], a[112:115], a[0:3], v[56:59]
    v_mfma_f32_16x16x32_bf16 v[176:179], a[120:123], a[0:3], v[176:179]
    buffer_load_dwordx4 v11, s[12:15], s30 offen nt lds
    v_mfma_f32_16x16x32_bf16 v[176:179], a[124:127], a[20:23], v[176:179]
    v_mfma_f32_16x16x32_bf16 v[180:183], a[124:127], a[24:27], v[180:183]
    v_mfma_f32_16x16x32_bf16 v[180:183], a[120:123], a[4:7], v[180:183]
    v_mfma_f32_16x16x32_bf16 v[184:187], a[120:123], a[8:11], v[184:187]
    v_mfma_f32_16x16x32_bf16 v[184:187], a[124:127], a[28:31], v[184:187]
    v_mfma_f32_16x16x32_bf16 v[188:191], a[124:127], a[32:35], v[188:191]
    v_mfma_f32_16x16x32_bf16 v[188:191], a[120:123], a[12:15], v[188:191]
    v_mfma_f32_16x16x32_bf16 v[192:195], a[120:123], a[16:19], v[192:195]
    v_mfma_f32_16x16x32_bf16 v[192:195], a[124:127], a[36:39], v[192:195]
    s_waitcnt lgkmcnt(0)
    v_mfma_f32_16x16x32_bf16 v[76:79], a[80:83], a[0:3], v[76:79]
    ds_read_b64_tr_b16 a[104:105], v1 offset:256
    v_mfma_f32_16x16x32_bf16 v[76:79], a[84:87], a[20:23], v[76:79]
    ds_read_b64_tr_b16 a[106:107], v1 offset:6400
    v_mfma_f32_16x16x32_bf16 v[80:83], a[84:87], a[24:27], v[80:83]
    ds_read_b64_tr_b16 a[108:109], v1 offset:12544
    v_mfma_f32_16x16x32_bf16 v[80:83], a[80:83], a[4:7], v[80:83]
    buffer_load_dwordx4 v12, s[12:15], s30 offen offset:1024 nt lds
    v_mfma_f32_16x16x32_bf16 v[84:87], a[80:83], a[8:11], v[84:87]
    ds_read_b64_tr_b16 a[110:111], v1 offset:18688
    v_mfma_f32_16x16x32_bf16 v[84:87], a[84:87], a[28:31], v[84:87]
    ds_read_b64_tr_b16 a[112:113], v2 offset:256
    v_mfma_f32_16x16x32_bf16 v[88:91], a[84:87], a[32:35], v[88:91]
    ds_read_b64_tr_b16 a[114:115], v2 offset:6400
    v_mfma_f32_16x16x32_bf16 v[88:91], a[80:83], a[12:15], v[88:91]
    ds_read_b64_tr_b16 a[116:117], v2 offset:12544
    v_mfma_f32_16x16x32_bf16 v[92:95], a[80:83], a[16:19], v[92:95]
    ds_read_b64_tr_b16 a[118:119], v2 offset:18688
    v_mfma_f32_16x16x32_bf16 v[92:95], a[84:87], a[36:39], v[92:95]
    ds_read_b64_tr_b16 a[120:121], v3 offset:256
    v_mfma_f32_16x16x32_bf16 v[212:215], a[92:95], a[36:39], v[212:215]
    ds_read_b64_tr_b16 a[122:123], v3 offset:6400
    v_mfma_f32_16x16x32_bf16 v[212:215], a[88:91], a[16:19], v[212:215]
    ds_read_b64_tr_b16 a[124:125], v3 offset:12544
    v_mfma_f32_16x16x32_bf16 v[208:211], a[88:91], a[12:15], v[208:211]
    ds_read_b64_tr_b16 a[126:127], v3 offset:18688
    v_mfma_f32_16x16x32_bf16 v[208:211], a[92:95], a[32:35], v[208:211]
    ds_read_b128 a[68:71], v5 offset:4096
    v_add_u32 v0, 0x6000, v0
    v_mfma_f32_16x16x32_bf16 v[204:207], a[92:95], a[28:31], v[204:207]
    ds_read_b128 a[52:55], v4 offset:6144
    v_add_u32 v1, 0x6000, v1
    v_mfma_f32_16x16x32_bf16 v[204:207], a[88:91], a[8:11], v[204:207]
    ds_read_b128 a[72:75], v5 offset:6144
    v_add_u32 v2, 0x6000, v2
    v_mfma_f32_16x16x32_bf16 v[200:203], a[88:91], a[4:7], v[200:203]
    buffer_load_dwordx4 v13, s[12:15], s30 offen offset:2048 nt lds
    v_mfma_f32_16x16x32_bf16 v[200:203], a[92:95], a[24:27], v[200:203]
    ds_read_b128 a[56:59], v4 offset:8192
    v_add_u32 v3, 0x6000, v3
    v_mfma_f32_16x16x32_bf16 v[196:199], a[92:95], a[20:23], v[196:199]
    ds_read_b128 a[76:79], v5 offset:8192
    v_mfma_f32_16x16x32_bf16 v[196:199], a[88:91], a[0:3], v[196:199]
    v_mfma_f32_16x16x32_bf16 v[96:99], a[96:99], a[0:3], v[96:99]
    v_mfma_f32_16x16x32_bf16 v[96:99], a[100:103], a[20:23], v[96:99]
    v_mfma_f32_16x16x32_bf16 v[100:103], a[100:103], a[24:27], v[100:103]
    v_mfma_f32_16x16x32_bf16 v[100:103], a[96:99], a[4:7], v[100:103]
    v_mfma_f32_16x16x32_bf16 v[104:107], a[96:99], a[8:11], v[104:107]
    v_mfma_f32_16x16x32_bf16 v[104:107], a[100:103], a[28:31], v[104:107]
    v_mfma_f32_16x16x32_bf16 v[108:111], a[100:103], a[32:35], v[108:111]
    v_mfma_f32_16x16x32_bf16 v[108:111], a[96:99], a[12:15], v[108:111]
    v_mfma_f32_16x16x32_bf16 v[112:115], a[96:99], a[16:19], v[112:115]
    s_waitcnt vmcnt(10) lgkmcnt(0)
    v_mfma_f32_16x16x32_bf16 v[112:115], a[100:103], a[36:39], v[112:115]

    s_barrier
    v_mfma_f32_16x16x32_bf16 v[216:219], a[104:107], a[0:3], v[216:219]
    s_add_u32 m0, s27, 61440
    ds_read_b64_tr_b16 a[80:81], v0 offset:0
    v_mfma_f32_16x16x32_bf16 v[216:219], a[108:111], a[20:23], v[216:219]
    s_mov_b32 s30, 18432
    ds_read_b64_tr_b16 a[82:83], v0 offset:6144
    v_mfma_f32_16x16x32_bf16 v[220:223], a[108:111], a[24:27], v[220:223]
    buffer_load_dwordx4 v11, s[12:15], s30 offen nt lds
    v_mfma_f32_16x16x32_bf16 v[220:223], a[104:107], a[4:7], v[220:223]
    ds_read_b64_tr_b16 a[84:85], v0 offset:12288
    v_mfma_f32_16x16x32_bf16 v[224:227], a[104:107], a[8:11], v[224:227]
    ds_read_b64_tr_b16 a[86:87], v0 offset:18432
    v_mfma_f32_16x16x32_bf16 v[224:227], a[108:111], a[28:31], v[224:227]
    ds_read_b64_tr_b16 a[88:89], v1 offset:0
    v_mfma_f32_16x16x32_bf16 v[228:231], a[108:111], a[32:35], v[228:231]
    ds_read_b64_tr_b16 a[90:91], v1 offset:6144
    v_mfma_f32_16x16x32_bf16 v[228:231], a[104:107], a[12:15], v[228:231]
    ds_read_b64_tr_b16 a[92:93], v1 offset:12288
    v_mfma_f32_16x16x32_bf16 v[232:235], a[104:107], a[16:19], v[232:235]
    ds_read_b64_tr_b16 a[94:95], v1 offset:18432
    v_mfma_f32_16x16x32_bf16 v[232:235], a[108:111], a[36:39], v[232:235]
    ds_read_b64_tr_b16 a[96:97], v2 offset:0
    v_mfma_f32_16x16x32_bf16 v[132:135], a[116:119], a[36:39], v[132:135]
    ds_read_b64_tr_b16 a[98:99], v2 offset:6144
    v_mfma_f32_16x16x32_bf16 v[132:135], a[112:115], a[16:19], v[132:135]
    ds_read_b64_tr_b16 a[100:101], v2 offset:12288
    v_mfma_f32_16x16x32_bf16 v[128:131], a[112:115], a[12:15], v[128:131]
    ds_read_b64_tr_b16 a[102:103], v2 offset:18432
    v_mfma_f32_16x16x32_bf16 v[128:131], a[116:119], a[32:35], v[128:131]
    v_mfma_f32_16x16x32_bf16 v[124:127], a[116:119], a[28:31], v[124:127]
    v_mfma_f32_16x16x32_bf16 v[124:127], a[112:115], a[8:11], v[124:127]
    v_mfma_f32_16x16x32_bf16 v[120:123], a[112:115], a[4:7], v[120:123]
    buffer_load_dwordx4 v12, s[12:15], s30 offen offset:1024 nt lds
    v_mfma_f32_16x16x32_bf16 v[120:123], a[116:119], a[24:27], v[120:123]
    v_mfma_f32_16x16x32_bf16 v[116:119], a[116:119], a[20:23], v[116:119]
    v_mfma_f32_16x16x32_bf16 v[116:119], a[112:115], a[0:3], v[116:119]
    v_mfma_f32_16x16x32_bf16 v[236:239], a[120:123], a[0:3], v[236:239]
    v_mfma_f32_16x16x32_bf16 v[236:239], a[124:127], a[20:23], v[236:239]
    v_mfma_f32_16x16x32_bf16 v[240:243], a[124:127], a[24:27], v[240:243]
    v_mfma_f32_16x16x32_bf16 v[240:243], a[120:123], a[4:7], v[240:243]
    v_mfma_f32_16x16x32_bf16 v[244:247], a[120:123], a[8:11], v[244:247]
    v_mfma_f32_16x16x32_bf16 v[244:247], a[124:127], a[28:31], v[244:247]
    v_mfma_f32_16x16x32_bf16 v[248:251], a[124:127], a[32:35], v[248:251]
    v_mfma_f32_16x16x32_bf16 v[248:251], a[120:123], a[12:15], v[248:251]
    v_mfma_f32_16x16x32_bf16 v[252:255], a[120:123], a[16:19], v[252:255]
    v_mfma_f32_16x16x32_bf16 v[252:255], a[124:127], a[36:39], v[252:255]
    s_waitcnt lgkmcnt(0)
    v_mfma_f32_16x16x32_bf16 v[16:19], a[80:83], a[40:43], v[16:19]
    buffer_load_dwordx4 v13, s[12:15], s30 offen offset:2048 nt lds
    v_mfma_f32_16x16x32_bf16 v[16:19], a[84:87], a[60:63], v[16:19]
    s_add_u32 m0, s27, 49152
    ds_read_b64_tr_b16 a[104:105], v3 offset:0
    v_mfma_f32_16x16x32_bf16 v[20:23], a[84:87], a[64:67], v[20:23]
    s_mov_b32 s31, 0
    ds_read_b64_tr_b16 a[106:107], v3 offset:6144
    v_add_u32 v4, 0xfffe2000, v4
    v_mfma_f32_16x16x32_bf16 v[20:23], a[80:83], a[44:47], v[20:23]
    ds_read_b64_tr_b16 a[108:109], v3 offset:12288
    v_add_u32 v5, 0xfffe2000, v5
    v_mfma_f32_16x16x32_bf16 v[24:27], a[80:83], a[48:51], v[24:27]
    ds_read_b64_tr_b16 a[110:111], v3 offset:18432
    v_mfma_f32_16x16x32_bf16 v[24:27], a[84:87], a[68:71], v[24:27]
    ds_read_b64_tr_b16 a[112:113], v0 offset:128
    v_mfma_f32_16x16x32_bf16 v[28:31], a[84:87], a[72:75], v[28:31]
    ds_read_b64_tr_b16 a[114:115], v0 offset:6272
    v_mfma_f32_16x16x32_bf16 v[28:31], a[80:83], a[52:55], v[28:31]
    ds_read_b64_tr_b16 a[116:117], v0 offset:12416
    v_mfma_f32_16x16x32_bf16 v[32:35], a[80:83], a[56:59], v[32:35]
    ds_read_b64_tr_b16 a[118:119], v0 offset:18560
    v_mfma_f32_16x16x32_bf16 v[32:35], a[84:87], a[76:79], v[32:35]
    ds_read_b64_tr_b16 a[120:121], v1 offset:128
    v_mfma_f32_16x16x32_bf16 v[152:155], a[92:95], a[76:79], v[152:155]
    ds_read_b64_tr_b16 a[122:123], v1 offset:6272
    v_mfma_f32_16x16x32_bf16 v[152:155], a[88:91], a[56:59], v[152:155]
    ds_read_b64_tr_b16 a[124:125], v1 offset:12416
    v_mfma_f32_16x16x32_bf16 v[148:151], a[88:91], a[52:55], v[148:151]
    ds_read_b64_tr_b16 a[126:127], v1 offset:18560
    v_mfma_f32_16x16x32_bf16 v[148:151], a[92:95], a[72:75], v[148:151]
    v_mfma_f32_16x16x32_bf16 v[144:147], a[92:95], a[68:71], v[144:147]
    buffer_load_dwordx4 v11, s[16:19], s31 offen nt lds
    v_mfma_f32_16x16x32_bf16 v[144:147], a[88:91], a[48:51], v[144:147]
    v_mfma_f32_16x16x32_bf16 v[140:143], a[88:91], a[44:47], v[140:143]
    v_mfma_f32_16x16x32_bf16 v[140:143], a[92:95], a[64:67], v[140:143]
    v_mfma_f32_16x16x32_bf16 v[136:139], a[92:95], a[60:63], v[136:139]
    v_mfma_f32_16x16x32_bf16 v[136:139], a[88:91], a[40:43], v[136:139]
    v_mfma_f32_16x16x32_bf16 v[36:39], a[96:99], a[40:43], v[36:39]
    v_mfma_f32_16x16x32_bf16 v[36:39], a[100:103], a[60:63], v[36:39]
    v_mfma_f32_16x16x32_bf16 v[40:43], a[100:103], a[64:67], v[40:43]
    v_mfma_f32_16x16x32_bf16 v[40:43], a[96:99], a[44:47], v[40:43]
    v_mfma_f32_16x16x32_bf16 v[44:47], a[96:99], a[48:51], v[44:47]
    v_mfma_f32_16x16x32_bf16 v[44:47], a[100:103], a[68:71], v[44:47]
    v_mfma_f32_16x16x32_bf16 v[48:51], a[100:103], a[72:75], v[48:51]
    v_mfma_f32_16x16x32_bf16 v[48:51], a[96:99], a[52:55], v[48:51]
    v_mfma_f32_16x16x32_bf16 v[52:55], a[96:99], a[56:59], v[52:55]
    buffer_load_dwordx4 v12, s[16:19], s31 offen offset:1024 nt lds
    v_mfma_f32_16x16x32_bf16 v[52:55], a[100:103], a[76:79], v[52:55]
    s_waitcnt lgkmcnt(0)
    v_mfma_f32_16x16x32_bf16 v[156:159], a[104:107], a[40:43], v[156:159]
    ds_read_b64_tr_b16 a[80:81], v2 offset:128
    v_accvgpr_read_b32 v14, a250
    v_mfma_f32_16x16x32_bf16 v[156:159], a[108:111], a[60:63], v[156:159]
    ds_read_b64_tr_b16 a[82:83], v2 offset:6272
    v_xor_b32 v15, 64, v14
    v_mfma_f32_16x16x32_bf16 v[160:163], a[108:111], a[64:67], v[160:163]
    ds_read_b64_tr_b16 a[84:85], v2 offset:12416
    v_mfma_f32_16x16x32_bf16 v[160:163], a[104:107], a[44:47], v[160:163]
    ds_read_b64_tr_b16 a[86:87], v2 offset:18560
    v_mfma_f32_16x16x32_bf16 v[164:167], a[104:107], a[48:51], v[164:167]
    ds_read_b64_tr_b16 a[88:89], v3 offset:128
    v_mfma_f32_16x16x32_bf16 v[164:167], a[108:111], a[68:71], v[164:167]
    ds_read_b64_tr_b16 a[90:91], v3 offset:6272
    v_mfma_f32_16x16x32_bf16 v[168:171], a[108:111], a[72:75], v[168:171]
    ds_read_b64_tr_b16 a[92:93], v3 offset:12416
    v_mfma_f32_16x16x32_bf16 v[168:171], a[104:107], a[52:55], v[168:171]
    ds_read_b64_tr_b16 a[94:95], v3 offset:18560
    v_mfma_f32_16x16x32_bf16 v[172:175], a[104:107], a[56:59], v[172:175]
    ds_read_b64_tr_b16 a[96:97], v0 offset:256
    v_mfma_f32_16x16x32_bf16 v[172:175], a[108:111], a[76:79], v[172:175]
    ds_read_b64_tr_b16 a[98:99], v0 offset:6400
    v_mfma_f32_16x16x32_bf16 v[72:75], a[116:119], a[76:79], v[72:75]
    ds_read_b64_tr_b16 a[100:101], v0 offset:12544
    v_mfma_f32_16x16x32_bf16 v[72:75], a[112:115], a[56:59], v[72:75]
    ds_read_b64_tr_b16 a[102:103], v0 offset:18688
    v_mfma_f32_16x16x32_bf16 v[68:71], a[112:115], a[52:55], v[68:71]
    buffer_load_dwordx4 v13, s[16:19], s31 offen offset:2048 nt lds
    v_mfma_f32_16x16x32_bf16 v[68:71], a[116:119], a[72:75], v[68:71]
    s_add_u32 m0, s27, 67584
    v_mfma_f32_16x16x32_bf16 v[64:67], a[116:119], a[68:71], v[64:67]
    s_mov_b32 s30, 24576
    v_mfma_f32_16x16x32_bf16 v[64:67], a[112:115], a[48:51], v[64:67]
    v_mfma_f32_16x16x32_bf16 v[60:63], a[112:115], a[44:47], v[60:63]
    v_mfma_f32_16x16x32_bf16 v[60:63], a[116:119], a[64:67], v[60:63]
    v_mfma_f32_16x16x32_bf16 v[56:59], a[116:119], a[60:63], v[56:59]
    v_mfma_f32_16x16x32_bf16 v[56:59], a[112:115], a[40:43], v[56:59]
    v_mfma_f32_16x16x32_bf16 v[176:179], a[120:123], a[40:43], v[176:179]
    v_mfma_f32_16x16x32_bf16 v[176:179], a[124:127], a[60:63], v[176:179]
    v_mfma_f32_16x16x32_bf16 v[180:183], a[124:127], a[64:67], v[180:183]
    v_mfma_f32_16x16x32_bf16 v[180:183], a[120:123], a[44:47], v[180:183]
    v_mfma_f32_16x16x32_bf16 v[184:187], a[120:123], a[48:51], v[184:187]
    v_mfma_f32_16x16x32_bf16 v[184:187], a[124:127], a[68:71], v[184:187]
    v_mfma_f32_16x16x32_bf16 v[188:191], a[124:127], a[72:75], v[188:191]
    buffer_load_dwordx4 v11, s[12:15], s30 offen nt lds
    v_mfma_f32_16x16x32_bf16 v[188:191], a[120:123], a[52:55], v[188:191]
    v_mfma_f32_16x16x32_bf16 v[192:195], a[120:123], a[56:59], v[192:195]
    v_mfma_f32_16x16x32_bf16 v[192:195], a[124:127], a[76:79], v[192:195]
    s_waitcnt lgkmcnt(0)
    v_mfma_f32_16x16x32_bf16 v[76:79], a[80:83], a[40:43], v[76:79]
    s_add_u32 s35, s48, 0xffff4000
    ds_read_b64_tr_b16 a[104:105], v1 offset:256
    v_mfma_f32_16x16x32_bf16 v[76:79], a[84:87], a[60:63], v[76:79]
    ds_read_b64_tr_b16 a[106:107], v1 offset:6400
    v_mfma_f32_16x16x32_bf16 v[80:83], a[84:87], a[64:67], v[80:83]
    ds_read_b64_tr_b16 a[108:109], v1 offset:12544
    v_mfma_f32_16x16x32_bf16 v[80:83], a[80:83], a[44:47], v[80:83]
    ds_read_b64_tr_b16 a[110:111], v1 offset:18688
    v_mfma_f32_16x16x32_bf16 v[84:87], a[80:83], a[48:51], v[84:87]
    ds_read_b64_tr_b16 a[112:113], v2 offset:256
    v_mfma_f32_16x16x32_bf16 v[84:87], a[84:87], a[68:71], v[84:87]
    ds_read_b64_tr_b16 a[114:115], v2 offset:6400
    v_mfma_f32_16x16x32_bf16 v[88:91], a[84:87], a[72:75], v[88:91]
    ds_read_b64_tr_b16 a[116:117], v2 offset:12544
    v_mfma_f32_16x16x32_bf16 v[88:91], a[80:83], a[52:55], v[88:91]
    ds_read_b64_tr_b16 a[118:119], v2 offset:18688
    v_mfma_f32_16x16x32_bf16 v[92:95], a[80:83], a[56:59], v[92:95]
    ds_read_b64_tr_b16 a[120:121], v3 offset:256
    v_mfma_f32_16x16x32_bf16 v[92:95], a[84:87], a[76:79], v[92:95]
    ds_read_b64_tr_b16 a[122:123], v3 offset:6400
    v_mfma_f32_16x16x32_bf16 v[212:215], a[92:95], a[76:79], v[212:215]
    buffer_load_dwordx4 v12, s[12:15], s30 offen offset:1024 nt lds
    v_mfma_f32_16x16x32_bf16 v[212:215], a[88:91], a[56:59], v[212:215]
    ds_read_b64_tr_b16 a[124:125], v3 offset:12544
    v_mfma_f32_16x16x32_bf16 v[208:211], a[88:91], a[52:55], v[208:211]
    ds_read_b64_tr_b16 a[126:127], v3 offset:18688
    v_mfma_f32_16x16x32_bf16 v[208:211], a[92:95], a[72:75], v[208:211]
    v_mfma_f32_16x16x32_bf16 v[204:207], a[92:95], a[68:71], v[204:207]
    v_mfma_f32_16x16x32_bf16 v[204:207], a[88:91], a[48:51], v[204:207]
    v_mfma_f32_16x16x32_bf16 v[200:203], a[88:91], a[44:47], v[200:203]
    v_mfma_f32_16x16x32_bf16 v[200:203], a[92:95], a[64:67], v[200:203]
    v_mfma_f32_16x16x32_bf16 v[196:199], a[92:95], a[60:63], v[196:199]
    v_mfma_f32_16x16x32_bf16 v[196:199], a[88:91], a[40:43], v[196:199]
    v_mfma_f32_16x16x32_bf16 v[96:99], a[96:99], a[40:43], v[96:99]
    v_mfma_f32_16x16x32_bf16 v[96:99], a[100:103], a[60:63], v[96:99]
    v_mfma_f32_16x16x32_bf16 v[100:103], a[100:103], a[64:67], v[100:103]
    v_mfma_f32_16x16x32_bf16 v[100:103], a[96:99], a[44:47], v[100:103]
    v_mfma_f32_16x16x32_bf16 v[104:107], a[96:99], a[48:51], v[104:107]
    buffer_load_dwordx4 v13, s[12:15], s30 offen offset:2048 nt lds
    v_mfma_f32_16x16x32_bf16 v[104:107], a[100:103], a[68:71], v[104:107]
    s_add_u32 m0, s27, 55296
    v_mfma_f32_16x16x32_bf16 v[108:111], a[100:103], a[72:75], v[108:111]
    s_mov_b32 s31, 6144
    v_mfma_f32_16x16x32_bf16 v[108:111], a[96:99], a[52:55], v[108:111]
    v_mfma_f32_16x16x32_bf16 v[112:115], a[96:99], a[56:59], v[112:115]
    v_mfma_f32_16x16x32_bf16 v[112:115], a[100:103], a[76:79], v[112:115]
    s_waitcnt vmcnt(9) lgkmcnt(0)
    s_barrier
    v_mfma_f32_16x16x32_bf16 v[216:219], a[104:107], a[40:43], v[216:219]
    ds_read_b128 a[128:131], v14 offset:0
    v_add_u32 v0, s35, v0
    v_mfma_f32_16x16x32_bf16 v[216:219], a[108:111], a[60:63], v[216:219]
    ds_read_b128 a[132:135], v15 offset:0
    v_add_u32 v1, s35, v1
    v_mfma_f32_16x16x32_bf16 v[220:223], a[108:111], a[64:67], v[220:223]
    ds_read_b128 a[136:139], v14 offset:128
    v_add_u32 v2, s35, v2
    v_mfma_f32_16x16x32_bf16 v[220:223], a[104:107], a[44:47], v[220:223]
    ds_read_b128 a[140:143], v15 offset:128
    v_add_u32 v3, s35, v3
    v_mfma_f32_16x16x32_bf16 v[224:227], a[104:107], a[48:51], v[224:227]
    ds_read_b128 a[144:147], v14 offset:256
    v_mfma_f32_16x16x32_bf16 v[224:227], a[108:111], a[68:71], v[224:227]
    ds_read_b128 a[148:151], v15 offset:256
    v_mfma_f32_16x16x32_bf16 v[228:231], a[108:111], a[72:75], v[228:231]
    ds_read_b128 a[152:155], v14 offset:6144
    v_mfma_f32_16x16x32_bf16 v[228:231], a[104:107], a[52:55], v[228:231]
    ds_read_b128 a[156:159], v15 offset:6144
    v_mfma_f32_16x16x32_bf16 v[232:235], a[104:107], a[56:59], v[232:235]
    buffer_load_dwordx4 v11, s[16:19], s31 offen nt lds
    v_mfma_f32_16x16x32_bf16 v[232:235], a[108:111], a[76:79], v[232:235]
    ds_read_b128 a[160:163], v14 offset:6272
    v_mfma_f32_16x16x32_bf16 v[132:135], a[116:119], a[76:79], v[132:135]
    ds_read_b128 a[164:167], v15 offset:6272
    v_mfma_f32_16x16x32_bf16 v[132:135], a[112:115], a[56:59], v[132:135]
    ds_read_b128 a[168:171], v14 offset:6400
    v_mfma_f32_16x16x32_bf16 v[128:131], a[112:115], a[52:55], v[128:131]
    ds_read_b128 a[172:175], v15 offset:6400
    v_mfma_f32_16x16x32_bf16 v[128:131], a[116:119], a[72:75], v[128:131]
    ds_read_b128 a[176:179], v14 offset:12288
    v_mfma_f32_16x16x32_bf16 v[124:127], a[116:119], a[68:71], v[124:127]
    ds_read_b128 a[180:183], v15 offset:12288
    v_mfma_f32_16x16x32_bf16 v[124:127], a[112:115], a[48:51], v[124:127]
    ds_read_b128 a[184:187], v14 offset:12416
    v_mfma_f32_16x16x32_bf16 v[120:123], a[112:115], a[44:47], v[120:123]
    ds_read_b128 a[188:191], v15 offset:12416
    v_mfma_f32_16x16x32_bf16 v[120:123], a[116:119], a[64:67], v[120:123]
    ds_read_b128 a[192:195], v14 offset:12544
    v_mfma_f32_16x16x32_bf16 v[116:119], a[116:119], a[60:63], v[116:119]
    ds_read_b128 a[196:199], v15 offset:12544
    v_mfma_f32_16x16x32_bf16 v[116:119], a[112:115], a[40:43], v[116:119]
    v_mfma_f32_16x16x32_bf16 v[236:239], a[120:123], a[40:43], v[236:239]
    v_mfma_f32_16x16x32_bf16 v[236:239], a[124:127], a[60:63], v[236:239]
    v_mfma_f32_16x16x32_bf16 v[240:243], a[124:127], a[64:67], v[240:243]
    v_mfma_f32_16x16x32_bf16 v[240:243], a[120:123], a[44:47], v[240:243]
    v_mfma_f32_16x16x32_bf16 v[244:247], a[120:123], a[48:51], v[244:247]
    v_mfma_f32_16x16x32_bf16 v[244:247], a[124:127], a[68:71], v[244:247]
    v_mfma_f32_16x16x32_bf16 v[248:251], a[124:127], a[72:75], v[248:251]
    v_mfma_f32_16x16x32_bf16 v[248:251], a[120:123], a[52:55], v[248:251]
    v_mfma_f32_16x16x32_bf16 v[252:255], a[120:123], a[56:59], v[252:255]
    v_mfma_f32_16x16x32_bf16 v[252:255], a[124:127], a[76:79], v[252:255]
    s_waitcnt lgkmcnt(0)
    s_add_u32 s8, s8, 6144
    s_addc_u32 s9, s9, 0
    s_cmp_eq_u32 s28, 1
    s_cselect_b32 s10, s10, 0
    s_cselect_b32 s43, 0, 983040
    s_add_u32 s20, s20, s43
    s_addc_u32 s21, s21, 0

    v_pk_mul_f32 v[16:17], v[16:17], s[38:39]
    v_pk_mul_f32 v[18:19], v[18:19], s[38:39]
    v_pk_mul_f32 v[136:137], v[136:137], s[38:39]
    v_pk_mul_f32 v[138:139], v[138:139], s[38:39]
    s_waitcnt vmcnt(5)
    buffer_load_dwordx4 v12, s[16:19], s31 offen offset:1024 nt lds
    v_cvt_pk_bf16_f32 v16, v16, v17
    v_cvt_pk_bf16_f32 v17, v18, v19
    v_cvt_pk_bf16_f32 v18, v136, v137
    v_cvt_pk_bf16_f32 v19, v138, v139
    v_pk_mul_f32 v[20:21], v[20:21], s[38:39]
    v_pk_mul_f32 v[22:23], v[22:23], s[38:39]
    v_pk_mul_f32 v[140:141], v[140:141], s[38:39]
    v_pk_mul_f32 v[142:143], v[142:143], s[38:39]
    v_permlane16_swap_b32 v16, v18
    v_permlane16_swap_b32 v17, v19
    v_cvt_pk_bf16_f32 v20, v20, v21
    v_cvt_pk_bf16_f32 v21, v22, v23
    v_cvt_pk_bf16_f32 v22, v140, v141
    v_cvt_pk_bf16_f32 v23, v142, v143
    v_pk_mul_f32 v[24:25], v[24:25], s[38:39]
    v_pk_mul_f32 v[26:27], v[26:27], s[38:39]
    v_pk_mul_f32 v[144:145], v[144:145], s[38:39]
    v_pk_mul_f32 v[146:147], v[146:147], s[38:39]
    v_permlane16_swap_b32 v20, v22
    v_permlane16_swap_b32 v21, v23
    v_cvt_pk_bf16_f32 v24, v24, v25
    v_cvt_pk_bf16_f32 v25, v26, v27
    v_cvt_pk_bf16_f32 v26, v144, v145
    v_cvt_pk_bf16_f32 v27, v146, v147
    v_pk_mul_f32 v[28:29], v[28:29], s[38:39]
    v_pk_mul_f32 v[30:31], v[30:31], s[38:39]
    v_pk_mul_f32 v[148:149], v[148:149], s[38:39]
    v_pk_mul_f32 v[150:151], v[150:151], s[38:39]
    v_permlane16_swap_b32 v24, v26
    v_permlane16_swap_b32 v25, v27
    v_cvt_pk_bf16_f32 v28, v28, v29
    v_cvt_pk_bf16_f32 v29, v30, v31
    v_cvt_pk_bf16_f32 v30, v148, v149
    v_cvt_pk_bf16_f32 v31, v150, v151
    v_pk_mul_f32 v[32:33], v[32:33], s[38:39]
    v_pk_mul_f32 v[34:35], v[34:35], s[38:39]
    v_pk_mul_f32 v[152:153], v[152:153], s[38:39]
    v_pk_mul_f32 v[154:155], v[154:155], s[38:39]
    v_permlane16_swap_b32 v28, v30
    v_permlane16_swap_b32 v29, v31
    v_cvt_pk_bf16_f32 v32, v32, v33
    v_cvt_pk_bf16_f32 v33, v34, v35
    v_cvt_pk_bf16_f32 v34, v152, v153
    v_cvt_pk_bf16_f32 v35, v154, v155
    v_pk_mul_f32 v[36:37], v[36:37], s[38:39]
    v_pk_mul_f32 v[38:39], v[38:39], s[38:39]
    v_pk_mul_f32 v[156:157], v[156:157], s[38:39]
    v_pk_mul_f32 v[158:159], v[158:159], s[38:39]
    v_permlane16_swap_b32 v32, v34
    v_permlane16_swap_b32 v33, v35
    v_cvt_pk_bf16_f32 v36, v36, v37
    v_cvt_pk_bf16_f32 v37, v38, v39
    v_cvt_pk_bf16_f32 v38, v156, v157
    v_cvt_pk_bf16_f32 v39, v158, v159
    v_pk_mul_f32 v[40:41], v[40:41], s[38:39]
    v_pk_mul_f32 v[42:43], v[42:43], s[38:39]
    v_pk_mul_f32 v[160:161], v[160:161], s[38:39]
    v_pk_mul_f32 v[162:163], v[162:163], s[38:39]
    s_waitcnt vmcnt(5)
    buffer_load_dwordx4 v13, s[16:19], s31 offen offset:2048 nt lds
    v_permlane16_swap_b32 v36, v38
    v_permlane16_swap_b32 v37, v39
    v_cvt_pk_bf16_f32 v40, v40, v41
    v_cvt_pk_bf16_f32 v41, v42, v43
    v_cvt_pk_bf16_f32 v42, v160, v161
    v_cvt_pk_bf16_f32 v43, v162, v163
    v_pk_mul_f32 v[44:45], v[44:45], s[38:39]
    v_pk_mul_f32 v[46:47], v[46:47], s[38:39]
    v_pk_mul_f32 v[164:165], v[164:165], s[38:39]
    v_pk_mul_f32 v[166:167], v[166:167], s[38:39]
    v_permlane16_swap_b32 v40, v42
    v_permlane16_swap_b32 v41, v43
    v_cvt_pk_bf16_f32 v44, v44, v45
    v_cvt_pk_bf16_f32 v45, v46, v47
    v_cvt_pk_bf16_f32 v46, v164, v165
    v_cvt_pk_bf16_f32 v47, v166, v167
    v_pk_mul_f32 v[48:49], v[48:49], s[38:39]
    v_pk_mul_f32 v[50:51], v[50:51], s[38:39]
    v_pk_mul_f32 v[168:169], v[168:169], s[38:39]
    v_pk_mul_f32 v[170:171], v[170:171], s[38:39]
    v_permlane16_swap_b32 v44, v46
    v_permlane16_swap_b32 v45, v47
    v_cvt_pk_bf16_f32 v48, v48, v49
    v_cvt_pk_bf16_f32 v49, v50, v51
    v_cvt_pk_bf16_f32 v50, v168, v169
    v_cvt_pk_bf16_f32 v51, v170, v171
    v_pk_mul_f32 v[52:53], v[52:53], s[38:39]
    v_pk_mul_f32 v[54:55], v[54:55], s[38:39]
    v_pk_mul_f32 v[172:173], v[172:173], s[38:39]
    v_pk_mul_f32 v[174:175], v[174:175], s[38:39]
    v_permlane16_swap_b32 v48, v50
    v_permlane16_swap_b32 v49, v51
    v_cvt_pk_bf16_f32 v52, v52, v53
    v_cvt_pk_bf16_f32 v53, v54, v55
    v_cvt_pk_bf16_f32 v54, v172, v173
    v_cvt_pk_bf16_f32 v55, v174, v175
    v_pk_mul_f32 v[56:57], v[56:57], s[38:39]
    v_pk_mul_f32 v[58:59], v[58:59], s[38:39]
    v_pk_mul_f32 v[176:177], v[176:177], s[38:39]
    v_pk_mul_f32 v[178:179], v[178:179], s[38:39]
    v_permlane16_swap_b32 v52, v54
    v_permlane16_swap_b32 v53, v55
    v_cvt_pk_bf16_f32 v56, v56, v57
    v_cvt_pk_bf16_f32 v57, v58, v59
    v_cvt_pk_bf16_f32 v58, v176, v177
    v_cvt_pk_bf16_f32 v59, v178, v179
    v_pk_mul_f32 v[60:61], v[60:61], s[38:39]
    v_pk_mul_f32 v[62:63], v[62:63], s[38:39]
    v_pk_mul_f32 v[180:181], v[180:181], s[38:39]
    v_pk_mul_f32 v[182:183], v[182:183], s[38:39]
    v_permlane16_swap_b32 v56, v58
    v_permlane16_swap_b32 v57, v59
    v_cvt_pk_bf16_f32 v60, v60, v61
    v_cvt_pk_bf16_f32 v61, v62, v63
    v_cvt_pk_bf16_f32 v62, v180, v181
    v_cvt_pk_bf16_f32 v63, v182, v183
    s_add_u32 m0, s27, 98304
    s_mov_b32 s31, 12288
    v_pk_mul_f32 v[64:65], v[64:65], s[38:39]
    v_pk_mul_f32 v[66:67], v[66:67], s[38:39]
    v_pk_mul_f32 v[184:185], v[184:185], s[38:39]
    v_pk_mul_f32 v[186:187], v[186:187], s[38:39]
    s_waitcnt vmcnt(5)
    buffer_load_dwordx4 v11, s[16:19], s31 offen nt lds
    v_permlane16_swap_b32 v60, v62
    v_permlane16_swap_b32 v61, v63
    v_cvt_pk_bf16_f32 v64, v64, v65
    v_cvt_pk_bf16_f32 v65, v66, v67
    v_cvt_pk_bf16_f32 v66, v184, v185
    v_cvt_pk_bf16_f32 v67, v186, v187
    v_pk_mul_f32 v[68:69], v[68:69], s[38:39]
    v_pk_mul_f32 v[70:71], v[70:71], s[38:39]
    v_pk_mul_f32 v[188:189], v[188:189], s[38:39]
    v_pk_mul_f32 v[190:191], v[190:191], s[38:39]
    v_permlane16_swap_b32 v64, v66
    v_permlane16_swap_b32 v65, v67
    v_cvt_pk_bf16_f32 v68, v68, v69
    v_cvt_pk_bf16_f32 v69, v70, v71
    v_cvt_pk_bf16_f32 v70, v188, v189
    v_cvt_pk_bf16_f32 v71, v190, v191
    v_pk_mul_f32 v[72:73], v[72:73], s[38:39]
    v_pk_mul_f32 v[74:75], v[74:75], s[38:39]
    v_pk_mul_f32 v[192:193], v[192:193], s[38:39]
    v_pk_mul_f32 v[194:195], v[194:195], s[38:39]
    v_permlane16_swap_b32 v68, v70
    v_permlane16_swap_b32 v69, v71
    v_cvt_pk_bf16_f32 v72, v72, v73
    v_cvt_pk_bf16_f32 v73, v74, v75
    v_cvt_pk_bf16_f32 v74, v192, v193
    v_cvt_pk_bf16_f32 v75, v194, v195
    v_pk_mul_f32 v[76:77], v[76:77], s[38:39]
    v_pk_mul_f32 v[78:79], v[78:79], s[38:39]
    v_pk_mul_f32 v[196:197], v[196:197], s[38:39]
    v_pk_mul_f32 v[198:199], v[198:199], s[38:39]
    v_permlane16_swap_b32 v72, v74
    v_permlane16_swap_b32 v73, v75
    v_cvt_pk_bf16_f32 v76, v76, v77
    v_cvt_pk_bf16_f32 v77, v78, v79
    v_cvt_pk_bf16_f32 v78, v196, v197
    v_cvt_pk_bf16_f32 v79, v198, v199
    v_pk_mul_f32 v[80:81], v[80:81], s[38:39]
    v_pk_mul_f32 v[82:83], v[82:83], s[38:39]
    v_pk_mul_f32 v[200:201], v[200:201], s[38:39]
    v_pk_mul_f32 v[202:203], v[202:203], s[38:39]
    v_permlane16_swap_b32 v76, v78
    v_permlane16_swap_b32 v77, v79
    v_cvt_pk_bf16_f32 v80, v80, v81
    v_cvt_pk_bf16_f32 v81, v82, v83
    v_cvt_pk_bf16_f32 v82, v200, v201
    v_cvt_pk_bf16_f32 v83, v202, v203
    v_pk_mul_f32 v[84:85], v[84:85], s[38:39]
    v_pk_mul_f32 v[86:87], v[86:87], s[38:39]
    v_pk_mul_f32 v[204:205], v[204:205], s[38:39]
    v_pk_mul_f32 v[206:207], v[206:207], s[38:39]
    v_permlane16_swap_b32 v80, v82
    v_permlane16_swap_b32 v81, v83
    v_cvt_pk_bf16_f32 v84, v84, v85
    v_cvt_pk_bf16_f32 v85, v86, v87
    v_cvt_pk_bf16_f32 v86, v204, v205
    v_cvt_pk_bf16_f32 v87, v206, v207
    v_pk_mul_f32 v[88:89], v[88:89], s[38:39]
    v_pk_mul_f32 v[90:91], v[90:91], s[38:39]
    v_pk_mul_f32 v[208:209], v[208:209], s[38:39]
    v_pk_mul_f32 v[210:211], v[210:211], s[38:39]
    s_waitcnt vmcnt(5)
    buffer_load_dwordx4 v12, s[16:19], s31 offen offset:1024 nt lds
    v_permlane16_swap_b32 v84, v86
    v_permlane16_swap_b32 v85, v87
    v_cvt_pk_bf16_f32 v88, v88, v89
    v_cvt_pk_bf16_f32 v89, v90, v91
    v_cvt_pk_bf16_f32 v90, v208, v209
    v_cvt_pk_bf16_f32 v91, v210, v211
    v_pk_mul_f32 v[92:93], v[92:93], s[38:39]
    v_pk_mul_f32 v[94:95], v[94:95], s[38:39]
    v_pk_mul_f32 v[212:213], v[212:213], s[38:39]
    v_pk_mul_f32 v[214:215], v[214:215], s[38:39]
    v_permlane16_swap_b32 v88, v90
    v_permlane16_swap_b32 v89, v91
    v_cvt_pk_bf16_f32 v92, v92, v93
    v_cvt_pk_bf16_f32 v93, v94, v95
    v_cvt_pk_bf16_f32 v94, v212, v213
    v_cvt_pk_bf16_f32 v95, v214, v215
    v_pk_mul_f32 v[96:97], v[96:97], s[38:39]
    v_pk_mul_f32 v[98:99], v[98:99], s[38:39]
    v_pk_mul_f32 v[216:217], v[216:217], s[38:39]
    v_pk_mul_f32 v[218:219], v[218:219], s[38:39]
    v_permlane16_swap_b32 v92, v94
    v_permlane16_swap_b32 v93, v95
    v_cvt_pk_bf16_f32 v96, v96, v97
    v_cvt_pk_bf16_f32 v97, v98, v99
    v_cvt_pk_bf16_f32 v98, v216, v217
    v_cvt_pk_bf16_f32 v99, v218, v219
    v_pk_mul_f32 v[100:101], v[100:101], s[38:39]
    v_pk_mul_f32 v[102:103], v[102:103], s[38:39]
    v_pk_mul_f32 v[220:221], v[220:221], s[38:39]
    v_pk_mul_f32 v[222:223], v[222:223], s[38:39]
    v_permlane16_swap_b32 v96, v98
    v_permlane16_swap_b32 v97, v99
    v_cvt_pk_bf16_f32 v100, v100, v101
    v_cvt_pk_bf16_f32 v101, v102, v103
    v_cvt_pk_bf16_f32 v102, v220, v221
    v_cvt_pk_bf16_f32 v103, v222, v223
    v_pk_mul_f32 v[104:105], v[104:105], s[38:39]
    v_pk_mul_f32 v[106:107], v[106:107], s[38:39]
    v_pk_mul_f32 v[224:225], v[224:225], s[38:39]
    v_pk_mul_f32 v[226:227], v[226:227], s[38:39]
    v_permlane16_swap_b32 v100, v102
    v_permlane16_swap_b32 v101, v103
    v_cvt_pk_bf16_f32 v104, v104, v105
    v_cvt_pk_bf16_f32 v105, v106, v107
    v_cvt_pk_bf16_f32 v106, v224, v225
    v_cvt_pk_bf16_f32 v107, v226, v227
    v_pk_mul_f32 v[108:109], v[108:109], s[38:39]
    v_pk_mul_f32 v[110:111], v[110:111], s[38:39]
    v_pk_mul_f32 v[228:229], v[228:229], s[38:39]
    v_pk_mul_f32 v[230:231], v[230:231], s[38:39]
    v_permlane16_swap_b32 v104, v106
    v_permlane16_swap_b32 v105, v107
    v_cvt_pk_bf16_f32 v108, v108, v109
    v_cvt_pk_bf16_f32 v109, v110, v111
    v_cvt_pk_bf16_f32 v110, v228, v229
    v_cvt_pk_bf16_f32 v111, v230, v231
    v_pk_mul_f32 v[112:113], v[112:113], s[38:39]
    v_pk_mul_f32 v[114:115], v[114:115], s[38:39]
    v_pk_mul_f32 v[232:233], v[232:233], s[38:39]
    v_pk_mul_f32 v[234:235], v[234:235], s[38:39]
    s_waitcnt vmcnt(5)
    buffer_load_dwordx4 v13, s[16:19], s31 offen offset:2048 nt lds
    v_permlane16_swap_b32 v108, v110
    v_permlane16_swap_b32 v109, v111
    v_cvt_pk_bf16_f32 v112, v112, v113
    v_cvt_pk_bf16_f32 v113, v114, v115
    v_cvt_pk_bf16_f32 v114, v232, v233
    v_cvt_pk_bf16_f32 v115, v234, v235
    v_pk_mul_f32 v[116:117], v[116:117], s[38:39]
    v_pk_mul_f32 v[118:119], v[118:119], s[38:39]
    v_pk_mul_f32 v[236:237], v[236:237], s[38:39]
    v_pk_mul_f32 v[238:239], v[238:239], s[38:39]
    v_permlane16_swap_b32 v112, v114
    v_permlane16_swap_b32 v113, v115
    v_cvt_pk_bf16_f32 v116, v116, v117
    v_cvt_pk_bf16_f32 v117, v118, v119
    v_cvt_pk_bf16_f32 v118, v236, v237
    v_cvt_pk_bf16_f32 v119, v238, v239
    v_pk_mul_f32 v[120:121], v[120:121], s[38:39]
    v_pk_mul_f32 v[122:123], v[122:123], s[38:39]
    v_pk_mul_f32 v[240:241], v[240:241], s[38:39]
    v_pk_mul_f32 v[242:243], v[242:243], s[38:39]
    v_permlane16_swap_b32 v116, v118
    v_permlane16_swap_b32 v117, v119
    v_cvt_pk_bf16_f32 v120, v120, v121
    v_cvt_pk_bf16_f32 v121, v122, v123
    v_cvt_pk_bf16_f32 v122, v240, v241
    v_cvt_pk_bf16_f32 v123, v242, v243
    v_pk_mul_f32 v[124:125], v[124:125], s[38:39]
    v_pk_mul_f32 v[126:127], v[126:127], s[38:39]
    v_pk_mul_f32 v[244:245], v[244:245], s[38:39]
    v_pk_mul_f32 v[246:247], v[246:247], s[38:39]
    v_permlane16_swap_b32 v120, v122
    v_permlane16_swap_b32 v121, v123
    v_cvt_pk_bf16_f32 v124, v124, v125
    v_cvt_pk_bf16_f32 v125, v126, v127
    v_cvt_pk_bf16_f32 v126, v244, v245
    v_cvt_pk_bf16_f32 v127, v246, v247
    v_pk_mul_f32 v[128:129], v[128:129], s[38:39]
    v_pk_mul_f32 v[130:131], v[130:131], s[38:39]
    v_pk_mul_f32 v[248:249], v[248:249], s[38:39]
    v_pk_mul_f32 v[250:251], v[250:251], s[38:39]
    v_permlane16_swap_b32 v124, v126
    v_permlane16_swap_b32 v125, v127
    v_cvt_pk_bf16_f32 v128, v128, v129
    v_cvt_pk_bf16_f32 v129, v130, v131
    v_cvt_pk_bf16_f32 v130, v248, v249
    v_cvt_pk_bf16_f32 v131, v250, v251
    v_pk_mul_f32 v[132:133], v[132:133], s[38:39]
    v_pk_mul_f32 v[134:135], v[134:135], s[38:39]
    v_pk_mul_f32 v[252:253], v[252:253], s[38:39]
    v_pk_mul_f32 v[254:255], v[254:255], s[38:39]
    v_permlane16_swap_b32 v128, v130
    v_permlane16_swap_b32 v129, v131
    v_cvt_pk_bf16_f32 v132, v132, v133
    v_cvt_pk_bf16_f32 v133, v134, v135
    v_cvt_pk_bf16_f32 v134, v252, v253
    v_cvt_pk_bf16_f32 v135, v254, v255
    s_nop 1
    v_permlane16_swap_b32 v132, v134
    v_permlane16_swap_b32 v133, v135
.p2align 3
L_at:
    v_mfma_f32_16x16x32_bf16 v[136:139], a[128:131], v[16:19], 0
    v_add_u32 v14, 0xc000, v14
    v_add_u32 v15, 0xc000, v15
    v_mfma_f32_16x16x32_bf16 v[136:139], a[132:135], v[36:39], v[136:139]
    v_accvgpr_read_b32 v255, a249
    v_accvgpr_read_b32 v254, a245
    v_mfma_f32_16x16x32_bf16 v[136:139], a[136:139], v[56:59], v[136:139]
    v_mov_b32 v244, 0
    v_mov_b32 v245, 0
    v_mfma_f32_16x16x32_bf16 v[136:139], a[140:143], v[76:79], v[136:139]
    v_mov_b32 v246, 0
    v_mov_b32 v247, 0
    v_mfma_f32_16x16x32_bf16 v[136:139], a[144:147], v[96:99], v[136:139]
    s_add_u32 m0, s27, 104448
    v_mov_b32 v248, 0
    v_lshlrev_b32 v249, 3, v254
    v_mfma_f32_16x16x32_bf16 v[136:139], a[148:151], v[116:119], v[136:139]
    s_mov_b32 s31, 18432
    v_mfma_f32_16x16x32_bf16 v[140:143], a[148:151], v[120:123], 0
    s_waitcnt vmcnt(5)
    buffer_load_dwordx4 v11, s[16:19], s31 offen nt lds
    v_mfma_f32_16x16x32_bf16 v[140:143], a[144:147], v[100:103], v[140:143]
    v_mfma_f32_16x16x32_bf16 v[140:143], a[140:143], v[80:83], v[140:143]
    v_mfma_f32_16x16x32_bf16 v[140:143], a[136:139], v[60:63], v[140:143]
    v_mfma_f32_16x16x32_bf16 v[140:143], a[132:135], v[40:43], v[140:143]
    v_mfma_f32_16x16x32_bf16 v[140:143], a[128:131], v[20:23], v[140:143]
    v_mfma_f32_16x16x32_bf16 v[144:147], a[128:131], v[24:27], 0
    v_mfma_f32_16x16x32_bf16 v[144:147], a[132:135], v[44:47], v[144:147]
    s_cmp_eq_u32 s84, 0
    s_cselect_b32 s36, 9, 9
    v_exp_f32 v136, v136
    v_mfma_f32_16x16x32_bf16 v[144:147], a[136:139], v[64:67], v[144:147]
    s_mov_b32 s42, 49152
    v_exp_f32 v137, v137
    v_mfma_f32_16x16x32_bf16 v[144:147], a[140:143], v[84:87], v[144:147]
    s_mov_b32 s29, 24576
    v_add_f32 v244, v244, v136
    v_add_f32 v244, v244, v137
    v_mfma_f32_16x16x32_bf16 v[144:147], a[144:147], v[104:107], v[144:147]
    s_mov_b32 s34, s27
    v_exp_f32 v138, v138
    v_mfma_f32_16x16x32_bf16 v[144:147], a[148:151], v[124:127], v[144:147]
    s_mov_b32 s37, 1
    v_exp_f32 v139, v139
    v_mfma_f32_16x16x32_bf16 v[148:151], a[148:151], v[128:131], 0
    s_add_u32 s49, s49, 3932160
    v_cvt_pk_bf16_f32 v176, v136, v137
    v_add_f32 v244, v244, v138
    v_mfma_f32_16x16x32_bf16 v[148:151], a[144:147], v[108:111], v[148:151]
    s_add_u32 s79, s27, 98304
    v_exp_f32 v140, v140
    v_mfma_f32_16x16x32_bf16 v[148:151], a[140:143], v[88:91], v[148:151]
    v_exp_f32 v141, v141
    v_mfma_f32_16x16x32_bf16 v[148:151], a[136:139], v[68:71], v[148:151]
    v_add_f32 v244, v244, v139
    v_cvt_pk_bf16_f32 v177, v138, v139
    v_mfma_f32_16x16x32_bf16 v[148:151], a[132:135], v[48:51], v[148:151]
    v_exp_f32 v142, v142
    v_mfma_f32_16x16x32_bf16 v[148:151], a[128:131], v[28:31], v[148:151]
    v_exp_f32 v143, v143
    v_mfma_f32_16x16x32_bf16 v[152:155], a[128:131], v[32:35], 0
    s_waitcnt vmcnt(5)
    buffer_load_dwordx4 v12, s[16:19], s31 offen offset:1024 nt lds
    v_mfma_f32_16x16x32_bf16 v[152:155], a[132:135], v[52:55], v[152:155]
    v_exp_f32 v144, v144
    v_mfma_f32_16x16x32_bf16 v[152:155], a[136:139], v[72:75], v[152:155]
    v_exp_f32 v145, v145
    v_mfma_f32_16x16x32_bf16 v[152:155], a[140:143], v[92:95], v[152:155]
    v_add_f32 v245, v245, v140
    v_add_f32 v245, v245, v141
    v_mfma_f32_16x16x32_bf16 v[152:155], a[144:147], v[112:115], v[152:155]
    v_exp_f32 v146, v146
    v_mfma_f32_16x16x32_bf16 v[152:155], a[148:151], v[132:135], v[152:155]
    v_exp_f32 v147, v147
    v_mfma_f32_16x16x32_bf16 v[156:159], a[152:155], v[16:19], 0
    v_cvt_pk_bf16_f32 v180, v140, v141
    v_add_f32 v245, v245, v142
    v_mfma_f32_16x16x32_bf16 v[156:159], a[156:159], v[36:39], v[156:159]
    v_exp_f32 v148, v148
    v_mfma_f32_16x16x32_bf16 v[156:159], a[160:163], v[56:59], v[156:159]
    v_exp_f32 v149, v149
    v_mfma_f32_16x16x32_bf16 v[156:159], a[164:167], v[76:79], v[156:159]
    v_add_f32 v245, v245, v143
    v_cvt_pk_bf16_f32 v181, v142, v143
    v_mfma_f32_16x16x32_bf16 v[156:159], a[168:171], v[96:99], v[156:159]
    v_exp_f32 v150, v150
    v_mfma_f32_16x16x32_bf16 v[156:159], a[172:175], v[116:119], v[156:159]
    v_exp_f32 v151, v151
    v_mfma_f32_16x16x32_bf16 v[160:163], a[172:175], v[120:123], 0
    v_add_f32 v246, v246, v144
    v_add_f32 v246, v246, v145
    v_mfma_f32_16x16x32_bf16 v[160:163], a[168:171], v[100:103], v[160:163]
    v_exp_f32 v152, v152
    v_mfma_f32_16x16x32_bf16 v[160:163], a[164:167], v[80:83], v[160:163]
    v_exp_f32 v153, v153
    v_mfma_f32_16x16x32_bf16 v[160:163], a[160:163], v[60:63], v[160:163]
    v_cvt_pk_bf16_f32 v184, v144, v145
    v_add_f32 v246, v246, v146
    v_mfma_f32_16x16x32_bf16 v[160:163], a[156:159], v[40:43], v[160:163]
    v_exp_f32 v154, v154
    v_mfma_f32_16x16x32_bf16 v[160:163], a[152:155], v[20:23], v[160:163]
    v_exp_f32 v155, v155
    v_mfma_f32_16x16x32_bf16 v[164:167], a[152:155], v[24:27], 0
    s_waitcnt vmcnt(5)
    buffer_load_dwordx4 v13, s[16:19], s31 offen offset:2048 nt lds
    v_mfma_f32_16x16x32_bf16 v[164:167], a[156:159], v[44:47], v[164:167]
    v_exp_f32 v156, v156
    v_mfma_f32_16x16x32_bf16 v[164:167], a[160:163], v[64:67], v[164:167]
    v_exp_f32 v157, v157
    v_mfma_f32_16x16x32_bf16 v[164:167], a[164:167], v[84:87], v[164:167]
    v_add_f32 v246, v246, v147
    v_cvt_pk_bf16_f32 v185, v146, v147
    v_mfma_f32_16x16x32_bf16 v[164:167], a[168:171], v[104:107], v[164:167]
    v_exp_f32 v158, v158
    v_mfma_f32_16x16x32_bf16 v[164:167], a[172:175], v[124:127], v[164:167]
    v_exp_f32 v159, v159
    v_mfma_f32_16x16x32_bf16 v[168:171], a[172:175], v[128:131], 0
    v_add_f32 v247, v247, v148
    v_add_f32 v247, v247, v149
    v_mfma_f32_16x16x32_bf16 v[168:171], a[168:171], v[108:111], v[168:171]
    v_exp_f32 v160, v160
    v_mfma_f32_16x16x32_bf16 v[168:171], a[164:167], v[88:91], v[168:171]
    v_exp_f32 v161, v161
    v_mfma_f32_16x16x32_bf16 v[168:171], a[160:163], v[68:71], v[168:171]
    v_cvt_pk_bf16_f32 v188, v148, v149
    v_add_f32 v247, v247, v150
    v_mfma_f32_16x16x32_bf16 v[168:171], a[156:159], v[48:51], v[168:171]
    v_exp_f32 v162, v162
    v_mfma_f32_16x16x32_bf16 v[168:171], a[152:155], v[28:31], v[168:171]
    v_exp_f32 v163, v163
    v_mfma_f32_16x16x32_bf16 v[172:175], a[152:155], v[32:35], 0
    v_add_f32 v247, v247, v151
    v_cvt_pk_bf16_f32 v189, v150, v151
    v_mfma_f32_16x16x32_bf16 v[172:175], a[156:159], v[52:55], v[172:175]
    v_exp_f32 v164, v164
    v_mfma_f32_16x16x32_bf16 v[172:175], a[160:163], v[72:75], v[172:175]
    v_exp_f32 v165, v165
    v_mfma_f32_16x16x32_bf16 v[172:175], a[164:167], v[92:95], v[172:175]
    v_add_f32 v248, v248, v152
    v_add_f32 v248, v248, v153
    v_mfma_f32_16x16x32_bf16 v[172:175], a[168:171], v[112:115], v[172:175]
    v_exp_f32 v166, v166
    v_cvt_pk_bf16_f32 v186, v164, v165
    v_mfma_f32_16x16x32_bf16 v[172:175], a[172:175], v[132:135], v[172:175]
    s_waitcnt vmcnt(6)
    s_barrier
    v_mfma_f32_16x16x32_bf16 v[136:139], a[176:179], v[16:19], 0
    s_add_u32 m0, s79, 12288
    ds_read_b64_tr_b16 v[220:221], v0 offset:0
    v_cvt_pk_bf16_f32 v192, v152, v153
    v_mfma_f32_16x16x32_bf16 v[136:139], a[180:183], v[36:39], v[136:139]
    s_add_u32 s30, s29, 6144
    ds_read_b64_tr_b16 v[222:223], v0 offset:6144
    v_add_f32 v248, v248, v154
    v_mfma_f32_16x16x32_bf16 v[136:139], a[184:187], v[56:59], v[136:139]
    s_waitcnt vmcnt(5)
    ds_read_b64_tr_b16 v[224:225], v1 offset:0
    buffer_load_dwordx4 v11, s[12:15], s30 offen nt lds
    v_mfma_f32_16x16x32_bf16 v[136:139], a[188:191], v[76:79], v[136:139]
    ds_read_b64_tr_b16 v[226:227], v1 offset:6144
    v_add_f32 v248, v248, v155
    v_mfma_f32_16x16x32_bf16 v[136:139], a[192:195], v[96:99], v[136:139]
    ds_read_b64_tr_b16 v[228:229], v2 offset:0
    v_cvt_pk_bf16_f32 v193, v154, v155
    v_mfma_f32_16x16x32_bf16 v[136:139], a[196:199], v[116:119], v[136:139]
    ds_read_b64_tr_b16 v[230:231], v2 offset:6144
    v_add_f32 v244, v244, v156
    v_mfma_f32_16x16x32_bf16 v[140:143], a[196:199], v[120:123], 0
    ds_read_b64_tr_b16 v[232:233], v3 offset:0
    v_add_f32 v244, v244, v157
    v_mfma_f32_16x16x32_bf16 v[140:143], a[192:195], v[100:103], v[140:143]
    ds_read_b64_tr_b16 v[234:235], v3 offset:6144
    v_cvt_pk_bf16_f32 v178, v156, v157
    v_mfma_f32_16x16x32_bf16 v[140:143], a[188:191], v[80:83], v[140:143]
    ds_read_b64_tr_b16 v[236:237], v0 offset:128
    v_add_f32 v244, v244, v158
    v_mfma_f32_16x16x32_bf16 v[140:143], a[184:187], v[60:63], v[140:143]
    ds_read_b64_tr_b16 v[238:239], v0 offset:6272
    v_add_f32 v244, v244, v159
    v_mfma_f32_16x16x32_bf16 v[140:143], a[180:183], v[40:43], v[140:143]
    s_waitcnt vmcnt(5)
    ds_read_b64_tr_b16 v[240:241], v1 offset:128
    buffer_load_dwordx4 v12, s[12:15], s30 offen offset:1024 nt lds
    v_mfma_f32_16x16x32_bf16 v[140:143], a[176:179], v[20:23], v[140:143]
    v_exp_f32 v136, v136
    v_add_f32 v246, v246, v166
    v_mfma_f32_16x16x32_bf16 v[144:147], a[176:179], v[24:27], 0
    ds_read_b64_tr_b16 v[242:243], v1 offset:6272
    v_cvt_pk_bf16_f32 v179, v158, v159
    v_mfma_f32_16x16x32_bf16 v[144:147], a[180:183], v[44:47], v[144:147]
    v_add_f32 v244, v244, v136
    v_add_f32 v245, v245, v160
    v_mfma_f32_16x16x32_bf16 v[144:147], a[184:187], v[64:67], v[144:147]
    v_exp_f32 v137, v137
    v_mfma_f32_16x16x32_bf16 v[144:147], a[188:191], v[84:87], v[144:147]
    v_add_f32 v244, v244, v137
    v_add_f32 v245, v245, v161
    v_mfma_f32_16x16x32_bf16 v[144:147], a[192:195], v[104:107], v[144:147]
    v_exp_f32 v167, v167
    v_mfma_f32_16x16x32_bf16 v[144:147], a[196:199], v[124:127], v[144:147]
    v_exp_f32 v138, v138
    v_add_f32 v246, v246, v167
    v_mfma_f32_16x16x32_bf16 v[148:151], a[196:199], v[128:131], 0
    v_add_f32 v244, v244, v138
    v_cvt_pk_bf16_f32 v182, v160, v161
    v_mfma_f32_16x16x32_bf16 v[148:151], a[192:195], v[108:111], v[148:151]
    s_waitcnt vmcnt(5)
    buffer_load_dwordx4 v13, s[12:15], s30 offen offset:2048 nt lds
    v_cvt_pk_bf16_f32 v187, v166, v167
    v_mfma_f32_16x16x32_bf16 v[148:151], a[188:191], v[88:91], v[148:151]
    s_add_u32 m0, s79, 18432
    v_exp_f32 v139, v139
    v_mfma_f32_16x16x32_bf16 v[148:151], a[184:187], v[68:71], v[148:151]
    s_add_u32 s31, s29, 12288
    v_exp_f32 v168, v168
    v_mfma_f32_16x16x32_bf16 v[148:151], a[180:183], v[48:51], v[148:151]
    v_add_f32 v244, v244, v139
    v_add_f32 v245, v245, v162
    v_mfma_f32_16x16x32_bf16 v[148:151], a[176:179], v[28:31], v[148:151]
    v_exp_f32 v140, v140
    v_mfma_f32_16x16x32_bf16 v[152:155], a[176:179], v[32:35], 0
    v_add_f32 v245, v245, v140
    v_add_f32 v245, v245, v163
    v_mfma_f32_16x16x32_bf16 v[152:155], a[180:183], v[52:55], v[152:155]
    v_exp_f32 v169, v169
    v_mfma_f32_16x16x32_bf16 v[152:155], a[184:187], v[72:75], v[152:155]
    v_exp_f32 v141, v141
    v_cvt_pk_bf16_f32 v190, v168, v169
    v_mfma_f32_16x16x32_bf16 v[152:155], a[188:191], v[92:95], v[152:155]
    v_add_f32 v245, v245, v141
    v_cvt_pk_bf16_f32 v183, v162, v163
    v_mfma_f32_16x16x32_bf16 v[152:155], a[192:195], v[112:115], v[152:155]
    s_waitcnt vmcnt(5)
    buffer_load_dwordx4 v11, s[12:15], s31 offen nt lds
    v_mfma_f32_16x16x32_bf16 v[152:155], a[196:199], v[132:135], v[152:155]
    s_waitcnt lgkmcnt(0)
    v_exp_f32 v142, v142
    v_mfma_f32_16x16x32_bf16 a[0:3], v[220:223], v[176:179], 0
    ds_read_b128 v[196:199], v14 offset:12288
    v_add_f32 v246, v246, v164
    v_mfma_f32_16x16x32_bf16 a[20:23], v[224:227], v[176:179], 0
    ds_read_b128 v[200:203], v15 offset:12288
    v_add_f32 v245, v245, v142
    v_mfma_f32_16x16x32_bf16 a[40:43], v[228:231], v[176:179], 0
    v_exp_f32 v143, v143
    v_mfma_f32_16x16x32_bf16 a[60:63], v[232:235], v[176:179], 0
    ds_read_b128 v[204:207], v14 offset:12416
    v_add_f32 v245, v245, v143
    v_mfma_f32_16x16x32_bf16 a[80:83], v[236:239], v[176:179], 0
    ds_read_b128 v[208:211], v15 offset:12416
    v_add_f32 v246, v246, v165
    v_mfma_f32_16x16x32_bf16 a[100:103], v[240:243], v[176:179], 0
    v_exp_f32 v144, v144
    v_mfma_f32_16x16x32_bf16 a[104:107], v[240:243], v[180:183], 0
    ds_read_b128 v[212:215], v14 offset:12544
    v_add_f32 v246, v246, v144
    v_mfma_f32_16x16x32_bf16 a[84:87], v[236:239], v[180:183], 0
    s_waitcnt vmcnt(5)
    ds_read_b128 v[216:219], v15 offset:12544
    buffer_load_dwordx4 v12, s[12:15], s31 offen offset:1024 nt lds
    v_mfma_f32_16x16x32_bf16 a[64:67], v[232:235], v[180:183], 0
    v_exp_f32 v145, v145
    v_mfma_f32_16x16x32_bf16 a[44:47], v[228:231], v[180:183], 0
    v_exp_f32 v170, v170
    v_mfma_f32_16x16x32_bf16 a[24:27], v[224:227], v[180:183], 0
    v_add_f32 v246, v246, v145
    v_add_f32 v247, v247, v168
    v_mfma_f32_16x16x32_bf16 a[4:7], v[220:223], v[180:183], 0
    v_exp_f32 v146, v146
    v_add_f32 v247, v247, v170
    v_mfma_f32_16x16x32_bf16 a[8:11], v[220:223], v[184:187], 0
    v_add_f32 v246, v246, v146
    v_add_f32 v247, v247, v169
    v_mfma_f32_16x16x32_bf16 a[28:31], v[224:227], v[184:187], 0
    v_exp_f32 v171, v171
    v_mfma_f32_16x16x32_bf16 a[48:51], v[228:231], v[184:187], 0
    v_exp_f32 v147, v147
    v_add_f32 v247, v247, v171
    v_cvt_pk_bf16_f32 v191, v170, v171
    v_mfma_f32_16x16x32_bf16 a[68:71], v[232:235], v[184:187], 0
    v_add_f32 v246, v246, v147
    v_mfma_f32_16x16x32_bf16 a[88:91], v[236:239], v[184:187], 0
    s_waitcnt vmcnt(5)
    buffer_load_dwordx4 v13, s[12:15], s31 offen offset:2048 nt lds
    v_mfma_f32_16x16x32_bf16 a[108:111], v[240:243], v[184:187], 0
    s_add_u32 m0, s34, 0
    v_exp_f32 v148, v148
    v_mfma_f32_16x16x32_bf16 a[112:115], v[240:243], v[188:191], 0
    s_add_u32 s30, s29, 0
    v_exp_f32 v172, v172
    v_mfma_f32_16x16x32_bf16 a[92:95], v[236:239], v[188:191], 0
    v_add_f32 v247, v247, v148
    v_exp_f32 v173, v173
    v_exp_f32 v174, v174
    v_exp_f32 v175, v175
    v_mfma_f32_16x16x32_bf16 a[72:75], v[232:235], v[188:191], 0
    v_exp_f32 v149, v149
    v_add_f32 v248, v248, v172
    v_add_f32 v248, v248, v173
    v_add_f32 v248, v248, v174
    v_add_f32 v248, v248, v175
    v_cvt_pk_bf16_f32 v194, v172, v173
    v_cvt_pk_bf16_f32 v195, v174, v175
    v_mfma_f32_16x16x32_bf16 a[52:55], v[228:231], v[188:191], 0
    v_add_f32 v247, v247, v149
    v_mfma_f32_16x16x32_bf16 a[32:35], v[224:227], v[188:191], 0
    v_mfma_f32_16x16x32_bf16 a[12:15], v[220:223], v[188:191], 0
    v_exp_f32 v150, v150
    v_mfma_f32_16x16x32_bf16 a[16:19], v[220:223], v[192:195], 0
    v_add_f32 v247, v247, v150
    v_mfma_f32_16x16x32_bf16 a[36:39], v[224:227], v[192:195], 0
    s_waitcnt vmcnt(5)
    buffer_load_dwordx4 v11, s[16:19], s30 offen nt lds
    v_mfma_f32_16x16x32_bf16 a[56:59], v[228:231], v[192:195], 0
    v_exp_f32 v151, v151
    v_mfma_f32_16x16x32_bf16 a[76:79], v[232:235], v[192:195], 0
    v_mfma_f32_16x16x32_bf16 a[96:99], v[236:239], v[192:195], 0
    v_add_f32 v247, v247, v151
    v_mfma_f32_16x16x32_bf16 a[116:119], v[240:243], v[192:195], 0
    s_waitcnt lgkmcnt(0)
    v_exp_f32 v152, v152
    v_mfma_f32_16x16x32_bf16 v[156:159], v[196:199], v[16:19], 0
    s_add_u32 s37, s37, 1
    ds_read_b64_tr_b16 v[220:221], v2 offset:128
    v_add_f32 v248, v248, v152
    v_mfma_f32_16x16x32_bf16 v[156:159], v[200:203], v[36:39], v[156:159]
    s_cmp_eq_u32 s37, 3
    ds_read_b64_tr_b16 v[222:223], v2 offset:6272
    v_accvgpr_read_b32 v249, a240
    v_mfma_f32_16x16x32_bf16 v[156:159], v[204:207], v[56:59], v[156:159]
    s_cselect_b32 s35, 0xfffe8000, s42
    v_exp_f32 v153, v153
    v_mfma_f32_16x16x32_bf16 v[156:159], v[208:211], v[76:79], v[156:159]
    s_cselect_b32 s37, 0, s37
    ds_read_b64_tr_b16 v[224:225], v3 offset:128
    v_add_f32 v248, v248, v153
    v_mfma_f32_16x16x32_bf16 v[156:159], v[212:215], v[96:99], v[156:159]
    s_waitcnt vmcnt(5)
    ds_read_b64_tr_b16 v[226:227], v3 offset:6272
    buffer_load_dwordx4 v12, s[16:19], s30 offen offset:1024 nt lds
    v_mfma_f32_16x16x32_bf16 v[156:159], v[216:219], v[116:119], v[156:159]
    v_exp_f32 v154, v154
    v_mfma_f32_16x16x32_bf16 v[160:163], v[216:219], v[120:123], 0
    ds_read_b64_tr_b16 v[228:229], v0 offset:256
    v_accvgpr_read_b32 v250, a241
    v_mfma_f32_16x16x32_bf16 v[160:163], v[212:215], v[100:103], v[160:163]
    ds_read_b64_tr_b16 v[230:231], v0 offset:6400
    v_add_f32 v248, v248, v154
    v_mfma_f32_16x16x32_bf16 v[160:163], v[208:211], v[80:83], v[160:163]
    v_exp_f32 v155, v155
    v_mfma_f32_16x16x32_bf16 v[160:163], v[204:207], v[60:63], v[160:163]
    ds_read_b64_tr_b16 v[232:233], v1 offset:256
    v_add_f32 v248, v248, v155
    v_mfma_f32_16x16x32_bf16 v[160:163], v[200:203], v[40:43], v[160:163]
    ds_read_b64_tr_b16 v[234:235], v1 offset:6400
    v_accvgpr_read_b32 v251, a242
    v_mfma_f32_16x16x32_bf16 v[160:163], v[196:199], v[20:23], v[160:163]
    v_exp_f32 v156, v156
    v_mfma_f32_16x16x32_bf16 v[164:167], v[196:199], v[24:27], 0
    ds_read_b64_tr_b16 v[236:237], v2 offset:256
    v_add_f32 v244, v244, v156
    v_mfma_f32_16x16x32_bf16 v[164:167], v[200:203], v[44:47], v[164:167]
    s_waitcnt vmcnt(5)
    ds_read_b64_tr_b16 v[238:239], v2 offset:6400
    buffer_load_dwordx4 v13, s[16:19], s30 offen offset:2048 nt lds
    v_mfma_f32_16x16x32_bf16 v[164:167], v[204:207], v[64:67], v[164:167]
    s_add_u32 m0, s34, 6144
    v_exp_f32 v157, v157
    v_mfma_f32_16x16x32_bf16 v[164:167], v[208:211], v[84:87], v[164:167]
    s_add_u32 s31, s29, 6144
    ds_read_b64_tr_b16 v[240:241], v3 offset:256
    v_accvgpr_read_b32 v252, a243
    v_mfma_f32_16x16x32_bf16 v[164:167], v[212:215], v[104:107], v[164:167]
    ds_read_b64_tr_b16 v[242:243], v3 offset:6400
    v_add_f32 v244, v244, v157
    v_mfma_f32_16x16x32_bf16 v[164:167], v[216:219], v[124:127], v[164:167]
    v_exp_f32 v158, v158
    v_mfma_f32_16x16x32_bf16 v[168:171], v[216:219], v[128:131], 0
    v_add_f32 v244, v244, v158
    v_mfma_f32_16x16x32_bf16 v[168:171], v[212:215], v[108:111], v[168:171]
    v_accvgpr_read_b32 v253, a244
    v_mfma_f32_16x16x32_bf16 v[168:171], v[208:211], v[88:91], v[168:171]
    v_exp_f32 v159, v159
    v_mfma_f32_16x16x32_bf16 v[168:171], v[204:207], v[68:71], v[168:171]
    v_add_f32 v244, v244, v159
    v_mfma_f32_16x16x32_bf16 v[168:171], v[200:203], v[48:51], v[168:171]
    s_waitcnt vmcnt(5)
    buffer_load_dwordx4 v11, s[16:19], s31 offen nt lds
    v_mfma_f32_16x16x32_bf16 v[168:171], v[196:199], v[28:31], v[168:171]
    v_exp_f32 v160, v160
    v_mfma_f32_16x16x32_bf16 v[172:175], v[196:199], v[32:35], 0
    v_mfma_f32_16x16x32_bf16 v[172:175], v[200:203], v[52:55], v[172:175]
    v_add_f32 v245, v245, v160
    v_mfma_f32_16x16x32_bf16 v[172:175], v[204:207], v[72:75], v[172:175]
    v_exp_f32 v161, v161
    v_mfma_f32_16x16x32_bf16 v[172:175], v[208:211], v[92:95], v[172:175]
    v_add_f32 v245, v245, v161
    v_mfma_f32_16x16x32_bf16 v[172:175], v[212:215], v[112:115], v[172:175]
    v_mfma_f32_16x16x32_bf16 v[172:175], v[216:219], v[132:135], v[172:175]
    s_waitcnt lgkmcnt(0)
    v_exp_f32 v162, v162
    v_mfma_f32_16x16x32_bf16 a[120:123], v[220:223], v[176:179], 0
    ds_read_b128 v[196:199], v14 offset:18432
    v_add_f32 v245, v245, v162
    v_mfma_f32_16x16x32_bf16 a[140:143], v[224:227], v[176:179], 0
    s_waitcnt vmcnt(5)
    ds_read_b128 v[200:203], v15 offset:18432
    buffer_load_dwordx4 v12, s[16:19], s31 offen offset:1024 nt lds
    v_mfma_f32_16x16x32_bf16 a[160:163], v[228:231], v[176:179], 0
    v_exp_f32 v163, v163
    v_mfma_f32_16x16x32_bf16 a[180:183], v[232:235], v[176:179], 0
    ds_read_b128 v[204:207], v14 offset:18560
    v_add_u32 v0, s35, v0
    v_mfma_f32_16x16x32_bf16 a[200:203], v[236:239], v[176:179], 0
    ds_read_b128 v[208:211], v15 offset:18560
    v_add_f32 v245, v245, v163
    v_mfma_f32_16x16x32_bf16 a[220:223], v[240:243], v[176:179], 0
    v_exp_f32 v164, v164
    v_mfma_f32_16x16x32_bf16 a[224:227], v[240:243], v[180:183], 0
    ds_read_b128 v[212:215], v14 offset:18688
    v_cvt_pk_bf16_f32 v176, v136, v137
    v_mfma_f32_16x16x32_bf16 a[204:207], v[236:239], v[180:183], 0
    ds_read_b128 v[216:219], v15 offset:18688
    v_cvt_pk_bf16_f32 v177, v138, v139
    v_mfma_f32_16x16x32_bf16 a[184:187], v[232:235], v[180:183], 0
    v_exp_f32 v165, v165
    v_mfma_f32_16x16x32_bf16 a[164:167], v[228:231], v[180:183], 0
    s_waitcnt vmcnt(5)
    v_cvt_pk_bf16_f32 v178, v156, v157
    buffer_load_dwordx4 v13, s[16:19], s31 offen offset:2048 nt lds
    v_mfma_f32_16x16x32_bf16 a[144:147], v[224:227], v[180:183], 0
    s_mov_b32 s79, s34
    v_cvt_pk_bf16_f32 v179, v158, v159
    v_add_f32 v246, v246, v164
    v_mfma_f32_16x16x32_bf16 a[124:127], v[220:223], v[180:183], 0
    s_add_u32 s29, s29, 12288
    v_exp_f32 v166, v166
    v_mfma_f32_16x16x32_bf16 a[128:131], v[220:223], v[184:187], 0
    s_add_u32 s34, s34, 49152
    v_add_u32 v1, s35, v1
    v_add_u32 v2, s35, v2
    v_mfma_f32_16x16x32_bf16 a[148:151], v[224:227], v[184:187], 0
    s_cmp_eq_u32 s34, s40
    v_add_f32 v246, v246, v165
    v_cvt_pk_bf16_f32 v182, v160, v161
    v_mfma_f32_16x16x32_bf16 a[168:171], v[228:231], v[184:187], 0
    s_cselect_b32 s34, s27, s34
    v_exp_f32 v167, v167
    v_mfma_f32_16x16x32_bf16 a[188:191], v[232:235], v[184:187], 0
    v_cvt_pk_bf16_f32 v180, v140, v141
    v_cvt_pk_bf16_f32 v183, v162, v163
    v_mfma_f32_16x16x32_bf16 a[208:211], v[236:239], v[184:187], 0
    v_cvt_pk_bf16_f32 v181, v142, v143
    v_add_f32 v246, v246, v166
    v_mfma_f32_16x16x32_bf16 a[228:231], v[240:243], v[184:187], 0
    v_exp_f32 v168, v168
    v_mfma_f32_16x16x32_bf16 a[232:235], v[240:243], v[188:191], 0
    v_add_f32 v246, v246, v167
    v_cvt_pk_bf16_f32 v187, v166, v167
    v_mfma_f32_16x16x32_bf16 a[212:215], v[236:239], v[188:191], 0
    v_cvt_pk_bf16_f32 v184, v144, v145
    v_add_f32 v247, v247, v168
    v_mfma_f32_16x16x32_bf16 a[192:195], v[232:235], v[188:191], 0
    v_exp_f32 v169, v169
    v_mfma_f32_16x16x32_bf16 a[172:175], v[228:231], v[188:191], 0
    v_cvt_pk_bf16_f32 v185, v146, v147
    v_add_u32 v3, s35, v3
    v_mfma_f32_16x16x32_bf16 a[152:155], v[224:227], v[188:191], 0
    v_cvt_pk_bf16_f32 v186, v164, v165
    v_add_u32 v14, s35, v14
    v_mfma_f32_16x16x32_bf16 a[132:135], v[220:223], v[188:191], 0
    v_exp_f32 v170, v170
    v_mfma_f32_16x16x32_bf16 a[136:139], v[220:223], v[192:195], 0
    v_add_f32 v247, v247, v169
    v_add_f32 v247, v247, v170
    v_mfma_f32_16x16x32_bf16 a[156:159], v[224:227], v[192:195], 0
    v_cvt_pk_bf16_f32 v188, v148, v149
    v_add_u32 v15, s35, v15
    v_mfma_f32_16x16x32_bf16 a[176:179], v[228:231], v[192:195], 0
    v_exp_f32 v171, v171
    v_mfma_f32_16x16x32_bf16 a[196:199], v[232:235], v[192:195], 0
    v_cvt_pk_bf16_f32 v189, v150, v151
    v_add_f32 v247, v247, v171
    v_mfma_f32_16x16x32_bf16 a[216:219], v[236:239], v[192:195], 0
    v_cvt_pk_bf16_f32 v190, v168, v169
    v_mfma_f32_16x16x32_bf16 a[236:239], v[240:243], v[192:195], 0
    s_waitcnt vmcnt(6) lgkmcnt(0)
    s_barrier
.p2align 3
L_attn:
    v_mfma_f32_16x16x32_bf16 v[136:139], v[196:199], v[16:19], 0
    s_add_u32 m0, s79, 12288
    v_exp_f32 v172, v172
    v_mfma_f32_16x16x32_bf16 v[136:139], v[200:203], v[36:39], v[136:139]
    s_add_u32 s30, s29, 6144
    ds_read_b64_tr_b16 v[220:221], v0 offset:0
    v_cvt_pk_bf16_f32 v191, v170, v171
    v_mfma_f32_16x16x32_bf16 v[136:139], v[204:207], v[56:59], v[136:139]
    v_exp_f32 v173, v173
    v_mfma_f32_16x16x32_bf16 v[136:139], v[208:211], v[76:79], v[136:139]
    s_waitcnt vmcnt(5)
    buffer_load_dwordx4 v11, s[12:15], s30 offen nt lds
    v_mfma_f32_16x16x32_bf16 v[136:139], v[212:215], v[96:99], v[136:139]
    ds_read_b64_tr_b16 v[222:223], v0 offset:6144
    v_cvt_pk_bf16_f32 v192, v152, v153
    v_mfma_f32_16x16x32_bf16 v[136:139], v[216:219], v[116:119], v[136:139]
    v_exp_f32 v174, v174
    v_mfma_f32_16x16x32_bf16 v[140:143], v[216:219], v[120:123], 0
    ds_read_b64_tr_b16 v[224:225], v1 offset:0
    v_cvt_pk_bf16_f32 v193, v154, v155
    v_mfma_f32_16x16x32_bf16 v[140:143], v[212:215], v[100:103], v[140:143]
    ds_read_b64_tr_b16 v[226:227], v1 offset:6144
    v_add_f32 v248, v248, v172
    v_mfma_f32_16x16x32_bf16 v[140:143], v[208:211], v[80:83], v[140:143]
    v_exp_f32 v175, v175
    v_mfma_f32_16x16x32_bf16 v[140:143], v[204:207], v[60:63], v[140:143]
    ds_read_b64_tr_b16 v[228:229], v2 offset:0
    v_cvt_pk_bf16_f32 v194, v172, v173
    v_mfma_f32_16x16x32_bf16 v[140:143], v[200:203], v[40:43], v[140:143]
    ds_read_b64_tr_b16 v[230:231], v2 offset:6144
    v_add_f32 v248, v248, v173
    v_mfma_f32_16x16x32_bf16 v[140:143], v[196:199], v[20:23], v[140:143]
    v_exp_f32 v136, v136
    v_mfma_f32_16x16x32_bf16 v[144:147], v[196:199], v[24:27], 0
    s_waitcnt vmcnt(5)
    buffer_load_dwordx4 v12, s[12:15], s30 offen offset:1024 nt lds
    v_mfma_f32_16x16x32_bf16 v[144:147], v[200:203], v[44:47], v[144:147]
    ds_read_b64_tr_b16 v[232:233], v3 offset:0
    v_add_f32 v244, v244, v136
    v_mfma_f32_16x16x32_bf16 v[144:147], v[204:207], v[64:67], v[144:147]
    v_exp_f32 v137, v137
    v_mfma_f32_16x16x32_bf16 v[144:147], v[208:211], v[84:87], v[144:147]
    ds_read_b64_tr_b16 v[234:235], v3 offset:6144
    v_add_f32 v244, v244, v137
    v_mfma_f32_16x16x32_bf16 v[144:147], v[212:215], v[104:107], v[144:147]
    ds_read_b64_tr_b16 v[236:237], v0 offset:128
    v_add_f32 v248, v248, v174
    v_mfma_f32_16x16x32_bf16 v[144:147], v[216:219], v[124:127], v[144:147]
    v_exp_f32 v138, v138
    v_mfma_f32_16x16x32_bf16 v[148:151], v[216:219], v[128:131], 0
    ds_read_b64_tr_b16 v[238:239], v0 offset:6272
    v_add_f32 v244, v244, v138
    v_mfma_f32_16x16x32_bf16 v[148:151], v[212:215], v[108:111], v[148:151]
    ds_read_b64_tr_b16 v[240:241], v1 offset:128
    v_cvt_pk_bf16_f32 v195, v174, v175
    v_mfma_f32_16x16x32_bf16 v[148:151], v[208:211], v[88:91], v[148:151]
    v_exp_f32 v139, v139
    v_mfma_f32_16x16x32_bf16 v[148:151], v[204:207], v[68:71], v[148:151]
    s_waitcnt vmcnt(5)
    buffer_load_dwordx4 v13, s[12:15], s30 offen offset:2048 nt lds
    v_mfma_f32_16x16x32_bf16 v[148:151], v[200:203], v[48:51], v[148:151]
    s_add_u32 m0, s79, 18432
    ds_read_b64_tr_b16 v[242:243], v1 offset:6272
    v_add_f32 v244, v244, v139
    v_mfma_f32_16x16x32_bf16 v[148:151], v[196:199], v[28:31], v[148:151]
    s_add_u32 s31, s29, 12288
    v_exp_f32 v140, v140
    v_mfma_f32_16x16x32_bf16 v[152:155], v[196:199], v[32:35], 0
    v_add_f32 v245, v245, v140
    v_add_f32 v248, v248, v175
    v_mfma_f32_16x16x32_bf16 v[152:155], v[200:203], v[52:55], v[152:155]
    v_mfma_f32_16x16x32_bf16 v[152:155], v[204:207], v[72:75], v[152:155]
    v_exp_f32 v141, v141
    v_mfma_f32_16x16x32_bf16 v[152:155], v[208:211], v[92:95], v[152:155]
    v_add_f32 v245, v245, v141
    v_mfma_f32_16x16x32_bf16 v[152:155], v[212:215], v[112:115], v[152:155]
    v_mfma_f32_16x16x32_bf16 v[152:155], v[216:219], v[132:135], v[152:155]
    s_waitcnt lgkmcnt(0)
    v_exp_f32 v142, v142
    v_mfma_f32_16x16x32_bf16 a[0:3], v[220:223], v[176:179], a[0:3]
    s_waitcnt vmcnt(5)
    buffer_load_dwordx4 v11, s[12:15], s31 offen nt lds
    v_mfma_f32_16x16x32_bf16 a[20:23], v[224:227], v[176:179], a[20:23]
    ds_read_b128 v[196:199], v14 offset:12288
    v_add_f32 v245, v245, v142
    v_mfma_f32_16x16x32_bf16 a[40:43], v[228:231], v[176:179], a[40:43]
    v_exp_f32 v143, v143
    v_mfma_f32_16x16x32_bf16 a[60:63], v[232:235], v[176:179], a[60:63]
    ds_read_b128 v[200:203], v15 offset:12288
    v_add_f32 v245, v245, v143
    v_mfma_f32_16x16x32_bf16 a[80:83], v[236:239], v[176:179], a[80:83]
    ds_read_b128 v[204:207], v14 offset:12416
    v_mfma_f32_16x16x32_bf16 a[100:103], v[240:243], v[176:179], a[100:103]
    v_exp_f32 v144, v144
    v_mfma_f32_16x16x32_bf16 a[104:107], v[240:243], v[180:183], a[104:107]
    ds_read_b128 v[208:211], v15 offset:12416
    v_add_f32 v246, v246, v144
    v_mfma_f32_16x16x32_bf16 a[84:87], v[236:239], v[180:183], a[84:87]
    ds_read_b128 v[212:215], v14 offset:12544
    v_mfma_f32_16x16x32_bf16 a[64:67], v[232:235], v[180:183], a[64:67]
    v_exp_f32 v145, v145
    v_mfma_f32_16x16x32_bf16 a[44:47], v[228:231], v[180:183], a[44:47]
    s_waitcnt vmcnt(5)
    buffer_load_dwordx4 v12, s[12:15], s31 offen offset:1024 nt lds
    v_mfma_f32_16x16x32_bf16 a[24:27], v[224:227], v[180:183], a[24:27]
    ds_read_b128 v[216:219], v15 offset:12544
    v_add_f32 v246, v246, v145
    v_mfma_f32_16x16x32_bf16 a[4:7], v[220:223], v[180:183], a[4:7]
    v_exp_f32 v146, v146
    v_mfma_f32_16x16x32_bf16 a[8:11], v[220:223], v[184:187], a[8:11]
    v_add_f32 v246, v246, v146
    v_mfma_f32_16x16x32_bf16 a[28:31], v[224:227], v[184:187], a[28:31]
    v_mfma_f32_16x16x32_bf16 a[48:51], v[228:231], v[184:187], a[48:51]
    v_exp_f32 v147, v147
    v_mfma_f32_16x16x32_bf16 a[68:71], v[232:235], v[184:187], a[68:71]
    v_add_f32 v246, v246, v147
    v_mfma_f32_16x16x32_bf16 a[88:91], v[236:239], v[184:187], a[88:91]
    v_mfma_f32_16x16x32_bf16 a[108:111], v[240:243], v[184:187], a[108:111]
    v_exp_f32 v148, v148
    v_mfma_f32_16x16x32_bf16 a[112:115], v[240:243], v[188:191], a[112:115]
    s_waitcnt vmcnt(5)
    buffer_load_dwordx4 v13, s[12:15], s31 offen offset:2048 nt lds
    v_mfma_f32_16x16x32_bf16 a[92:95], v[236:239], v[188:191], a[92:95]
    s_add_u32 m0, s34, 0
    v_add_f32 v247, v247, v148
    v_mfma_f32_16x16x32_bf16 a[72:75], v[232:235], v[188:191], a[72:75]
    s_add_u32 s30, s29, 0
    v_exp_f32 v149, v149
    v_mfma_f32_16x16x32_bf16 a[52:55], v[228:231], v[188:191], a[52:55]
    v_add_f32 v247, v247, v149
    v_mfma_f32_16x16x32_bf16 a[32:35], v[224:227], v[188:191], a[32:35]
    v_mfma_f32_16x16x32_bf16 a[12:15], v[220:223], v[188:191], a[12:15]
    v_exp_f32 v150, v150
    v_mfma_f32_16x16x32_bf16 a[16:19], v[220:223], v[192:195], a[16:19]
    v_add_f32 v247, v247, v150
    v_mfma_f32_16x16x32_bf16 a[36:39], v[224:227], v[192:195], a[36:39]
    v_mfma_f32_16x16x32_bf16 a[56:59], v[228:231], v[192:195], a[56:59]
    v_exp_f32 v151, v151
    v_mfma_f32_16x16x32_bf16 a[76:79], v[232:235], v[192:195], a[76:79]
    s_waitcnt vmcnt(5)
    buffer_load_dwordx4 v11, s[16:19], s30 offen nt lds
    v_mfma_f32_16x16x32_bf16 a[96:99], v[236:239], v[192:195], a[96:99]
    v_add_f32 v247, v247, v151
    v_mfma_f32_16x16x32_bf16 a[116:119], v[240:243], v[192:195], a[116:119]
    s_waitcnt lgkmcnt(0)
    v_exp_f32 v152, v152
    v_mfma_f32_16x16x32_bf16 v[156:159], v[196:199], v[16:19], 0
    s_add_u32 s37, s37, 1
    ds_read_b64_tr_b16 v[220:221], v2 offset:128
    v_add_f32 v248, v248, v152
    v_mfma_f32_16x16x32_bf16 v[156:159], v[200:203], v[36:39], v[156:159]
    s_cmp_eq_u32 s37, 3
    ds_read_b64_tr_b16 v[222:223], v2 offset:6272
    v_mfma_f32_16x16x32_bf16 v[156:159], v[204:207], v[56:59], v[156:159]
    s_cselect_b32 s35, 0xfffe8000, s42
    v_exp_f32 v153, v153
    v_mfma_f32_16x16x32_bf16 v[156:159], v[208:211], v[76:79], v[156:159]
    s_cselect_b32 s37, 0, s37
    ds_read_b64_tr_b16 v[224:225], v3 offset:128
    v_add_f32 v248, v248, v153
    v_mfma_f32_16x16x32_bf16 v[156:159], v[212:215], v[96:99], v[156:159]
    ds_read_b64_tr_b16 v[226:227], v3 offset:6272
    v_mfma_f32_16x16x32_bf16 v[156:159], v[216:219], v[116:119], v[156:159]
    v_exp_f32 v154, v154
    v_mfma_f32_16x16x32_bf16 v[160:163], v[216:219], v[120:123], 0
    s_waitcnt vmcnt(5)
    buffer_load_dwordx4 v12, s[16:19], s30 offen offset:1024 nt lds
    v_mfma_f32_16x16x32_bf16 v[160:163], v[212:215], v[100:103], v[160:163]
    ds_read_b64_tr_b16 v[228:229], v0 offset:256
    v_add_f32 v248, v248, v154
    v_mfma_f32_16x16x32_bf16 v[160:163], v[208:211], v[80:83], v[160:163]
    v_exp_f32 v155, v155
    v_mfma_f32_16x16x32_bf16 v[160:163], v[204:207], v[60:63], v[160:163]
    ds_read_b64_tr_b16 v[230:231], v0 offset:6400
    v_add_f32 v248, v248, v155
    v_mfma_f32_16x16x32_bf16 v[160:163], v[200:203], v[40:43], v[160:163]
    ds_read_b64_tr_b16 v[232:233], v1 offset:256
    v_mfma_f32_16x16x32_bf16 v[160:163], v[196:199], v[20:23], v[160:163]
    v_exp_f32 v156, v156
    v_mfma_f32_16x16x32_bf16 v[164:167], v[196:199], v[24:27], 0
    ds_read_b64_tr_b16 v[234:235], v1 offset:6400
    v_add_f32 v244, v244, v156
    v_mfma_f32_16x16x32_bf16 v[164:167], v[200:203], v[44:47], v[164:167]
    ds_read_b64_tr_b16 v[236:237], v2 offset:256
    v_mfma_f32_16x16x32_bf16 v[164:167], v[204:207], v[64:67], v[164:167]
    v_exp_f32 v157, v157
    v_mfma_f32_16x16x32_bf16 v[164:167], v[208:211], v[84:87], v[164:167]
    s_waitcnt vmcnt(5)
    buffer_load_dwordx4 v13, s[16:19], s30 offen offset:2048 nt lds
    v_mfma_f32_16x16x32_bf16 v[164:167], v[212:215], v[104:107], v[164:167]
    s_add_u32 m0, s34, 6144
    ds_read_b64_tr_b16 v[238:239], v2 offset:6400
    v_add_f32 v244, v244, v157
    v_mfma_f32_16x16x32_bf16 v[164:167], v[216:219], v[124:127], v[164:167]
    s_add_u32 s31, s29, 6144
    v_exp_f32 v158, v158
    v_mfma_f32_16x16x32_bf16 v[168:171], v[216:219], v[128:131], 0
    ds_read_b64_tr_b16 v[240:241], v3 offset:256
    v_add_f32 v244, v244, v158
    v_mfma_f32_16x16x32_bf16 v[168:171], v[212:215], v[108:111], v[168:171]
    ds_read_b64_tr_b16 v[242:243], v3 offset:6400
    v_mfma_f32_16x16x32_bf16 v[168:171], v[208:211], v[88:91], v[168:171]
    v_exp_f32 v159, v159
    v_mfma_f32_16x16x32_bf16 v[168:171], v[204:207], v[68:71], v[168:171]
    v_add_f32 v244, v244, v159
    v_mfma_f32_16x16x32_bf16 v[168:171], v[200:203], v[48:51], v[168:171]
    v_mfma_f32_16x16x32_bf16 v[168:171], v[196:199], v[28:31], v[168:171]
    v_exp_f32 v160, v160
    v_mfma_f32_16x16x32_bf16 v[172:175], v[196:199], v[32:35], 0
    s_waitcnt vmcnt(5)
    buffer_load_dwordx4 v11, s[16:19], s31 offen nt lds
    v_mfma_f32_16x16x32_bf16 v[172:175], v[200:203], v[52:55], v[172:175]
    v_add_f32 v245, v245, v160
    v_mfma_f32_16x16x32_bf16 v[172:175], v[204:207], v[72:75], v[172:175]
    v_exp_f32 v161, v161
    v_mfma_f32_16x16x32_bf16 v[172:175], v[208:211], v[92:95], v[172:175]
    v_add_f32 v245, v245, v161
    v_mfma_f32_16x16x32_bf16 v[172:175], v[212:215], v[112:115], v[172:175]
    v_mfma_f32_16x16x32_bf16 v[172:175], v[216:219], v[132:135], v[172:175]
    s_waitcnt lgkmcnt(0)
    v_exp_f32 v162, v162
    v_mfma_f32_16x16x32_bf16 a[120:123], v[220:223], v[176:179], a[120:123]
    ds_read_b128 v[196:199], v14 offset:18432
    v_add_f32 v245, v245, v162
    v_mfma_f32_16x16x32_bf16 a[140:143], v[224:227], v[176:179], a[140:143]
    ds_read_b128 v[200:203], v15 offset:18432
    v_add_u32 v0, s35, v0
    v_mfma_f32_16x16x32_bf16 a[160:163], v[228:231], v[176:179], a[160:163]
    v_exp_f32 v163, v163
    v_mfma_f32_16x16x32_bf16 a[180:183], v[232:235], v[176:179], a[180:183]
    s_waitcnt vmcnt(5)
    buffer_load_dwordx4 v12, s[16:19], s31 offen offset:1024 nt lds
    v_mfma_f32_16x16x32_bf16 a[200:203], v[236:239], v[176:179], a[200:203]
    ds_read_b128 v[204:207], v14 offset:18560
    v_add_f32 v245, v245, v163
    v_mfma_f32_16x16x32_bf16 a[220:223], v[240:243], v[176:179], a[220:223]
    v_exp_f32 v164, v164
    v_mfma_f32_16x16x32_bf16 a[224:227], v[240:243], v[180:183], a[224:227]
    ds_read_b128 v[208:211], v15 offset:18560
    v_cvt_pk_bf16_f32 v176, v136, v137
    v_mfma_f32_16x16x32_bf16 a[204:207], v[236:239], v[180:183], a[204:207]
    ds_read_b128 v[212:215], v14 offset:18688
    v_cvt_pk_bf16_f32 v177, v138, v139
    v_mfma_f32_16x16x32_bf16 a[184:187], v[232:235], v[180:183], a[184:187]
    v_exp_f32 v165, v165
    v_mfma_f32_16x16x32_bf16 a[164:167], v[228:231], v[180:183], a[164:167]
    ds_read_b128 v[216:219], v15 offset:18688
    v_cvt_pk_bf16_f32 v178, v156, v157
    v_mfma_f32_16x16x32_bf16 a[144:147], v[224:227], v[180:183], a[144:147]
    v_cvt_pk_bf16_f32 v179, v158, v159
    v_add_f32 v246, v246, v164
    v_mfma_f32_16x16x32_bf16 a[124:127], v[220:223], v[180:183], a[124:127]
    v_exp_f32 v166, v166
    v_add_u32 v15, s35, v15
    v_mfma_f32_16x16x32_bf16 a[128:131], v[220:223], v[184:187], a[128:131]
    s_waitcnt vmcnt(5)
    buffer_load_dwordx4 v13, s[16:19], s31 offen offset:2048 nt lds
    v_mfma_f32_16x16x32_bf16 a[148:151], v[224:227], v[184:187], a[148:151]
    s_mov_b32 s79, s34
    v_add_f32 v246, v246, v165
    v_cvt_pk_bf16_f32 v182, v160, v161
    v_mfma_f32_16x16x32_bf16 a[168:171], v[228:231], v[184:187], a[168:171]
    s_add_u32 s29, s29, 12288
    v_exp_f32 v167, v167
    v_mfma_f32_16x16x32_bf16 a[188:191], v[232:235], v[184:187], a[188:191]
    s_add_u32 s34, s34, 49152
    v_cvt_pk_bf16_f32 v180, v140, v141
    v_cvt_pk_bf16_f32 v183, v162, v163
    v_mfma_f32_16x16x32_bf16 a[208:211], v[236:239], v[184:187], a[208:211]
    s_cmp_eq_u32 s34, s40
    v_cvt_pk_bf16_f32 v181, v142, v143
    v_add_f32 v246, v246, v166
    v_mfma_f32_16x16x32_bf16 a[228:231], v[240:243], v[184:187], a[228:231]
    s_cselect_b32 s34, s27, s34
    v_exp_f32 v168, v168
    v_mfma_f32_16x16x32_bf16 a[232:235], v[240:243], v[188:191], a[232:235]
    v_add_f32 v246, v246, v167
    v_cvt_pk_bf16_f32 v187, v166, v167
    v_mfma_f32_16x16x32_bf16 a[212:215], v[236:239], v[188:191], a[212:215]
    v_cvt_pk_bf16_f32 v184, v144, v145
    v_add_f32 v247, v247, v168
    v_mfma_f32_16x16x32_bf16 a[192:195], v[232:235], v[188:191], a[192:195]
    v_exp_f32 v169, v169
    v_mfma_f32_16x16x32_bf16 a[172:175], v[228:231], v[188:191], a[172:175]
    v_cvt_pk_bf16_f32 v185, v146, v147
    v_add_u32 v1, s35, v1
    v_mfma_f32_16x16x32_bf16 a[152:155], v[224:227], v[188:191], a[152:155]
    v_cvt_pk_bf16_f32 v186, v164, v165
    v_add_u32 v2, s35, v2
    v_mfma_f32_16x16x32_bf16 a[132:135], v[220:223], v[188:191], a[132:135]
    v_exp_f32 v170, v170
    v_mfma_f32_16x16x32_bf16 a[136:139], v[220:223], v[192:195], a[136:139]
    v_add_f32 v247, v247, v169
    v_add_f32 v247, v247, v170
    v_mfma_f32_16x16x32_bf16 a[156:159], v[224:227], v[192:195], a[156:159]
    v_cvt_pk_bf16_f32 v188, v148, v149
    v_add_u32 v3, s35, v3
    v_mfma_f32_16x16x32_bf16 a[176:179], v[228:231], v[192:195], a[176:179]
    s_sub_u32 s36, s36, 1
    v_exp_f32 v171, v171
    v_mfma_f32_16x16x32_bf16 a[196:199], v[232:235], v[192:195], a[196:199]
    s_cmp_lg_u32 s36, 0
    v_cvt_pk_bf16_f32 v189, v150, v151
    v_add_f32 v247, v247, v171
    v_mfma_f32_16x16x32_bf16 a[216:219], v[236:239], v[192:195], a[216:219]
    v_cvt_pk_bf16_f32 v190, v168, v169
    v_add_u32 v14, s35, v14
    v_mfma_f32_16x16x32_bf16 a[236:239], v[240:243], v[192:195], a[236:239]
    s_waitcnt vmcnt(6) lgkmcnt(0)
    s_barrier
    s_cbranch_scc1 L_attn
    s_cmp_eq_u32 s29, 196608
    s_cbranch_scc1 L_attn_done
    s_getpc_b64 s[44:45]
    s_mov_b32 s46, L_end - . - 16
    s_mov_b32 s47, 0x20000
    s_lshr_b32 s43, s2, 3
    s_lshl_b32 s43, s43, 2
    s_add_u32 s43, s43, s24
    s_lshl_b32 s43, s43, 7
    v_lshlrev_b32 v255, 10, v254

    buffer_load_dword a255, v255, s[44:47], s43 offen
    s_cmp_eq_u32 s84, 0
    s_cselect_b32 s36, 4, 4
    s_branch L_attn
L_attn_done:
    s_cmp_lg_u32 s28, 1
    s_cbranch_scc1 L_ato
    v_mfma_f32_16x16x32_bf16 v[136:139], v[196:199], v[16:19], 0
    s_add_u32 m0, s25, 98304
    v_exp_f32 v172, v172
    v_mfma_f32_16x16x32_bf16 v[136:139], v[200:203], v[36:39], v[136:139]
    s_mov_b32 s30, 0
    ds_read_b64_tr_b16 v[220:221], v0 offset:0
    v_cvt_pk_bf16_f32 v191, v170, v171
    v_mfma_f32_16x16x32_bf16 v[136:139], v[204:207], v[56:59], v[136:139]
    v_exp_f32 v173, v173
    v_mfma_f32_16x16x32_bf16 v[136:139], v[208:211], v[76:79], v[136:139]
    buffer_load_dwordx4 v6, s[8:11], s30 offen lds
    v_mfma_f32_16x16x32_bf16 v[136:139], v[212:215], v[96:99], v[136:139]
    v_cvt_pk_bf16_f32 v192, v152, v153
    v_accvgpr_read_b32 v249, a249
    v_mfma_f32_16x16x32_bf16 v[136:139], v[216:219], v[116:119], v[136:139]
    v_exp_f32 v174, v174
    v_mfma_f32_16x16x32_bf16 v[140:143], v[216:219], v[120:123], 0
    v_cvt_pk_bf16_f32 v193, v154, v155
    v_accvgpr_read_b32 v250, a252
    v_mfma_f32_16x16x32_bf16 v[140:143], v[212:215], v[100:103], v[140:143]
    ds_read_b64_tr_b16 v[222:223], v0 offset:6144
    v_add_f32 v248, v248, v172
    v_mfma_f32_16x16x32_bf16 v[140:143], v[208:211], v[80:83], v[140:143]
    v_exp_f32 v175, v175
    v_mfma_f32_16x16x32_bf16 v[140:143], v[204:207], v[60:63], v[140:143]
    ds_read_b64_tr_b16 v[224:225], v1 offset:0
    v_cvt_pk_bf16_f32 v194, v172, v173
    v_mfma_f32_16x16x32_bf16 v[140:143], v[200:203], v[40:43], v[140:143]
    ds_read_b64_tr_b16 v[226:227], v1 offset:6144
    v_add_f32 v248, v248, v173
    v_mfma_f32_16x16x32_bf16 v[140:143], v[196:199], v[20:23], v[140:143]
    v_exp_f32 v136, v136
    v_mfma_f32_16x16x32_bf16 v[144:147], v[196:199], v[24:27], 0
    buffer_load_dwordx4 v7, s[8:11], s30 offen offset:1024 lds
    v_mfma_f32_16x16x32_bf16 v[144:147], v[200:203], v[44:47], v[144:147]
    ds_read_b64_tr_b16 v[228:229], v2 offset:0
    v_add_f32 v244, v244, v136
    v_mfma_f32_16x16x32_bf16 v[144:147], v[204:207], v[64:67], v[144:147]
    v_exp_f32 v137, v137
    v_mfma_f32_16x16x32_bf16 v[144:147], v[208:211], v[84:87], v[144:147]
    ds_read_b64_tr_b16 v[230:231], v2 offset:6144
    v_add_f32 v244, v244, v137
    v_mfma_f32_16x16x32_bf16 v[144:147], v[212:215], v[104:107], v[144:147]
    ds_read_b64_tr_b16 v[232:233], v3 offset:0
    v_add_f32 v248, v248, v174
    v_mfma_f32_16x16x32_bf16 v[144:147], v[216:219], v[124:127], v[144:147]
    v_exp_f32 v138, v138
    v_mfma_f32_16x16x32_bf16 v[148:151], v[216:219], v[128:131], 0
    buffer_load_dwordx4 v8, s[8:11], s30 offen offset:2048 lds
    v_mfma_f32_16x16x32_bf16 v[148:151], v[212:215], v[108:111], v[148:151]
    s_add_u32 m0, s25, 110592
    ds_read_b64_tr_b16 v[234:235], v3 offset:6144
    v_cvt_pk_bf16_f32 v195, v174, v175
    v_mfma_f32_16x16x32_bf16 v[148:151], v[208:211], v[88:91], v[148:151]
    s_mov_b32 s31, 393216
    v_exp_f32 v139, v139
    v_mfma_f32_16x16x32_bf16 v[148:151], v[204:207], v[68:71], v[148:151]
    ds_read_b64_tr_b16 v[236:237], v0 offset:128
    v_add_f32 v244, v244, v138
    v_mfma_f32_16x16x32_bf16 v[148:151], v[200:203], v[48:51], v[148:151]
    buffer_load_dwordx4 v6, s[8:11], s31 offen lds
    v_mfma_f32_16x16x32_bf16 v[148:151], v[196:199], v[28:31], v[148:151]
    v_exp_f32 v140, v140
    v_mfma_f32_16x16x32_bf16 v[152:155], v[196:199], v[32:35], 0
    ds_read_b64_tr_b16 v[238:239], v0 offset:6272
    v_add_f32 v248, v248, v175
    ds_read_b64_tr_b16 v[240:241], v1 offset:128
    ds_read_b64_tr_b16 v[242:243], v1 offset:6272
    v_mfma_f32_16x16x32_bf16 v[152:155], v[200:203], v[52:55], v[152:155]
    v_add_f32 v244, v244, v139
    v_add_f32 v245, v245, v140
    v_mfma_f32_16x16x32_bf16 v[152:155], v[204:207], v[72:75], v[152:155]
    v_exp_f32 v141, v141
    v_mfma_f32_16x16x32_bf16 v[152:155], v[208:211], v[92:95], v[152:155]
    buffer_load_dwordx4 v7, s[8:11], s31 offen offset:1024 lds
    v_mfma_f32_16x16x32_bf16 v[152:155], v[212:215], v[112:115], v[152:155]
    v_add_f32 v245, v245, v141
    v_mfma_f32_16x16x32_bf16 v[152:155], v[216:219], v[132:135], v[152:155]
    s_waitcnt lgkmcnt(0)
    v_exp_f32 v142, v142
    v_mfma_f32_16x16x32_bf16 a[0:3], v[220:223], v[176:179], a[0:3]
    ds_read_b128 v[196:199], v14 offset:12288
    v_add_f32 v245, v245, v142
    v_mfma_f32_16x16x32_bf16 a[20:23], v[224:227], v[176:179], a[20:23]
    buffer_load_dwordx4 v8, s[8:11], s31 offen offset:2048 lds
    v_mfma_f32_16x16x32_bf16 a[40:43], v[228:231], v[176:179], a[40:43]
    s_add_u32 m0, s26, 122880
    v_exp_f32 v143, v143
    v_mfma_f32_16x16x32_bf16 a[60:63], v[232:235], v[176:179], a[60:63]
    s_mov_b32 s32, 128
    ds_read_b128 v[200:203], v15 offset:12288
    v_add_f32 v245, v245, v143
    v_mfma_f32_16x16x32_bf16 a[80:83], v[236:239], v[176:179], a[80:83]
    ds_read_b128 v[204:207], v14 offset:12416
    v_mfma_f32_16x16x32_bf16 a[100:103], v[240:243], v[176:179], a[100:103]
    v_exp_f32 v144, v144
    v_mfma_f32_16x16x32_bf16 a[104:107], v[240:243], v[180:183], a[104:107]
    buffer_load_dwordx4 v9, s[4:7], s32 offen lds
    v_mfma_f32_16x16x32_bf16 a[84:87], v[236:239], v[180:183], a[84:87]
    s_mov_b32 s33, 9344
    ds_read_b128 v[208:211], v15 offset:12416
    v_add_f32 v246, v246, v144
    v_mfma_f32_16x16x32_bf16 a[64:67], v[232:235], v[180:183], a[64:67]
    v_exp_f32 v145, v145
    v_mfma_f32_16x16x32_bf16 a[44:47], v[228:231], v[180:183], a[44:47]
    ds_read_b128 v[212:215], v14 offset:12544
    v_add_f32 v246, v246, v145
    v_mfma_f32_16x16x32_bf16 a[24:27], v[224:227], v[180:183], a[24:27]
    buffer_load_dwordx4 v10, s[4:7], s33 offen offset:1024 lds
    v_mfma_f32_16x16x32_bf16 a[4:7], v[220:223], v[180:183], a[4:7]
    s_mov_b32 s32, 18560
    v_exp_f32 v146, v146
    v_mfma_f32_16x16x32_bf16 a[8:11], v[220:223], v[184:187], a[8:11]
    ds_read_b128 v[216:219], v15 offset:12544
    v_add_f32 v246, v246, v146
    v_mfma_f32_16x16x32_bf16 a[28:31], v[224:227], v[184:187], a[28:31]
    v_mfma_f32_16x16x32_bf16 a[48:51], v[228:231], v[184:187], a[48:51]
    v_exp_f32 v147, v147
    v_mfma_f32_16x16x32_bf16 a[68:71], v[232:235], v[184:187], a[68:71]
    buffer_load_dwordx4 v9, s[4:7], s32 offen offset:2048 lds
    v_mfma_f32_16x16x32_bf16 a[88:91], v[236:239], v[184:187], a[88:91]
    s_mov_b32 s33, 27776
    v_add_f32 v246, v246, v147
    v_mfma_f32_16x16x32_bf16 a[108:111], v[240:243], v[184:187], a[108:111]
    v_exp_f32 v148, v148
    v_mfma_f32_16x16x32_bf16 a[112:115], v[240:243], v[188:191], a[112:115]
    v_add_f32 v247, v247, v148
    v_mfma_f32_16x16x32_bf16 a[92:95], v[236:239], v[188:191], a[92:95]
    buffer_load_dwordx4 v10, s[4:7], s33 offen offset:3072 lds
    v_mfma_f32_16x16x32_bf16 a[72:75], v[232:235], v[188:191], a[72:75]
    s_add_u32 m0, s26, 126976
    v_exp_f32 v149, v149
    v_mfma_f32_16x16x32_bf16 a[52:55], v[228:231], v[188:191], a[52:55]
    s_mov_b32 s32, 41088
    v_add_f32 v247, v247, v149
    v_mfma_f32_16x16x32_bf16 a[32:35], v[224:227], v[188:191], a[32:35]
    v_mfma_f32_16x16x32_bf16 a[12:15], v[220:223], v[188:191], a[12:15]
    v_exp_f32 v150, v150
    v_mfma_f32_16x16x32_bf16 a[16:19], v[220:223], v[192:195], a[16:19]
    buffer_load_dwordx4 v9, s[4:7], s32 offen lds
    v_mfma_f32_16x16x32_bf16 a[36:39], v[224:227], v[192:195], a[36:39]
    s_mov_b32 s33, 50304
    v_add_f32 v247, v247, v150
    v_mfma_f32_16x16x32_bf16 a[56:59], v[228:231], v[192:195], a[56:59]
    v_exp_f32 v151, v151
    v_mfma_f32_16x16x32_bf16 a[76:79], v[232:235], v[192:195], a[76:79]
    v_add_f32 v247, v247, v151
    v_mfma_f32_16x16x32_bf16 a[96:99], v[236:239], v[192:195], a[96:99]
    buffer_load_dwordx4 v10, s[4:7], s33 offen offset:1024 lds
    v_mfma_f32_16x16x32_bf16 a[116:119], v[240:243], v[192:195], a[116:119]
    s_waitcnt lgkmcnt(0)
    v_exp_f32 v152, v152
    v_mfma_f32_16x16x32_bf16 v[156:159], v[196:199], v[16:19], 0
    s_mov_b32 s32, 59520
    ds_read_b64_tr_b16 v[220:221], v2 offset:128
    v_add_f32 v248, v248, v152
    v_mfma_f32_16x16x32_bf16 v[156:159], v[200:203], v[36:39], v[156:159]
    ds_read_b64_tr_b16 v[222:223], v2 offset:6272
    v_mfma_f32_16x16x32_bf16 v[156:159], v[204:207], v[56:59], v[156:159]
    v_exp_f32 v153, v153
    v_mfma_f32_16x16x32_bf16 v[156:159], v[208:211], v[76:79], v[156:159]
    buffer_load_dwordx4 v9, s[4:7], s32 offen offset:2048 lds
    v_mfma_f32_16x16x32_bf16 v[156:159], v[212:215], v[96:99], v[156:159]
    s_mov_b32 s33, 68736
    ds_read_b64_tr_b16 v[224:225], v3 offset:128
    v_add_f32 v248, v248, v153
    v_mfma_f32_16x16x32_bf16 v[156:159], v[216:219], v[116:119], v[156:159]
    v_exp_f32 v154, v154
    v_mfma_f32_16x16x32_bf16 v[160:163], v[216:219], v[120:123], 0
    ds_read_b64_tr_b16 v[226:227], v3 offset:6272
    v_add_f32 v248, v248, v154
    v_mfma_f32_16x16x32_bf16 v[160:163], v[212:215], v[100:103], v[160:163]
    buffer_load_dwordx4 v10, s[4:7], s33 offen offset:3072 lds
    v_mfma_f32_16x16x32_bf16 v[160:163], v[208:211], v[80:83], v[160:163]
    s_add_u32 m0, s26, 131072
    v_exp_f32 v155, v155
    v_mfma_f32_16x16x32_bf16 v[160:163], v[204:207], v[60:63], v[160:163]
    s_mov_b32 s32, 82048
    ds_read_b64_tr_b16 v[228:229], v0 offset:256
    v_add_f32 v248, v248, v155
    v_mfma_f32_16x16x32_bf16 v[160:163], v[200:203], v[40:43], v[160:163]
    ds_read_b64_tr_b16 v[230:231], v0 offset:6400
    v_mfma_f32_16x16x32_bf16 v[160:163], v[196:199], v[20:23], v[160:163]
    v_exp_f32 v156, v156
    v_mfma_f32_16x16x32_bf16 v[164:167], v[196:199], v[24:27], 0
    buffer_load_dwordx4 v9, s[4:7], s32 offen lds
    v_mfma_f32_16x16x32_bf16 v[164:167], v[200:203], v[44:47], v[164:167]
    s_mov_b32 s33, 91264
    ds_read_b64_tr_b16 v[232:233], v1 offset:256
    v_add_f32 v244, v244, v156
    v_mfma_f32_16x16x32_bf16 v[164:167], v[204:207], v[64:67], v[164:167]
    v_exp_f32 v157, v157
    v_mfma_f32_16x16x32_bf16 v[164:167], v[208:211], v[84:87], v[164:167]
    ds_read_b64_tr_b16 v[234:235], v1 offset:6400
    v_add_f32 v244, v244, v157
    v_mfma_f32_16x16x32_bf16 v[164:167], v[212:215], v[104:107], v[164:167]
    buffer_load_dwordx4 v10, s[4:7], s33 offen offset:1024 lds
    v_mfma_f32_16x16x32_bf16 v[164:167], v[216:219], v[124:127], v[164:167]
    v_exp_f32 v158, v158
    v_mfma_f32_16x16x32_bf16 v[168:171], v[216:219], v[128:131], 0
    ds_read_b64_tr_b16 v[236:237], v2 offset:256
    v_add_f32 v244, v244, v158
    v_mfma_f32_16x16x32_bf16 v[168:171], v[212:215], v[108:111], v[168:171]
    ds_read_b64_tr_b16 v[238:239], v2 offset:6400
    v_mfma_f32_16x16x32_bf16 v[168:171], v[208:211], v[88:91], v[168:171]
    v_exp_f32 v159, v159
    v_mfma_f32_16x16x32_bf16 v[168:171], v[204:207], v[68:71], v[168:171]
    ds_read_b64_tr_b16 v[240:241], v3 offset:256
    v_add_f32 v244, v244, v159
    v_mfma_f32_16x16x32_bf16 v[168:171], v[200:203], v[48:51], v[168:171]
    ds_read_b64_tr_b16 v[242:243], v3 offset:6400
    v_mfma_f32_16x16x32_bf16 v[168:171], v[196:199], v[28:31], v[168:171]
    v_exp_f32 v160, v160
    v_mfma_f32_16x16x32_bf16 v[172:175], v[196:199], v[32:35], 0
    v_add_u32 v0, 0xc000, v0
    v_add_u32 v2, 0xc000, v2
    v_mfma_f32_16x16x32_bf16 v[172:175], v[200:203], v[52:55], v[172:175]
    v_add_u32 v1, 0xc000, v1
    v_add_u32 v3, 0xc000, v3
    v_mfma_f32_16x16x32_bf16 v[172:175], v[204:207], v[72:75], v[172:175]
    v_exp_f32 v161, v161
    v_mfma_f32_16x16x32_bf16 v[172:175], v[208:211], v[92:95], v[172:175]
    v_add_f32 v245, v245, v160
    v_mfma_f32_16x16x32_bf16 v[172:175], v[212:215], v[112:115], v[172:175]
    v_add_f32 v245, v245, v161
    v_mfma_f32_16x16x32_bf16 v[172:175], v[216:219], v[132:135], v[172:175]
    s_waitcnt vmcnt(16) lgkmcnt(0)
    s_barrier
    v_mfma_f32_16x16x32_bf16 a[120:123], v[220:223], v[176:179], a[120:123]
    s_add_u32 m0, s26, 0
    v_exp_f32 v162, v162
    v_mfma_f32_16x16x32_bf16 a[140:143], v[224:227], v[176:179], a[140:143]
    s_mov_b32 s32, 0
    buffer_load_dwordx4 v9, s[4:7], s32 offen lds
    v_mfma_f32_16x16x32_bf16 a[160:163], v[228:231], v[176:179], a[160:163]
    s_mov_b32 s33, 9216
    v_exp_f32 v163, v163
    v_mfma_f32_16x16x32_bf16 a[180:183], v[232:235], v[176:179], a[180:183]
    ds_read_b64_tr_b16 v[196:197], v0 offset:0
    v_add_f32 v245, v245, v162
    v_mfma_f32_16x16x32_bf16 a[200:203], v[236:239], v[176:179], a[200:203]
    ds_read_b64_tr_b16 v[198:199], v0 offset:6144
    v_add_f32 v245, v245, v163
    v_mfma_f32_16x16x32_bf16 a[220:223], v[240:243], v[176:179], a[220:223]
    v_exp_f32 v164, v164
    v_mfma_f32_16x16x32_bf16 a[224:227], v[240:243], v[180:183], a[224:227]
    buffer_load_dwordx4 v10, s[4:7], s33 offen offset:1024 lds
    v_mfma_f32_16x16x32_bf16 a[204:207], v[236:239], v[180:183], a[204:207]
    s_mov_b32 s32, 18432
    ds_read_b64_tr_b16 v[200:201], v1 offset:0
    v_cvt_pk_bf16_f32 v176, v136, v137
    v_mfma_f32_16x16x32_bf16 a[184:187], v[232:235], v[180:183], a[184:187]
    v_exp_f32 v165, v165
    v_mfma_f32_16x16x32_bf16 a[164:167], v[228:231], v[180:183], a[164:167]
    ds_read_b64_tr_b16 v[202:203], v1 offset:6144
    v_cvt_pk_bf16_f32 v177, v138, v139
    v_mfma_f32_16x16x32_bf16 a[144:147], v[224:227], v[180:183], a[144:147]
    buffer_load_dwordx4 v9, s[4:7], s32 offen offset:2048 lds
    v_mfma_f32_16x16x32_bf16 a[124:127], v[220:223], v[180:183], a[124:127]
    s_mov_b32 s33, 27648
    v_exp_f32 v166, v166
    v_mfma_f32_16x16x32_bf16 a[128:131], v[220:223], v[184:187], a[128:131]
    ds_read_b64_tr_b16 v[204:205], v2 offset:0
    v_cvt_pk_bf16_f32 v178, v156, v157
    v_mfma_f32_16x16x32_bf16 a[148:151], v[224:227], v[184:187], a[148:151]
    ds_read_b64_tr_b16 v[206:207], v2 offset:6144
    v_cvt_pk_bf16_f32 v179, v158, v159
    v_mfma_f32_16x16x32_bf16 a[168:171], v[228:231], v[184:187], a[168:171]
    v_exp_f32 v167, v167
    v_mfma_f32_16x16x32_bf16 a[188:191], v[232:235], v[184:187], a[188:191]
    buffer_load_dwordx4 v10, s[4:7], s33 offen offset:3072 lds
    v_mfma_f32_16x16x32_bf16 a[208:211], v[236:239], v[184:187], a[208:211]
    s_add_u32 m0, s26, 4096
    ds_read_b64_tr_b16 v[208:209], v3 offset:0
    v_cvt_pk_bf16_f32 v180, v140, v141
    v_mfma_f32_16x16x32_bf16 a[228:231], v[240:243], v[184:187], a[228:231]
    s_mov_b32 s32, 40960
    v_exp_f32 v168, v168
    v_mfma_f32_16x16x32_bf16 a[232:235], v[240:243], v[188:191], a[232:235]
    ds_read_b64_tr_b16 v[210:211], v3 offset:6144
    v_cvt_pk_bf16_f32 v181, v142, v143
    v_mfma_f32_16x16x32_bf16 a[212:215], v[236:239], v[188:191], a[212:215]
    buffer_load_dwordx4 v9, s[4:7], s32 offen lds
    v_mfma_f32_16x16x32_bf16 a[192:195], v[232:235], v[188:191], a[192:195]
    s_mov_b32 s33, 50176
    v_exp_f32 v169, v169
    v_mfma_f32_16x16x32_bf16 a[172:175], v[228:231], v[188:191], a[172:175]
    ds_read_b64_tr_b16 v[212:213], v0 offset:128
    v_cvt_pk_bf16_f32 v182, v160, v161
    v_mfma_f32_16x16x32_bf16 a[152:155], v[224:227], v[188:191], a[152:155]
    ds_read_b64_tr_b16 v[214:215], v0 offset:6272
    v_cvt_pk_bf16_f32 v183, v162, v163
    v_mfma_f32_16x16x32_bf16 a[132:135], v[220:223], v[188:191], a[132:135]
    v_exp_f32 v170, v170
    ds_read_b64_tr_b16 v[216:217], v1 offset:128
    v_mfma_f32_16x16x32_bf16 a[136:139], v[220:223], v[192:195], a[136:139]
    buffer_load_dwordx4 v10, s[4:7], s33 offen offset:1024 lds
    ds_read_b64_tr_b16 v[218:219], v1 offset:6272
    v_mfma_f32_16x16x32_bf16 a[156:159], v[224:227], v[192:195], a[156:159]
    s_mov_b32 s32, 59392
    v_cvt_pk_bf16_f32 v184, v144, v145
    v_cvt_pk_bf16_f32 v185, v146, v147
    v_mfma_f32_16x16x32_bf16 a[176:179], v[228:231], v[192:195], a[176:179]
    v_exp_f32 v171, v171
    v_mfma_f32_16x16x32_bf16 a[196:199], v[232:235], v[192:195], a[196:199]
    v_cvt_pk_bf16_f32 v186, v164, v165
    v_cvt_pk_bf16_f32 v187, v166, v167
    v_mfma_f32_16x16x32_bf16 a[216:219], v[236:239], v[192:195], a[216:219]
    buffer_load_dwordx4 v9, s[4:7], s32 offen offset:2048 lds
    v_mfma_f32_16x16x32_bf16 a[236:239], v[240:243], v[192:195], a[236:239]
    s_waitcnt lgkmcnt(0)
    v_exp_f32 v172, v172
    v_mfma_f32_16x16x32_bf16 a[0:3], v[196:199], v[176:179], a[0:3]
    s_mov_b32 s33, 68608
    ds_read_b64_tr_b16 v[220:221], v2 offset:128
    v_cvt_pk_bf16_f32 v188, v148, v149
    v_mfma_f32_16x16x32_bf16 a[20:23], v[200:203], v[176:179], a[20:23]
    s_sub_u32 s35, 49152, s48
    ds_read_b64_tr_b16 v[222:223], v2 offset:6272
    v_cvt_pk_bf16_f32 v189, v150, v151
    v_mfma_f32_16x16x32_bf16 a[40:43], v[204:207], v[176:179], a[40:43]
    v_exp_f32 v173, v173
    v_mfma_f32_16x16x32_bf16 a[60:63], v[208:211], v[176:179], a[60:63]
    buffer_load_dwordx4 v10, s[4:7], s33 offen offset:3072 lds
    v_mfma_f32_16x16x32_bf16 a[80:83], v[212:215], v[176:179], a[80:83]
    s_add_u32 m0, s26, 8192
    ds_read_b64_tr_b16 v[224:225], v3 offset:128
    v_cvt_pk_bf16_f32 v190, v168, v169
    v_mfma_f32_16x16x32_bf16 a[100:103], v[216:219], v[176:179], a[100:103]
    s_mov_b32 s32, 81920
    v_exp_f32 v174, v174
    v_mfma_f32_16x16x32_bf16 a[104:107], v[216:219], v[180:183], a[104:107]
    ds_read_b64_tr_b16 v[226:227], v3 offset:6272
    v_cvt_pk_bf16_f32 v191, v170, v171
    v_mfma_f32_16x16x32_bf16 a[84:87], v[212:215], v[180:183], a[84:87]
    buffer_load_dwordx4 v9, s[4:7], s32 offen lds
    v_mfma_f32_16x16x32_bf16 a[64:67], v[208:211], v[180:183], a[64:67]
    s_mov_b32 s33, 91136
    v_exp_f32 v175, v175
    v_mfma_f32_16x16x32_bf16 a[44:47], v[204:207], v[180:183], a[44:47]
    ds_read_b64_tr_b16 v[228:229], v0 offset:256
    v_cvt_pk_bf16_f32 v192, v152, v153
    v_mfma_f32_16x16x32_bf16 a[24:27], v[200:203], v[180:183], a[24:27]
    ds_read_b64_tr_b16 v[230:231], v0 offset:6400
    v_cvt_pk_bf16_f32 v193, v154, v155
    v_mfma_f32_16x16x32_bf16 a[4:7], v[196:199], v[180:183], a[4:7]
    buffer_load_dwordx4 v10, s[4:7], s33 offen offset:1024 lds
    v_mfma_f32_16x16x32_bf16 a[8:11], v[196:199], v[184:187], a[8:11]
    ds_read_b64_tr_b16 v[232:233], v1 offset:256
    v_cvt_pk_bf16_f32 v194, v172, v173
    v_mfma_f32_16x16x32_bf16 a[28:31], v[200:203], v[184:187], a[28:31]
    ds_read_b64_tr_b16 v[234:235], v1 offset:6400
    v_cvt_pk_bf16_f32 v195, v174, v175
    v_mfma_f32_16x16x32_bf16 a[48:51], v[204:207], v[184:187], a[48:51]
    ds_read_b64_tr_b16 v[236:237], v2 offset:256
    v_add_f32 v246, v246, v164
    v_mfma_f32_16x16x32_bf16 a[68:71], v[208:211], v[184:187], a[68:71]
    ds_read_b64_tr_b16 v[238:239], v2 offset:6400
    v_add_f32 v246, v246, v165
    v_mfma_f32_16x16x32_bf16 a[88:91], v[212:215], v[184:187], a[88:91]
    ds_read_b64_tr_b16 v[240:241], v3 offset:256
    v_add_f32 v246, v246, v166
    v_mfma_f32_16x16x32_bf16 a[108:111], v[216:219], v[184:187], a[108:111]
    ds_read_b64_tr_b16 v[242:243], v3 offset:6400
    v_add_f32 v246, v246, v167
    v_mfma_f32_16x16x32_bf16 a[112:115], v[216:219], v[188:191], a[112:115]
    v_add_f32 v247, v247, v168
    v_add_f32 v247, v247, v169
    v_mfma_f32_16x16x32_bf16 a[92:95], v[212:215], v[188:191], a[92:95]
    v_add_f32 v247, v247, v170
    v_add_f32 v247, v247, v171
    v_mfma_f32_16x16x32_bf16 a[72:75], v[208:211], v[188:191], a[72:75]
    v_add_f32 v248, v248, v172
    v_add_f32 v248, v248, v173
    v_mfma_f32_16x16x32_bf16 a[52:55], v[204:207], v[188:191], a[52:55]
    v_add_f32 v248, v248, v174
    v_add_f32 v248, v248, v175
    v_mfma_f32_16x16x32_bf16 a[32:35], v[200:203], v[188:191], a[32:35]
    v_mfma_f32_16x16x32_bf16 a[12:15], v[196:199], v[188:191], a[12:15]
    v_mov_b32 v136, v244
    v_mov_b32 v137, v245
    v_mfma_f32_16x16x32_bf16 a[16:19], v[196:199], v[192:195], a[16:19]
    v_mov_b32 v138, v246
    v_mov_b32 v139, v247
    v_mfma_f32_16x16x32_bf16 a[36:39], v[200:203], v[192:195], a[36:39]
    v_add_u32 v0, s35, v0
    v_mov_b32 v140, v248
    v_mfma_f32_16x16x32_bf16 a[56:59], v[204:207], v[192:195], a[56:59]
    v_add_u32 v1, s35, v1
    v_permlane32_swap_b32 v136, v244
    v_mfma_f32_16x16x32_bf16 a[76:79], v[208:211], v[192:195], a[76:79]
    v_add_u32 v2, s35, v2
    v_permlane32_swap_b32 v137, v245
    v_mfma_f32_16x16x32_bf16 a[96:99], v[212:215], v[192:195], a[96:99]
    v_add_u32 v3, s35, v3
    v_permlane32_swap_b32 v138, v246
    v_mfma_f32_16x16x32_bf16 a[116:119], v[216:219], v[192:195], a[116:119]
    s_waitcnt vmcnt(20) lgkmcnt(0)
    s_barrier
    v_mfma_f32_16x16x32_bf16 a[120:123], v[220:223], v[176:179], a[120:123]
    s_add_u32 m0, s25, 49152
    v_permlane32_swap_b32 v139, v247
    v_permlane32_swap_b32 v140, v248
    v_mfma_f32_16x16x32_bf16 a[140:143], v[224:227], v[176:179], a[140:143]
    s_mov_b32 s30, 786432
    v_add_f32 v244, v244, v136
    v_add_f32 v245, v245, v137
    v_mfma_f32_16x16x32_bf16 a[160:163], v[228:231], v[176:179], a[160:163]
    buffer_load_dwordx4 v6, s[8:11], s30 offen lds
    v_mfma_f32_16x16x32_bf16 a[180:183], v[232:235], v[176:179], a[180:183]
    v_add_f32 v246, v246, v138
    v_add_f32 v247, v247, v139
    v_mfma_f32_16x16x32_bf16 a[200:203], v[236:239], v[176:179], a[200:203]
    v_add_f32 v248, v248, v140
    v_mfma_f32_16x16x32_bf16 a[220:223], v[240:243], v[176:179], a[220:223]
    v_mov_b32 v136, v244
    v_mov_b32 v137, v245
    v_mfma_f32_16x16x32_bf16 a[224:227], v[240:243], v[180:183], a[224:227]
    buffer_load_dwordx4 v7, s[8:11], s30 offen offset:1024 lds
    v_mfma_f32_16x16x32_bf16 a[204:207], v[236:239], v[180:183], a[204:207]
    v_mov_b32 v138, v246
    v_mov_b32 v139, v247
    v_mfma_f32_16x16x32_bf16 a[184:187], v[232:235], v[180:183], a[184:187]
    v_mov_b32 v140, v248
    v_mfma_f32_16x16x32_bf16 a[164:167], v[228:231], v[180:183], a[164:167]
    v_permlane16_swap_b32 v136, v244
    v_permlane16_swap_b32 v137, v245
    v_mfma_f32_16x16x32_bf16 a[144:147], v[224:227], v[180:183], a[144:147]
    buffer_load_dwordx4 v8, s[8:11], s30 offen offset:2048 lds
    v_mfma_f32_16x16x32_bf16 a[124:127], v[220:223], v[180:183], a[124:127]
    s_add_u32 m0, s25, 61440
    v_permlane16_swap_b32 v138, v246
    v_permlane16_swap_b32 v139, v247
    v_mfma_f32_16x16x32_bf16 a[128:131], v[220:223], v[184:187], a[128:131]
    s_mov_b32 s31, 1179648
    v_permlane16_swap_b32 v140, v248
    v_mfma_f32_16x16x32_bf16 a[148:151], v[224:227], v[184:187], a[148:151]
    v_add_f32 v244, v244, v136
    v_add_f32 v245, v245, v137
    v_mfma_f32_16x16x32_bf16 a[168:171], v[228:231], v[184:187], a[168:171]
    buffer_load_dwordx4 v6, s[8:11], s31 offen lds
    v_mfma_f32_16x16x32_bf16 a[188:191], v[232:235], v[184:187], a[188:191]
    v_add_f32 v246, v246, v138
    v_add_f32 v247, v247, v139
    v_mfma_f32_16x16x32_bf16 a[208:211], v[236:239], v[184:187], a[208:211]
    v_add_f32 v248, v248, v140
    v_mfma_f32_16x16x32_bf16 a[228:231], v[240:243], v[184:187], a[228:231]
    v_subrev_u32 v136, 0x30800000, v244
    v_subrev_u32 v137, 0x30800000, v245
    v_mfma_f32_16x16x32_bf16 a[232:235], v[240:243], v[188:191], a[232:235]
    buffer_load_dwordx4 v7, s[8:11], s31 offen offset:1024 lds
    v_mfma_f32_16x16x32_bf16 a[212:215], v[236:239], v[188:191], a[212:215]
    v_subrev_u32 v138, 0x30800000, v246
    v_subrev_u32 v139, 0x30800000, v247
    v_mfma_f32_16x16x32_bf16 a[192:195], v[232:235], v[188:191], a[192:195]
    v_subrev_u32 v140, 0x30800000, v248
    v_mfma_f32_16x16x32_bf16 a[172:175], v[228:231], v[188:191], a[172:175]
    v_max3_u32 v136, v136, v137, v138
    v_max3_u32 v136, v136, v139, v140
    v_mfma_f32_16x16x32_bf16 a[152:155], v[224:227], v[188:191], a[152:155]
    buffer_load_dwordx4 v8, s[8:11], s31 offen offset:2048 lds
    v_mfma_f32_16x16x32_bf16 a[132:135], v[220:223], v[188:191], a[132:135]
    v_mfma_f32_16x16x32_bf16 a[136:139], v[220:223], v[192:195], a[136:139]
    v_mfma_f32_16x16x32_bf16 a[156:159], v[224:227], v[192:195], a[156:159]
    v_mfma_f32_16x16x32_bf16 a[176:179], v[228:231], v[192:195], a[176:179]
    v_mfma_f32_16x16x32_bf16 a[196:199], v[232:235], v[192:195], a[196:199]
    v_mfma_f32_16x16x32_bf16 a[216:219], v[236:239], v[192:195], a[216:219]
    v_mfma_f32_16x16x32_bf16 a[236:239], v[240:243], v[192:195], a[236:239]
    v_cmp_lt_u32 vcc, 0x2f000000, v136
    s_cmp_lg_u64 vcc, 0
    s_cbranch_scc1 L_slow
        L_backQ:

    v_rcp_f32 v244, v244
    v_rcp_f32 v245, v245
    v_rcp_f32 v246, v246
    v_rcp_f32 v247, v247
    v_rcp_f32 v248, v248
    s_add_u32 s12, s12, 3145728
    s_addc_u32 s13, s13, 0
    s_add_u32 s16, s16, 3145728
    s_addc_u32 s17, s17, 0

    v_accvgpr_read_b32 v228, a0
    v_accvgpr_read_b32 v229, a1
    v_accvgpr_read_b32 v230, a2
    v_accvgpr_read_b32 v231, a3
    buffer_load_dword a255, v249, s[8:11], 0 offen
    v_accvgpr_read_b32 v232, a20
    v_accvgpr_read_b32 v233, a21
    v_accvgpr_read_b32 v234, a22
    v_accvgpr_read_b32 v235, a23
    v_pk_mul_f32 v[228:229], v[228:229], v[244:245] op_sel_hi:[1,0]
    v_pk_mul_f32 v[230:231], v[230:231], v[244:245] op_sel_hi:[1,0]
    v_pk_mul_f32 v[232:233], v[232:233], v[244:245] op_sel_hi:[1,0]
    v_pk_mul_f32 v[234:235], v[234:235], v[244:245] op_sel_hi:[1,0]
    v_cvt_pk_bf16_f32 v64, v228, v229
    v_cvt_pk_bf16_f32 v65, v230, v231
    v_cvt_pk_bf16_f32 v66, v232, v233
    v_cvt_pk_bf16_f32 v67, v234, v235
    v_accvgpr_read_b32 v236, a4
    v_accvgpr_read_b32 v237, a5
    v_accvgpr_read_b32 v238, a6
    v_accvgpr_read_b32 v239, a7
    v_accvgpr_read_b32 v240, a24
    v_accvgpr_read_b32 v241, a25
    v_accvgpr_read_b32 v242, a26
    v_accvgpr_read_b32 v243, a27
    v_pk_mul_f32 v[236:237], v[236:237], v[244:245] op_sel:[0,1] op_sel_hi:[1,1]
    v_pk_mul_f32 v[238:239], v[238:239], v[244:245] op_sel:[0,1] op_sel_hi:[1,1]
    v_pk_mul_f32 v[240:241], v[240:241], v[244:245] op_sel:[0,1] op_sel_hi:[1,1]
    v_pk_mul_f32 v[242:243], v[242:243], v[244:245] op_sel:[0,1] op_sel_hi:[1,1]
    v_cvt_pk_bf16_f32 v68, v236, v237
    v_cvt_pk_bf16_f32 v69, v238, v239
    v_cvt_pk_bf16_f32 v70, v240, v241
    v_cvt_pk_bf16_f32 v71, v242, v243
    v_accvgpr_read_b32 v228, a8
    v_accvgpr_read_b32 v229, a9
    v_accvgpr_read_b32 v230, a10
    v_accvgpr_read_b32 v231, a11
    v_accvgpr_read_b32 v232, a28
    v_accvgpr_read_b32 v233, a29
    v_accvgpr_read_b32 v234, a30
    v_accvgpr_read_b32 v235, a31
    v_pk_mul_f32 v[228:229], v[228:229], v[246:247] op_sel_hi:[1,0]
    v_pk_mul_f32 v[230:231], v[230:231], v[246:247] op_sel_hi:[1,0]
    v_pk_mul_f32 v[232:233], v[232:233], v[246:247] op_sel_hi:[1,0]
    v_pk_mul_f32 v[234:235], v[234:235], v[246:247] op_sel_hi:[1,0]
    v_cvt_pk_bf16_f32 v72, v228, v229
    v_cvt_pk_bf16_f32 v73, v230, v231
    v_cvt_pk_bf16_f32 v74, v232, v233
    v_cvt_pk_bf16_f32 v75, v234, v235
    v_accvgpr_read_b32 v236, a12
    v_accvgpr_read_b32 v237, a13
    v_accvgpr_read_b32 v238, a14
    v_accvgpr_read_b32 v239, a15
    v_accvgpr_read_b32 v240, a32
    v_accvgpr_read_b32 v241, a33
    v_accvgpr_read_b32 v242, a34
    v_accvgpr_read_b32 v243, a35
    v_pk_mul_f32 v[236:237], v[236:237], v[246:247] op_sel:[0,1] op_sel_hi:[1,1]
    v_pk_mul_f32 v[238:239], v[238:239], v[246:247] op_sel:[0,1] op_sel_hi:[1,1]
    v_pk_mul_f32 v[240:241], v[240:241], v[246:247] op_sel:[0,1] op_sel_hi:[1,1]
    v_pk_mul_f32 v[242:243], v[242:243], v[246:247] op_sel:[0,1] op_sel_hi:[1,1]
    v_cvt_pk_bf16_f32 v176, v236, v237
    v_cvt_pk_bf16_f32 v177, v238, v239
    v_cvt_pk_bf16_f32 v178, v240, v241
    v_cvt_pk_bf16_f32 v179, v242, v243
    v_accvgpr_read_b32 v228, a16
    v_accvgpr_read_b32 v229, a17
    v_accvgpr_read_b32 v230, a18
    v_accvgpr_read_b32 v231, a19
    v_accvgpr_read_b32 v232, a36
    v_accvgpr_read_b32 v233, a37
    v_accvgpr_read_b32 v234, a38
    v_accvgpr_read_b32 v235, a39
    v_pk_mul_f32 v[228:229], v[228:229], v[248:249] op_sel_hi:[1,0]
    v_pk_mul_f32 v[230:231], v[230:231], v[248:249] op_sel_hi:[1,0]
    v_pk_mul_f32 v[232:233], v[232:233], v[248:249] op_sel_hi:[1,0]
    v_pk_mul_f32 v[234:235], v[234:235], v[248:249] op_sel_hi:[1,0]
    v_cvt_pk_bf16_f32 v180, v228, v229
    v_cvt_pk_bf16_f32 v181, v230, v231
    v_cvt_pk_bf16_f32 v182, v232, v233
    v_cvt_pk_bf16_f32 v183, v234, v235
    v_accvgpr_read_b32 v236, a80
    v_accvgpr_read_b32 v237, a81
    v_accvgpr_read_b32 v238, a82
    v_accvgpr_read_b32 v239, a83
    v_accvgpr_read_b32 v240, a100
    v_accvgpr_read_b32 v241, a101
    v_accvgpr_read_b32 v242, a102
    v_accvgpr_read_b32 v243, a103
    v_pk_mul_f32 v[236:237], v[236:237], v[244:245] op_sel_hi:[1,0]
    v_pk_mul_f32 v[238:239], v[238:239], v[244:245] op_sel_hi:[1,0]
    v_pk_mul_f32 v[240:241], v[240:241], v[244:245] op_sel_hi:[1,0]
    v_pk_mul_f32 v[242:243], v[242:243], v[244:245] op_sel_hi:[1,0]
    v_cvt_pk_bf16_f32 v184, v236, v237
    v_cvt_pk_bf16_f32 v185, v238, v239
    v_cvt_pk_bf16_f32 v186, v240, v241
    v_cvt_pk_bf16_f32 v187, v242, v243
    v_accvgpr_read_b32 v228, a84
    v_accvgpr_read_b32 v229, a85
    v_accvgpr_read_b32 v230, a86
    v_accvgpr_read_b32 v231, a87
    v_accvgpr_read_b32 v232, a104
    v_accvgpr_read_b32 v233, a105
    v_accvgpr_read_b32 v234, a106
    v_accvgpr_read_b32 v235, a107
    v_pk_mul_f32 v[228:229], v[228:229], v[244:245] op_sel:[0,1] op_sel_hi:[1,1]
    v_pk_mul_f32 v[230:231], v[230:231], v[244:245] op_sel:[0,1] op_sel_hi:[1,1]
    v_pk_mul_f32 v[232:233], v[232:233], v[244:245] op_sel:[0,1] op_sel_hi:[1,1]
    v_pk_mul_f32 v[234:235], v[234:235], v[244:245] op_sel:[0,1] op_sel_hi:[1,1]
    v_cvt_pk_bf16_f32 v188, v228, v229
    v_cvt_pk_bf16_f32 v189, v230, v231
    v_cvt_pk_bf16_f32 v190, v232, v233
    v_cvt_pk_bf16_f32 v191, v234, v235
    v_accvgpr_read_b32 v236, a88
    v_accvgpr_read_b32 v237, a89
    v_accvgpr_read_b32 v238, a90
    v_accvgpr_read_b32 v239, a91
    v_accvgpr_read_b32 v240, a108
    v_accvgpr_read_b32 v241, a109
    v_accvgpr_read_b32 v242, a110
    v_accvgpr_read_b32 v243, a111
    v_pk_mul_f32 v[236:237], v[236:237], v[246:247] op_sel_hi:[1,0]
    v_pk_mul_f32 v[238:239], v[238:239], v[246:247] op_sel_hi:[1,0]
    v_pk_mul_f32 v[240:241], v[240:241], v[246:247] op_sel_hi:[1,0]
    v_pk_mul_f32 v[242:243], v[242:243], v[246:247] op_sel_hi:[1,0]
    v_cvt_pk_bf16_f32 v192, v236, v237
    v_cvt_pk_bf16_f32 v193, v238, v239
    v_cvt_pk_bf16_f32 v194, v240, v241
    v_cvt_pk_bf16_f32 v195, v242, v243
    v_accvgpr_read_b32 v228, a92
    v_accvgpr_read_b32 v229, a93
    v_accvgpr_read_b32 v230, a94
    v_accvgpr_read_b32 v231, a95
    v_accvgpr_read_b32 v232, a112
    v_accvgpr_read_b32 v233, a113
    v_accvgpr_read_b32 v234, a114
    v_accvgpr_read_b32 v235, a115
    v_pk_mul_f32 v[228:229], v[228:229], v[246:247] op_sel:[0,1] op_sel_hi:[1,1]
    v_pk_mul_f32 v[230:231], v[230:231], v[246:247] op_sel:[0,1] op_sel_hi:[1,1]
    v_pk_mul_f32 v[232:233], v[232:233], v[246:247] op_sel:[0,1] op_sel_hi:[1,1]
    v_pk_mul_f32 v[234:235], v[234:235], v[246:247] op_sel:[0,1] op_sel_hi:[1,1]
    v_cvt_pk_bf16_f32 v76, v228, v229
    v_cvt_pk_bf16_f32 v77, v230, v231
    v_cvt_pk_bf16_f32 v78, v232, v233
    v_cvt_pk_bf16_f32 v79, v234, v235
    v_accvgpr_read_b32 v236, a96
    v_accvgpr_read_b32 v237, a97
    v_accvgpr_read_b32 v238, a98
    v_accvgpr_read_b32 v239, a99
    v_accvgpr_read_b32 v240, a116
    v_accvgpr_read_b32 v241, a117
    v_accvgpr_read_b32 v242, a118
    v_accvgpr_read_b32 v243, a119
    v_pk_mul_f32 v[236:237], v[236:237], v[248:249] op_sel_hi:[1,0]
    v_pk_mul_f32 v[238:239], v[238:239], v[248:249] op_sel_hi:[1,0]
    v_pk_mul_f32 v[240:241], v[240:241], v[248:249] op_sel_hi:[1,0]
    v_pk_mul_f32 v[242:243], v[242:243], v[248:249] op_sel_hi:[1,0]
    v_cvt_pk_bf16_f32 v80, v236, v237
    v_cvt_pk_bf16_f32 v81, v238, v239
    v_cvt_pk_bf16_f32 v82, v240, v241
    v_cvt_pk_bf16_f32 v83, v242, v243
    s_waitcnt vmcnt(7)
    v_accvgpr_read_b32 v228, a40
    v_accvgpr_read_b32 v229, a41
    v_accvgpr_read_b32 v230, a42
    v_accvgpr_read_b32 v231, a43
    v_accvgpr_read_b32 v232, a60
    v_accvgpr_read_b32 v233, a61
    v_accvgpr_read_b32 v234, a62
    v_accvgpr_read_b32 v235, a63
    ds_read_b128 a[0:3], v4 offset:0
    ds_read_b128 a[20:23], v5 offset:0
    v_pk_mul_f32 v[228:229], v[228:229], v[244:245] op_sel_hi:[1,0]
    v_pk_mul_f32 v[230:231], v[230:231], v[244:245] op_sel_hi:[1,0]
    v_pk_mul_f32 v[232:233], v[232:233], v[244:245] op_sel_hi:[1,0]
    v_pk_mul_f32 v[234:235], v[234:235], v[244:245] op_sel_hi:[1,0]
    v_cvt_pk_bf16_f32 v84, v228, v229
    v_cvt_pk_bf16_f32 v85, v230, v231
    v_cvt_pk_bf16_f32 v86, v232, v233
    v_cvt_pk_bf16_f32 v87, v234, v235
    v_accvgpr_read_b32 v236, a44
    v_accvgpr_read_b32 v237, a45
    v_accvgpr_read_b32 v238, a46
    v_accvgpr_read_b32 v239, a47
    v_accvgpr_read_b32 v240, a64
    v_accvgpr_read_b32 v241, a65
    v_accvgpr_read_b32 v242, a66
    v_accvgpr_read_b32 v243, a67
    ds_read_b128 a[4:7], v4 offset:2048
    ds_read_b128 a[24:27], v5 offset:2048
    v_pk_mul_f32 v[236:237], v[236:237], v[244:245] op_sel:[0,1] op_sel_hi:[1,1]
    v_pk_mul_f32 v[238:239], v[238:239], v[244:245] op_sel:[0,1] op_sel_hi:[1,1]
    v_pk_mul_f32 v[240:241], v[240:241], v[244:245] op_sel:[0,1] op_sel_hi:[1,1]
    v_pk_mul_f32 v[242:243], v[242:243], v[244:245] op_sel:[0,1] op_sel_hi:[1,1]
    v_cvt_pk_bf16_f32 v88, v236, v237
    v_cvt_pk_bf16_f32 v89, v238, v239
    v_cvt_pk_bf16_f32 v90, v240, v241
    v_cvt_pk_bf16_f32 v91, v242, v243
    v_accvgpr_read_b32 v228, a48
    v_accvgpr_read_b32 v229, a49
    v_accvgpr_read_b32 v230, a50
    v_accvgpr_read_b32 v231, a51
    v_accvgpr_read_b32 v232, a68
    v_accvgpr_read_b32 v233, a69
    v_accvgpr_read_b32 v234, a70
    v_accvgpr_read_b32 v235, a71
    ds_read_b128 a[8:11], v4 offset:4096
    ds_read_b128 a[28:31], v5 offset:4096
    v_pk_mul_f32 v[228:229], v[228:229], v[246:247] op_sel_hi:[1,0]
    v_pk_mul_f32 v[230:231], v[230:231], v[246:247] op_sel_hi:[1,0]
    v_pk_mul_f32 v[232:233], v[232:233], v[246:247] op_sel_hi:[1,0]
    v_pk_mul_f32 v[234:235], v[234:235], v[246:247] op_sel_hi:[1,0]
    v_cvt_pk_bf16_f32 v92, v228, v229
    v_cvt_pk_bf16_f32 v93, v230, v231
    v_cvt_pk_bf16_f32 v94, v232, v233
    v_cvt_pk_bf16_f32 v95, v234, v235
    v_accvgpr_read_b32 v236, a52
    v_accvgpr_read_b32 v237, a53
    v_accvgpr_read_b32 v238, a54
    v_accvgpr_read_b32 v239, a55
    v_accvgpr_read_b32 v240, a72
    v_accvgpr_read_b32 v241, a73
    v_accvgpr_read_b32 v242, a74
    v_accvgpr_read_b32 v243, a75
    ds_read_b128 a[12:15], v4 offset:6144
    ds_read_b128 a[32:35], v5 offset:6144
    v_pk_mul_f32 v[236:237], v[236:237], v[246:247] op_sel:[0,1] op_sel_hi:[1,1]
    v_pk_mul_f32 v[238:239], v[238:239], v[246:247] op_sel:[0,1] op_sel_hi:[1,1]
    v_pk_mul_f32 v[240:241], v[240:241], v[246:247] op_sel:[0,1] op_sel_hi:[1,1]
    v_pk_mul_f32 v[242:243], v[242:243], v[246:247] op_sel:[0,1] op_sel_hi:[1,1]
    v_cvt_pk_bf16_f32 v196, v236, v237
    v_cvt_pk_bf16_f32 v197, v238, v239
    v_cvt_pk_bf16_f32 v198, v240, v241
    v_cvt_pk_bf16_f32 v199, v242, v243
    v_accvgpr_read_b32 v228, a56
    v_accvgpr_read_b32 v229, a57
    v_accvgpr_read_b32 v230, a58
    v_accvgpr_read_b32 v231, a59
    v_accvgpr_read_b32 v232, a76
    v_accvgpr_read_b32 v233, a77
    v_accvgpr_read_b32 v234, a78
    v_accvgpr_read_b32 v235, a79
    ds_read_b128 a[16:19], v4 offset:8192
    ds_read_b128 a[36:39], v5 offset:8192
    v_pk_mul_f32 v[228:229], v[228:229], v[248:249] op_sel_hi:[1,0]
    v_pk_mul_f32 v[230:231], v[230:231], v[248:249] op_sel_hi:[1,0]
    v_pk_mul_f32 v[232:233], v[232:233], v[248:249] op_sel_hi:[1,0]
    v_pk_mul_f32 v[234:235], v[234:235], v[248:249] op_sel_hi:[1,0]
    v_cvt_pk_bf16_f32 v200, v228, v229
    v_cvt_pk_bf16_f32 v201, v230, v231
    v_cvt_pk_bf16_f32 v202, v232, v233
    v_cvt_pk_bf16_f32 v203, v234, v235
    v_accvgpr_read_b32 v236, a120
    v_accvgpr_read_b32 v237, a121
    v_accvgpr_read_b32 v238, a122
    v_accvgpr_read_b32 v239, a123
    v_accvgpr_read_b32 v240, a140
    v_accvgpr_read_b32 v241, a141
    v_accvgpr_read_b32 v242, a142
    v_accvgpr_read_b32 v243, a143
    ds_read_b64_tr_b16 a[80:81], v0 offset:0
    ds_read_b64_tr_b16 a[82:83], v0 offset:6144
    v_pk_mul_f32 v[236:237], v[236:237], v[244:245] op_sel_hi:[1,0]
    v_pk_mul_f32 v[238:239], v[238:239], v[244:245] op_sel_hi:[1,0]
    v_pk_mul_f32 v[240:241], v[240:241], v[244:245] op_sel_hi:[1,0]
    v_pk_mul_f32 v[242:243], v[242:243], v[244:245] op_sel_hi:[1,0]
    v_cvt_pk_bf16_f32 v204, v236, v237
    v_cvt_pk_bf16_f32 v205, v238, v239
    v_cvt_pk_bf16_f32 v206, v240, v241
    v_cvt_pk_bf16_f32 v207, v242, v243
    v_accvgpr_read_b32 v228, a124
    v_accvgpr_read_b32 v229, a125
    v_accvgpr_read_b32 v230, a126
    v_accvgpr_read_b32 v231, a127
    v_accvgpr_read_b32 v232, a144
    v_accvgpr_read_b32 v233, a145
    v_accvgpr_read_b32 v234, a146
    v_accvgpr_read_b32 v235, a147
    ds_read_b64_tr_b16 a[84:85], v0 offset:12288
    ds_read_b64_tr_b16 a[86:87], v0 offset:18432
    v_pk_mul_f32 v[228:229], v[228:229], v[244:245] op_sel:[0,1] op_sel_hi:[1,1]
    v_pk_mul_f32 v[230:231], v[230:231], v[244:245] op_sel:[0,1] op_sel_hi:[1,1]
    v_pk_mul_f32 v[232:233], v[232:233], v[244:245] op_sel:[0,1] op_sel_hi:[1,1]
    v_pk_mul_f32 v[234:235], v[234:235], v[244:245] op_sel:[0,1] op_sel_hi:[1,1]
    v_cvt_pk_bf16_f32 v208, v228, v229
    v_cvt_pk_bf16_f32 v209, v230, v231
    v_cvt_pk_bf16_f32 v210, v232, v233
    v_cvt_pk_bf16_f32 v211, v234, v235
    v_accvgpr_read_b32 v236, a128
    v_accvgpr_read_b32 v237, a129
    v_accvgpr_read_b32 v238, a130
    v_accvgpr_read_b32 v239, a131
    v_accvgpr_read_b32 v240, a148
    v_accvgpr_read_b32 v241, a149
    v_accvgpr_read_b32 v242, a150
    v_accvgpr_read_b32 v243, a151
    ds_read_b64_tr_b16 a[88:89], v1 offset:0
    ds_read_b64_tr_b16 a[90:91], v1 offset:6144
    v_pk_mul_f32 v[236:237], v[236:237], v[246:247] op_sel_hi:[1,0]
    v_pk_mul_f32 v[238:239], v[238:239], v[246:247] op_sel_hi:[1,0]
    v_pk_mul_f32 v[240:241], v[240:241], v[246:247] op_sel_hi:[1,0]
    v_pk_mul_f32 v[242:243], v[242:243], v[246:247] op_sel_hi:[1,0]
    v_cvt_pk_bf16_f32 v212, v236, v237
    v_cvt_pk_bf16_f32 v213, v238, v239
    v_cvt_pk_bf16_f32 v214, v240, v241
    v_cvt_pk_bf16_f32 v215, v242, v243
    v_accvgpr_read_b32 v228, a132
    v_accvgpr_read_b32 v229, a133
    v_accvgpr_read_b32 v230, a134
    v_accvgpr_read_b32 v231, a135
    v_accvgpr_read_b32 v232, a152
    v_accvgpr_read_b32 v233, a153
    v_accvgpr_read_b32 v234, a154
    v_accvgpr_read_b32 v235, a155
    ds_read_b64_tr_b16 a[92:93], v1 offset:12288
    ds_read_b64_tr_b16 a[94:95], v1 offset:18432
    v_pk_mul_f32 v[228:229], v[228:229], v[246:247] op_sel:[0,1] op_sel_hi:[1,1]
    v_pk_mul_f32 v[230:231], v[230:231], v[246:247] op_sel:[0,1] op_sel_hi:[1,1]
    v_pk_mul_f32 v[232:233], v[232:233], v[246:247] op_sel:[0,1] op_sel_hi:[1,1]
    v_pk_mul_f32 v[234:235], v[234:235], v[246:247] op_sel:[0,1] op_sel_hi:[1,1]
    v_cvt_pk_bf16_f32 v96, v228, v229
    v_cvt_pk_bf16_f32 v97, v230, v231
    v_cvt_pk_bf16_f32 v98, v232, v233
    v_cvt_pk_bf16_f32 v99, v234, v235
    v_accvgpr_read_b32 v236, a136
    v_accvgpr_read_b32 v237, a137
    v_accvgpr_read_b32 v238, a138
    v_accvgpr_read_b32 v239, a139
    v_accvgpr_read_b32 v240, a156
    v_accvgpr_read_b32 v241, a157
    v_accvgpr_read_b32 v242, a158
    v_accvgpr_read_b32 v243, a159
    ds_read_b64_tr_b16 a[96:97], v2 offset:0
    ds_read_b64_tr_b16 a[98:99], v2 offset:6144
    v_pk_mul_f32 v[236:237], v[236:237], v[248:249] op_sel_hi:[1,0]
    v_pk_mul_f32 v[238:239], v[238:239], v[248:249] op_sel_hi:[1,0]
    v_pk_mul_f32 v[240:241], v[240:241], v[248:249] op_sel_hi:[1,0]
    v_pk_mul_f32 v[242:243], v[242:243], v[248:249] op_sel_hi:[1,0]
    v_cvt_pk_bf16_f32 v100, v236, v237
    v_cvt_pk_bf16_f32 v101, v238, v239
    v_cvt_pk_bf16_f32 v102, v240, v241
    v_cvt_pk_bf16_f32 v103, v242, v243
    v_accvgpr_read_b32 v228, a160
    v_accvgpr_read_b32 v229, a161
    v_accvgpr_read_b32 v230, a162
    v_accvgpr_read_b32 v231, a163
    v_accvgpr_read_b32 v232, a180
    v_accvgpr_read_b32 v233, a181
    v_accvgpr_read_b32 v234, a182
    v_accvgpr_read_b32 v235, a183
    ds_read_b64_tr_b16 a[100:101], v2 offset:12288
    ds_read_b64_tr_b16 a[102:103], v2 offset:18432
    v_pk_mul_f32 v[228:229], v[228:229], v[244:245] op_sel_hi:[1,0]
    v_pk_mul_f32 v[230:231], v[230:231], v[244:245] op_sel_hi:[1,0]
    v_pk_mul_f32 v[232:233], v[232:233], v[244:245] op_sel_hi:[1,0]
    v_pk_mul_f32 v[234:235], v[234:235], v[244:245] op_sel_hi:[1,0]
    v_cvt_pk_bf16_f32 v104, v228, v229
    v_cvt_pk_bf16_f32 v105, v230, v231
    v_cvt_pk_bf16_f32 v106, v232, v233
    v_cvt_pk_bf16_f32 v107, v234, v235
    v_accvgpr_read_b32 v236, a164
    v_accvgpr_read_b32 v237, a165
    v_accvgpr_read_b32 v238, a166
    v_accvgpr_read_b32 v239, a167
    v_accvgpr_read_b32 v240, a184
    v_accvgpr_read_b32 v241, a185
    v_accvgpr_read_b32 v242, a186
    v_accvgpr_read_b32 v243, a187
    v_pk_mul_f32 v[236:237], v[236:237], v[244:245] op_sel:[0,1] op_sel_hi:[1,1]
    v_pk_mul_f32 v[238:239], v[238:239], v[244:245] op_sel:[0,1] op_sel_hi:[1,1]
    v_pk_mul_f32 v[240:241], v[240:241], v[244:245] op_sel:[0,1] op_sel_hi:[1,1]
    v_pk_mul_f32 v[242:243], v[242:243], v[244:245] op_sel:[0,1] op_sel_hi:[1,1]
    v_cvt_pk_bf16_f32 v108, v236, v237
    v_cvt_pk_bf16_f32 v109, v238, v239
    v_cvt_pk_bf16_f32 v110, v240, v241
    v_cvt_pk_bf16_f32 v111, v242, v243
    v_accvgpr_read_b32 v228, a168
    v_accvgpr_read_b32 v229, a169
    v_accvgpr_read_b32 v230, a170
    v_accvgpr_read_b32 v231, a171
    v_accvgpr_read_b32 v232, a188
    v_accvgpr_read_b32 v233, a189
    v_accvgpr_read_b32 v234, a190
    v_accvgpr_read_b32 v235, a191
    v_pk_mul_f32 v[228:229], v[228:229], v[246:247] op_sel_hi:[1,0]
    v_pk_mul_f32 v[230:231], v[230:231], v[246:247] op_sel_hi:[1,0]
    v_pk_mul_f32 v[232:233], v[232:233], v[246:247] op_sel_hi:[1,0]
    v_pk_mul_f32 v[234:235], v[234:235], v[246:247] op_sel_hi:[1,0]
    v_cvt_pk_bf16_f32 v112, v228, v229
    v_cvt_pk_bf16_f32 v113, v230, v231
    v_cvt_pk_bf16_f32 v114, v232, v233
    v_cvt_pk_bf16_f32 v115, v234, v235
    v_accvgpr_read_b32 v236, a172
    v_accvgpr_read_b32 v237, a173
    v_accvgpr_read_b32 v238, a174
    v_accvgpr_read_b32 v239, a175
    v_accvgpr_read_b32 v240, a192
    v_accvgpr_read_b32 v241, a193
    v_accvgpr_read_b32 v242, a194
    v_accvgpr_read_b32 v243, a195
    v_pk_mul_f32 v[236:237], v[236:237], v[246:247] op_sel:[0,1] op_sel_hi:[1,1]
    v_pk_mul_f32 v[238:239], v[238:239], v[246:247] op_sel:[0,1] op_sel_hi:[1,1]
    v_pk_mul_f32 v[240:241], v[240:241], v[246:247] op_sel:[0,1] op_sel_hi:[1,1]
    v_pk_mul_f32 v[242:243], v[242:243], v[246:247] op_sel:[0,1] op_sel_hi:[1,1]
    v_cvt_pk_bf16_f32 v116, v236, v237
    v_cvt_pk_bf16_f32 v117, v238, v239
    v_cvt_pk_bf16_f32 v118, v240, v241
    v_cvt_pk_bf16_f32 v119, v242, v243
    v_accvgpr_read_b32 v228, a176
    v_accvgpr_read_b32 v229, a177
    v_accvgpr_read_b32 v230, a178
    v_accvgpr_read_b32 v231, a179
    v_accvgpr_read_b32 v232, a196
    v_accvgpr_read_b32 v233, a197
    v_accvgpr_read_b32 v234, a198
    v_accvgpr_read_b32 v235, a199
    v_pk_mul_f32 v[228:229], v[228:229], v[248:249] op_sel_hi:[1,0]
    v_pk_mul_f32 v[230:231], v[230:231], v[248:249] op_sel_hi:[1,0]
    v_pk_mul_f32 v[232:233], v[232:233], v[248:249] op_sel_hi:[1,0]
    v_pk_mul_f32 v[234:235], v[234:235], v[248:249] op_sel_hi:[1,0]
    v_cvt_pk_bf16_f32 v120, v228, v229
    v_cvt_pk_bf16_f32 v121, v230, v231
    v_cvt_pk_bf16_f32 v122, v232, v233
    v_cvt_pk_bf16_f32 v123, v234, v235
    v_accvgpr_read_b32 v236, a200
    v_accvgpr_read_b32 v237, a201
    v_accvgpr_read_b32 v238, a202
    v_accvgpr_read_b32 v239, a203
    v_accvgpr_read_b32 v240, a220
    v_accvgpr_read_b32 v241, a221
    v_accvgpr_read_b32 v242, a222
    v_accvgpr_read_b32 v243, a223
    v_pk_mul_f32 v[236:237], v[236:237], v[244:245] op_sel_hi:[1,0]
    v_pk_mul_f32 v[238:239], v[238:239], v[244:245] op_sel_hi:[1,0]
    v_pk_mul_f32 v[240:241], v[240:241], v[244:245] op_sel_hi:[1,0]
    v_pk_mul_f32 v[242:243], v[242:243], v[244:245] op_sel_hi:[1,0]
    v_cvt_pk_bf16_f32 v124, v236, v237
    v_cvt_pk_bf16_f32 v125, v238, v239
    v_cvt_pk_bf16_f32 v126, v240, v241
    v_cvt_pk_bf16_f32 v127, v242, v243
    v_accvgpr_read_b32 v228, a204
    v_accvgpr_read_b32 v229, a205
    v_accvgpr_read_b32 v230, a206
    v_accvgpr_read_b32 v231, a207
    v_accvgpr_read_b32 v232, a224
    v_accvgpr_read_b32 v233, a225
    v_accvgpr_read_b32 v234, a226
    v_accvgpr_read_b32 v235, a227
    v_pk_mul_f32 v[228:229], v[228:229], v[244:245] op_sel:[0,1] op_sel_hi:[1,1]
    v_pk_mul_f32 v[230:231], v[230:231], v[244:245] op_sel:[0,1] op_sel_hi:[1,1]
    v_pk_mul_f32 v[232:233], v[232:233], v[244:245] op_sel:[0,1] op_sel_hi:[1,1]
    v_pk_mul_f32 v[234:235], v[234:235], v[244:245] op_sel:[0,1] op_sel_hi:[1,1]
    v_cvt_pk_bf16_f32 v128, v228, v229
    v_cvt_pk_bf16_f32 v129, v230, v231
    v_cvt_pk_bf16_f32 v130, v232, v233
    v_cvt_pk_bf16_f32 v131, v234, v235
    v_accvgpr_read_b32 v236, a208
    v_accvgpr_read_b32 v237, a209
    v_accvgpr_read_b32 v238, a210
    v_accvgpr_read_b32 v239, a211
    v_accvgpr_read_b32 v240, a228
    v_accvgpr_read_b32 v241, a229
    v_accvgpr_read_b32 v242, a230
    v_accvgpr_read_b32 v243, a231
    v_pk_mul_f32 v[236:237], v[236:237], v[246:247] op_sel_hi:[1,0]
    v_pk_mul_f32 v[238:239], v[238:239], v[246:247] op_sel_hi:[1,0]
    v_pk_mul_f32 v[240:241], v[240:241], v[246:247] op_sel_hi:[1,0]
    v_pk_mul_f32 v[242:243], v[242:243], v[246:247] op_sel_hi:[1,0]
    v_cvt_pk_bf16_f32 v132, v236, v237
    v_cvt_pk_bf16_f32 v133, v238, v239
    v_cvt_pk_bf16_f32 v134, v240, v241
    v_cvt_pk_bf16_f32 v135, v242, v243
    v_accvgpr_read_b32 v228, a212
    v_accvgpr_read_b32 v229, a213
    v_accvgpr_read_b32 v230, a214
    v_accvgpr_read_b32 v231, a215
    v_accvgpr_read_b32 v232, a232
    v_accvgpr_read_b32 v233, a233
    v_accvgpr_read_b32 v234, a234
    v_accvgpr_read_b32 v235, a235
    v_pk_mul_f32 v[228:229], v[228:229], v[246:247] op_sel:[0,1] op_sel_hi:[1,1]
    v_pk_mul_f32 v[230:231], v[230:231], v[246:247] op_sel:[0,1] op_sel_hi:[1,1]
    v_pk_mul_f32 v[232:233], v[232:233], v[246:247] op_sel:[0,1] op_sel_hi:[1,1]
    v_pk_mul_f32 v[234:235], v[234:235], v[246:247] op_sel:[0,1] op_sel_hi:[1,1]
    v_cvt_pk_bf16_f32 v56, v228, v229
    v_cvt_pk_bf16_f32 v57, v230, v231
    v_cvt_pk_bf16_f32 v58, v232, v233
    v_cvt_pk_bf16_f32 v59, v234, v235
    v_accvgpr_read_b32 v236, a216
    v_accvgpr_read_b32 v237, a217
    v_accvgpr_read_b32 v238, a218
    v_accvgpr_read_b32 v239, a219
    v_accvgpr_read_b32 v240, a236
    v_accvgpr_read_b32 v241, a237
    v_accvgpr_read_b32 v242, a238
    v_accvgpr_read_b32 v243, a239
    v_pk_mul_f32 v[236:237], v[236:237], v[248:249] op_sel_hi:[1,0]
    v_pk_mul_f32 v[238:239], v[238:239], v[248:249] op_sel_hi:[1,0]
    v_pk_mul_f32 v[240:241], v[240:241], v[248:249] op_sel_hi:[1,0]
    v_pk_mul_f32 v[242:243], v[242:243], v[248:249] op_sel_hi:[1,0]
    v_cvt_pk_bf16_f32 v60, v236, v237
    v_cvt_pk_bf16_f32 v61, v238, v239
    v_cvt_pk_bf16_f32 v62, v240, v241
    v_cvt_pk_bf16_f32 v63, v242, v243
    s_mov_b32 s22, 56320
    v_mov_b32 v228, 0
    v_mov_b32 v229, 0
    v_mov_b32 v230, 0
    v_mov_b32 v231, 0
    s_mov_b32 s30, 54272
    buffer_store_dwordx4 v[56:59], v254, s[20:23], s30 offen sc1
    s_mov_b32 s31, 55296
    buffer_store_dwordx4 v[60:63], v254, s[20:23], s31 offen sc1
    buffer_store_dwordx4 v[228:231], off, s[64:67], s87 sc1
    s_mov_b32 s28, 3
    s_waitcnt lgkmcnt(0)
    s_branch L_qp
.p2align 3
L_ato:
    s_mul_i32 s45, s84, 24
    s_mov_b32 s36, 2
    s_mov_b32 s79, 0
    s_mov_b32 s86, 0x0808
    s_mov_b32 s37, s81
    s_mul_i32 s77, s45, 81920
    s_mul_i32 s78, s45, 20480
    v_mfma_f32_16x16x32_bf16 v[136:139], v[196:199], v[16:19], 0
    v_exp_f32 v172, v172
    v_mfma_f32_16x16x32_bf16 v[136:139], v[200:203], v[36:39], v[136:139]
    ds_read_b64_tr_b16 v[220:221], v0 offset:0
    v_cvt_pk_bf16_f32 v191, v170, v171
    v_mfma_f32_16x16x32_bf16 v[136:139], v[204:207], v[56:59], v[136:139]
    v_exp_f32 v173, v173
    v_mfma_f32_16x16x32_bf16 v[136:139], v[208:211], v[76:79], v[136:139]
    ds_read_b64_tr_b16 v[222:223], v0 offset:6144
    v_mfma_f32_16x16x32_bf16 v[136:139], v[212:215], v[96:99], v[136:139]
    ds_read_b64_tr_b16 v[224:225], v1 offset:0
    v_cvt_pk_bf16_f32 v192, v152, v153
    v_mfma_f32_16x16x32_bf16 v[136:139], v[216:219], v[116:119], v[136:139]
    v_exp_f32 v174, v174
    v_mfma_f32_16x16x32_bf16 v[140:143], v[216:219], v[120:123], 0
    ds_read_b64_tr_b16 v[226:227], v1 offset:6144
    v_cvt_pk_bf16_f32 v193, v154, v155
    v_mfma_f32_16x16x32_bf16 v[140:143], v[212:215], v[100:103], v[140:143]
    ds_read_b64_tr_b16 v[228:229], v2 offset:0
    v_add_f32 v248, v248, v172
    v_mfma_f32_16x16x32_bf16 v[140:143], v[208:211], v[80:83], v[140:143]
    v_exp_f32 v175, v175
    v_mfma_f32_16x16x32_bf16 v[140:143], v[204:207], v[60:63], v[140:143]
    ds_read_b64_tr_b16 v[230:231], v2 offset:6144
    v_cvt_pk_bf16_f32 v194, v172, v173
    v_mfma_f32_16x16x32_bf16 v[140:143], v[200:203], v[40:43], v[140:143]
    ds_read_b64_tr_b16 v[232:233], v3 offset:0
    v_add_f32 v248, v248, v173
    v_mfma_f32_16x16x32_bf16 v[140:143], v[196:199], v[20:23], v[140:143]
    v_exp_f32 v136, v136
    v_mfma_f32_16x16x32_bf16 v[144:147], v[196:199], v[24:27], 0
    ds_read_b64_tr_b16 v[234:235], v3 offset:6144
    v_add_f32 v244, v244, v136
    v_mfma_f32_16x16x32_bf16 v[144:147], v[200:203], v[44:47], v[144:147]
    ds_read_b64_tr_b16 v[236:237], v0 offset:128
    v_mfma_f32_16x16x32_bf16 v[144:147], v[204:207], v[64:67], v[144:147]
    v_exp_f32 v137, v137
    v_mfma_f32_16x16x32_bf16 v[144:147], v[208:211], v[84:87], v[144:147]
    ds_read_b64_tr_b16 v[238:239], v0 offset:6272
    v_add_f32 v244, v244, v137
    v_mfma_f32_16x16x32_bf16 v[144:147], v[212:215], v[104:107], v[144:147]
    ds_read_b64_tr_b16 v[240:241], v1 offset:128
    v_add_f32 v248, v248, v174
    v_mfma_f32_16x16x32_bf16 v[144:147], v[216:219], v[124:127], v[144:147]
    v_exp_f32 v138, v138
    v_mfma_f32_16x16x32_bf16 v[148:151], v[216:219], v[128:131], 0
    ds_read_b64_tr_b16 v[242:243], v1 offset:6272
    v_add_f32 v244, v244, v138
    v_mfma_f32_16x16x32_bf16 v[148:151], v[212:215], v[108:111], v[148:151]
    v_cvt_pk_bf16_f32 v195, v174, v175
    v_mfma_f32_16x16x32_bf16 v[148:151], v[208:211], v[88:91], v[148:151]
    v_exp_f32 v139, v139
    v_mfma_f32_16x16x32_bf16 v[148:151], v[204:207], v[68:71], v[148:151]
    buffer_load_dword v255, off, s[68:71], s37 sc1
    v_mfma_f32_16x16x32_bf16 v[148:151], v[200:203], v[48:51], v[148:151]
    s_add_u32 m0, s76, 143360
    v_add_f32 v244, v244, v139
    v_mfma_f32_16x16x32_bf16 v[148:151], v[196:199], v[28:31], v[148:151]
    s_mov_b32 s33, s77
    v_exp_f32 v140, v140
    v_mfma_f32_16x16x32_bf16 v[152:155], v[196:199], v[32:35], 0
    v_add_f32 v248, v248, v175
    v_mfma_f32_16x16x32_bf16 v[152:155], v[200:203], v[52:55], v[152:155]
    v_add_f32 v245, v245, v140
    v_mfma_f32_16x16x32_bf16 v[152:155], v[204:207], v[72:75], v[152:155]
    v_exp_f32 v141, v141
    v_mfma_f32_16x16x32_bf16 v[152:155], v[208:211], v[92:95], v[152:155]
    v_add_f32 v245, v245, v141
    v_mfma_f32_16x16x32_bf16 v[152:155], v[212:215], v[112:115], v[152:155]
    v_mfma_f32_16x16x32_bf16 v[152:155], v[216:219], v[132:135], v[152:155]
    s_waitcnt lgkmcnt(0)
    v_exp_f32 v142, v142
    v_mfma_f32_16x16x32_bf16 a[0:3], v[220:223], v[176:179], a[0:3]
    buffer_load_dwordx4 v249, s[52:55], s33 offen lds
    v_mfma_f32_16x16x32_bf16 a[20:23], v[224:227], v[176:179], a[20:23]
    ds_read_b128 v[196:199], v14 offset:12288
    v_add_f32 v245, v245, v142
    v_mfma_f32_16x16x32_bf16 a[40:43], v[228:231], v[176:179], a[40:43]
    v_exp_f32 v143, v143
    v_mfma_f32_16x16x32_bf16 a[60:63], v[232:235], v[176:179], a[60:63]
    ds_read_b128 v[200:203], v15 offset:12288
    v_add_f32 v245, v245, v143
    v_mfma_f32_16x16x32_bf16 a[80:83], v[236:239], v[176:179], a[80:83]
    ds_read_b128 v[204:207], v14 offset:12416
    v_mfma_f32_16x16x32_bf16 a[100:103], v[240:243], v[176:179], a[100:103]
    v_exp_f32 v144, v144
    v_mfma_f32_16x16x32_bf16 a[104:107], v[240:243], v[180:183], a[104:107]
    ds_read_b128 v[208:211], v15 offset:12416
    v_add_f32 v246, v246, v144
    v_mfma_f32_16x16x32_bf16 a[84:87], v[236:239], v[180:183], a[84:87]
    ds_read_b128 v[212:215], v14 offset:12544
    v_mfma_f32_16x16x32_bf16 a[64:67], v[232:235], v[180:183], a[64:67]
    v_exp_f32 v145, v145
    v_mfma_f32_16x16x32_bf16 a[44:47], v[228:231], v[180:183], a[44:47]
    buffer_load_dwordx4 v250, s[52:55], s33 offen offset:1024 lds
    v_mfma_f32_16x16x32_bf16 a[24:27], v[224:227], v[180:183], a[24:27]
    ds_read_b128 v[216:219], v15 offset:12544
    v_add_f32 v246, v246, v145
    v_mfma_f32_16x16x32_bf16 a[4:7], v[220:223], v[180:183], a[4:7]
    v_exp_f32 v146, v146
    v_mfma_f32_16x16x32_bf16 a[8:11], v[220:223], v[184:187], a[8:11]
    v_add_f32 v246, v246, v146
    v_mfma_f32_16x16x32_bf16 a[28:31], v[224:227], v[184:187], a[28:31]
    v_mfma_f32_16x16x32_bf16 a[48:51], v[228:231], v[184:187], a[48:51]
    v_exp_f32 v147, v147
    v_mfma_f32_16x16x32_bf16 a[68:71], v[232:235], v[184:187], a[68:71]
    v_add_f32 v246, v246, v147
    v_mfma_f32_16x16x32_bf16 a[88:91], v[236:239], v[184:187], a[88:91]
    v_mfma_f32_16x16x32_bf16 a[108:111], v[240:243], v[184:187], a[108:111]
    v_exp_f32 v148, v148
    v_mfma_f32_16x16x32_bf16 a[112:115], v[240:243], v[188:191], a[112:115]
    buffer_load_dwordx4 v251, s[52:55], s33 offen offset:2048 lds
    v_mfma_f32_16x16x32_bf16 a[92:95], v[236:239], v[188:191], a[92:95]
    v_add_f32 v247, v247, v148
    v_mfma_f32_16x16x32_bf16 a[72:75], v[232:235], v[188:191], a[72:75]
    v_exp_f32 v149, v149
    v_mfma_f32_16x16x32_bf16 a[52:55], v[228:231], v[188:191], a[52:55]
    v_add_f32 v247, v247, v149
    v_mfma_f32_16x16x32_bf16 a[32:35], v[224:227], v[188:191], a[32:35]
    v_mfma_f32_16x16x32_bf16 a[12:15], v[220:223], v[188:191], a[12:15]
    v_exp_f32 v150, v150
    v_mfma_f32_16x16x32_bf16 a[16:19], v[220:223], v[192:195], a[16:19]
    v_add_f32 v247, v247, v150
    v_mfma_f32_16x16x32_bf16 a[36:39], v[224:227], v[192:195], a[36:39]
    v_mfma_f32_16x16x32_bf16 a[56:59], v[228:231], v[192:195], a[56:59]
    v_exp_f32 v151, v151
    v_mfma_f32_16x16x32_bf16 a[76:79], v[232:235], v[192:195], a[76:79]
    buffer_load_dwordx4 v252, s[52:55], s33 offen offset:3072 lds
    v_mfma_f32_16x16x32_bf16 a[96:99], v[236:239], v[192:195], a[96:99]
    s_add_u32 m0, s76, 147456
    v_add_f32 v247, v247, v151
    v_mfma_f32_16x16x32_bf16 a[116:119], v[240:243], v[192:195], a[116:119]
    s_waitcnt lgkmcnt(0)
    v_exp_f32 v152, v152
    v_mfma_f32_16x16x32_bf16 v[156:159], v[196:199], v[16:19], 0
    s_add_u32 s77, s77, 81920
    ds_read_b64_tr_b16 v[220:221], v2 offset:128
    v_add_f32 v248, v248, v152
    v_mfma_f32_16x16x32_bf16 v[156:159], v[200:203], v[36:39], v[156:159]
    ds_read_b64_tr_b16 v[222:223], v2 offset:6272
    v_mfma_f32_16x16x32_bf16 v[156:159], v[204:207], v[56:59], v[156:159]
    v_exp_f32 v153, v153
    v_mfma_f32_16x16x32_bf16 v[156:159], v[208:211], v[76:79], v[156:159]
    ds_read_b64_tr_b16 v[224:225], v3 offset:128
    v_add_f32 v248, v248, v153
    v_mfma_f32_16x16x32_bf16 v[156:159], v[212:215], v[96:99], v[156:159]
    ds_read_b64_tr_b16 v[226:227], v3 offset:6272
    v_mfma_f32_16x16x32_bf16 v[156:159], v[216:219], v[116:119], v[156:159]
    v_exp_f32 v154, v154
    v_mfma_f32_16x16x32_bf16 v[160:163], v[216:219], v[120:123], 0
    buffer_load_dwordx4 v253, s[52:55], s33 offen lds
    v_mfma_f32_16x16x32_bf16 v[160:163], v[212:215], v[100:103], v[160:163]
    ds_read_b64_tr_b16 v[228:229], v0 offset:256
    v_add_f32 v248, v248, v154
    v_mfma_f32_16x16x32_bf16 v[160:163], v[208:211], v[80:83], v[160:163]
    v_exp_f32 v155, v155
    v_mfma_f32_16x16x32_bf16 v[160:163], v[204:207], v[60:63], v[160:163]
    ds_read_b64_tr_b16 v[230:231], v0 offset:6400
    v_add_f32 v248, v248, v155
    v_mfma_f32_16x16x32_bf16 v[160:163], v[200:203], v[40:43], v[160:163]
    ds_read_b64_tr_b16 v[232:233], v1 offset:256
    v_mfma_f32_16x16x32_bf16 v[160:163], v[196:199], v[20:23], v[160:163]
    v_exp_f32 v156, v156
    v_mfma_f32_16x16x32_bf16 v[164:167], v[196:199], v[24:27], 0
    ds_read_b64_tr_b16 v[234:235], v1 offset:6400
    v_add_f32 v244, v244, v156
    v_mfma_f32_16x16x32_bf16 v[164:167], v[200:203], v[44:47], v[164:167]
    ds_read_b64_tr_b16 v[236:237], v2 offset:256
    v_mfma_f32_16x16x32_bf16 v[164:167], v[204:207], v[64:67], v[164:167]
    v_exp_f32 v157, v157
    v_mfma_f32_16x16x32_bf16 v[164:167], v[208:211], v[84:87], v[164:167]
    ds_read_b64_tr_b16 v[238:239], v2 offset:6400
    v_add_f32 v244, v244, v157
    v_mfma_f32_16x16x32_bf16 v[164:167], v[212:215], v[104:107], v[164:167]
    ds_read_b64_tr_b16 v[240:241], v3 offset:256
    v_mfma_f32_16x16x32_bf16 v[164:167], v[216:219], v[124:127], v[164:167]
    v_exp_f32 v158, v158
    v_mfma_f32_16x16x32_bf16 v[168:171], v[216:219], v[128:131], 0
    ds_read_b64_tr_b16 v[242:243], v3 offset:6400
    v_add_f32 v244, v244, v158
    v_mfma_f32_16x16x32_bf16 v[168:171], v[212:215], v[108:111], v[168:171]
    v_add_u32 v0, 0xc000, v0
    v_add_u32 v2, 0xc000, v2
    v_mfma_f32_16x16x32_bf16 v[168:171], v[208:211], v[88:91], v[168:171]
    v_exp_f32 v159, v159
    v_mfma_f32_16x16x32_bf16 v[168:171], v[204:207], v[68:71], v[168:171]
    v_add_u32 v1, 0xc000, v1
    v_add_u32 v3, 0xc000, v3
    v_mfma_f32_16x16x32_bf16 v[168:171], v[200:203], v[48:51], v[168:171]
    v_add_f32 v244, v244, v159
    v_mfma_f32_16x16x32_bf16 v[168:171], v[196:199], v[28:31], v[168:171]
    v_exp_f32 v160, v160
    v_mfma_f32_16x16x32_bf16 v[172:175], v[196:199], v[32:35], 0
    v_add_f32 v245, v245, v160
    v_mfma_f32_16x16x32_bf16 v[172:175], v[200:203], v[52:55], v[172:175]
    v_mfma_f32_16x16x32_bf16 v[172:175], v[204:207], v[72:75], v[172:175]
    v_exp_f32 v161, v161
    v_mfma_f32_16x16x32_bf16 v[172:175], v[208:211], v[92:95], v[172:175]
    v_add_f32 v245, v245, v161
    v_mfma_f32_16x16x32_bf16 v[172:175], v[212:215], v[112:115], v[172:175]
    v_mfma_f32_16x16x32_bf16 v[172:175], v[216:219], v[132:135], v[172:175]
    s_waitcnt vmcnt(5) lgkmcnt(0)
    s_barrier
    v_readfirstlane_b32 s43, v255
    s_mov_b32 s44, 0x80000
    L_chk2:
    s_and_b32 s43, s43, s86
    s_cmp_eq_u32 s43, s86
    s_cbranch_scc1 L_ok2
    s_sub_u32 s44, s44, 1
    s_cbranch_scc1 L_ok2
    buffer_load_dword v255, off, s[68:71], s37 sc1
    s_waitcnt vmcnt(0)
    v_readfirstlane_b32 s43, v255
    s_branch L_chk2
    L_ok2:
    v_mfma_f32_16x16x32_bf16 a[120:123], v[220:223], v[176:179], a[120:123]
    s_add_u32 m0, s76, 122880
    v_exp_f32 v162, v162
    v_mfma_f32_16x16x32_bf16 a[140:143], v[224:227], v[176:179], a[140:143]
    buffer_load_dwordx4 v254, s[56:59], s78 offen sc1 lds
    v_mfma_f32_16x16x32_bf16 a[160:163], v[228:231], v[176:179], a[160:163]
    v_exp_f32 v163, v163
    v_mfma_f32_16x16x32_bf16 a[180:183], v[232:235], v[176:179], a[180:183]
    ds_read_b64_tr_b16 v[196:197], v0 offset:0
    v_add_f32 v245, v245, v162
    v_mfma_f32_16x16x32_bf16 a[200:203], v[236:239], v[176:179], a[200:203]
    ds_read_b64_tr_b16 v[198:199], v0 offset:6144
    v_add_f32 v245, v245, v163
    v_mfma_f32_16x16x32_bf16 a[220:223], v[240:243], v[176:179], a[220:223]
    v_exp_f32 v164, v164
    v_mfma_f32_16x16x32_bf16 a[224:227], v[240:243], v[180:183], a[224:227]
    buffer_load_dwordx4 v254, s[56:59], s78 offen offset:1024 sc1 lds
    v_mfma_f32_16x16x32_bf16 a[204:207], v[236:239], v[180:183], a[204:207]
    ds_read_b64_tr_b16 v[200:201], v1 offset:0
    v_cvt_pk_bf16_f32 v176, v136, v137
    v_mfma_f32_16x16x32_bf16 a[184:187], v[232:235], v[180:183], a[184:187]
    v_exp_f32 v165, v165
    v_mfma_f32_16x16x32_bf16 a[164:167], v[228:231], v[180:183], a[164:167]
    ds_read_b64_tr_b16 v[202:203], v1 offset:6144
    v_cvt_pk_bf16_f32 v177, v138, v139
    v_mfma_f32_16x16x32_bf16 a[144:147], v[224:227], v[180:183], a[144:147]
    buffer_load_dwordx4 v254, s[56:59], s78 offen offset:2048 sc1 lds
    v_mfma_f32_16x16x32_bf16 a[124:127], v[220:223], v[180:183], a[124:127]
    v_exp_f32 v166, v166
    v_mfma_f32_16x16x32_bf16 a[128:131], v[220:223], v[184:187], a[128:131]
    ds_read_b64_tr_b16 v[204:205], v2 offset:0
    v_cvt_pk_bf16_f32 v178, v156, v157
    v_mfma_f32_16x16x32_bf16 a[148:151], v[224:227], v[184:187], a[148:151]
    ds_read_b64_tr_b16 v[206:207], v2 offset:6144
    v_cvt_pk_bf16_f32 v179, v158, v159
    v_mfma_f32_16x16x32_bf16 a[168:171], v[228:231], v[184:187], a[168:171]
    v_exp_f32 v167, v167
    v_mfma_f32_16x16x32_bf16 a[188:191], v[232:235], v[184:187], a[188:191]
    buffer_load_dwordx4 v254, s[56:59], s78 offen offset:3072 sc1 lds
    v_mfma_f32_16x16x32_bf16 a[208:211], v[236:239], v[184:187], a[208:211]
    s_add_u32 m0, s76, 126976
    ds_read_b64_tr_b16 v[208:209], v3 offset:0
    v_cvt_pk_bf16_f32 v180, v140, v141
    v_mfma_f32_16x16x32_bf16 a[228:231], v[240:243], v[184:187], a[228:231]
    s_add_u32 s32, s78, 4096
    v_exp_f32 v168, v168
    v_mfma_f32_16x16x32_bf16 a[232:235], v[240:243], v[188:191], a[232:235]
    s_add_u32 s78, s78, 20480
    ds_read_b64_tr_b16 v[210:211], v3 offset:6144
    v_cvt_pk_bf16_f32 v181, v142, v143
    v_mfma_f32_16x16x32_bf16 a[212:215], v[236:239], v[188:191], a[212:215]
    buffer_load_dwordx4 v254, s[56:59], s32 offen sc1 lds
    v_mfma_f32_16x16x32_bf16 a[192:195], v[232:235], v[188:191], a[192:195]
    s_add_u32 m0, s76, 20480
    v_exp_f32 v169, v169
    v_mfma_f32_16x16x32_bf16 a[172:175], v[228:231], v[188:191], a[172:175]
    s_mov_b32 s33, s77
    ds_read_b64_tr_b16 v[212:213], v0 offset:128
    v_cvt_pk_bf16_f32 v182, v160, v161
    v_mfma_f32_16x16x32_bf16 a[152:155], v[224:227], v[188:191], a[152:155]
    ds_read_b64_tr_b16 v[214:215], v0 offset:6272
    v_cvt_pk_bf16_f32 v183, v162, v163
    v_mfma_f32_16x16x32_bf16 a[132:135], v[220:223], v[188:191], a[132:135]
    v_exp_f32 v170, v170
    ds_read_b64_tr_b16 v[216:217], v1 offset:128
    v_mfma_f32_16x16x32_bf16 a[136:139], v[220:223], v[192:195], a[136:139]
    buffer_load_dwordx4 v249, s[52:55], s33 offen lds
    ds_read_b64_tr_b16 v[218:219], v1 offset:6272
    v_mfma_f32_16x16x32_bf16 a[156:159], v[224:227], v[192:195], a[156:159]
    v_cvt_pk_bf16_f32 v184, v144, v145
    v_cvt_pk_bf16_f32 v185, v146, v147
    v_mfma_f32_16x16x32_bf16 a[176:179], v[228:231], v[192:195], a[176:179]
    v_exp_f32 v171, v171
    v_mfma_f32_16x16x32_bf16 a[196:199], v[232:235], v[192:195], a[196:199]
    v_cvt_pk_bf16_f32 v186, v164, v165
    v_cvt_pk_bf16_f32 v187, v166, v167
    v_mfma_f32_16x16x32_bf16 a[216:219], v[236:239], v[192:195], a[216:219]
    buffer_load_dwordx4 v250, s[52:55], s33 offen offset:1024 lds
    v_mfma_f32_16x16x32_bf16 a[236:239], v[240:243], v[192:195], a[236:239]
    s_waitcnt lgkmcnt(0)
    v_exp_f32 v172, v172
    v_mfma_f32_16x16x32_bf16 a[0:3], v[196:199], v[176:179], a[0:3]
    ds_read_b64_tr_b16 v[220:221], v2 offset:128
    v_cvt_pk_bf16_f32 v188, v148, v149
    v_mfma_f32_16x16x32_bf16 a[20:23], v[200:203], v[176:179], a[20:23]
    ds_read_b64_tr_b16 v[222:223], v2 offset:6272
    v_cvt_pk_bf16_f32 v189, v150, v151
    v_mfma_f32_16x16x32_bf16 a[40:43], v[204:207], v[176:179], a[40:43]
    v_exp_f32 v173, v173
    v_mfma_f32_16x16x32_bf16 a[60:63], v[208:211], v[176:179], a[60:63]
    buffer_load_dwordx4 v251, s[52:55], s33 offen offset:2048 lds
    v_mfma_f32_16x16x32_bf16 a[80:83], v[212:215], v[176:179], a[80:83]
    ds_read_b64_tr_b16 v[224:225], v3 offset:128
    v_cvt_pk_bf16_f32 v190, v168, v169
    v_mfma_f32_16x16x32_bf16 a[100:103], v[216:219], v[176:179], a[100:103]
    v_exp_f32 v174, v174
    v_mfma_f32_16x16x32_bf16 a[104:107], v[216:219], v[180:183], a[104:107]
    ds_read_b64_tr_b16 v[226:227], v3 offset:6272
    v_cvt_pk_bf16_f32 v191, v170, v171
    v_mfma_f32_16x16x32_bf16 a[84:87], v[212:215], v[180:183], a[84:87]
    buffer_load_dwordx4 v252, s[52:55], s33 offen offset:3072 lds
    v_mfma_f32_16x16x32_bf16 a[64:67], v[208:211], v[180:183], a[64:67]
    s_add_u32 m0, s76, 24576
    v_exp_f32 v175, v175
    v_mfma_f32_16x16x32_bf16 a[44:47], v[204:207], v[180:183], a[44:47]
    s_add_u32 s77, s77, 81920
    ds_read_b64_tr_b16 v[228:229], v0 offset:256
    v_cvt_pk_bf16_f32 v192, v152, v153
    v_mfma_f32_16x16x32_bf16 a[24:27], v[200:203], v[180:183], a[24:27]
    ds_read_b64_tr_b16 v[230:231], v0 offset:6400
    v_cvt_pk_bf16_f32 v193, v154, v155
    v_mfma_f32_16x16x32_bf16 a[4:7], v[196:199], v[180:183], a[4:7]
    buffer_load_dwordx4 v253, s[52:55], s33 offen lds
    v_mfma_f32_16x16x32_bf16 a[8:11], v[196:199], v[184:187], a[8:11]
    ds_read_b64_tr_b16 v[232:233], v1 offset:256
    v_cvt_pk_bf16_f32 v194, v172, v173
    v_mfma_f32_16x16x32_bf16 a[28:31], v[200:203], v[184:187], a[28:31]
    ds_read_b64_tr_b16 v[234:235], v1 offset:6400
    v_cvt_pk_bf16_f32 v195, v174, v175
    v_mfma_f32_16x16x32_bf16 a[48:51], v[204:207], v[184:187], a[48:51]
    ds_read_b64_tr_b16 v[236:237], v2 offset:256
    v_add_f32 v246, v246, v164
    v_mfma_f32_16x16x32_bf16 a[68:71], v[208:211], v[184:187], a[68:71]
    ds_read_b64_tr_b16 v[238:239], v2 offset:6400
    v_add_f32 v246, v246, v165
    v_mfma_f32_16x16x32_bf16 a[88:91], v[212:215], v[184:187], a[88:91]
    ds_read_b64_tr_b16 v[240:241], v3 offset:256
    v_add_f32 v246, v246, v166
    v_mfma_f32_16x16x32_bf16 a[108:111], v[216:219], v[184:187], a[108:111]
    ds_read_b64_tr_b16 v[242:243], v3 offset:6400
    v_add_f32 v246, v246, v167
    v_mfma_f32_16x16x32_bf16 a[112:115], v[216:219], v[188:191], a[112:115]
    v_add_f32 v247, v247, v168
    v_add_f32 v247, v247, v169
    v_mfma_f32_16x16x32_bf16 a[92:95], v[212:215], v[188:191], a[92:95]
    v_add_f32 v247, v247, v170
    v_add_f32 v247, v247, v171
    v_mfma_f32_16x16x32_bf16 a[72:75], v[208:211], v[188:191], a[72:75]
    v_add_f32 v248, v248, v172
    v_add_f32 v248, v248, v173
    v_mfma_f32_16x16x32_bf16 a[52:55], v[204:207], v[188:191], a[52:55]
    v_add_f32 v248, v248, v174
    v_add_f32 v248, v248, v175
    v_mfma_f32_16x16x32_bf16 a[32:35], v[200:203], v[188:191], a[32:35]
    v_mfma_f32_16x16x32_bf16 a[12:15], v[196:199], v[188:191], a[12:15]
    v_mov_b32 v136, v244
    v_mov_b32 v137, v245
    v_mfma_f32_16x16x32_bf16 a[16:19], v[196:199], v[192:195], a[16:19]
    v_mov_b32 v138, v246
    v_mov_b32 v139, v247
    v_mfma_f32_16x16x32_bf16 a[36:39], v[200:203], v[192:195], a[36:39]
    v_mov_b32 v140, v248
    v_mfma_f32_16x16x32_bf16 a[56:59], v[204:207], v[192:195], a[56:59]
    v_permlane32_swap_b32 v136, v244
    v_permlane32_swap_b32 v137, v245
    v_mfma_f32_16x16x32_bf16 a[76:79], v[208:211], v[192:195], a[76:79]
    v_permlane32_swap_b32 v138, v246
    v_permlane32_swap_b32 v139, v247
    v_mfma_f32_16x16x32_bf16 a[96:99], v[212:215], v[192:195], a[96:99]
    v_permlane32_swap_b32 v140, v248
    v_mfma_f32_16x16x32_bf16 a[116:119], v[216:219], v[192:195], a[116:119]
    s_waitcnt lgkmcnt(0)
    s_barrier
    v_mfma_f32_16x16x32_bf16 a[120:123], v[220:223], v[176:179], a[120:123]
    s_add_u32 m0, s76, 0
    v_add_f32 v244, v244, v136
    v_add_f32 v245, v245, v137
    v_mfma_f32_16x16x32_bf16 a[140:143], v[224:227], v[176:179], a[140:143]
    buffer_load_dwordx4 v254, s[56:59], s78 offen sc1 lds
    v_mfma_f32_16x16x32_bf16 a[160:163], v[228:231], v[176:179], a[160:163]
    v_add_f32 v246, v246, v138
    v_add_f32 v247, v247, v139
    v_mfma_f32_16x16x32_bf16 a[180:183], v[232:235], v[176:179], a[180:183]
    v_add_f32 v248, v248, v140
    v_mfma_f32_16x16x32_bf16 a[200:203], v[236:239], v[176:179], a[200:203]
    v_mov_b32 v136, v244
    v_mov_b32 v137, v245
    v_mfma_f32_16x16x32_bf16 a[220:223], v[240:243], v[176:179], a[220:223]
    buffer_load_dwordx4 v254, s[56:59], s78 offen offset:1024 sc1 lds
    v_mfma_f32_16x16x32_bf16 a[224:227], v[240:243], v[180:183], a[224:227]
    v_mov_b32 v138, v246
    v_mov_b32 v139, v247
    v_mfma_f32_16x16x32_bf16 a[204:207], v[236:239], v[180:183], a[204:207]
    v_mov_b32 v140, v248
    v_mfma_f32_16x16x32_bf16 a[184:187], v[232:235], v[180:183], a[184:187]
    v_permlane16_swap_b32 v136, v244
    v_permlane16_swap_b32 v137, v245
    v_mfma_f32_16x16x32_bf16 a[164:167], v[228:231], v[180:183], a[164:167]
    buffer_load_dwordx4 v254, s[56:59], s78 offen offset:2048 sc1 lds
    v_mfma_f32_16x16x32_bf16 a[144:147], v[224:227], v[180:183], a[144:147]
    v_permlane16_swap_b32 v138, v246
    v_permlane16_swap_b32 v139, v247
    v_mfma_f32_16x16x32_bf16 a[124:127], v[220:223], v[180:183], a[124:127]
    v_permlane16_swap_b32 v140, v248
    v_mfma_f32_16x16x32_bf16 a[128:131], v[220:223], v[184:187], a[128:131]
    v_add_f32 v244, v244, v136
    v_add_f32 v245, v245, v137
    v_mfma_f32_16x16x32_bf16 a[148:151], v[224:227], v[184:187], a[148:151]
    buffer_load_dwordx4 v254, s[56:59], s78 offen offset:3072 sc1 lds
    v_mfma_f32_16x16x32_bf16 a[168:171], v[228:231], v[184:187], a[168:171]
    s_add_u32 m0, s76, 4096
    v_add_f32 v246, v246, v138
    v_add_f32 v247, v247, v139
    v_mfma_f32_16x16x32_bf16 a[188:191], v[232:235], v[184:187], a[188:191]
    s_add_u32 s32, s78, 4096
    v_add_f32 v248, v248, v140
    v_mfma_f32_16x16x32_bf16 a[208:211], v[236:239], v[184:187], a[208:211]
    s_add_u32 s78, s78, 20480
    v_subrev_u32 v136, 0x30800000, v244
    v_subrev_u32 v137, 0x30800000, v245
    v_mfma_f32_16x16x32_bf16 a[228:231], v[240:243], v[184:187], a[228:231]
    buffer_load_dwordx4 v254, s[56:59], s32 offen sc1 lds
    v_mfma_f32_16x16x32_bf16 a[232:235], v[240:243], v[188:191], a[232:235]
    v_subrev_u32 v138, 0x30800000, v246
    v_subrev_u32 v139, 0x30800000, v247
    v_mfma_f32_16x16x32_bf16 a[212:215], v[236:239], v[188:191], a[212:215]
    v_subrev_u32 v140, 0x30800000, v248
    v_mfma_f32_16x16x32_bf16 a[192:195], v[232:235], v[188:191], a[192:195]
    v_max3_u32 v136, v136, v137, v138
    v_max3_u32 v136, v136, v139, v140
    v_mfma_f32_16x16x32_bf16 a[172:175], v[228:231], v[188:191], a[172:175]
    v_mfma_f32_16x16x32_bf16 a[152:155], v[224:227], v[188:191], a[152:155]
    v_mfma_f32_16x16x32_bf16 a[132:135], v[220:223], v[188:191], a[132:135]
    v_mfma_f32_16x16x32_bf16 a[136:139], v[220:223], v[192:195], a[136:139]
    v_mfma_f32_16x16x32_bf16 a[156:159], v[224:227], v[192:195], a[156:159]
    v_mfma_f32_16x16x32_bf16 a[176:179], v[228:231], v[192:195], a[176:179]
    v_mfma_f32_16x16x32_bf16 a[196:199], v[232:235], v[192:195], a[196:199]
    v_mfma_f32_16x16x32_bf16 a[216:219], v[236:239], v[192:195], a[216:219]
    v_mfma_f32_16x16x32_bf16 a[236:239], v[240:243], v[192:195], a[236:239]
    v_cmp_lt_u32 vcc, 0x2f000000, v136
    s_cmp_lg_u64 vcc, 0
    s_cbranch_scc1 L_slow
        L_backO:

    v_rcp_f32 v244, v244
    v_rcp_f32 v245, v245
    v_rcp_f32 v246, v246
    v_rcp_f32 v247, v247
    v_rcp_f32 v248, v248
    s_add_u32 s12, s12, 3145728
    s_addc_u32 s13, s13, 0
    s_add_u32 s16, s16, 3145728
    s_addc_u32 s17, s17, 0

    v_accvgpr_read_b32 v219, a246
    v_accvgpr_read_b32 v220, a247
    v_accvgpr_read_b32 v221, a248
    v_add_u32 v216, 122880, v219
    v_add_u32 v217, 122880, v220
    v_add_u32 v218, 122880, v221
    v_add_u32 v222, 40960, v219
    v_add_u32 v223, 40960, v220
    v_add_u32 v224, 40960, v221
    v_add_u32 v225, 81920, v219
    v_add_u32 v226, 81920, v220
    v_add_u32 v227, 81920, v221
    s_add_u32 m0, s76, 61440
    s_mov_b32 s33, s77
    v_accvgpr_read_b32 v228, a0
    v_accvgpr_read_b32 v229, a1
    v_accvgpr_read_b32 v230, a2
    v_accvgpr_read_b32 v231, a3
    buffer_load_dwordx4 v249, s[52:55], s33 offen lds
    v_accvgpr_read_b32 v232, a20
    v_accvgpr_read_b32 v233, a21
    v_accvgpr_read_b32 v234, a22
    v_accvgpr_read_b32 v235, a23
    v_pk_mul_f32 v[228:229], v[228:229], v[244:245] op_sel_hi:[1,0]
    v_pk_mul_f32 v[230:231], v[230:231], v[244:245] op_sel_hi:[1,0]
    v_pk_mul_f32 v[232:233], v[232:233], v[244:245] op_sel_hi:[1,0]
    v_pk_mul_f32 v[234:235], v[234:235], v[244:245] op_sel_hi:[1,0]
    v_cvt_pk_bf16_f32 v16, v228, v229
    v_cvt_pk_bf16_f32 v17, v230, v231
    v_cvt_pk_bf16_f32 v18, v232, v233
    v_cvt_pk_bf16_f32 v19, v234, v235
    v_accvgpr_read_b32 v236, a4
    v_accvgpr_read_b32 v237, a5
    v_accvgpr_read_b32 v238, a6
    v_accvgpr_read_b32 v239, a7
    buffer_load_dwordx4 v250, s[52:55], s33 offen offset:1024 lds
    v_accvgpr_read_b32 v240, a24
    v_accvgpr_read_b32 v241, a25
    v_accvgpr_read_b32 v242, a26
    v_accvgpr_read_b32 v243, a27
    v_pk_mul_f32 v[236:237], v[236:237], v[244:245] op_sel:[0,1] op_sel_hi:[1,1]
    v_pk_mul_f32 v[238:239], v[238:239], v[244:245] op_sel:[0,1] op_sel_hi:[1,1]
    v_pk_mul_f32 v[240:241], v[240:241], v[244:245] op_sel:[0,1] op_sel_hi:[1,1]
    v_pk_mul_f32 v[242:243], v[242:243], v[244:245] op_sel:[0,1] op_sel_hi:[1,1]
    v_cvt_pk_bf16_f32 v20, v236, v237
    v_cvt_pk_bf16_f32 v21, v238, v239
    v_cvt_pk_bf16_f32 v22, v240, v241
    v_cvt_pk_bf16_f32 v23, v242, v243
    v_accvgpr_read_b32 v228, a8
    v_accvgpr_read_b32 v229, a9
    v_accvgpr_read_b32 v230, a10
    v_accvgpr_read_b32 v231, a11
    buffer_load_dwordx4 v251, s[52:55], s33 offen offset:2048 lds
    v_accvgpr_read_b32 v232, a28
    v_accvgpr_read_b32 v233, a29
    v_accvgpr_read_b32 v234, a30
    v_accvgpr_read_b32 v235, a31
    v_pk_mul_f32 v[228:229], v[228:229], v[246:247] op_sel_hi:[1,0]
    v_pk_mul_f32 v[230:231], v[230:231], v[246:247] op_sel_hi:[1,0]
    v_pk_mul_f32 v[232:233], v[232:233], v[246:247] op_sel_hi:[1,0]
    v_pk_mul_f32 v[234:235], v[234:235], v[246:247] op_sel_hi:[1,0]
    v_cvt_pk_bf16_f32 v24, v228, v229
    v_cvt_pk_bf16_f32 v25, v230, v231
    v_cvt_pk_bf16_f32 v26, v232, v233
    v_cvt_pk_bf16_f32 v27, v234, v235
    v_accvgpr_read_b32 v236, a12
    v_accvgpr_read_b32 v237, a13
    v_accvgpr_read_b32 v238, a14
    v_accvgpr_read_b32 v239, a15
    v_accvgpr_read_b32 v240, a32
    v_accvgpr_read_b32 v241, a33
    v_accvgpr_read_b32 v242, a34
    v_accvgpr_read_b32 v243, a35
    v_pk_mul_f32 v[236:237], v[236:237], v[246:247] op_sel:[0,1] op_sel_hi:[1,1]
    v_pk_mul_f32 v[238:239], v[238:239], v[246:247] op_sel:[0,1] op_sel_hi:[1,1]
    v_pk_mul_f32 v[240:241], v[240:241], v[246:247] op_sel:[0,1] op_sel_hi:[1,1]
    v_pk_mul_f32 v[242:243], v[242:243], v[246:247] op_sel:[0,1] op_sel_hi:[1,1]
    v_cvt_pk_bf16_f32 v28, v236, v237
    v_cvt_pk_bf16_f32 v29, v238, v239
    v_cvt_pk_bf16_f32 v30, v240, v241
    v_cvt_pk_bf16_f32 v31, v242, v243
    v_accvgpr_read_b32 v228, a16
    v_accvgpr_read_b32 v229, a17
    v_accvgpr_read_b32 v230, a18
    v_accvgpr_read_b32 v231, a19
    buffer_load_dwordx4 v252, s[52:55], s33 offen offset:3072 lds
    v_accvgpr_read_b32 v232, a36
    v_accvgpr_read_b32 v233, a37
    v_accvgpr_read_b32 v234, a38
    v_accvgpr_read_b32 v235, a39
    v_pk_mul_f32 v[228:229], v[228:229], v[248:249] op_sel_hi:[1,0]
    v_pk_mul_f32 v[230:231], v[230:231], v[248:249] op_sel_hi:[1,0]
    v_pk_mul_f32 v[232:233], v[232:233], v[248:249] op_sel_hi:[1,0]
    v_pk_mul_f32 v[234:235], v[234:235], v[248:249] op_sel_hi:[1,0]
    v_cvt_pk_bf16_f32 v32, v228, v229
    v_cvt_pk_bf16_f32 v33, v230, v231
    v_cvt_pk_bf16_f32 v34, v232, v233
    v_cvt_pk_bf16_f32 v35, v234, v235
    s_add_u32 m0, s76, 65536
    s_add_u32 s77, s77, 81920
    v_accvgpr_read_b32 v236, a80
    v_accvgpr_read_b32 v237, a81
    v_accvgpr_read_b32 v238, a82
    v_accvgpr_read_b32 v239, a83
    buffer_load_dwordx4 v253, s[52:55], s33 offen lds
    v_accvgpr_read_b32 v240, a100
    v_accvgpr_read_b32 v241, a101
    v_accvgpr_read_b32 v242, a102
    v_accvgpr_read_b32 v243, a103
    v_pk_mul_f32 v[236:237], v[236:237], v[244:245] op_sel_hi:[1,0]
    v_pk_mul_f32 v[238:239], v[238:239], v[244:245] op_sel_hi:[1,0]
    v_pk_mul_f32 v[240:241], v[240:241], v[244:245] op_sel_hi:[1,0]
    v_pk_mul_f32 v[242:243], v[242:243], v[244:245] op_sel_hi:[1,0]
    v_cvt_pk_bf16_f32 v36, v236, v237
    v_cvt_pk_bf16_f32 v37, v238, v239
    v_cvt_pk_bf16_f32 v38, v240, v241
    v_cvt_pk_bf16_f32 v39, v242, v243
    s_add_u32 m0, s76, 40960
    v_accvgpr_read_b32 v228, a84
    v_accvgpr_read_b32 v229, a85
    v_accvgpr_read_b32 v230, a86
    v_accvgpr_read_b32 v231, a87
    buffer_load_dwordx4 v254, s[56:59], s78 offen sc1 lds
    v_accvgpr_read_b32 v232, a104
    v_accvgpr_read_b32 v233, a105
    v_accvgpr_read_b32 v234, a106
    v_accvgpr_read_b32 v235, a107
    v_pk_mul_f32 v[228:229], v[228:229], v[244:245] op_sel:[0,1] op_sel_hi:[1,1]
    v_pk_mul_f32 v[230:231], v[230:231], v[244:245] op_sel:[0,1] op_sel_hi:[1,1]
    v_pk_mul_f32 v[232:233], v[232:233], v[244:245] op_sel:[0,1] op_sel_hi:[1,1]
    v_pk_mul_f32 v[234:235], v[234:235], v[244:245] op_sel:[0,1] op_sel_hi:[1,1]
    v_cvt_pk_bf16_f32 v40, v228, v229
    v_cvt_pk_bf16_f32 v41, v230, v231
    v_cvt_pk_bf16_f32 v42, v232, v233
    v_cvt_pk_bf16_f32 v43, v234, v235
    v_accvgpr_read_b32 v236, a88
    v_accvgpr_read_b32 v237, a89
    v_accvgpr_read_b32 v238, a90
    v_accvgpr_read_b32 v239, a91
    v_accvgpr_read_b32 v240, a108
    v_accvgpr_read_b32 v241, a109
    v_accvgpr_read_b32 v242, a110
    v_accvgpr_read_b32 v243, a111
    v_pk_mul_f32 v[236:237], v[236:237], v[246:247] op_sel_hi:[1,0]
    v_pk_mul_f32 v[238:239], v[238:239], v[246:247] op_sel_hi:[1,0]
    v_pk_mul_f32 v[240:241], v[240:241], v[246:247] op_sel_hi:[1,0]
    v_pk_mul_f32 v[242:243], v[242:243], v[246:247] op_sel_hi:[1,0]
    v_cvt_pk_bf16_f32 v44, v236, v237
    v_cvt_pk_bf16_f32 v45, v238, v239
    v_cvt_pk_bf16_f32 v46, v240, v241
    v_cvt_pk_bf16_f32 v47, v242, v243
    v_accvgpr_read_b32 v228, a92
    v_accvgpr_read_b32 v229, a93
    v_accvgpr_read_b32 v230, a94
    v_accvgpr_read_b32 v231, a95
    buffer_load_dwordx4 v254, s[56:59], s78 offen offset:1024 sc1 lds
    v_accvgpr_read_b32 v232, a112
    v_accvgpr_read_b32 v233, a113
    v_accvgpr_read_b32 v234, a114
    v_accvgpr_read_b32 v235, a115
    v_pk_mul_f32 v[228:229], v[228:229], v[246:247] op_sel:[0,1] op_sel_hi:[1,1]
    v_pk_mul_f32 v[230:231], v[230:231], v[246:247] op_sel:[0,1] op_sel_hi:[1,1]
    v_pk_mul_f32 v[232:233], v[232:233], v[246:247] op_sel:[0,1] op_sel_hi:[1,1]
    v_pk_mul_f32 v[234:235], v[234:235], v[246:247] op_sel:[0,1] op_sel_hi:[1,1]
    v_cvt_pk_bf16_f32 v48, v228, v229
    v_cvt_pk_bf16_f32 v49, v230, v231
    v_cvt_pk_bf16_f32 v50, v232, v233
    v_cvt_pk_bf16_f32 v51, v234, v235
    v_accvgpr_read_b32 v236, a96
    v_accvgpr_read_b32 v237, a97
    v_accvgpr_read_b32 v238, a98
    v_accvgpr_read_b32 v239, a99
    buffer_load_dwordx4 v254, s[56:59], s78 offen offset:2048 sc1 lds
    v_accvgpr_read_b32 v240, a116
    v_accvgpr_read_b32 v241, a117
    v_accvgpr_read_b32 v242, a118
    v_accvgpr_read_b32 v243, a119
    v_pk_mul_f32 v[236:237], v[236:237], v[248:249] op_sel_hi:[1,0]
    v_pk_mul_f32 v[238:239], v[238:239], v[248:249] op_sel_hi:[1,0]
    v_pk_mul_f32 v[240:241], v[240:241], v[248:249] op_sel_hi:[1,0]
    v_pk_mul_f32 v[242:243], v[242:243], v[248:249] op_sel_hi:[1,0]
    v_cvt_pk_bf16_f32 v52, v236, v237
    v_cvt_pk_bf16_f32 v53, v238, v239
    v_cvt_pk_bf16_f32 v54, v240, v241
    v_cvt_pk_bf16_f32 v55, v242, v243
    v_accvgpr_read_b32 v228, a40
    v_accvgpr_read_b32 v229, a41
    v_accvgpr_read_b32 v230, a42
    v_accvgpr_read_b32 v231, a43
    buffer_load_dwordx4 v254, s[56:59], s78 offen offset:3072 sc1 lds
    v_accvgpr_read_b32 v232, a60
    v_accvgpr_read_b32 v233, a61
    v_accvgpr_read_b32 v234, a62
    v_accvgpr_read_b32 v235, a63
    v_pk_mul_f32 v[228:229], v[228:229], v[244:245] op_sel_hi:[1,0]
    v_pk_mul_f32 v[230:231], v[230:231], v[244:245] op_sel_hi:[1,0]
    v_pk_mul_f32 v[232:233], v[232:233], v[244:245] op_sel_hi:[1,0]
    v_pk_mul_f32 v[234:235], v[234:235], v[244:245] op_sel_hi:[1,0]
    v_cvt_pk_bf16_f32 v56, v228, v229
    v_cvt_pk_bf16_f32 v57, v230, v231
    v_cvt_pk_bf16_f32 v58, v232, v233
    v_cvt_pk_bf16_f32 v59, v234, v235
    v_accvgpr_read_b32 v236, a44
    v_accvgpr_read_b32 v237, a45
    v_accvgpr_read_b32 v238, a46
    v_accvgpr_read_b32 v239, a47
    v_accvgpr_read_b32 v240, a64
    v_accvgpr_read_b32 v241, a65
    v_accvgpr_read_b32 v242, a66
    v_accvgpr_read_b32 v243, a67
    v_pk_mul_f32 v[236:237], v[236:237], v[244:245] op_sel:[0,1] op_sel_hi:[1,1]
    v_pk_mul_f32 v[238:239], v[238:239], v[244:245] op_sel:[0,1] op_sel_hi:[1,1]
    v_pk_mul_f32 v[240:241], v[240:241], v[244:245] op_sel:[0,1] op_sel_hi:[1,1]
    v_pk_mul_f32 v[242:243], v[242:243], v[244:245] op_sel:[0,1] op_sel_hi:[1,1]
    v_cvt_pk_bf16_f32 v60, v236, v237
    v_cvt_pk_bf16_f32 v61, v238, v239
    v_cvt_pk_bf16_f32 v62, v240, v241
    v_cvt_pk_bf16_f32 v63, v242, v243
    s_add_u32 m0, s76, 45056
    s_add_u32 s32, s78, 4096
    s_add_u32 s78, s78, 20480
    v_accvgpr_read_b32 v228, a48
    v_accvgpr_read_b32 v229, a49
    v_accvgpr_read_b32 v230, a50
    v_accvgpr_read_b32 v231, a51
    buffer_load_dwordx4 v254, s[56:59], s32 offen sc1 lds
    v_accvgpr_read_b32 v232, a68
    v_accvgpr_read_b32 v233, a69
    v_accvgpr_read_b32 v234, a70
    v_accvgpr_read_b32 v235, a71
    v_pk_mul_f32 v[228:229], v[228:229], v[246:247] op_sel_hi:[1,0]
    v_pk_mul_f32 v[230:231], v[230:231], v[246:247] op_sel_hi:[1,0]
    v_pk_mul_f32 v[232:233], v[232:233], v[246:247] op_sel_hi:[1,0]
    v_pk_mul_f32 v[234:235], v[234:235], v[246:247] op_sel_hi:[1,0]
    v_cvt_pk_bf16_f32 v64, v228, v229
    v_cvt_pk_bf16_f32 v65, v230, v231
    v_cvt_pk_bf16_f32 v66, v232, v233
    v_cvt_pk_bf16_f32 v67, v234, v235
    s_add_u32 m0, s76, 102400
    s_mov_b32 s33, s77
    v_accvgpr_read_b32 v236, a52
    v_accvgpr_read_b32 v237, a53
    v_accvgpr_read_b32 v238, a54
    v_accvgpr_read_b32 v239, a55
    buffer_load_dwordx4 v249, s[52:55], s33 offen lds
    v_accvgpr_read_b32 v240, a72
    v_accvgpr_read_b32 v241, a73
    v_accvgpr_read_b32 v242, a74
    v_accvgpr_read_b32 v243, a75
    v_pk_mul_f32 v[236:237], v[236:237], v[246:247] op_sel:[0,1] op_sel_hi:[1,1]
    v_pk_mul_f32 v[238:239], v[238:239], v[246:247] op_sel:[0,1] op_sel_hi:[1,1]
    v_pk_mul_f32 v[240:241], v[240:241], v[246:247] op_sel:[0,1] op_sel_hi:[1,1]
    v_pk_mul_f32 v[242:243], v[242:243], v[246:247] op_sel:[0,1] op_sel_hi:[1,1]
    v_cvt_pk_bf16_f32 v68, v236, v237
    v_cvt_pk_bf16_f32 v69, v238, v239
    v_cvt_pk_bf16_f32 v70, v240, v241
    v_cvt_pk_bf16_f32 v71, v242, v243
    v_accvgpr_read_b32 v228, a56
    v_accvgpr_read_b32 v229, a57
    v_accvgpr_read_b32 v230, a58
    v_accvgpr_read_b32 v231, a59
    buffer_load_dwordx4 v250, s[52:55], s33 offen offset:1024 lds
    v_accvgpr_read_b32 v232, a76
    v_accvgpr_read_b32 v233, a77
    v_accvgpr_read_b32 v234, a78
    v_accvgpr_read_b32 v235, a79
    v_pk_mul_f32 v[228:229], v[228:229], v[248:249] op_sel_hi:[1,0]
    v_pk_mul_f32 v[230:231], v[230:231], v[248:249] op_sel_hi:[1,0]
    v_pk_mul_f32 v[232:233], v[232:233], v[248:249] op_sel_hi:[1,0]
    v_pk_mul_f32 v[234:235], v[234:235], v[248:249] op_sel_hi:[1,0]
    v_cvt_pk_bf16_f32 v72, v228, v229
    v_cvt_pk_bf16_f32 v73, v230, v231
    v_cvt_pk_bf16_f32 v74, v232, v233
    v_cvt_pk_bf16_f32 v75, v234, v235
    s_waitcnt vmcnt(12)
    s_barrier
    v_accvgpr_read_b32 v236, a120
    v_accvgpr_read_b32 v237, a121
    v_accvgpr_read_b32 v238, a122
    v_accvgpr_read_b32 v239, a123
    v_accvgpr_read_b32 v240, a140
    v_accvgpr_read_b32 v241, a141
    v_accvgpr_read_b32 v242, a142
    v_accvgpr_read_b32 v243, a143
    ds_read_b64_tr_b16 v[176:177], v217 offset:0
    ds_read_b64_tr_b16 v[178:179], v217 offset:5120
    v_pk_mul_f32 v[236:237], v[236:237], v[244:245] op_sel_hi:[1,0]
    v_pk_mul_f32 v[238:239], v[238:239], v[244:245] op_sel_hi:[1,0]
    v_pk_mul_f32 v[240:241], v[240:241], v[244:245] op_sel_hi:[1,0]
    v_pk_mul_f32 v[242:243], v[242:243], v[244:245] op_sel_hi:[1,0]
    v_cvt_pk_bf16_f32 v76, v236, v237
    v_cvt_pk_bf16_f32 v77, v238, v239
    v_cvt_pk_bf16_f32 v78, v240, v241
    v_cvt_pk_bf16_f32 v79, v242, v243
    v_accvgpr_read_b32 v228, a124
    v_accvgpr_read_b32 v229, a125
    v_accvgpr_read_b32 v230, a126
    v_accvgpr_read_b32 v231, a127
    buffer_load_dwordx4 v251, s[52:55], s33 offen offset:2048 lds
    v_accvgpr_read_b32 v232, a144
    v_accvgpr_read_b32 v233, a145
    v_accvgpr_read_b32 v234, a146
    v_accvgpr_read_b32 v235, a147
    ds_read_b128 v[136:139], v216 offset:0
    ds_read_b64_tr_b16 v[180:181], v218 offset:0
    v_pk_mul_f32 v[228:229], v[228:229], v[244:245] op_sel:[0,1] op_sel_hi:[1,1]
    v_pk_mul_f32 v[230:231], v[230:231], v[244:245] op_sel:[0,1] op_sel_hi:[1,1]
    v_pk_mul_f32 v[232:233], v[232:233], v[244:245] op_sel:[0,1] op_sel_hi:[1,1]
    v_pk_mul_f32 v[234:235], v[234:235], v[244:245] op_sel:[0,1] op_sel_hi:[1,1]
    v_cvt_pk_bf16_f32 v80, v228, v229
    v_cvt_pk_bf16_f32 v81, v230, v231
    v_cvt_pk_bf16_f32 v82, v232, v233
    v_cvt_pk_bf16_f32 v83, v234, v235
    v_accvgpr_read_b32 v236, a128
    v_accvgpr_read_b32 v237, a129
    v_accvgpr_read_b32 v238, a130
    v_accvgpr_read_b32 v239, a131
    buffer_load_dwordx4 v252, s[52:55], s33 offen offset:3072 lds
    v_accvgpr_read_b32 v240, a148
    v_accvgpr_read_b32 v241, a149
    v_accvgpr_read_b32 v242, a150
    v_accvgpr_read_b32 v243, a151
    ds_read_b64_tr_b16 v[182:183], v218 offset:5120
    ds_read_b128 v[140:143], v216 offset:1024
    v_pk_mul_f32 v[236:237], v[236:237], v[246:247] op_sel_hi:[1,0]
    v_pk_mul_f32 v[238:239], v[238:239], v[246:247] op_sel_hi:[1,0]
    v_pk_mul_f32 v[240:241], v[240:241], v[246:247] op_sel_hi:[1,0]
    v_pk_mul_f32 v[242:243], v[242:243], v[246:247] op_sel_hi:[1,0]
    v_cvt_pk_bf16_f32 v84, v236, v237
    v_cvt_pk_bf16_f32 v85, v238, v239
    v_cvt_pk_bf16_f32 v86, v240, v241
    v_cvt_pk_bf16_f32 v87, v242, v243
    s_add_u32 m0, s76, 106496
    s_add_u32 s77, s77, 81920
    v_accvgpr_read_b32 v228, a132
    v_accvgpr_read_b32 v229, a133
    v_accvgpr_read_b32 v230, a134
    v_accvgpr_read_b32 v231, a135
    buffer_load_dwordx4 v253, s[52:55], s33 offen lds
    v_accvgpr_read_b32 v232, a152
    v_accvgpr_read_b32 v233, a153
    v_accvgpr_read_b32 v234, a154
    v_accvgpr_read_b32 v235, a155
    ds_read_b64_tr_b16 v[184:185], v217 offset:64
    ds_read_b64_tr_b16 v[186:187], v217 offset:5184
    v_pk_mul_f32 v[228:229], v[228:229], v[246:247] op_sel:[0,1] op_sel_hi:[1,1]
    v_pk_mul_f32 v[230:231], v[230:231], v[246:247] op_sel:[0,1] op_sel_hi:[1,1]
    v_pk_mul_f32 v[232:233], v[232:233], v[246:247] op_sel:[0,1] op_sel_hi:[1,1]
    v_pk_mul_f32 v[234:235], v[234:235], v[246:247] op_sel:[0,1] op_sel_hi:[1,1]
    v_cvt_pk_bf16_f32 v88, v228, v229
    v_cvt_pk_bf16_f32 v89, v230, v231
    v_cvt_pk_bf16_f32 v90, v232, v233
    v_cvt_pk_bf16_f32 v91, v234, v235
    v_accvgpr_read_b32 v236, a136
    v_accvgpr_read_b32 v237, a137
    v_accvgpr_read_b32 v238, a138
    v_accvgpr_read_b32 v239, a139
    v_accvgpr_read_b32 v240, a156
    v_accvgpr_read_b32 v241, a157
    v_accvgpr_read_b32 v242, a158
    v_accvgpr_read_b32 v243, a159
    ds_read_b128 v[144:147], v216 offset:2048
    ds_read_b64_tr_b16 v[188:189], v218 offset:64
    v_pk_mul_f32 v[236:237], v[236:237], v[248:249] op_sel_hi:[1,0]
    v_pk_mul_f32 v[238:239], v[238:239], v[248:249] op_sel_hi:[1,0]
    v_pk_mul_f32 v[240:241], v[240:241], v[248:249] op_sel_hi:[1,0]
    v_pk_mul_f32 v[242:243], v[242:243], v[248:249] op_sel_hi:[1,0]
    v_cvt_pk_bf16_f32 v92, v236, v237
    v_cvt_pk_bf16_f32 v93, v238, v239
    v_cvt_pk_bf16_f32 v94, v240, v241
    v_cvt_pk_bf16_f32 v95, v242, v243
    s_add_u32 m0, s76, 81920
    v_accvgpr_read_b32 v228, a160
    v_accvgpr_read_b32 v229, a161
    v_accvgpr_read_b32 v230, a162
    v_accvgpr_read_b32 v231, a163
    buffer_load_dwordx4 v254, s[56:59], s78 offen sc1 lds
    v_accvgpr_read_b32 v232, a180
    v_accvgpr_read_b32 v233, a181
    v_accvgpr_read_b32 v234, a182
    v_accvgpr_read_b32 v235, a183
    ds_read_b64_tr_b16 v[190:191], v218 offset:5184
    ds_read_b128 v[148:151], v216 offset:3072
    v_pk_mul_f32 v[228:229], v[228:229], v[244:245] op_sel_hi:[1,0]
    v_pk_mul_f32 v[230:231], v[230:231], v[244:245] op_sel_hi:[1,0]
    v_pk_mul_f32 v[232:233], v[232:233], v[244:245] op_sel_hi:[1,0]
    v_pk_mul_f32 v[234:235], v[234:235], v[244:245] op_sel_hi:[1,0]
    v_cvt_pk_bf16_f32 v96, v228, v229
    v_cvt_pk_bf16_f32 v97, v230, v231
    v_cvt_pk_bf16_f32 v98, v232, v233
    v_cvt_pk_bf16_f32 v99, v234, v235
    v_accvgpr_read_b32 v236, a164
    v_accvgpr_read_b32 v237, a165
    v_accvgpr_read_b32 v238, a166
    v_accvgpr_read_b32 v239, a167
    buffer_load_dwordx4 v254, s[56:59], s78 offen offset:1024 sc1 lds
    v_accvgpr_read_b32 v240, a184
    v_accvgpr_read_b32 v241, a185
    v_accvgpr_read_b32 v242, a186
    v_accvgpr_read_b32 v243, a187
    ds_read_b64_tr_b16 v[192:193], v217 offset:128
    ds_read_b64_tr_b16 v[194:195], v217 offset:5248
    v_pk_mul_f32 v[236:237], v[236:237], v[244:245] op_sel:[0,1] op_sel_hi:[1,1]
    v_pk_mul_f32 v[238:239], v[238:239], v[244:245] op_sel:[0,1] op_sel_hi:[1,1]
    v_pk_mul_f32 v[240:241], v[240:241], v[244:245] op_sel:[0,1] op_sel_hi:[1,1]
    v_pk_mul_f32 v[242:243], v[242:243], v[244:245] op_sel:[0,1] op_sel_hi:[1,1]
    v_cvt_pk_bf16_f32 v100, v236, v237
    v_cvt_pk_bf16_f32 v101, v238, v239
    v_cvt_pk_bf16_f32 v102, v240, v241
    v_cvt_pk_bf16_f32 v103, v242, v243
    v_accvgpr_read_b32 v228, a168
    v_accvgpr_read_b32 v229, a169
    v_accvgpr_read_b32 v230, a170
    v_accvgpr_read_b32 v231, a171
    buffer_load_dwordx4 v254, s[56:59], s78 offen offset:2048 sc1 lds
    v_accvgpr_read_b32 v232, a188
    v_accvgpr_read_b32 v233, a189
    v_accvgpr_read_b32 v234, a190
    v_accvgpr_read_b32 v235, a191
    ds_read_b128 v[152:155], v216 offset:4096
    ds_read_b64_tr_b16 v[196:197], v217 offset:10240
    v_pk_mul_f32 v[228:229], v[228:229], v[246:247] op_sel_hi:[1,0]
    v_pk_mul_f32 v[230:231], v[230:231], v[246:247] op_sel_hi:[1,0]
    v_pk_mul_f32 v[232:233], v[232:233], v[246:247] op_sel_hi:[1,0]
    v_pk_mul_f32 v[234:235], v[234:235], v[246:247] op_sel_hi:[1,0]
    v_cvt_pk_bf16_f32 v104, v228, v229
    v_cvt_pk_bf16_f32 v105, v230, v231
    v_cvt_pk_bf16_f32 v106, v232, v233
    v_cvt_pk_bf16_f32 v107, v234, v235
    s_mov_b32 s30, 0
    buffer_store_dwordx4 v[16:19], v254, s[20:23], s30 offen sc1
    v_accvgpr_read_b32 v236, a172
    v_accvgpr_read_b32 v237, a173
    v_accvgpr_read_b32 v238, a174
    v_accvgpr_read_b32 v239, a175
    v_accvgpr_read_b32 v240, a192
    v_accvgpr_read_b32 v241, a193
    v_accvgpr_read_b32 v242, a194
    v_accvgpr_read_b32 v243, a195
    ds_read_b64_tr_b16 v[198:199], v217 offset:15360
    ds_read_b128 v[156:159], v216 offset:10240
    v_pk_mul_f32 v[236:237], v[236:237], v[246:247] op_sel:[0,1] op_sel_hi:[1,1]
    v_pk_mul_f32 v[238:239], v[238:239], v[246:247] op_sel:[0,1] op_sel_hi:[1,1]
    v_pk_mul_f32 v[240:241], v[240:241], v[246:247] op_sel:[0,1] op_sel_hi:[1,1]
    v_pk_mul_f32 v[242:243], v[242:243], v[246:247] op_sel:[0,1] op_sel_hi:[1,1]
    v_cvt_pk_bf16_f32 v108, v236, v237
    v_cvt_pk_bf16_f32 v109, v238, v239
    v_cvt_pk_bf16_f32 v110, v240, v241
    v_cvt_pk_bf16_f32 v111, v242, v243
    s_mov_b32 s31, 1024
    buffer_store_dwordx4 v[20:23], v254, s[20:23], s31 offen sc1
    v_accvgpr_read_b32 v228, a176
    v_accvgpr_read_b32 v229, a177
    v_accvgpr_read_b32 v230, a178
    v_accvgpr_read_b32 v231, a179
    buffer_load_dwordx4 v254, s[56:59], s78 offen offset:3072 sc1 lds
    v_accvgpr_read_b32 v232, a196
    v_accvgpr_read_b32 v233, a197
    v_accvgpr_read_b32 v234, a198
    v_accvgpr_read_b32 v235, a199
    ds_read_b64_tr_b16 v[200:201], v218 offset:10240
    ds_read_b64_tr_b16 v[202:203], v218 offset:15360
    v_pk_mul_f32 v[228:229], v[228:229], v[248:249] op_sel_hi:[1,0]
    v_pk_mul_f32 v[230:231], v[230:231], v[248:249] op_sel_hi:[1,0]
    v_pk_mul_f32 v[232:233], v[232:233], v[248:249] op_sel_hi:[1,0]
    v_pk_mul_f32 v[234:235], v[234:235], v[248:249] op_sel_hi:[1,0]
    v_cvt_pk_bf16_f32 v112, v228, v229
    v_cvt_pk_bf16_f32 v113, v230, v231
    v_cvt_pk_bf16_f32 v114, v232, v233
    v_cvt_pk_bf16_f32 v115, v234, v235
    s_mov_b32 s30, 2048
    buffer_store_dwordx4 v[24:27], v254, s[20:23], s30 offen sc1
    s_add_u32 m0, s76, 86016
    s_add_u32 s32, s78, 4096
    s_add_u32 s78, s78, 20480
    v_accvgpr_read_b32 v236, a200
    v_accvgpr_read_b32 v237, a201
    v_accvgpr_read_b32 v238, a202
    v_accvgpr_read_b32 v239, a203
    buffer_load_dwordx4 v254, s[56:59], s32 offen sc1 lds
    v_accvgpr_read_b32 v240, a220
    v_accvgpr_read_b32 v241, a221
    v_accvgpr_read_b32 v242, a222
    v_accvgpr_read_b32 v243, a223
    ds_read_b128 v[160:163], v216 offset:11264
    ds_read_b64_tr_b16 v[204:205], v217 offset:10304
    v_pk_mul_f32 v[236:237], v[236:237], v[244:245] op_sel_hi:[1,0]
    v_pk_mul_f32 v[238:239], v[238:239], v[244:245] op_sel_hi:[1,0]
    v_pk_mul_f32 v[240:241], v[240:241], v[244:245] op_sel_hi:[1,0]
    v_pk_mul_f32 v[242:243], v[242:243], v[244:245] op_sel_hi:[1,0]
    v_cvt_pk_bf16_f32 v116, v236, v237
    v_cvt_pk_bf16_f32 v117, v238, v239
    v_cvt_pk_bf16_f32 v118, v240, v241
    v_cvt_pk_bf16_f32 v119, v242, v243
    s_mov_b32 s31, 3072
    buffer_store_dwordx4 v[28:31], v254, s[20:23], s31 offen sc1
    v_accvgpr_read_b32 v228, a204
    v_accvgpr_read_b32 v229, a205
    v_accvgpr_read_b32 v230, a206
    v_accvgpr_read_b32 v231, a207
    v_accvgpr_read_b32 v232, a224
    v_accvgpr_read_b32 v233, a225
    v_accvgpr_read_b32 v234, a226
    v_accvgpr_read_b32 v235, a227
    ds_read_b64_tr_b16 v[206:207], v217 offset:15424
    ds_read_b128 v[164:167], v216 offset:12288
    v_pk_mul_f32 v[228:229], v[228:229], v[244:245] op_sel:[0,1] op_sel_hi:[1,1]
    v_pk_mul_f32 v[230:231], v[230:231], v[244:245] op_sel:[0,1] op_sel_hi:[1,1]
    v_pk_mul_f32 v[232:233], v[232:233], v[244:245] op_sel:[0,1] op_sel_hi:[1,1]
    v_pk_mul_f32 v[234:235], v[234:235], v[244:245] op_sel:[0,1] op_sel_hi:[1,1]
    v_cvt_pk_bf16_f32 v120, v228, v229
    v_cvt_pk_bf16_f32 v121, v230, v231
    v_cvt_pk_bf16_f32 v122, v232, v233
    v_cvt_pk_bf16_f32 v123, v234, v235
    s_mov_b32 s30, 4096
    buffer_store_dwordx4 v[32:35], v254, s[20:23], s30 offen sc1
    v_accvgpr_read_b32 v236, a208
    v_accvgpr_read_b32 v237, a209
    v_accvgpr_read_b32 v238, a210
    v_accvgpr_read_b32 v239, a211
    v_accvgpr_read_b32 v240, a228
    v_accvgpr_read_b32 v241, a229
    v_accvgpr_read_b32 v242, a230
    v_accvgpr_read_b32 v243, a231
    ds_read_b64_tr_b16 v[208:209], v218 offset:10304
    ds_read_b64_tr_b16 v[210:211], v218 offset:15424
    v_pk_mul_f32 v[236:237], v[236:237], v[246:247] op_sel_hi:[1,0]
    v_pk_mul_f32 v[238:239], v[238:239], v[246:247] op_sel_hi:[1,0]
    v_pk_mul_f32 v[240:241], v[240:241], v[246:247] op_sel_hi:[1,0]
    v_pk_mul_f32 v[242:243], v[242:243], v[246:247] op_sel_hi:[1,0]
    v_cvt_pk_bf16_f32 v124, v236, v237
    v_cvt_pk_bf16_f32 v125, v238, v239
    v_cvt_pk_bf16_f32 v126, v240, v241
    v_cvt_pk_bf16_f32 v127, v242, v243
    s_mov_b32 s31, 20480
    buffer_store_dwordx4 v[36:39], v254, s[20:23], s31 offen sc1
    v_accvgpr_read_b32 v228, a212
    v_accvgpr_read_b32 v229, a213
    v_accvgpr_read_b32 v230, a214
    v_accvgpr_read_b32 v231, a215
    v_accvgpr_read_b32 v232, a232
    v_accvgpr_read_b32 v233, a233
    v_accvgpr_read_b32 v234, a234
    v_accvgpr_read_b32 v235, a235
    ds_read_b128 v[168:171], v216 offset:13312
    ds_read_b64_tr_b16 v[212:213], v217 offset:10368
    v_pk_mul_f32 v[228:229], v[228:229], v[246:247] op_sel:[0,1] op_sel_hi:[1,1]
    v_pk_mul_f32 v[230:231], v[230:231], v[246:247] op_sel:[0,1] op_sel_hi:[1,1]
    v_pk_mul_f32 v[232:233], v[232:233], v[246:247] op_sel:[0,1] op_sel_hi:[1,1]
    v_pk_mul_f32 v[234:235], v[234:235], v[246:247] op_sel:[0,1] op_sel_hi:[1,1]
    v_cvt_pk_bf16_f32 v128, v228, v229
    v_cvt_pk_bf16_f32 v129, v230, v231
    v_cvt_pk_bf16_f32 v130, v232, v233
    v_cvt_pk_bf16_f32 v131, v234, v235
    s_mov_b32 s30, 21504
    buffer_store_dwordx4 v[40:43], v254, s[20:23], s30 offen sc1
    v_accvgpr_read_b32 v236, a216
    v_accvgpr_read_b32 v237, a217
    v_accvgpr_read_b32 v238, a218
    v_accvgpr_read_b32 v239, a219
    v_accvgpr_read_b32 v240, a236
    v_accvgpr_read_b32 v241, a237
    v_accvgpr_read_b32 v242, a238
    v_accvgpr_read_b32 v243, a239
    ds_read_b64_tr_b16 v[214:215], v217 offset:15488
    ds_read_b128 v[172:175], v216 offset:14336
    v_pk_mul_f32 v[236:237], v[236:237], v[248:249] op_sel_hi:[1,0]
    v_pk_mul_f32 v[238:239], v[238:239], v[248:249] op_sel_hi:[1,0]
    v_pk_mul_f32 v[240:241], v[240:241], v[248:249] op_sel_hi:[1,0]
    v_pk_mul_f32 v[242:243], v[242:243], v[248:249] op_sel_hi:[1,0]
    v_cvt_pk_bf16_f32 v132, v236, v237
    v_cvt_pk_bf16_f32 v133, v238, v239
    v_cvt_pk_bf16_f32 v134, v240, v241
    v_cvt_pk_bf16_f32 v135, v242, v243
    s_mov_b32 s31, 22528
    buffer_store_dwordx4 v[44:47], v254, s[20:23], s31 offen sc1
    s_waitcnt lgkmcnt(0)
    s_barrier
    v_mfma_f32_16x16x32_bf16 a[0:3], v[176:179], v[136:139], 0
    s_add_u32 m0, s76, 122880
    ds_read_b64_tr_b16 a[140:141], v220 offset:0
    v_mfma_f32_16x16x32_bf16 a[0:3], v[196:199], v[156:159], a[0:3]
    buffer_load_dwordx4 v254, s[56:59], s78 offen sc1 lds
    v_mfma_f32_16x16x32_bf16 a[4:7], v[200:203], v[156:159], 0
    ds_read_b64_tr_b16 a[142:143], v220 offset:5120
    v_mfma_f32_16x16x32_bf16 a[4:7], v[180:183], v[136:139], a[4:7]
    ds_read_b128 a[100:103], v219 offset:0
    v_mfma_f32_16x16x32_bf16 a[8:11], v[184:187], v[136:139], 0
    ds_read_b64_tr_b16 a[144:145], v221 offset:0
    v_mfma_f32_16x16x32_bf16 a[8:11], v[204:207], v[156:159], a[8:11]
    buffer_load_dwordx4 v254, s[56:59], s78 offen offset:1024 sc1 lds
    v_mfma_f32_16x16x32_bf16 a[12:15], v[208:211], v[156:159], 0
    ds_read_b64_tr_b16 a[146:147], v221 offset:5120
    v_mfma_f32_16x16x32_bf16 a[12:15], v[188:191], v[136:139], a[12:15]
    ds_read_b128 a[104:107], v219 offset:1024
    v_mfma_f32_16x16x32_bf16 a[16:19], v[192:195], v[136:139], 0
    ds_read_b64_tr_b16 a[148:149], v220 offset:64
    v_mfma_f32_16x16x32_bf16 a[16:19], v[212:215], v[156:159], a[16:19]
    buffer_load_dwordx4 v254, s[56:59], s78 offen offset:2048 sc1 lds
    v_mfma_f32_16x16x32_bf16 a[36:39], v[212:215], v[160:163], 0
    ds_read_b64_tr_b16 a[150:151], v220 offset:5184
    v_mfma_f32_16x16x32_bf16 a[36:39], v[192:195], v[140:143], a[36:39]
    ds_read_b128 a[108:111], v219 offset:2048
    v_mfma_f32_16x16x32_bf16 a[32:35], v[188:191], v[140:143], 0
    ds_read_b64_tr_b16 a[152:153], v221 offset:64
    v_mfma_f32_16x16x32_bf16 a[32:35], v[208:211], v[160:163], a[32:35]
    buffer_load_dwordx4 v254, s[56:59], s78 offen offset:3072 sc1 lds
    v_mfma_f32_16x16x32_bf16 a[28:31], v[204:207], v[160:163], 0
    s_add_u32 m0, s76, 126976
    ds_read_b64_tr_b16 a[154:155], v221 offset:5184
    v_mfma_f32_16x16x32_bf16 a[28:31], v[184:187], v[140:143], a[28:31]
    s_add_u32 s32, s78, 4096
    ds_read_b128 a[112:115], v219 offset:3072
    v_mfma_f32_16x16x32_bf16 a[24:27], v[180:183], v[140:143], 0
    s_add_u32 s78, s78, 20480
    ds_read_b64_tr_b16 a[156:157], v220 offset:128
    v_mfma_f32_16x16x32_bf16 a[24:27], v[200:203], v[160:163], a[24:27]
    buffer_load_dwordx4 v254, s[56:59], s32 offen sc1 lds
    v_mfma_f32_16x16x32_bf16 a[20:23], v[196:199], v[160:163], 0
    s_add_u32 m0, s76, 143360
    ds_read_b64_tr_b16 a[158:159], v220 offset:5248
    v_mfma_f32_16x16x32_bf16 a[20:23], v[176:179], v[140:143], a[20:23]
    s_mov_b32 s33, s77
    ds_read_b128 a[116:119], v219 offset:4096
    v_mfma_f32_16x16x32_bf16 a[40:43], v[176:179], v[144:147], 0
    ds_read_b64_tr_b16 a[160:161], v220 offset:10240
    v_mfma_f32_16x16x32_bf16 a[40:43], v[196:199], v[164:167], a[40:43]
    buffer_load_dwordx4 v249, s[52:55], s33 offen lds
    v_mfma_f32_16x16x32_bf16 a[44:47], v[200:203], v[164:167], 0
    ds_read_b64_tr_b16 a[162:163], v220 offset:15360
    v_mfma_f32_16x16x32_bf16 a[44:47], v[180:183], v[144:147], a[44:47]
    ds_read_b128 a[120:123], v219 offset:10240
    v_mfma_f32_16x16x32_bf16 a[48:51], v[184:187], v[144:147], 0
    ds_read_b64_tr_b16 a[164:165], v221 offset:10240
    v_mfma_f32_16x16x32_bf16 a[48:51], v[204:207], v[164:167], a[48:51]
    buffer_load_dwordx4 v250, s[52:55], s33 offen offset:1024 lds
    v_mfma_f32_16x16x32_bf16 a[52:55], v[208:211], v[164:167], 0
    ds_read_b64_tr_b16 a[166:167], v221 offset:15360
    v_mfma_f32_16x16x32_bf16 a[52:55], v[188:191], v[144:147], a[52:55]
    ds_read_b128 a[124:127], v219 offset:11264
    v_mfma_f32_16x16x32_bf16 a[56:59], v[192:195], v[144:147], 0
    ds_read_b64_tr_b16 a[168:169], v220 offset:10304
    v_mfma_f32_16x16x32_bf16 a[56:59], v[212:215], v[164:167], a[56:59]
    buffer_load_dwordx4 v251, s[52:55], s33 offen offset:2048 lds
    v_mfma_f32_16x16x32_bf16 a[76:79], v[212:215], v[168:171], 0
    ds_read_b64_tr_b16 a[170:171], v220 offset:15424
    v_mfma_f32_16x16x32_bf16 a[76:79], v[192:195], v[148:151], a[76:79]
    ds_read_b128 a[128:131], v219 offset:12288
    v_mfma_f32_16x16x32_bf16 a[72:75], v[188:191], v[148:151], 0
    ds_read_b64_tr_b16 a[172:173], v221 offset:10304
    v_mfma_f32_16x16x32_bf16 a[72:75], v[208:211], v[168:171], a[72:75]
    buffer_load_dwordx4 v252, s[52:55], s33 offen offset:3072 lds
    v_mfma_f32_16x16x32_bf16 a[68:71], v[204:207], v[168:171], 0
    s_add_u32 m0, s76, 147456
    ds_read_b64_tr_b16 a[174:175], v221 offset:15424
    v_mfma_f32_16x16x32_bf16 a[68:71], v[184:187], v[148:151], a[68:71]
    s_add_u32 s77, s77, 81920
    ds_read_b128 a[132:135], v219 offset:13312
    v_mfma_f32_16x16x32_bf16 a[64:67], v[180:183], v[148:151], 0
    ds_read_b64_tr_b16 a[176:177], v220 offset:10368
    v_mfma_f32_16x16x32_bf16 a[64:67], v[200:203], v[168:171], a[64:67]
    buffer_load_dwordx4 v253, s[52:55], s33 offen lds
    v_mfma_f32_16x16x32_bf16 a[60:63], v[196:199], v[168:171], 0
    ds_read_b64_tr_b16 a[178:179], v220 offset:15488
    v_mfma_f32_16x16x32_bf16 a[60:63], v[176:179], v[148:151], a[60:63]
    ds_read_b128 a[136:139], v219 offset:14336
    v_mfma_f32_16x16x32_bf16 a[80:83], v[176:179], v[152:155], 0
    s_mov_b32 s30, 23552
    buffer_store_dwordx4 v[48:51], v254, s[20:23], s30 offen sc1
    v_mfma_f32_16x16x32_bf16 a[80:83], v[196:199], v[172:175], a[80:83]
    s_mov_b32 s30, 24576
    v_mfma_f32_16x16x32_bf16 a[84:87], v[200:203], v[172:175], 0
    v_mfma_f32_16x16x32_bf16 a[84:87], v[180:183], v[152:155], a[84:87]
    buffer_store_dwordx4 v[52:55], v254, s[20:23], s30 offen sc1
    v_mfma_f32_16x16x32_bf16 a[88:91], v[184:187], v[152:155], 0
    v_mfma_f32_16x16x32_bf16 a[88:91], v[204:207], v[172:175], a[88:91]
    v_mfma_f32_16x16x32_bf16 a[92:95], v[208:211], v[172:175], 0
    v_mfma_f32_16x16x32_bf16 a[92:95], v[188:191], v[152:155], a[92:95]
    v_mfma_f32_16x16x32_bf16 a[96:99], v[192:195], v[152:155], 0
    s_waitcnt vmcnt(30) lgkmcnt(0)
    v_mfma_f32_16x16x32_bf16 a[96:99], v[212:215], v[172:175], a[96:99]

    s_barrier
    v_mfma_f32_16x16x32_bf16 a[0:3], a[140:143], a[100:103], a[0:3]
    s_add_u32 m0, s76, 0
    ds_read_b64_tr_b16 v[176:177], v223 offset:0
    v_mfma_f32_16x16x32_bf16 a[0:3], a[160:163], a[120:123], a[0:3]
    buffer_load_dwordx4 v254, s[56:59], s78 offen sc1 lds
    v_mfma_f32_16x16x32_bf16 a[4:7], a[164:167], a[120:123], a[4:7]
    ds_read_b64_tr_b16 v[178:179], v223 offset:5120
    v_mfma_f32_16x16x32_bf16 a[4:7], a[144:147], a[100:103], a[4:7]
    ds_read_b128 v[136:139], v222 offset:0
    v_mfma_f32_16x16x32_bf16 a[8:11], a[148:151], a[100:103], a[8:11]
    ds_read_b64_tr_b16 v[180:181], v224 offset:0
    v_mfma_f32_16x16x32_bf16 a[8:11], a[168:171], a[120:123], a[8:11]
    buffer_load_dwordx4 v254, s[56:59], s78 offen offset:1024 sc1 lds
    v_mfma_f32_16x16x32_bf16 a[12:15], a[172:175], a[120:123], a[12:15]
    ds_read_b64_tr_b16 v[182:183], v224 offset:5120
    v_mfma_f32_16x16x32_bf16 a[12:15], a[152:155], a[100:103], a[12:15]
    ds_read_b128 v[140:143], v222 offset:1024
    v_mfma_f32_16x16x32_bf16 a[16:19], a[156:159], a[100:103], a[16:19]
    ds_read_b64_tr_b16 v[184:185], v223 offset:64
    v_mfma_f32_16x16x32_bf16 a[16:19], a[176:179], a[120:123], a[16:19]
    buffer_load_dwordx4 v254, s[56:59], s78 offen offset:2048 sc1 lds
    v_mfma_f32_16x16x32_bf16 a[36:39], a[176:179], a[124:127], a[36:39]
    ds_read_b64_tr_b16 v[186:187], v223 offset:5184
    v_mfma_f32_16x16x32_bf16 a[36:39], a[156:159], a[104:107], a[36:39]
    ds_read_b128 v[144:147], v222 offset:2048
    v_mfma_f32_16x16x32_bf16 a[32:35], a[152:155], a[104:107], a[32:35]
    ds_read_b64_tr_b16 v[188:189], v224 offset:64
    v_mfma_f32_16x16x32_bf16 a[32:35], a[172:175], a[124:127], a[32:35]
    buffer_load_dwordx4 v254, s[56:59], s78 offen offset:3072 sc1 lds
    v_mfma_f32_16x16x32_bf16 a[28:31], a[168:171], a[124:127], a[28:31]
    s_add_u32 m0, s76, 4096
    ds_read_b64_tr_b16 v[190:191], v224 offset:5184
    v_mfma_f32_16x16x32_bf16 a[28:31], a[148:151], a[104:107], a[28:31]
    s_add_u32 s32, s78, 4096
    ds_read_b128 v[148:151], v222 offset:3072
    v_mfma_f32_16x16x32_bf16 a[24:27], a[144:147], a[104:107], a[24:27]
    s_add_u32 s78, s78, 20480
    ds_read_b64_tr_b16 v[192:193], v223 offset:128
    v_mfma_f32_16x16x32_bf16 a[24:27], a[164:167], a[124:127], a[24:27]
    buffer_load_dwordx4 v254, s[56:59], s32 offen sc1 lds
    v_mfma_f32_16x16x32_bf16 a[20:23], a[160:163], a[124:127], a[20:23]
    s_add_u32 m0, s76, 20480
    ds_read_b64_tr_b16 v[194:195], v223 offset:5248
    v_mfma_f32_16x16x32_bf16 a[20:23], a[140:143], a[104:107], a[20:23]
    s_mov_b32 s33, s77
    ds_read_b128 v[152:155], v222 offset:4096
    v_mfma_f32_16x16x32_bf16 a[40:43], a[140:143], a[108:111], a[40:43]
    ds_read_b64_tr_b16 v[196:197], v223 offset:10240
    v_mfma_f32_16x16x32_bf16 a[40:43], a[160:163], a[128:131], a[40:43]
    buffer_load_dwordx4 v249, s[52:55], s33 offen lds
    v_mfma_f32_16x16x32_bf16 a[44:47], a[164:167], a[128:131], a[44:47]
    ds_read_b64_tr_b16 v[198:199], v223 offset:15360
    v_mfma_f32_16x16x32_bf16 a[44:47], a[144:147], a[108:111], a[44:47]
    ds_read_b128 v[156:159], v222 offset:10240
    v_mfma_f32_16x16x32_bf16 a[48:51], a[148:151], a[108:111], a[48:51]
    ds_read_b64_tr_b16 v[200:201], v224 offset:10240
    v_mfma_f32_16x16x32_bf16 a[48:51], a[168:171], a[128:131], a[48:51]
    buffer_load_dwordx4 v250, s[52:55], s33 offen offset:1024 lds
    v_mfma_f32_16x16x32_bf16 a[52:55], a[172:175], a[128:131], a[52:55]
    ds_read_b64_tr_b16 v[202:203], v224 offset:15360
    v_mfma_f32_16x16x32_bf16 a[52:55], a[152:155], a[108:111], a[52:55]
    ds_read_b128 v[160:163], v222 offset:11264
    v_mfma_f32_16x16x32_bf16 a[56:59], a[156:159], a[108:111], a[56:59]
    ds_read_b64_tr_b16 v[204:205], v223 offset:10304
    v_mfma_f32_16x16x32_bf16 a[56:59], a[176:179], a[128:131], a[56:59]
    buffer_load_dwordx4 v251, s[52:55], s33 offen offset:2048 lds
    v_mfma_f32_16x16x32_bf16 a[76:79], a[176:179], a[132:135], a[76:79]
    ds_read_b64_tr_b16 v[206:207], v223 offset:15424
    v_mfma_f32_16x16x32_bf16 a[76:79], a[156:159], a[112:115], a[76:79]
    ds_read_b128 v[164:167], v222 offset:12288
    v_mfma_f32_16x16x32_bf16 a[72:75], a[152:155], a[112:115], a[72:75]
    ds_read_b64_tr_b16 v[208:209], v224 offset:10304
    v_mfma_f32_16x16x32_bf16 a[72:75], a[172:175], a[132:135], a[72:75]
    buffer_load_dwordx4 v252, s[52:55], s33 offen offset:3072 lds
    v_mfma_f32_16x16x32_bf16 a[68:71], a[168:171], a[132:135], a[68:71]
    s_add_u32 m0, s76, 24576
    ds_read_b64_tr_b16 v[210:211], v224 offset:15424
    v_mfma_f32_16x16x32_bf16 a[68:71], a[148:151], a[112:115], a[68:71]
    s_add_u32 s77, s77, 81920
    ds_read_b128 v[168:171], v222 offset:13312
    v_mfma_f32_16x16x32_bf16 a[64:67], a[144:147], a[112:115], a[64:67]
    ds_read_b64_tr_b16 v[212:213], v223 offset:10368
    v_mfma_f32_16x16x32_bf16 a[64:67], a[164:167], a[132:135], a[64:67]
    buffer_load_dwordx4 v253, s[52:55], s33 offen lds
    v_mfma_f32_16x16x32_bf16 a[60:63], a[160:163], a[132:135], a[60:63]
    ds_read_b64_tr_b16 v[214:215], v223 offset:15488
    v_mfma_f32_16x16x32_bf16 a[60:63], a[140:143], a[112:115], a[60:63]
    ds_read_b128 v[172:175], v222 offset:14336
    v_mfma_f32_16x16x32_bf16 a[80:83], a[140:143], a[116:119], a[80:83]
    s_mov_b32 s30, 10240
    buffer_store_dwordx4 v[56:59], v254, s[20:23], s30 offen sc1
    v_mfma_f32_16x16x32_bf16 a[80:83], a[160:163], a[136:139], a[80:83]
    s_mov_b32 s30, 11264
    v_mfma_f32_16x16x32_bf16 a[84:87], a[164:167], a[136:139], a[84:87]
    v_mfma_f32_16x16x32_bf16 a[84:87], a[144:147], a[116:119], a[84:87]
    buffer_store_dwordx4 v[60:63], v254, s[20:23], s30 offen sc1
    v_mfma_f32_16x16x32_bf16 a[88:91], a[148:151], a[116:119], a[88:91]
    v_mfma_f32_16x16x32_bf16 a[88:91], a[168:171], a[136:139], a[88:91]
    v_mfma_f32_16x16x32_bf16 a[92:95], a[172:175], a[136:139], a[92:95]
    v_mfma_f32_16x16x32_bf16 a[92:95], a[152:155], a[116:119], a[92:95]
    v_mfma_f32_16x16x32_bf16 a[96:99], a[156:159], a[116:119], a[96:99]
    s_waitcnt vmcnt(29) lgkmcnt(0)
    v_mfma_f32_16x16x32_bf16 a[96:99], a[176:179], a[136:139], a[96:99]

    s_barrier
    v_mfma_f32_16x16x32_bf16 a[0:3], v[176:179], v[136:139], a[0:3]
    s_add_u32 m0, s76, 40960
    ds_read_b64_tr_b16 a[140:141], v226 offset:0
    v_mfma_f32_16x16x32_bf16 a[0:3], v[196:199], v[156:159], a[0:3]
    buffer_load_dwordx4 v254, s[56:59], s78 offen sc1 lds
    v_mfma_f32_16x16x32_bf16 a[4:7], v[200:203], v[156:159], a[4:7]
    ds_read_b64_tr_b16 a[142:143], v226 offset:5120
    v_mfma_f32_16x16x32_bf16 a[4:7], v[180:183], v[136:139], a[4:7]
    ds_read_b128 a[100:103], v225 offset:0
    v_mfma_f32_16x16x32_bf16 a[8:11], v[184:187], v[136:139], a[8:11]
    ds_read_b64_tr_b16 a[144:145], v227 offset:0
    v_mfma_f32_16x16x32_bf16 a[8:11], v[204:207], v[156:159], a[8:11]
    buffer_load_dwordx4 v254, s[56:59], s78 offen offset:1024 sc1 lds
    v_mfma_f32_16x16x32_bf16 a[12:15], v[208:211], v[156:159], a[12:15]
    ds_read_b64_tr_b16 a[146:147], v227 offset:5120
    v_mfma_f32_16x16x32_bf16 a[12:15], v[188:191], v[136:139], a[12:15]
    ds_read_b128 a[104:107], v225 offset:1024
    v_mfma_f32_16x16x32_bf16 a[16:19], v[192:195], v[136:139], a[16:19]
    ds_read_b64_tr_b16 a[148:149], v226 offset:64
    v_mfma_f32_16x16x32_bf16 a[16:19], v[212:215], v[156:159], a[16:19]
    buffer_load_dwordx4 v254, s[56:59], s78 offen offset:2048 sc1 lds
    v_mfma_f32_16x16x32_bf16 a[36:39], v[212:215], v[160:163], a[36:39]
    ds_read_b64_tr_b16 a[150:151], v226 offset:5184
    v_mfma_f32_16x16x32_bf16 a[36:39], v[192:195], v[140:143], a[36:39]
    ds_read_b128 a[108:111], v225 offset:2048
    v_mfma_f32_16x16x32_bf16 a[32:35], v[188:191], v[140:143], a[32:35]
    ds_read_b64_tr_b16 a[152:153], v227 offset:64
    v_mfma_f32_16x16x32_bf16 a[32:35], v[208:211], v[160:163], a[32:35]
    buffer_load_dwordx4 v254, s[56:59], s78 offen offset:3072 sc1 lds
    v_mfma_f32_16x16x32_bf16 a[28:31], v[204:207], v[160:163], a[28:31]
    s_add_u32 m0, s76, 45056
    ds_read_b64_tr_b16 a[154:155], v227 offset:5184
    v_mfma_f32_16x16x32_bf16 a[28:31], v[184:187], v[140:143], a[28:31]
    s_add_u32 s32, s78, 4096
    ds_read_b128 a[112:115], v225 offset:3072
    v_mfma_f32_16x16x32_bf16 a[24:27], v[180:183], v[140:143], a[24:27]
    s_add_u32 s78, s78, 20480
    ds_read_b64_tr_b16 a[156:157], v226 offset:128
    v_mfma_f32_16x16x32_bf16 a[24:27], v[200:203], v[160:163], a[24:27]
    buffer_load_dwordx4 v254, s[56:59], s32 offen sc1 lds
    v_mfma_f32_16x16x32_bf16 a[20:23], v[196:199], v[160:163], a[20:23]
    s_add_u32 m0, s76, 61440
    ds_read_b64_tr_b16 a[158:159], v226 offset:5248
    v_mfma_f32_16x16x32_bf16 a[20:23], v[176:179], v[140:143], a[20:23]
    s_mov_b32 s33, s77
    ds_read_b128 a[116:119], v225 offset:4096
    v_mfma_f32_16x16x32_bf16 a[40:43], v[176:179], v[144:147], a[40:43]
    ds_read_b64_tr_b16 a[160:161], v226 offset:10240
    v_mfma_f32_16x16x32_bf16 a[40:43], v[196:199], v[164:167], a[40:43]
    buffer_load_dwordx4 v249, s[52:55], s33 offen lds
    v_mfma_f32_16x16x32_bf16 a[44:47], v[200:203], v[164:167], a[44:47]
    ds_read_b64_tr_b16 a[162:163], v226 offset:15360
    v_mfma_f32_16x16x32_bf16 a[44:47], v[180:183], v[144:147], a[44:47]
    ds_read_b128 a[120:123], v225 offset:10240
    v_mfma_f32_16x16x32_bf16 a[48:51], v[184:187], v[144:147], a[48:51]
    ds_read_b64_tr_b16 a[164:165], v227 offset:10240
    v_mfma_f32_16x16x32_bf16 a[48:51], v[204:207], v[164:167], a[48:51]
    buffer_load_dwordx4 v250, s[52:55], s33 offen offset:1024 lds
    v_mfma_f32_16x16x32_bf16 a[52:55], v[208:211], v[164:167], a[52:55]
    ds_read_b64_tr_b16 a[166:167], v227 offset:15360
    v_mfma_f32_16x16x32_bf16 a[52:55], v[188:191], v[144:147], a[52:55]
    ds_read_b128 a[124:127], v225 offset:11264
    v_mfma_f32_16x16x32_bf16 a[56:59], v[192:195], v[144:147], a[56:59]
    ds_read_b64_tr_b16 a[168:169], v226 offset:10304
    v_mfma_f32_16x16x32_bf16 a[56:59], v[212:215], v[164:167], a[56:59]
    buffer_load_dwordx4 v251, s[52:55], s33 offen offset:2048 lds
    v_mfma_f32_16x16x32_bf16 a[76:79], v[212:215], v[168:171], a[76:79]
    ds_read_b64_tr_b16 a[170:171], v226 offset:15424
    v_mfma_f32_16x16x32_bf16 a[76:79], v[192:195], v[148:151], a[76:79]
    ds_read_b128 a[128:131], v225 offset:12288
    v_mfma_f32_16x16x32_bf16 a[72:75], v[188:191], v[148:151], a[72:75]
    ds_read_b64_tr_b16 a[172:173], v227 offset:10304
    v_mfma_f32_16x16x32_bf16 a[72:75], v[208:211], v[168:171], a[72:75]
    buffer_load_dwordx4 v252, s[52:55], s33 offen offset:3072 lds
    v_mfma_f32_16x16x32_bf16 a[68:71], v[204:207], v[168:171], a[68:71]
    s_add_u32 m0, s76, 65536
    ds_read_b64_tr_b16 a[174:175], v227 offset:15424
    v_mfma_f32_16x16x32_bf16 a[68:71], v[184:187], v[148:151], a[68:71]
    s_add_u32 s77, s77, 81920
    ds_read_b128 a[132:135], v225 offset:13312
    v_mfma_f32_16x16x32_bf16 a[64:67], v[180:183], v[148:151], a[64:67]
    ds_read_b64_tr_b16 a[176:177], v226 offset:10368
    v_mfma_f32_16x16x32_bf16 a[64:67], v[200:203], v[168:171], a[64:67]
    buffer_load_dwordx4 v253, s[52:55], s33 offen lds
    v_mfma_f32_16x16x32_bf16 a[60:63], v[196:199], v[168:171], a[60:63]
    ds_read_b64_tr_b16 a[178:179], v226 offset:15488
    v_mfma_f32_16x16x32_bf16 a[60:63], v[176:179], v[148:151], a[60:63]
    ds_read_b128 a[136:139], v225 offset:14336
    v_mfma_f32_16x16x32_bf16 a[80:83], v[176:179], v[152:155], a[80:83]
    s_mov_b32 s30, 12288
    buffer_store_dwordx4 v[64:67], v254, s[20:23], s30 offen sc1
    v_mfma_f32_16x16x32_bf16 a[80:83], v[196:199], v[172:175], a[80:83]
    s_mov_b32 s30, 13312
    v_mfma_f32_16x16x32_bf16 a[84:87], v[200:203], v[172:175], a[84:87]
    v_mfma_f32_16x16x32_bf16 a[84:87], v[180:183], v[152:155], a[84:87]
    buffer_store_dwordx4 v[68:71], v254, s[20:23], s30 offen sc1
    v_mfma_f32_16x16x32_bf16 a[88:91], v[184:187], v[152:155], a[88:91]
    v_mfma_f32_16x16x32_bf16 a[88:91], v[204:207], v[172:175], a[88:91]
    v_mfma_f32_16x16x32_bf16 a[92:95], v[208:211], v[172:175], a[92:95]
    v_mfma_f32_16x16x32_bf16 a[92:95], v[188:191], v[152:155], a[92:95]
    v_mfma_f32_16x16x32_bf16 a[96:99], v[192:195], v[152:155], a[96:99]
    s_waitcnt vmcnt(26) lgkmcnt(0)
    v_mfma_f32_16x16x32_bf16 a[96:99], v[212:215], v[172:175], a[96:99]

    s_barrier
    v_mfma_f32_16x16x32_bf16 a[0:3], a[140:143], a[100:103], a[0:3]
    s_add_u32 m0, s76, 81920
    ds_read_b64_tr_b16 v[176:177], v217 offset:0
    v_mfma_f32_16x16x32_bf16 a[0:3], a[160:163], a[120:123], a[0:3]
    buffer_load_dwordx4 v254, s[56:59], s78 offen sc1 lds
    v_mfma_f32_16x16x32_bf16 a[4:7], a[164:167], a[120:123], a[4:7]
    ds_read_b64_tr_b16 v[178:179], v217 offset:5120
    v_mfma_f32_16x16x32_bf16 a[4:7], a[144:147], a[100:103], a[4:7]
    ds_read_b128 v[136:139], v216 offset:0
    v_mfma_f32_16x16x32_bf16 a[8:11], a[148:151], a[100:103], a[8:11]
    ds_read_b64_tr_b16 v[180:181], v218 offset:0
    v_mfma_f32_16x16x32_bf16 a[8:11], a[168:171], a[120:123], a[8:11]
    buffer_load_dwordx4 v254, s[56:59], s78 offen offset:1024 sc1 lds
    v_mfma_f32_16x16x32_bf16 a[12:15], a[172:175], a[120:123], a[12:15]
    ds_read_b64_tr_b16 v[182:183], v218 offset:5120
    v_mfma_f32_16x16x32_bf16 a[12:15], a[152:155], a[100:103], a[12:15]
    ds_read_b128 v[140:143], v216 offset:1024
    v_mfma_f32_16x16x32_bf16 a[16:19], a[156:159], a[100:103], a[16:19]
    ds_read_b64_tr_b16 v[184:185], v217 offset:64
    v_mfma_f32_16x16x32_bf16 a[16:19], a[176:179], a[120:123], a[16:19]
    buffer_load_dwordx4 v254, s[56:59], s78 offen offset:2048 sc1 lds
    v_mfma_f32_16x16x32_bf16 a[36:39], a[176:179], a[124:127], a[36:39]
    ds_read_b64_tr_b16 v[186:187], v217 offset:5184
    v_mfma_f32_16x16x32_bf16 a[36:39], a[156:159], a[104:107], a[36:39]
    ds_read_b128 v[144:147], v216 offset:2048
    v_mfma_f32_16x16x32_bf16 a[32:35], a[152:155], a[104:107], a[32:35]
    ds_read_b64_tr_b16 v[188:189], v218 offset:64
    v_mfma_f32_16x16x32_bf16 a[32:35], a[172:175], a[124:127], a[32:35]
    buffer_load_dwordx4 v254, s[56:59], s78 offen offset:3072 sc1 lds
    v_mfma_f32_16x16x32_bf16 a[28:31], a[168:171], a[124:127], a[28:31]
    s_add_u32 m0, s76, 86016
    ds_read_b64_tr_b16 v[190:191], v218 offset:5184
    v_mfma_f32_16x16x32_bf16 a[28:31], a[148:151], a[104:107], a[28:31]
    s_add_u32 s32, s78, 4096
    ds_read_b128 v[148:151], v216 offset:3072
    v_mfma_f32_16x16x32_bf16 a[24:27], a[144:147], a[104:107], a[24:27]
    s_add_u32 s78, s78, 20480
    ds_read_b64_tr_b16 v[192:193], v217 offset:128
    v_mfma_f32_16x16x32_bf16 a[24:27], a[164:167], a[124:127], a[24:27]
    buffer_load_dwordx4 v254, s[56:59], s32 offen sc1 lds
    v_mfma_f32_16x16x32_bf16 a[20:23], a[160:163], a[124:127], a[20:23]
    s_add_u32 m0, s76, 102400
    ds_read_b64_tr_b16 v[194:195], v217 offset:5248
    v_mfma_f32_16x16x32_bf16 a[20:23], a[140:143], a[104:107], a[20:23]
    s_mov_b32 s33, s77
    ds_read_b128 v[152:155], v216 offset:4096
    v_mfma_f32_16x16x32_bf16 a[40:43], a[140:143], a[108:111], a[40:43]
    ds_read_b64_tr_b16 v[196:197], v217 offset:10240
    v_mfma_f32_16x16x32_bf16 a[40:43], a[160:163], a[128:131], a[40:43]
    buffer_load_dwordx4 v249, s[52:55], s33 offen lds
    v_mfma_f32_16x16x32_bf16 a[44:47], a[164:167], a[128:131], a[44:47]
    ds_read_b64_tr_b16 v[198:199], v217 offset:15360
    v_mfma_f32_16x16x32_bf16 a[44:47], a[144:147], a[108:111], a[44:47]
    ds_read_b128 v[156:159], v216 offset:10240
    v_mfma_f32_16x16x32_bf16 a[48:51], a[148:151], a[108:111], a[48:51]
    ds_read_b64_tr_b16 v[200:201], v218 offset:10240
    v_mfma_f32_16x16x32_bf16 a[48:51], a[168:171], a[128:131], a[48:51]
    buffer_load_dwordx4 v250, s[52:55], s33 offen offset:1024 lds
    v_mfma_f32_16x16x32_bf16 a[52:55], a[172:175], a[128:131], a[52:55]
    ds_read_b64_tr_b16 v[202:203], v218 offset:15360
    v_mfma_f32_16x16x32_bf16 a[52:55], a[152:155], a[108:111], a[52:55]
    ds_read_b128 v[160:163], v216 offset:11264
    v_mfma_f32_16x16x32_bf16 a[56:59], a[156:159], a[108:111], a[56:59]
    ds_read_b64_tr_b16 v[204:205], v217 offset:10304
    v_mfma_f32_16x16x32_bf16 a[56:59], a[176:179], a[128:131], a[56:59]
    buffer_load_dwordx4 v251, s[52:55], s33 offen offset:2048 lds
    v_mfma_f32_16x16x32_bf16 a[76:79], a[176:179], a[132:135], a[76:79]
    ds_read_b64_tr_b16 v[206:207], v217 offset:15424
    v_mfma_f32_16x16x32_bf16 a[76:79], a[156:159], a[112:115], a[76:79]
    ds_read_b128 v[164:167], v216 offset:12288
    v_mfma_f32_16x16x32_bf16 a[72:75], a[152:155], a[112:115], a[72:75]
    ds_read_b64_tr_b16 v[208:209], v218 offset:10304
    v_mfma_f32_16x16x32_bf16 a[72:75], a[172:175], a[132:135], a[72:75]
    buffer_load_dwordx4 v252, s[52:55], s33 offen offset:3072 lds
    v_mfma_f32_16x16x32_bf16 a[68:71], a[168:171], a[132:135], a[68:71]
    s_add_u32 m0, s76, 106496
    ds_read_b64_tr_b16 v[210:211], v218 offset:15424
    v_mfma_f32_16x16x32_bf16 a[68:71], a[148:151], a[112:115], a[68:71]
    s_add_u32 s77, s77, 81920
    ds_read_b128 v[168:171], v216 offset:13312
    v_mfma_f32_16x16x32_bf16 a[64:67], a[144:147], a[112:115], a[64:67]
    ds_read_b64_tr_b16 v[212:213], v217 offset:10368
    v_mfma_f32_16x16x32_bf16 a[64:67], a[164:167], a[132:135], a[64:67]
    buffer_load_dwordx4 v253, s[52:55], s33 offen lds
    v_mfma_f32_16x16x32_bf16 a[60:63], a[160:163], a[132:135], a[60:63]
    ds_read_b64_tr_b16 v[214:215], v217 offset:15488
    v_mfma_f32_16x16x32_bf16 a[60:63], a[140:143], a[112:115], a[60:63]
    ds_read_b128 v[172:175], v216 offset:14336
    v_mfma_f32_16x16x32_bf16 a[80:83], a[140:143], a[116:119], a[80:83]
    s_mov_b32 s30, 14336
    buffer_store_dwordx4 v[72:75], v254, s[20:23], s30 offen sc1
    v_mfma_f32_16x16x32_bf16 a[80:83], a[160:163], a[136:139], a[80:83]
    s_mov_b32 s30, 30720
    v_mfma_f32_16x16x32_bf16 a[84:87], a[164:167], a[136:139], a[84:87]
    v_mfma_f32_16x16x32_bf16 a[84:87], a[144:147], a[116:119], a[84:87]
    buffer_store_dwordx4 v[76:79], v254, s[20:23], s30 offen sc1
    v_mfma_f32_16x16x32_bf16 a[88:91], a[148:151], a[116:119], a[88:91]
    v_mfma_f32_16x16x32_bf16 a[88:91], a[168:171], a[136:139], a[88:91]
    v_mfma_f32_16x16x32_bf16 a[92:95], a[172:175], a[136:139], a[92:95]
    v_mfma_f32_16x16x32_bf16 a[92:95], a[152:155], a[116:119], a[92:95]
    v_mfma_f32_16x16x32_bf16 a[96:99], a[156:159], a[116:119], a[96:99]
    s_waitcnt vmcnt(26) lgkmcnt(0)
    v_mfma_f32_16x16x32_bf16 a[96:99], a[176:179], a[136:139], a[96:99]

    s_barrier
    v_mfma_f32_16x16x32_bf16 a[0:3], v[176:179], v[136:139], a[0:3]
    s_add_u32 m0, s76, 122880
    ds_read_b64_tr_b16 a[140:141], v220 offset:0
    v_mfma_f32_16x16x32_bf16 a[0:3], v[196:199], v[156:159], a[0:3]
    buffer_load_dwordx4 v254, s[56:59], s78 offen sc1 lds
    v_mfma_f32_16x16x32_bf16 a[4:7], v[200:203], v[156:159], a[4:7]
    ds_read_b64_tr_b16 a[142:143], v220 offset:5120
    v_mfma_f32_16x16x32_bf16 a[4:7], v[180:183], v[136:139], a[4:7]
    ds_read_b128 a[100:103], v219 offset:0
    v_mfma_f32_16x16x32_bf16 a[8:11], v[184:187], v[136:139], a[8:11]
    ds_read_b64_tr_b16 a[144:145], v221 offset:0
    v_mfma_f32_16x16x32_bf16 a[8:11], v[204:207], v[156:159], a[8:11]
    buffer_load_dwordx4 v254, s[56:59], s78 offen offset:1024 sc1 lds
    v_mfma_f32_16x16x32_bf16 a[12:15], v[208:211], v[156:159], a[12:15]
    ds_read_b64_tr_b16 a[146:147], v221 offset:5120
    v_mfma_f32_16x16x32_bf16 a[12:15], v[188:191], v[136:139], a[12:15]
    ds_read_b128 a[104:107], v219 offset:1024
    v_mfma_f32_16x16x32_bf16 a[16:19], v[192:195], v[136:139], a[16:19]
    ds_read_b64_tr_b16 a[148:149], v220 offset:64
    v_mfma_f32_16x16x32_bf16 a[16:19], v[212:215], v[156:159], a[16:19]
    buffer_load_dwordx4 v254, s[56:59], s78 offen offset:2048 sc1 lds
    v_mfma_f32_16x16x32_bf16 a[36:39], v[212:215], v[160:163], a[36:39]
    ds_read_b64_tr_b16 a[150:151], v220 offset:5184
    v_mfma_f32_16x16x32_bf16 a[36:39], v[192:195], v[140:143], a[36:39]
    ds_read_b128 a[108:111], v219 offset:2048
    v_mfma_f32_16x16x32_bf16 a[32:35], v[188:191], v[140:143], a[32:35]
    ds_read_b64_tr_b16 a[152:153], v221 offset:64
    v_mfma_f32_16x16x32_bf16 a[32:35], v[208:211], v[160:163], a[32:35]
    buffer_load_dwordx4 v254, s[56:59], s78 offen offset:3072 sc1 lds
    v_mfma_f32_16x16x32_bf16 a[28:31], v[204:207], v[160:163], a[28:31]
    s_add_u32 m0, s76, 126976
    ds_read_b64_tr_b16 a[154:155], v221 offset:5184
    v_mfma_f32_16x16x32_bf16 a[28:31], v[184:187], v[140:143], a[28:31]
    s_add_u32 s32, s78, 4096
    ds_read_b128 a[112:115], v219 offset:3072
    v_mfma_f32_16x16x32_bf16 a[24:27], v[180:183], v[140:143], a[24:27]
    s_add_u32 s78, s78, 20480
    ds_read_b64_tr_b16 a[156:157], v220 offset:128
    v_mfma_f32_16x16x32_bf16 a[24:27], v[200:203], v[160:163], a[24:27]
    buffer_load_dwordx4 v254, s[56:59], s32 offen sc1 lds
    v_mfma_f32_16x16x32_bf16 a[20:23], v[196:199], v[160:163], a[20:23]
    s_add_u32 m0, s76, 143360
    ds_read_b64_tr_b16 a[158:159], v220 offset:5248
    v_mfma_f32_16x16x32_bf16 a[20:23], v[176:179], v[140:143], a[20:23]
    s_mov_b32 s33, s77
    ds_read_b128 a[116:119], v219 offset:4096
    v_mfma_f32_16x16x32_bf16 a[40:43], v[176:179], v[144:147], a[40:43]
    ds_read_b64_tr_b16 a[160:161], v220 offset:10240
    v_mfma_f32_16x16x32_bf16 a[40:43], v[196:199], v[164:167], a[40:43]
    buffer_load_dwordx4 v249, s[52:55], s33 offen lds
    v_mfma_f32_16x16x32_bf16 a[44:47], v[200:203], v[164:167], a[44:47]
    ds_read_b64_tr_b16 a[162:163], v220 offset:15360
    v_mfma_f32_16x16x32_bf16 a[44:47], v[180:183], v[144:147], a[44:47]
    ds_read_b128 a[120:123], v219 offset:10240
    v_mfma_f32_16x16x32_bf16 a[48:51], v[184:187], v[144:147], a[48:51]
    ds_read_b64_tr_b16 a[164:165], v221 offset:10240
    v_mfma_f32_16x16x32_bf16 a[48:51], v[204:207], v[164:167], a[48:51]
    buffer_load_dwordx4 v250, s[52:55], s33 offen offset:1024 lds
    v_mfma_f32_16x16x32_bf16 a[52:55], v[208:211], v[164:167], a[52:55]
    ds_read_b64_tr_b16 a[166:167], v221 offset:15360
    v_mfma_f32_16x16x32_bf16 a[52:55], v[188:191], v[144:147], a[52:55]
    ds_read_b128 a[124:127], v219 offset:11264
    v_mfma_f32_16x16x32_bf16 a[56:59], v[192:195], v[144:147], a[56:59]
    ds_read_b64_tr_b16 a[168:169], v220 offset:10304
    v_mfma_f32_16x16x32_bf16 a[56:59], v[212:215], v[164:167], a[56:59]
    buffer_load_dwordx4 v251, s[52:55], s33 offen offset:2048 lds
    v_mfma_f32_16x16x32_bf16 a[76:79], v[212:215], v[168:171], a[76:79]
    ds_read_b64_tr_b16 a[170:171], v220 offset:15424
    v_mfma_f32_16x16x32_bf16 a[76:79], v[192:195], v[148:151], a[76:79]
    ds_read_b128 a[128:131], v219 offset:12288
    v_mfma_f32_16x16x32_bf16 a[72:75], v[188:191], v[148:151], a[72:75]
    ds_read_b64_tr_b16 a[172:173], v221 offset:10304
    v_mfma_f32_16x16x32_bf16 a[72:75], v[208:211], v[168:171], a[72:75]
    buffer_load_dwordx4 v252, s[52:55], s33 offen offset:3072 lds
    v_mfma_f32_16x16x32_bf16 a[68:71], v[204:207], v[168:171], a[68:71]
    s_add_u32 m0, s76, 147456
    ds_read_b64_tr_b16 a[174:175], v221 offset:15424
    v_mfma_f32_16x16x32_bf16 a[68:71], v[184:187], v[148:151], a[68:71]
    s_add_u32 s77, s77, 81920
    ds_read_b128 a[132:135], v219 offset:13312
    v_mfma_f32_16x16x32_bf16 a[64:67], v[180:183], v[148:151], a[64:67]
    ds_read_b64_tr_b16 a[176:177], v220 offset:10368
    v_mfma_f32_16x16x32_bf16 a[64:67], v[200:203], v[168:171], a[64:67]
    buffer_load_dwordx4 v253, s[52:55], s33 offen lds
    v_mfma_f32_16x16x32_bf16 a[60:63], v[196:199], v[168:171], a[60:63]
    ds_read_b64_tr_b16 a[178:179], v220 offset:15488
    v_mfma_f32_16x16x32_bf16 a[60:63], v[176:179], v[148:151], a[60:63]
    ds_read_b128 a[136:139], v219 offset:14336
    v_mfma_f32_16x16x32_bf16 a[80:83], v[176:179], v[152:155], a[80:83]
    s_mov_b32 s30, 31744
    buffer_store_dwordx4 v[80:83], v254, s[20:23], s30 offen sc1
    v_mfma_f32_16x16x32_bf16 a[80:83], v[196:199], v[172:175], a[80:83]
    s_mov_b32 s30, 32768
    v_mfma_f32_16x16x32_bf16 a[84:87], v[200:203], v[172:175], a[84:87]
    v_mfma_f32_16x16x32_bf16 a[84:87], v[180:183], v[152:155], a[84:87]
    buffer_store_dwordx4 v[84:87], v254, s[20:23], s30 offen sc1
    v_mfma_f32_16x16x32_bf16 a[88:91], v[184:187], v[152:155], a[88:91]
    v_mfma_f32_16x16x32_bf16 a[88:91], v[204:207], v[172:175], a[88:91]
    v_mfma_f32_16x16x32_bf16 a[92:95], v[208:211], v[172:175], a[92:95]
    v_mfma_f32_16x16x32_bf16 a[92:95], v[188:191], v[152:155], a[92:95]
    v_mfma_f32_16x16x32_bf16 a[96:99], v[192:195], v[152:155], a[96:99]
    s_waitcnt vmcnt(26) lgkmcnt(0)
    v_mfma_f32_16x16x32_bf16 a[96:99], v[212:215], v[172:175], a[96:99]

    s_barrier
    v_mfma_f32_16x16x32_bf16 a[0:3], a[140:143], a[100:103], a[0:3]
    s_add_u32 m0, s76, 0
    ds_read_b64_tr_b16 v[176:177], v223 offset:0
    v_mfma_f32_16x16x32_bf16 a[0:3], a[160:163], a[120:123], a[0:3]
    buffer_load_dwordx4 v254, s[56:59], s78 offen sc1 lds
    v_mfma_f32_16x16x32_bf16 a[4:7], a[164:167], a[120:123], a[4:7]
    ds_read_b64_tr_b16 v[178:179], v223 offset:5120
    v_mfma_f32_16x16x32_bf16 a[4:7], a[144:147], a[100:103], a[4:7]
    ds_read_b128 v[136:139], v222 offset:0
    v_mfma_f32_16x16x32_bf16 a[8:11], a[148:151], a[100:103], a[8:11]
    ds_read_b64_tr_b16 v[180:181], v224 offset:0
    v_mfma_f32_16x16x32_bf16 a[8:11], a[168:171], a[120:123], a[8:11]
    buffer_load_dwordx4 v254, s[56:59], s78 offen offset:1024 sc1 lds
    v_mfma_f32_16x16x32_bf16 a[12:15], a[172:175], a[120:123], a[12:15]
    ds_read_b64_tr_b16 v[182:183], v224 offset:5120
    v_mfma_f32_16x16x32_bf16 a[12:15], a[152:155], a[100:103], a[12:15]
    ds_read_b128 v[140:143], v222 offset:1024
    v_mfma_f32_16x16x32_bf16 a[16:19], a[156:159], a[100:103], a[16:19]
    ds_read_b64_tr_b16 v[184:185], v223 offset:64
    v_mfma_f32_16x16x32_bf16 a[16:19], a[176:179], a[120:123], a[16:19]
    buffer_load_dwordx4 v254, s[56:59], s78 offen offset:2048 sc1 lds
    v_mfma_f32_16x16x32_bf16 a[36:39], a[176:179], a[124:127], a[36:39]
    ds_read_b64_tr_b16 v[186:187], v223 offset:5184
    v_mfma_f32_16x16x32_bf16 a[36:39], a[156:159], a[104:107], a[36:39]
    ds_read_b128 v[144:147], v222 offset:2048
    v_mfma_f32_16x16x32_bf16 a[32:35], a[152:155], a[104:107], a[32:35]
    ds_read_b64_tr_b16 v[188:189], v224 offset:64
    v_mfma_f32_16x16x32_bf16 a[32:35], a[172:175], a[124:127], a[32:35]
    buffer_load_dwordx4 v254, s[56:59], s78 offen offset:3072 sc1 lds
    v_mfma_f32_16x16x32_bf16 a[28:31], a[168:171], a[124:127], a[28:31]
    s_add_u32 m0, s76, 4096
    ds_read_b64_tr_b16 v[190:191], v224 offset:5184
    v_mfma_f32_16x16x32_bf16 a[28:31], a[148:151], a[104:107], a[28:31]
    s_add_u32 s32, s78, 4096
    ds_read_b128 v[148:151], v222 offset:3072
    v_mfma_f32_16x16x32_bf16 a[24:27], a[144:147], a[104:107], a[24:27]
    s_add_u32 s78, s78, 20480
    ds_read_b64_tr_b16 v[192:193], v223 offset:128
    v_mfma_f32_16x16x32_bf16 a[24:27], a[164:167], a[124:127], a[24:27]
    buffer_load_dwordx4 v254, s[56:59], s32 offen sc1 lds
    v_mfma_f32_16x16x32_bf16 a[20:23], a[160:163], a[124:127], a[20:23]
    s_add_u32 m0, s76, 20480
    ds_read_b64_tr_b16 v[194:195], v223 offset:5248
    v_mfma_f32_16x16x32_bf16 a[20:23], a[140:143], a[104:107], a[20:23]
    s_mov_b32 s33, s77
    ds_read_b128 v[152:155], v222 offset:4096
    v_mfma_f32_16x16x32_bf16 a[40:43], a[140:143], a[108:111], a[40:43]
    ds_read_b64_tr_b16 v[196:197], v223 offset:10240
    v_mfma_f32_16x16x32_bf16 a[40:43], a[160:163], a[128:131], a[40:43]
    buffer_load_dwordx4 v249, s[52:55], s33 offen lds
    v_mfma_f32_16x16x32_bf16 a[44:47], a[164:167], a[128:131], a[44:47]
    ds_read_b64_tr_b16 v[198:199], v223 offset:15360
    v_mfma_f32_16x16x32_bf16 a[44:47], a[144:147], a[108:111], a[44:47]
    ds_read_b128 v[156:159], v222 offset:10240
    v_mfma_f32_16x16x32_bf16 a[48:51], a[148:151], a[108:111], a[48:51]
    ds_read_b64_tr_b16 v[200:201], v224 offset:10240
    v_mfma_f32_16x16x32_bf16 a[48:51], a[168:171], a[128:131], a[48:51]
    buffer_load_dwordx4 v250, s[52:55], s33 offen offset:1024 lds
    v_mfma_f32_16x16x32_bf16 a[52:55], a[172:175], a[128:131], a[52:55]
    ds_read_b64_tr_b16 v[202:203], v224 offset:15360
    v_mfma_f32_16x16x32_bf16 a[52:55], a[152:155], a[108:111], a[52:55]
    ds_read_b128 v[160:163], v222 offset:11264
    v_mfma_f32_16x16x32_bf16 a[56:59], a[156:159], a[108:111], a[56:59]
    ds_read_b64_tr_b16 v[204:205], v223 offset:10304
    v_mfma_f32_16x16x32_bf16 a[56:59], a[176:179], a[128:131], a[56:59]
    buffer_load_dwordx4 v251, s[52:55], s33 offen offset:2048 lds
    v_mfma_f32_16x16x32_bf16 a[76:79], a[176:179], a[132:135], a[76:79]
    ds_read_b64_tr_b16 v[206:207], v223 offset:15424
    v_mfma_f32_16x16x32_bf16 a[76:79], a[156:159], a[112:115], a[76:79]
    ds_read_b128 v[164:167], v222 offset:12288
    v_mfma_f32_16x16x32_bf16 a[72:75], a[152:155], a[112:115], a[72:75]
    ds_read_b64_tr_b16 v[208:209], v224 offset:10304
    v_mfma_f32_16x16x32_bf16 a[72:75], a[172:175], a[132:135], a[72:75]
    buffer_load_dwordx4 v252, s[52:55], s33 offen offset:3072 lds
    v_mfma_f32_16x16x32_bf16 a[68:71], a[168:171], a[132:135], a[68:71]
    s_add_u32 m0, s76, 24576
    ds_read_b64_tr_b16 v[210:211], v224 offset:15424
    v_mfma_f32_16x16x32_bf16 a[68:71], a[148:151], a[112:115], a[68:71]
    s_add_u32 s77, s77, 81920
    ds_read_b128 v[168:171], v222 offset:13312
    v_mfma_f32_16x16x32_bf16 a[64:67], a[144:147], a[112:115], a[64:67]
    ds_read_b64_tr_b16 v[212:213], v223 offset:10368
    v_mfma_f32_16x16x32_bf16 a[64:67], a[164:167], a[132:135], a[64:67]
    buffer_load_dwordx4 v253, s[52:55], s33 offen lds
    v_mfma_f32_16x16x32_bf16 a[60:63], a[160:163], a[132:135], a[60:63]
    ds_read_b64_tr_b16 v[214:215], v223 offset:15488
    v_mfma_f32_16x16x32_bf16 a[60:63], a[140:143], a[112:115], a[60:63]
    ds_read_b128 v[172:175], v222 offset:14336
    v_mfma_f32_16x16x32_bf16 a[80:83], a[140:143], a[116:119], a[80:83]
    s_mov_b32 s30, 33792
    buffer_store_dwordx4 v[88:91], v254, s[20:23], s30 offen sc1
    v_mfma_f32_16x16x32_bf16 a[80:83], a[160:163], a[136:139], a[80:83]
    s_mov_b32 s30, 34816
    v_mfma_f32_16x16x32_bf16 a[84:87], a[164:167], a[136:139], a[84:87]
    v_mfma_f32_16x16x32_bf16 a[84:87], a[144:147], a[116:119], a[84:87]
    buffer_store_dwordx4 v[92:95], v254, s[20:23], s30 offen sc1
    v_mfma_f32_16x16x32_bf16 a[88:91], a[148:151], a[116:119], a[88:91]
    v_mfma_f32_16x16x32_bf16 a[88:91], a[168:171], a[136:139], a[88:91]
    v_mfma_f32_16x16x32_bf16 a[92:95], a[172:175], a[136:139], a[92:95]
    v_mfma_f32_16x16x32_bf16 a[92:95], a[152:155], a[116:119], a[92:95]
    v_mfma_f32_16x16x32_bf16 a[96:99], a[156:159], a[116:119], a[96:99]
    s_waitcnt vmcnt(26) lgkmcnt(0)
    v_mfma_f32_16x16x32_bf16 a[96:99], a[176:179], a[136:139], a[96:99]

    s_barrier
    v_mfma_f32_16x16x32_bf16 a[0:3], v[176:179], v[136:139], a[0:3]
    s_add_u32 m0, s76, 40960
    ds_read_b64_tr_b16 a[140:141], v226 offset:0
    v_mfma_f32_16x16x32_bf16 a[0:3], v[196:199], v[156:159], a[0:3]
    buffer_load_dwordx4 v254, s[56:59], s78 offen sc1 lds
    v_mfma_f32_16x16x32_bf16 a[4:7], v[200:203], v[156:159], a[4:7]
    ds_read_b64_tr_b16 a[142:143], v226 offset:5120
    v_mfma_f32_16x16x32_bf16 a[4:7], v[180:183], v[136:139], a[4:7]
    ds_read_b128 a[100:103], v225 offset:0
    v_mfma_f32_16x16x32_bf16 a[8:11], v[184:187], v[136:139], a[8:11]
    ds_read_b64_tr_b16 a[144:145], v227 offset:0
    v_mfma_f32_16x16x32_bf16 a[8:11], v[204:207], v[156:159], a[8:11]
    buffer_load_dwordx4 v254, s[56:59], s78 offen offset:1024 sc1 lds
    v_mfma_f32_16x16x32_bf16 a[12:15], v[208:211], v[156:159], a[12:15]
    ds_read_b64_tr_b16 a[146:147], v227 offset:5120
    v_mfma_f32_16x16x32_bf16 a[12:15], v[188:191], v[136:139], a[12:15]
    ds_read_b128 a[104:107], v225 offset:1024
    v_mfma_f32_16x16x32_bf16 a[16:19], v[192:195], v[136:139], a[16:19]
    ds_read_b64_tr_b16 a[148:149], v226 offset:64
    v_mfma_f32_16x16x32_bf16 a[16:19], v[212:215], v[156:159], a[16:19]
    buffer_load_dwordx4 v254, s[56:59], s78 offen offset:2048 sc1 lds
    v_mfma_f32_16x16x32_bf16 a[36:39], v[212:215], v[160:163], a[36:39]
    ds_read_b64_tr_b16 a[150:151], v226 offset:5184
    v_mfma_f32_16x16x32_bf16 a[36:39], v[192:195], v[140:143], a[36:39]
    ds_read_b128 a[108:111], v225 offset:2048
    v_mfma_f32_16x16x32_bf16 a[32:35], v[188:191], v[140:143], a[32:35]
    ds_read_b64_tr_b16 a[152:153], v227 offset:64
    v_mfma_f32_16x16x32_bf16 a[32:35], v[208:211], v[160:163], a[32:35]
    buffer_load_dwordx4 v254, s[56:59], s78 offen offset:3072 sc1 lds
    v_mfma_f32_16x16x32_bf16 a[28:31], v[204:207], v[160:163], a[28:31]
    s_add_u32 m0, s76, 45056
    ds_read_b64_tr_b16 a[154:155], v227 offset:5184
    v_mfma_f32_16x16x32_bf16 a[28:31], v[184:187], v[140:143], a[28:31]
    s_add_u32 s32, s78, 4096
    ds_read_b128 a[112:115], v225 offset:3072
    v_mfma_f32_16x16x32_bf16 a[24:27], v[180:183], v[140:143], a[24:27]
    s_add_u32 s78, s78, 20480
    ds_read_b64_tr_b16 a[156:157], v226 offset:128
    v_mfma_f32_16x16x32_bf16 a[24:27], v[200:203], v[160:163], a[24:27]
    buffer_load_dwordx4 v254, s[56:59], s32 offen sc1 lds
    v_mfma_f32_16x16x32_bf16 a[20:23], v[196:199], v[160:163], a[20:23]
    s_add_u32 m0, s76, 61440
    ds_read_b64_tr_b16 a[158:159], v226 offset:5248
    v_mfma_f32_16x16x32_bf16 a[20:23], v[176:179], v[140:143], a[20:23]
    s_mov_b32 s33, s77
    ds_read_b128 a[116:119], v225 offset:4096
    v_mfma_f32_16x16x32_bf16 a[40:43], v[176:179], v[144:147], a[40:43]
    ds_read_b64_tr_b16 a[160:161], v226 offset:10240
    v_mfma_f32_16x16x32_bf16 a[40:43], v[196:199], v[164:167], a[40:43]
    buffer_load_dwordx4 v249, s[52:55], s33 offen lds
    v_mfma_f32_16x16x32_bf16 a[44:47], v[200:203], v[164:167], a[44:47]
    ds_read_b64_tr_b16 a[162:163], v226 offset:15360
    v_mfma_f32_16x16x32_bf16 a[44:47], v[180:183], v[144:147], a[44:47]
    ds_read_b128 a[120:123], v225 offset:10240
    v_mfma_f32_16x16x32_bf16 a[48:51], v[184:187], v[144:147], a[48:51]
    ds_read_b64_tr_b16 a[164:165], v227 offset:10240
    v_mfma_f32_16x16x32_bf16 a[48:51], v[204:207], v[164:167], a[48:51]
    buffer_load_dwordx4 v250, s[52:55], s33 offen offset:1024 lds
    v_mfma_f32_16x16x32_bf16 a[52:55], v[208:211], v[164:167], a[52:55]
    ds_read_b64_tr_b16 a[166:167], v227 offset:15360
    v_mfma_f32_16x16x32_bf16 a[52:55], v[188:191], v[144:147], a[52:55]
    ds_read_b128 a[124:127], v225 offset:11264
    v_mfma_f32_16x16x32_bf16 a[56:59], v[192:195], v[144:147], a[56:59]
    ds_read_b64_tr_b16 a[168:169], v226 offset:10304
    v_mfma_f32_16x16x32_bf16 a[56:59], v[212:215], v[164:167], a[56:59]
    buffer_load_dwordx4 v251, s[52:55], s33 offen offset:2048 lds
    v_mfma_f32_16x16x32_bf16 a[76:79], v[212:215], v[168:171], a[76:79]
    ds_read_b64_tr_b16 a[170:171], v226 offset:15424
    v_mfma_f32_16x16x32_bf16 a[76:79], v[192:195], v[148:151], a[76:79]
    ds_read_b128 a[128:131], v225 offset:12288
    v_mfma_f32_16x16x32_bf16 a[72:75], v[188:191], v[148:151], a[72:75]
    ds_read_b64_tr_b16 a[172:173], v227 offset:10304
    v_mfma_f32_16x16x32_bf16 a[72:75], v[208:211], v[168:171], a[72:75]
    buffer_load_dwordx4 v252, s[52:55], s33 offen offset:3072 lds
    v_mfma_f32_16x16x32_bf16 a[68:71], v[204:207], v[168:171], a[68:71]
    s_add_u32 m0, s76, 65536
    ds_read_b64_tr_b16 a[174:175], v227 offset:15424
    v_mfma_f32_16x16x32_bf16 a[68:71], v[184:187], v[148:151], a[68:71]
    s_add_u32 s77, s77, 81920
    ds_read_b128 a[132:135], v225 offset:13312
    v_mfma_f32_16x16x32_bf16 a[64:67], v[180:183], v[148:151], a[64:67]
    ds_read_b64_tr_b16 a[176:177], v226 offset:10368
    v_mfma_f32_16x16x32_bf16 a[64:67], v[200:203], v[168:171], a[64:67]
    buffer_load_dwordx4 v253, s[52:55], s33 offen lds
    v_mfma_f32_16x16x32_bf16 a[60:63], v[196:199], v[168:171], a[60:63]
    ds_read_b64_tr_b16 a[178:179], v226 offset:15488
    v_mfma_f32_16x16x32_bf16 a[60:63], v[176:179], v[148:151], a[60:63]
    ds_read_b128 a[136:139], v225 offset:14336
    v_mfma_f32_16x16x32_bf16 a[80:83], v[176:179], v[152:155], a[80:83]
    s_mov_b32 s30, 40960
    buffer_store_dwordx4 v[96:99], v254, s[20:23], s30 offen sc1
    v_mfma_f32_16x16x32_bf16 a[80:83], v[196:199], v[172:175], a[80:83]
    s_mov_b32 s30, 41984
    v_mfma_f32_16x16x32_bf16 a[84:87], v[200:203], v[172:175], a[84:87]
    v_mfma_f32_16x16x32_bf16 a[84:87], v[180:183], v[152:155], a[84:87]
    buffer_store_dwordx4 v[100:103], v254, s[20:23], s30 offen sc1
    v_mfma_f32_16x16x32_bf16 a[88:91], v[184:187], v[152:155], a[88:91]
    v_mfma_f32_16x16x32_bf16 a[88:91], v[204:207], v[172:175], a[88:91]
    v_mfma_f32_16x16x32_bf16 a[92:95], v[208:211], v[172:175], a[92:95]
    v_mfma_f32_16x16x32_bf16 a[92:95], v[188:191], v[152:155], a[92:95]
    v_mfma_f32_16x16x32_bf16 a[96:99], v[192:195], v[152:155], a[96:99]
    s_waitcnt vmcnt(26) lgkmcnt(0)
    v_mfma_f32_16x16x32_bf16 a[96:99], v[212:215], v[172:175], a[96:99]

    s_barrier
    v_mfma_f32_16x16x32_bf16 a[0:3], a[140:143], a[100:103], a[0:3]
    s_add_u32 m0, s76, 81920
    ds_read_b64_tr_b16 v[176:177], v217 offset:0
    v_mfma_f32_16x16x32_bf16 a[0:3], a[160:163], a[120:123], a[0:3]
    buffer_load_dwordx4 v254, s[56:59], s78 offen sc1 lds
    v_mfma_f32_16x16x32_bf16 a[4:7], a[164:167], a[120:123], a[4:7]
    ds_read_b64_tr_b16 v[178:179], v217 offset:5120
    v_mfma_f32_16x16x32_bf16 a[4:7], a[144:147], a[100:103], a[4:7]
    ds_read_b128 v[136:139], v216 offset:0
    v_mfma_f32_16x16x32_bf16 a[8:11], a[148:151], a[100:103], a[8:11]
    ds_read_b64_tr_b16 v[180:181], v218 offset:0
    v_mfma_f32_16x16x32_bf16 a[8:11], a[168:171], a[120:123], a[8:11]
    buffer_load_dwordx4 v254, s[56:59], s78 offen offset:1024 sc1 lds
    v_mfma_f32_16x16x32_bf16 a[12:15], a[172:175], a[120:123], a[12:15]
    ds_read_b64_tr_b16 v[182:183], v218 offset:5120
    v_mfma_f32_16x16x32_bf16 a[12:15], a[152:155], a[100:103], a[12:15]
    ds_read_b128 v[140:143], v216 offset:1024
    v_mfma_f32_16x16x32_bf16 a[16:19], a[156:159], a[100:103], a[16:19]
    ds_read_b64_tr_b16 v[184:185], v217 offset:64
    v_mfma_f32_16x16x32_bf16 a[16:19], a[176:179], a[120:123], a[16:19]
    buffer_load_dwordx4 v254, s[56:59], s78 offen offset:2048 sc1 lds
    v_mfma_f32_16x16x32_bf16 a[36:39], a[176:179], a[124:127], a[36:39]
    ds_read_b64_tr_b16 v[186:187], v217 offset:5184
    v_mfma_f32_16x16x32_bf16 a[36:39], a[156:159], a[104:107], a[36:39]
    ds_read_b128 v[144:147], v216 offset:2048
    v_mfma_f32_16x16x32_bf16 a[32:35], a[152:155], a[104:107], a[32:35]
    ds_read_b64_tr_b16 v[188:189], v218 offset:64
    v_mfma_f32_16x16x32_bf16 a[32:35], a[172:175], a[124:127], a[32:35]
    buffer_load_dwordx4 v254, s[56:59], s78 offen offset:3072 sc1 lds
    v_mfma_f32_16x16x32_bf16 a[28:31], a[168:171], a[124:127], a[28:31]
    s_add_u32 m0, s76, 86016
    ds_read_b64_tr_b16 v[190:191], v218 offset:5184
    v_mfma_f32_16x16x32_bf16 a[28:31], a[148:151], a[104:107], a[28:31]
    s_add_u32 s32, s78, 4096
    ds_read_b128 v[148:151], v216 offset:3072
    v_mfma_f32_16x16x32_bf16 a[24:27], a[144:147], a[104:107], a[24:27]
    s_add_u32 s78, s78, 20480
    ds_read_b64_tr_b16 v[192:193], v217 offset:128
    v_mfma_f32_16x16x32_bf16 a[24:27], a[164:167], a[124:127], a[24:27]
    buffer_load_dwordx4 v254, s[56:59], s32 offen sc1 lds
    v_mfma_f32_16x16x32_bf16 a[20:23], a[160:163], a[124:127], a[20:23]
    s_add_u32 m0, s76, 102400
    ds_read_b64_tr_b16 v[194:195], v217 offset:5248
    v_mfma_f32_16x16x32_bf16 a[20:23], a[140:143], a[104:107], a[20:23]
    s_mov_b32 s33, s77
    ds_read_b128 v[152:155], v216 offset:4096
    v_mfma_f32_16x16x32_bf16 a[40:43], a[140:143], a[108:111], a[40:43]
    ds_read_b64_tr_b16 v[196:197], v217 offset:10240
    v_mfma_f32_16x16x32_bf16 a[40:43], a[160:163], a[128:131], a[40:43]
    buffer_load_dwordx4 v249, s[52:55], s33 offen lds
    v_mfma_f32_16x16x32_bf16 a[44:47], a[164:167], a[128:131], a[44:47]
    ds_read_b64_tr_b16 v[198:199], v217 offset:15360
    v_mfma_f32_16x16x32_bf16 a[44:47], a[144:147], a[108:111], a[44:47]
    ds_read_b128 v[156:159], v216 offset:10240
    v_mfma_f32_16x16x32_bf16 a[48:51], a[148:151], a[108:111], a[48:51]
    ds_read_b64_tr_b16 v[200:201], v218 offset:10240
    v_mfma_f32_16x16x32_bf16 a[48:51], a[168:171], a[128:131], a[48:51]
    buffer_load_dwordx4 v250, s[52:55], s33 offen offset:1024 lds
    v_mfma_f32_16x16x32_bf16 a[52:55], a[172:175], a[128:131], a[52:55]
    ds_read_b64_tr_b16 v[202:203], v218 offset:15360
    v_mfma_f32_16x16x32_bf16 a[52:55], a[152:155], a[108:111], a[52:55]
    ds_read_b128 v[160:163], v216 offset:11264
    v_mfma_f32_16x16x32_bf16 a[56:59], a[156:159], a[108:111], a[56:59]
    ds_read_b64_tr_b16 v[204:205], v217 offset:10304
    v_mfma_f32_16x16x32_bf16 a[56:59], a[176:179], a[128:131], a[56:59]
    buffer_load_dwordx4 v251, s[52:55], s33 offen offset:2048 lds
    v_mfma_f32_16x16x32_bf16 a[76:79], a[176:179], a[132:135], a[76:79]
    ds_read_b64_tr_b16 v[206:207], v217 offset:15424
    v_mfma_f32_16x16x32_bf16 a[76:79], a[156:159], a[112:115], a[76:79]
    ds_read_b128 v[164:167], v216 offset:12288
    v_mfma_f32_16x16x32_bf16 a[72:75], a[152:155], a[112:115], a[72:75]
    ds_read_b64_tr_b16 v[208:209], v218 offset:10304
    v_mfma_f32_16x16x32_bf16 a[72:75], a[172:175], a[132:135], a[72:75]
    buffer_load_dwordx4 v252, s[52:55], s33 offen offset:3072 lds
    v_mfma_f32_16x16x32_bf16 a[68:71], a[168:171], a[132:135], a[68:71]
    s_add_u32 m0, s76, 106496
    ds_read_b64_tr_b16 v[210:211], v218 offset:15424
    v_mfma_f32_16x16x32_bf16 a[68:71], a[148:151], a[112:115], a[68:71]
    s_add_u32 s77, s77, 81920
    ds_read_b128 v[168:171], v216 offset:13312
    v_mfma_f32_16x16x32_bf16 a[64:67], a[144:147], a[112:115], a[64:67]
    ds_read_b64_tr_b16 v[212:213], v217 offset:10368
    v_mfma_f32_16x16x32_bf16 a[64:67], a[164:167], a[132:135], a[64:67]
    buffer_load_dwordx4 v253, s[52:55], s33 offen lds
    v_mfma_f32_16x16x32_bf16 a[60:63], a[160:163], a[132:135], a[60:63]
    ds_read_b64_tr_b16 v[214:215], v217 offset:15488
    v_mfma_f32_16x16x32_bf16 a[60:63], a[140:143], a[112:115], a[60:63]
    ds_read_b128 v[172:175], v216 offset:14336
    v_mfma_f32_16x16x32_bf16 a[80:83], a[140:143], a[116:119], a[80:83]
    s_mov_b32 s30, 43008
    buffer_store_dwordx4 v[104:107], v254, s[20:23], s30 offen sc1
    v_mfma_f32_16x16x32_bf16 a[80:83], a[160:163], a[136:139], a[80:83]
    s_mov_b32 s30, 44032
    v_mfma_f32_16x16x32_bf16 a[84:87], a[164:167], a[136:139], a[84:87]
    v_mfma_f32_16x16x32_bf16 a[84:87], a[144:147], a[116:119], a[84:87]
    buffer_store_dwordx4 v[108:111], v254, s[20:23], s30 offen sc1
    v_mfma_f32_16x16x32_bf16 a[88:91], a[148:151], a[116:119], a[88:91]
    v_mfma_f32_16x16x32_bf16 a[88:91], a[168:171], a[136:139], a[88:91]
    v_mfma_f32_16x16x32_bf16 a[92:95], a[172:175], a[136:139], a[92:95]
    v_mfma_f32_16x16x32_bf16 a[92:95], a[152:155], a[116:119], a[92:95]
    v_mfma_f32_16x16x32_bf16 a[96:99], a[156:159], a[116:119], a[96:99]
    s_waitcnt vmcnt(26) lgkmcnt(0)
    v_mfma_f32_16x16x32_bf16 a[96:99], a[176:179], a[136:139], a[96:99]

    s_barrier
    v_mfma_f32_16x16x32_bf16 a[0:3], v[176:179], v[136:139], a[0:3]
    s_add_u32 m0, s76, 122880
    ds_read_b64_tr_b16 a[140:141], v220 offset:0
    v_mfma_f32_16x16x32_bf16 a[0:3], v[196:199], v[156:159], a[0:3]
    buffer_load_dwordx4 v254, s[56:59], s78 offen sc1 lds
    v_mfma_f32_16x16x32_bf16 a[4:7], v[200:203], v[156:159], a[4:7]
    ds_read_b64_tr_b16 a[142:143], v220 offset:5120
    v_mfma_f32_16x16x32_bf16 a[4:7], v[180:183], v[136:139], a[4:7]
    ds_read_b128 a[100:103], v219 offset:0
    v_mfma_f32_16x16x32_bf16 a[8:11], v[184:187], v[136:139], a[8:11]
    ds_read_b64_tr_b16 a[144:145], v221 offset:0
    v_mfma_f32_16x16x32_bf16 a[8:11], v[204:207], v[156:159], a[8:11]
    buffer_load_dwordx4 v254, s[56:59], s78 offen offset:1024 sc1 lds
    v_mfma_f32_16x16x32_bf16 a[12:15], v[208:211], v[156:159], a[12:15]
    ds_read_b64_tr_b16 a[146:147], v221 offset:5120
    v_mfma_f32_16x16x32_bf16 a[12:15], v[188:191], v[136:139], a[12:15]
    ds_read_b128 a[104:107], v219 offset:1024
    v_mfma_f32_16x16x32_bf16 a[16:19], v[192:195], v[136:139], a[16:19]
    ds_read_b64_tr_b16 a[148:149], v220 offset:64
    v_mfma_f32_16x16x32_bf16 a[16:19], v[212:215], v[156:159], a[16:19]
    buffer_load_dwordx4 v254, s[56:59], s78 offen offset:2048 sc1 lds
    v_mfma_f32_16x16x32_bf16 a[36:39], v[212:215], v[160:163], a[36:39]
    ds_read_b64_tr_b16 a[150:151], v220 offset:5184
    v_mfma_f32_16x16x32_bf16 a[36:39], v[192:195], v[140:143], a[36:39]
    ds_read_b128 a[108:111], v219 offset:2048
    v_mfma_f32_16x16x32_bf16 a[32:35], v[188:191], v[140:143], a[32:35]
    ds_read_b64_tr_b16 a[152:153], v221 offset:64
    v_mfma_f32_16x16x32_bf16 a[32:35], v[208:211], v[160:163], a[32:35]
    buffer_load_dwordx4 v254, s[56:59], s78 offen offset:3072 sc1 lds
    v_mfma_f32_16x16x32_bf16 a[28:31], v[204:207], v[160:163], a[28:31]
    s_add_u32 m0, s76, 126976
    ds_read_b64_tr_b16 a[154:155], v221 offset:5184
    v_mfma_f32_16x16x32_bf16 a[28:31], v[184:187], v[140:143], a[28:31]
    s_add_u32 s32, s78, 4096
    ds_read_b128 a[112:115], v219 offset:3072
    v_mfma_f32_16x16x32_bf16 a[24:27], v[180:183], v[140:143], a[24:27]
    s_add_u32 s78, s78, 20480
    ds_read_b64_tr_b16 a[156:157], v220 offset:128
    v_mfma_f32_16x16x32_bf16 a[24:27], v[200:203], v[160:163], a[24:27]
    buffer_load_dwordx4 v254, s[56:59], s32 offen sc1 lds
    v_mfma_f32_16x16x32_bf16 a[20:23], v[196:199], v[160:163], a[20:23]
    s_add_u32 m0, s76, 143360
    ds_read_b64_tr_b16 a[158:159], v220 offset:5248
    v_mfma_f32_16x16x32_bf16 a[20:23], v[176:179], v[140:143], a[20:23]
    s_mov_b32 s33, s77
    ds_read_b128 a[116:119], v219 offset:4096
    v_mfma_f32_16x16x32_bf16 a[40:43], v[176:179], v[144:147], a[40:43]
    ds_read_b64_tr_b16 a[160:161], v220 offset:10240
    v_mfma_f32_16x16x32_bf16 a[40:43], v[196:199], v[164:167], a[40:43]
    buffer_load_dwordx4 v249, s[52:55], s33 offen lds
    v_mfma_f32_16x16x32_bf16 a[44:47], v[200:203], v[164:167], a[44:47]
    ds_read_b64_tr_b16 a[162:163], v220 offset:15360
    v_mfma_f32_16x16x32_bf16 a[44:47], v[180:183], v[144:147], a[44:47]
    ds_read_b128 a[120:123], v219 offset:10240
    v_mfma_f32_16x16x32_bf16 a[48:51], v[184:187], v[144:147], a[48:51]
    ds_read_b64_tr_b16 a[164:165], v221 offset:10240
    v_mfma_f32_16x16x32_bf16 a[48:51], v[204:207], v[164:167], a[48:51]
    buffer_load_dwordx4 v250, s[52:55], s33 offen offset:1024 lds
    v_mfma_f32_16x16x32_bf16 a[52:55], v[208:211], v[164:167], a[52:55]
    ds_read_b64_tr_b16 a[166:167], v221 offset:15360
    v_mfma_f32_16x16x32_bf16 a[52:55], v[188:191], v[144:147], a[52:55]
    ds_read_b128 a[124:127], v219 offset:11264
    v_mfma_f32_16x16x32_bf16 a[56:59], v[192:195], v[144:147], a[56:59]
    ds_read_b64_tr_b16 a[168:169], v220 offset:10304
    v_mfma_f32_16x16x32_bf16 a[56:59], v[212:215], v[164:167], a[56:59]
    buffer_load_dwordx4 v251, s[52:55], s33 offen offset:2048 lds
    v_mfma_f32_16x16x32_bf16 a[76:79], v[212:215], v[168:171], a[76:79]
    ds_read_b64_tr_b16 a[170:171], v220 offset:15424
    v_mfma_f32_16x16x32_bf16 a[76:79], v[192:195], v[148:151], a[76:79]
    ds_read_b128 a[128:131], v219 offset:12288
    v_mfma_f32_16x16x32_bf16 a[72:75], v[188:191], v[148:151], a[72:75]
    ds_read_b64_tr_b16 a[172:173], v221 offset:10304
    v_mfma_f32_16x16x32_bf16 a[72:75], v[208:211], v[168:171], a[72:75]
    buffer_load_dwordx4 v252, s[52:55], s33 offen offset:3072 lds
    v_mfma_f32_16x16x32_bf16 a[68:71], v[204:207], v[168:171], a[68:71]
    s_add_u32 m0, s76, 147456
    ds_read_b64_tr_b16 a[174:175], v221 offset:15424
    v_mfma_f32_16x16x32_bf16 a[68:71], v[184:187], v[148:151], a[68:71]
    s_add_u32 s77, s77, 81920
    ds_read_b128 a[132:135], v219 offset:13312
    v_mfma_f32_16x16x32_bf16 a[64:67], v[180:183], v[148:151], a[64:67]
    ds_read_b64_tr_b16 a[176:177], v220 offset:10368
    v_mfma_f32_16x16x32_bf16 a[64:67], v[200:203], v[168:171], a[64:67]
    buffer_load_dwordx4 v253, s[52:55], s33 offen lds
    v_mfma_f32_16x16x32_bf16 a[60:63], v[196:199], v[168:171], a[60:63]
    ds_read_b64_tr_b16 a[178:179], v220 offset:15488
    v_mfma_f32_16x16x32_bf16 a[60:63], v[176:179], v[148:151], a[60:63]
    ds_read_b128 a[136:139], v219 offset:14336
    v_mfma_f32_16x16x32_bf16 a[80:83], v[176:179], v[152:155], a[80:83]
    s_mov_b32 s30, 45056
    buffer_store_dwordx4 v[112:115], v254, s[20:23], s30 offen sc1
    v_mfma_f32_16x16x32_bf16 a[80:83], v[196:199], v[172:175], a[80:83]
    s_mov_b32 s30, 51200
    v_mfma_f32_16x16x32_bf16 a[84:87], v[200:203], v[172:175], a[84:87]
    v_mfma_f32_16x16x32_bf16 a[84:87], v[180:183], v[152:155], a[84:87]
    buffer_store_dwordx4 v[116:119], v254, s[20:23], s30 offen sc1
    v_mfma_f32_16x16x32_bf16 a[88:91], v[184:187], v[152:155], a[88:91]
    v_mfma_f32_16x16x32_bf16 a[88:91], v[204:207], v[172:175], a[88:91]
    v_mfma_f32_16x16x32_bf16 a[92:95], v[208:211], v[172:175], a[92:95]
    v_mfma_f32_16x16x32_bf16 a[92:95], v[188:191], v[152:155], a[92:95]
    v_mfma_f32_16x16x32_bf16 a[96:99], v[192:195], v[152:155], a[96:99]
    s_waitcnt vmcnt(26) lgkmcnt(0)
    v_mfma_f32_16x16x32_bf16 a[96:99], v[212:215], v[172:175], a[96:99]

    s_barrier
    v_mfma_f32_16x16x32_bf16 a[0:3], a[140:143], a[100:103], a[0:3]
    s_add_u32 m0, s76, 0
    ds_read_b64_tr_b16 v[176:177], v223 offset:0
    v_mfma_f32_16x16x32_bf16 a[0:3], a[160:163], a[120:123], a[0:3]
    buffer_load_dwordx4 v254, s[56:59], s78 offen sc1 lds
    v_mfma_f32_16x16x32_bf16 a[4:7], a[164:167], a[120:123], a[4:7]
    ds_read_b64_tr_b16 v[178:179], v223 offset:5120
    v_mfma_f32_16x16x32_bf16 a[4:7], a[144:147], a[100:103], a[4:7]
    ds_read_b128 v[136:139], v222 offset:0
    v_mfma_f32_16x16x32_bf16 a[8:11], a[148:151], a[100:103], a[8:11]
    ds_read_b64_tr_b16 v[180:181], v224 offset:0
    v_mfma_f32_16x16x32_bf16 a[8:11], a[168:171], a[120:123], a[8:11]
    buffer_load_dwordx4 v254, s[56:59], s78 offen offset:1024 sc1 lds
    v_mfma_f32_16x16x32_bf16 a[12:15], a[172:175], a[120:123], a[12:15]
    ds_read_b64_tr_b16 v[182:183], v224 offset:5120
    v_mfma_f32_16x16x32_bf16 a[12:15], a[152:155], a[100:103], a[12:15]
    ds_read_b128 v[140:143], v222 offset:1024
    v_mfma_f32_16x16x32_bf16 a[16:19], a[156:159], a[100:103], a[16:19]
    ds_read_b64_tr_b16 v[184:185], v223 offset:64
    v_mfma_f32_16x16x32_bf16 a[16:19], a[176:179], a[120:123], a[16:19]
    buffer_load_dwordx4 v254, s[56:59], s78 offen offset:2048 sc1 lds
    v_mfma_f32_16x16x32_bf16 a[36:39], a[176:179], a[124:127], a[36:39]
    ds_read_b64_tr_b16 v[186:187], v223 offset:5184
    v_mfma_f32_16x16x32_bf16 a[36:39], a[156:159], a[104:107], a[36:39]
    ds_read_b128 v[144:147], v222 offset:2048
    v_mfma_f32_16x16x32_bf16 a[32:35], a[152:155], a[104:107], a[32:35]
    ds_read_b64_tr_b16 v[188:189], v224 offset:64
    v_mfma_f32_16x16x32_bf16 a[32:35], a[172:175], a[124:127], a[32:35]
    buffer_load_dwordx4 v254, s[56:59], s78 offen offset:3072 sc1 lds
    v_mfma_f32_16x16x32_bf16 a[28:31], a[168:171], a[124:127], a[28:31]
    s_add_u32 m0, s76, 4096
    ds_read_b64_tr_b16 v[190:191], v224 offset:5184
    v_mfma_f32_16x16x32_bf16 a[28:31], a[148:151], a[104:107], a[28:31]
    s_add_u32 s32, s78, 4096
    ds_read_b128 v[148:151], v222 offset:3072
    v_mfma_f32_16x16x32_bf16 a[24:27], a[144:147], a[104:107], a[24:27]
    s_add_u32 s78, s78, 20480
    ds_read_b64_tr_b16 v[192:193], v223 offset:128
    v_mfma_f32_16x16x32_bf16 a[24:27], a[164:167], a[124:127], a[24:27]
    buffer_load_dwordx4 v254, s[56:59], s32 offen sc1 lds
    v_mfma_f32_16x16x32_bf16 a[20:23], a[160:163], a[124:127], a[20:23]
    s_add_u32 m0, s76, 20480
    ds_read_b64_tr_b16 v[194:195], v223 offset:5248
    v_mfma_f32_16x16x32_bf16 a[20:23], a[140:143], a[104:107], a[20:23]
    s_mov_b32 s33, s77
    ds_read_b128 v[152:155], v222 offset:4096
    v_mfma_f32_16x16x32_bf16 a[40:43], a[140:143], a[108:111], a[40:43]
    ds_read_b64_tr_b16 v[196:197], v223 offset:10240
    v_mfma_f32_16x16x32_bf16 a[40:43], a[160:163], a[128:131], a[40:43]
    buffer_load_dwordx4 v249, s[52:55], s33 offen lds
    v_mfma_f32_16x16x32_bf16 a[44:47], a[164:167], a[128:131], a[44:47]
    ds_read_b64_tr_b16 v[198:199], v223 offset:15360
    v_mfma_f32_16x16x32_bf16 a[44:47], a[144:147], a[108:111], a[44:47]
    ds_read_b128 v[156:159], v222 offset:10240
    v_mfma_f32_16x16x32_bf16 a[48:51], a[148:151], a[108:111], a[48:51]
    ds_read_b64_tr_b16 v[200:201], v224 offset:10240
    v_mfma_f32_16x16x32_bf16 a[48:51], a[168:171], a[128:131], a[48:51]
    buffer_load_dwordx4 v250, s[52:55], s33 offen offset:1024 lds
    v_mfma_f32_16x16x32_bf16 a[52:55], a[172:175], a[128:131], a[52:55]
    ds_read_b64_tr_b16 v[202:203], v224 offset:15360
    v_mfma_f32_16x16x32_bf16 a[52:55], a[152:155], a[108:111], a[52:55]
    ds_read_b128 v[160:163], v222 offset:11264
    v_mfma_f32_16x16x32_bf16 a[56:59], a[156:159], a[108:111], a[56:59]
    ds_read_b64_tr_b16 v[204:205], v223 offset:10304
    v_mfma_f32_16x16x32_bf16 a[56:59], a[176:179], a[128:131], a[56:59]
    buffer_load_dwordx4 v251, s[52:55], s33 offen offset:2048 lds
    v_mfma_f32_16x16x32_bf16 a[76:79], a[176:179], a[132:135], a[76:79]
    ds_read_b64_tr_b16 v[206:207], v223 offset:15424
    v_mfma_f32_16x16x32_bf16 a[76:79], a[156:159], a[112:115], a[76:79]
    ds_read_b128 v[164:167], v222 offset:12288
    v_mfma_f32_16x16x32_bf16 a[72:75], a[152:155], a[112:115], a[72:75]
    ds_read_b64_tr_b16 v[208:209], v224 offset:10304
    v_mfma_f32_16x16x32_bf16 a[72:75], a[172:175], a[132:135], a[72:75]
    buffer_load_dwordx4 v252, s[52:55], s33 offen offset:3072 lds
    v_mfma_f32_16x16x32_bf16 a[68:71], a[168:171], a[132:135], a[68:71]
    s_add_u32 m0, s76, 24576
    ds_read_b64_tr_b16 v[210:211], v224 offset:15424
    v_mfma_f32_16x16x32_bf16 a[68:71], a[148:151], a[112:115], a[68:71]
    s_add_u32 s77, s77, 81920
    ds_read_b128 v[168:171], v222 offset:13312
    v_mfma_f32_16x16x32_bf16 a[64:67], a[144:147], a[112:115], a[64:67]
    ds_read_b64_tr_b16 v[212:213], v223 offset:10368
    v_mfma_f32_16x16x32_bf16 a[64:67], a[164:167], a[132:135], a[64:67]
    buffer_load_dwordx4 v253, s[52:55], s33 offen lds
    v_mfma_f32_16x16x32_bf16 a[60:63], a[160:163], a[132:135], a[60:63]
    ds_read_b64_tr_b16 v[214:215], v223 offset:15488
    v_mfma_f32_16x16x32_bf16 a[60:63], a[140:143], a[112:115], a[60:63]
    ds_read_b128 v[172:175], v222 offset:14336
    v_mfma_f32_16x16x32_bf16 a[80:83], a[140:143], a[116:119], a[80:83]
    s_mov_b32 s30, 52224
    buffer_store_dwordx4 v[120:123], v254, s[20:23], s30 offen sc1
    v_mfma_f32_16x16x32_bf16 a[80:83], a[160:163], a[136:139], a[80:83]
    s_mov_b32 s30, 53248
    v_mfma_f32_16x16x32_bf16 a[84:87], a[164:167], a[136:139], a[84:87]
    v_mfma_f32_16x16x32_bf16 a[84:87], a[144:147], a[116:119], a[84:87]
    buffer_store_dwordx4 v[124:127], v254, s[20:23], s30 offen sc1
    v_mfma_f32_16x16x32_bf16 a[88:91], a[148:151], a[116:119], a[88:91]
    v_mfma_f32_16x16x32_bf16 a[88:91], a[168:171], a[136:139], a[88:91]
    v_mfma_f32_16x16x32_bf16 a[92:95], a[172:175], a[136:139], a[92:95]
    v_mfma_f32_16x16x32_bf16 a[92:95], a[152:155], a[116:119], a[92:95]
    v_mfma_f32_16x16x32_bf16 a[96:99], a[156:159], a[116:119], a[96:99]
    s_waitcnt vmcnt(26) lgkmcnt(0)
    v_mfma_f32_16x16x32_bf16 a[96:99], a[176:179], a[136:139], a[96:99]

    s_barrier
    v_mfma_f32_16x16x32_bf16 a[0:3], v[176:179], v[136:139], a[0:3]
    s_add_u32 m0, s76, 40960
    ds_read_b64_tr_b16 a[140:141], v226 offset:0
    v_mfma_f32_16x16x32_bf16 a[0:3], v[196:199], v[156:159], a[0:3]
    buffer_load_dwordx4 v254, s[56:59], s78 offen sc1 lds
    v_mfma_f32_16x16x32_bf16 a[4:7], v[200:203], v[156:159], a[4:7]
    ds_read_b64_tr_b16 a[142:143], v226 offset:5120
    v_mfma_f32_16x16x32_bf16 a[4:7], v[180:183], v[136:139], a[4:7]
    ds_read_b128 a[100:103], v225 offset:0
    v_mfma_f32_16x16x32_bf16 a[8:11], v[184:187], v[136:139], a[8:11]
    ds_read_b64_tr_b16 a[144:145], v227 offset:0
    v_mfma_f32_16x16x32_bf16 a[8:11], v[204:207], v[156:159], a[8:11]
    buffer_load_dwordx4 v254, s[56:59], s78 offen offset:1024 sc1 lds
    v_mfma_f32_16x16x32_bf16 a[12:15], v[208:211], v[156:159], a[12:15]
    ds_read_b64_tr_b16 a[146:147], v227 offset:5120
    v_mfma_f32_16x16x32_bf16 a[12:15], v[188:191], v[136:139], a[12:15]
    ds_read_b128 a[104:107], v225 offset:1024
    v_mfma_f32_16x16x32_bf16 a[16:19], v[192:195], v[136:139], a[16:19]
    ds_read_b64_tr_b16 a[148:149], v226 offset:64
    v_mfma_f32_16x16x32_bf16 a[16:19], v[212:215], v[156:159], a[16:19]
    buffer_load_dwordx4 v254, s[56:59], s78 offen offset:2048 sc1 lds
    v_mfma_f32_16x16x32_bf16 a[36:39], v[212:215], v[160:163], a[36:39]
    ds_read_b64_tr_b16 a[150:151], v226 offset:5184
    v_mfma_f32_16x16x32_bf16 a[36:39], v[192:195], v[140:143], a[36:39]
    ds_read_b128 a[108:111], v225 offset:2048
    v_mfma_f32_16x16x32_bf16 a[32:35], v[188:191], v[140:143], a[32:35]
    ds_read_b64_tr_b16 a[152:153], v227 offset:64
    v_mfma_f32_16x16x32_bf16 a[32:35], v[208:211], v[160:163], a[32:35]
    buffer_load_dwordx4 v254, s[56:59], s78 offen offset:3072 sc1 lds
    v_mfma_f32_16x16x32_bf16 a[28:31], v[204:207], v[160:163], a[28:31]
    s_add_u32 m0, s76, 45056
    ds_read_b64_tr_b16 a[154:155], v227 offset:5184
    v_mfma_f32_16x16x32_bf16 a[28:31], v[184:187], v[140:143], a[28:31]
    s_add_u32 s32, s78, 4096
    ds_read_b128 a[112:115], v225 offset:3072
    v_mfma_f32_16x16x32_bf16 a[24:27], v[180:183], v[140:143], a[24:27]
    s_add_u32 s78, s78, 20480
    ds_read_b64_tr_b16 a[156:157], v226 offset:128
    v_mfma_f32_16x16x32_bf16 a[24:27], v[200:203], v[160:163], a[24:27]
    buffer_load_dwordx4 v254, s[56:59], s32 offen sc1 lds
    v_mfma_f32_16x16x32_bf16 a[20:23], v[196:199], v[160:163], a[20:23]
    s_add_u32 m0, s76, 61440
    ds_read_b64_tr_b16 a[158:159], v226 offset:5248
    v_mfma_f32_16x16x32_bf16 a[20:23], v[176:179], v[140:143], a[20:23]
    s_mov_b32 s33, s77
    ds_read_b128 a[116:119], v225 offset:4096
    v_mfma_f32_16x16x32_bf16 a[40:43], v[176:179], v[144:147], a[40:43]
    ds_read_b64_tr_b16 a[160:161], v226 offset:10240
    v_mfma_f32_16x16x32_bf16 a[40:43], v[196:199], v[164:167], a[40:43]
    buffer_load_dwordx4 v249, s[52:55], s33 offen lds
    v_mfma_f32_16x16x32_bf16 a[44:47], v[200:203], v[164:167], a[44:47]
    ds_read_b64_tr_b16 a[162:163], v226 offset:15360
    v_mfma_f32_16x16x32_bf16 a[44:47], v[180:183], v[144:147], a[44:47]
    ds_read_b128 a[120:123], v225 offset:10240
    v_mfma_f32_16x16x32_bf16 a[48:51], v[184:187], v[144:147], a[48:51]
    ds_read_b64_tr_b16 a[164:165], v227 offset:10240
    v_mfma_f32_16x16x32_bf16 a[48:51], v[204:207], v[164:167], a[48:51]
    buffer_load_dwordx4 v250, s[52:55], s33 offen offset:1024 lds
    v_mfma_f32_16x16x32_bf16 a[52:55], v[208:211], v[164:167], a[52:55]
    ds_read_b64_tr_b16 a[166:167], v227 offset:15360
    v_mfma_f32_16x16x32_bf16 a[52:55], v[188:191], v[144:147], a[52:55]
    ds_read_b128 a[124:127], v225 offset:11264
    v_mfma_f32_16x16x32_bf16 a[56:59], v[192:195], v[144:147], a[56:59]
    ds_read_b64_tr_b16 a[168:169], v226 offset:10304
    v_mfma_f32_16x16x32_bf16 a[56:59], v[212:215], v[164:167], a[56:59]
    buffer_load_dwordx4 v251, s[52:55], s33 offen offset:2048 lds
    v_mfma_f32_16x16x32_bf16 a[76:79], v[212:215], v[168:171], a[76:79]
    ds_read_b64_tr_b16 a[170:171], v226 offset:15424
    v_mfma_f32_16x16x32_bf16 a[76:79], v[192:195], v[148:151], a[76:79]
    ds_read_b128 a[128:131], v225 offset:12288
    v_mfma_f32_16x16x32_bf16 a[72:75], v[188:191], v[148:151], a[72:75]
    ds_read_b64_tr_b16 a[172:173], v227 offset:10304
    v_mfma_f32_16x16x32_bf16 a[72:75], v[208:211], v[168:171], a[72:75]
    buffer_load_dwordx4 v252, s[52:55], s33 offen offset:3072 lds
    v_mfma_f32_16x16x32_bf16 a[68:71], v[204:207], v[168:171], a[68:71]
    s_add_u32 m0, s76, 65536
    ds_read_b64_tr_b16 a[174:175], v227 offset:15424
    v_mfma_f32_16x16x32_bf16 a[68:71], v[184:187], v[148:151], a[68:71]
    s_add_u32 s77, s77, 81920
    ds_read_b128 a[132:135], v225 offset:13312
    v_mfma_f32_16x16x32_bf16 a[64:67], v[180:183], v[148:151], a[64:67]
    ds_read_b64_tr_b16 a[176:177], v226 offset:10368
    v_mfma_f32_16x16x32_bf16 a[64:67], v[200:203], v[168:171], a[64:67]
    buffer_load_dwordx4 v253, s[52:55], s33 offen lds
    v_mfma_f32_16x16x32_bf16 a[60:63], v[196:199], v[168:171], a[60:63]
    ds_read_b64_tr_b16 a[178:179], v226 offset:15488
    v_mfma_f32_16x16x32_bf16 a[60:63], v[176:179], v[148:151], a[60:63]
    ds_read_b128 a[136:139], v225 offset:14336
    v_mfma_f32_16x16x32_bf16 a[80:83], v[176:179], v[152:155], a[80:83]
    s_mov_b32 s30, 54272
    buffer_store_dwordx4 v[128:131], v254, s[20:23], s30 offen sc1
    v_mfma_f32_16x16x32_bf16 a[80:83], v[196:199], v[172:175], a[80:83]
    s_mov_b32 s30, 55296
    v_mfma_f32_16x16x32_bf16 a[84:87], v[200:203], v[172:175], a[84:87]
    v_mfma_f32_16x16x32_bf16 a[84:87], v[180:183], v[152:155], a[84:87]
    buffer_store_dwordx4 v[132:135], v254, s[20:23], s30 offen sc1
    v_mfma_f32_16x16x32_bf16 a[88:91], v[184:187], v[152:155], a[88:91]
    v_mfma_f32_16x16x32_bf16 a[88:91], v[204:207], v[172:175], a[88:91]
    v_mfma_f32_16x16x32_bf16 a[92:95], v[208:211], v[172:175], a[92:95]
    v_mfma_f32_16x16x32_bf16 a[92:95], v[188:191], v[152:155], a[92:95]
    v_mfma_f32_16x16x32_bf16 a[96:99], v[192:195], v[152:155], a[96:99]
    s_waitcnt vmcnt(26) lgkmcnt(0)
    v_mfma_f32_16x16x32_bf16 a[96:99], v[212:215], v[172:175], a[96:99]

    s_barrier
    v_mfma_f32_16x16x32_bf16 a[0:3], a[140:143], a[100:103], a[0:3]
    s_add_u32 m0, s76, 81920
    ds_read_b64_tr_b16 v[176:177], v217 offset:0
    v_mfma_f32_16x16x32_bf16 a[0:3], a[160:163], a[120:123], a[0:3]
    buffer_load_dwordx4 v254, s[56:59], s78 offen sc1 lds
    v_mfma_f32_16x16x32_bf16 a[4:7], a[164:167], a[120:123], a[4:7]
    ds_read_b64_tr_b16 v[178:179], v217 offset:5120
    v_mfma_f32_16x16x32_bf16 a[4:7], a[144:147], a[100:103], a[4:7]
    ds_read_b128 v[136:139], v216 offset:0
    v_mfma_f32_16x16x32_bf16 a[8:11], a[148:151], a[100:103], a[8:11]
    ds_read_b64_tr_b16 v[180:181], v218 offset:0
    v_mfma_f32_16x16x32_bf16 a[8:11], a[168:171], a[120:123], a[8:11]
    buffer_load_dwordx4 v254, s[56:59], s78 offen offset:1024 sc1 lds
    v_mfma_f32_16x16x32_bf16 a[12:15], a[172:175], a[120:123], a[12:15]
    ds_read_b64_tr_b16 v[182:183], v218 offset:5120
    v_mfma_f32_16x16x32_bf16 a[12:15], a[152:155], a[100:103], a[12:15]
    ds_read_b128 v[140:143], v216 offset:1024
    v_mfma_f32_16x16x32_bf16 a[16:19], a[156:159], a[100:103], a[16:19]
    ds_read_b64_tr_b16 v[184:185], v217 offset:64
    v_mfma_f32_16x16x32_bf16 a[16:19], a[176:179], a[120:123], a[16:19]
    buffer_load_dwordx4 v254, s[56:59], s78 offen offset:2048 sc1 lds
    v_mfma_f32_16x16x32_bf16 a[36:39], a[176:179], a[124:127], a[36:39]
    ds_read_b64_tr_b16 v[186:187], v217 offset:5184
    v_mfma_f32_16x16x32_bf16 a[36:39], a[156:159], a[104:107], a[36:39]
    ds_read_b128 v[144:147], v216 offset:2048
    v_mfma_f32_16x16x32_bf16 a[32:35], a[152:155], a[104:107], a[32:35]
    ds_read_b64_tr_b16 v[188:189], v218 offset:64
    v_mfma_f32_16x16x32_bf16 a[32:35], a[172:175], a[124:127], a[32:35]
    buffer_load_dwordx4 v254, s[56:59], s78 offen offset:3072 sc1 lds
    v_mfma_f32_16x16x32_bf16 a[28:31], a[168:171], a[124:127], a[28:31]
    s_add_u32 m0, s76, 86016
    ds_read_b64_tr_b16 v[190:191], v218 offset:5184
    v_mfma_f32_16x16x32_bf16 a[28:31], a[148:151], a[104:107], a[28:31]
    s_add_u32 s32, s78, 4096
    ds_read_b128 v[148:151], v216 offset:3072
    v_mfma_f32_16x16x32_bf16 a[24:27], a[144:147], a[104:107], a[24:27]
    s_add_u32 s78, s78, 20480
    ds_read_b64_tr_b16 v[192:193], v217 offset:128
    v_mfma_f32_16x16x32_bf16 a[24:27], a[164:167], a[124:127], a[24:27]
    buffer_load_dwordx4 v254, s[56:59], s32 offen sc1 lds
    v_mfma_f32_16x16x32_bf16 a[20:23], a[160:163], a[124:127], a[20:23]
    s_add_u32 m0, s76, 102400
    ds_read_b64_tr_b16 v[194:195], v217 offset:5248
    v_mfma_f32_16x16x32_bf16 a[20:23], a[140:143], a[104:107], a[20:23]
    s_mov_b32 s33, s77
    ds_read_b128 v[152:155], v216 offset:4096
    v_mfma_f32_16x16x32_bf16 a[40:43], a[140:143], a[108:111], a[40:43]
    ds_read_b64_tr_b16 v[196:197], v217 offset:10240
    v_mfma_f32_16x16x32_bf16 a[40:43], a[160:163], a[128:131], a[40:43]
    buffer_load_dwordx4 v249, s[52:55], s33 offen lds
    v_mfma_f32_16x16x32_bf16 a[44:47], a[164:167], a[128:131], a[44:47]
    ds_read_b64_tr_b16 v[198:199], v217 offset:15360
    v_mfma_f32_16x16x32_bf16 a[44:47], a[144:147], a[108:111], a[44:47]
    ds_read_b128 v[156:159], v216 offset:10240
    v_mfma_f32_16x16x32_bf16 a[48:51], a[148:151], a[108:111], a[48:51]
    ds_read_b64_tr_b16 v[200:201], v218 offset:10240
    v_mfma_f32_16x16x32_bf16 a[48:51], a[168:171], a[128:131], a[48:51]
    buffer_load_dwordx4 v250, s[52:55], s33 offen offset:1024 lds
    v_mfma_f32_16x16x32_bf16 a[52:55], a[172:175], a[128:131], a[52:55]
    ds_read_b64_tr_b16 v[202:203], v218 offset:15360
    v_mfma_f32_16x16x32_bf16 a[52:55], a[152:155], a[108:111], a[52:55]
    ds_read_b128 v[160:163], v216 offset:11264
    v_mfma_f32_16x16x32_bf16 a[56:59], a[156:159], a[108:111], a[56:59]
    ds_read_b64_tr_b16 v[204:205], v217 offset:10304
    v_mfma_f32_16x16x32_bf16 a[56:59], a[176:179], a[128:131], a[56:59]
    buffer_load_dwordx4 v251, s[52:55], s33 offen offset:2048 lds
    v_mfma_f32_16x16x32_bf16 a[76:79], a[176:179], a[132:135], a[76:79]
    ds_read_b64_tr_b16 v[206:207], v217 offset:15424
    v_mfma_f32_16x16x32_bf16 a[76:79], a[156:159], a[112:115], a[76:79]
    ds_read_b128 v[164:167], v216 offset:12288
    v_mfma_f32_16x16x32_bf16 a[72:75], a[152:155], a[112:115], a[72:75]
    ds_read_b64_tr_b16 v[208:209], v218 offset:10304
    v_mfma_f32_16x16x32_bf16 a[72:75], a[172:175], a[132:135], a[72:75]
    buffer_load_dwordx4 v252, s[52:55], s33 offen offset:3072 lds
    v_mfma_f32_16x16x32_bf16 a[68:71], a[168:171], a[132:135], a[68:71]
    s_add_u32 m0, s76, 106496
    ds_read_b64_tr_b16 v[210:211], v218 offset:15424
    v_mfma_f32_16x16x32_bf16 a[68:71], a[148:151], a[112:115], a[68:71]
    s_add_u32 s77, s77, 81920
    ds_read_b128 v[168:171], v216 offset:13312
    v_mfma_f32_16x16x32_bf16 a[64:67], a[144:147], a[112:115], a[64:67]
    ds_read_b64_tr_b16 v[212:213], v217 offset:10368
    v_mfma_f32_16x16x32_bf16 a[64:67], a[164:167], a[132:135], a[64:67]
    buffer_load_dwordx4 v253, s[52:55], s33 offen lds
    v_mfma_f32_16x16x32_bf16 a[60:63], a[160:163], a[132:135], a[60:63]
    ds_read_b64_tr_b16 v[214:215], v217 offset:15488
    v_mfma_f32_16x16x32_bf16 a[60:63], a[140:143], a[112:115], a[60:63]
    ds_read_b128 v[172:175], v216 offset:14336
    v_mfma_f32_16x16x32_bf16 a[80:83], a[140:143], a[116:119], a[80:83]
    v_mfma_f32_16x16x32_bf16 a[80:83], a[160:163], a[136:139], a[80:83]
    v_mfma_f32_16x16x32_bf16 a[84:87], a[164:167], a[136:139], a[84:87]
    v_mfma_f32_16x16x32_bf16 a[84:87], a[144:147], a[116:119], a[84:87]
    v_mfma_f32_16x16x32_bf16 a[88:91], a[148:151], a[116:119], a[88:91]
    v_mfma_f32_16x16x32_bf16 a[88:91], a[168:171], a[136:139], a[88:91]
    v_mfma_f32_16x16x32_bf16 a[92:95], a[172:175], a[136:139], a[92:95]
    v_mfma_f32_16x16x32_bf16 a[92:95], a[152:155], a[116:119], a[92:95]
    v_mfma_f32_16x16x32_bf16 a[96:99], a[156:159], a[116:119], a[96:99]
    s_waitcnt vmcnt(10) lgkmcnt(0)
    v_mfma_f32_16x16x32_bf16 a[96:99], a[176:179], a[136:139], a[96:99]

    s_barrier
    s_cmp_lg_u32 s24, 0
    s_cbranch_scc1 L_sig3
    v_accvgpr_write_b32 a254, s41
    s_mov_b64 exec, 1
    buffer_atomic_add a254, off, s[68:71], s80 sc1
    s_mov_b64 exec, -1
    L_sig3:
    s_add_u32 s80, s80, 128
    s_getpc_b64 s[72:73]
    s_mov_b32 s74, 0x4000
    s_lshr_b32 s49, s2, 3
    s_lshl_b32 s49, s49, 2
    s_add_u32 s49, s49, s24
    s_lshl_b32 s49, s49, 7
    v_lshlrev_b32 v14, 10, v254

.p2align 3
L_op:
    v_mfma_f32_16x16x32_bf16 a[0:3], v[176:179], v[136:139], a[0:3]
    s_add_u32 m0, s76, 122880
    ds_read_b64_tr_b16 a[140:141], v220 offset:0
    v_mfma_f32_16x16x32_bf16 a[0:3], v[196:199], v[156:159], a[0:3]
    buffer_load_dwordx4 v254, s[56:59], s78 offen sc1 lds
    v_mfma_f32_16x16x32_bf16 a[4:7], v[200:203], v[156:159], a[4:7]
    ds_read_b64_tr_b16 a[142:143], v220 offset:5120
    v_mfma_f32_16x16x32_bf16 a[4:7], v[180:183], v[136:139], a[4:7]
    ds_read_b128 a[100:103], v219 offset:0
    v_mfma_f32_16x16x32_bf16 a[8:11], v[184:187], v[136:139], a[8:11]
    ds_read_b64_tr_b16 a[144:145], v221 offset:0
    v_mfma_f32_16x16x32_bf16 a[8:11], v[204:207], v[156:159], a[8:11]
    ds_read_b64_tr_b16 a[146:147], v221 offset:5120
    v_mfma_f32_16x16x32_bf16 a[12:15], v[208:211], v[156:159], a[12:15]
    buffer_load_dwordx4 v254, s[56:59], s78 offen offset:1024 sc1 lds
    v_mfma_f32_16x16x32_bf16 a[12:15], v[188:191], v[136:139], a[12:15]
    ds_read_b128 a[104:107], v219 offset:1024
    v_mfma_f32_16x16x32_bf16 a[16:19], v[192:195], v[136:139], a[16:19]
    ds_read_b64_tr_b16 a[148:149], v220 offset:64
    v_mfma_f32_16x16x32_bf16 a[16:19], v[212:215], v[156:159], a[16:19]
    ds_read_b64_tr_b16 a[150:151], v220 offset:5184
    v_mfma_f32_16x16x32_bf16 a[36:39], v[212:215], v[160:163], a[36:39]
    ds_read_b128 a[108:111], v219 offset:2048
    v_mfma_f32_16x16x32_bf16 a[36:39], v[192:195], v[140:143], a[36:39]
    buffer_load_dwordx4 v254, s[56:59], s78 offen offset:2048 sc1 lds
    v_mfma_f32_16x16x32_bf16 a[32:35], v[188:191], v[140:143], a[32:35]
    ds_read_b64_tr_b16 a[152:153], v221 offset:64
    v_mfma_f32_16x16x32_bf16 a[32:35], v[208:211], v[160:163], a[32:35]
    ds_read_b64_tr_b16 a[154:155], v221 offset:5184
    v_mfma_f32_16x16x32_bf16 a[28:31], v[204:207], v[160:163], a[28:31]
    ds_read_b128 a[112:115], v219 offset:3072
    v_mfma_f32_16x16x32_bf16 a[28:31], v[184:187], v[140:143], a[28:31]
    ds_read_b64_tr_b16 a[156:157], v220 offset:128
    v_mfma_f32_16x16x32_bf16 a[24:27], v[180:183], v[140:143], a[24:27]
    buffer_load_dwordx4 v254, s[56:59], s78 offen offset:3072 sc1 lds
    v_mfma_f32_16x16x32_bf16 a[24:27], v[200:203], v[160:163], a[24:27]
    s_add_u32 m0, s76, 126976
    ds_read_b64_tr_b16 a[158:159], v220 offset:5248
    v_mfma_f32_16x16x32_bf16 a[20:23], v[196:199], v[160:163], a[20:23]
    s_add_u32 s32, s78, 4096
    ds_read_b128 a[116:119], v219 offset:4096
    v_mfma_f32_16x16x32_bf16 a[20:23], v[176:179], v[140:143], a[20:23]
    s_add_u32 s78, s78, 20480
    ds_read_b64_tr_b16 a[160:161], v220 offset:10240
    v_mfma_f32_16x16x32_bf16 a[40:43], v[176:179], v[144:147], a[40:43]
    ds_read_b64_tr_b16 a[162:163], v220 offset:15360
    v_mfma_f32_16x16x32_bf16 a[40:43], v[196:199], v[164:167], a[40:43]
    buffer_load_dwordx4 v254, s[56:59], s32 offen sc1 lds
    v_mfma_f32_16x16x32_bf16 a[44:47], v[200:203], v[164:167], a[44:47]
    s_add_u32 m0, s76, 143360
    ds_read_b128 a[120:123], v219 offset:10240
    v_mfma_f32_16x16x32_bf16 a[44:47], v[180:183], v[144:147], a[44:47]
    s_mov_b32 s33, s77
    ds_read_b64_tr_b16 a[164:165], v221 offset:10240
    v_mfma_f32_16x16x32_bf16 a[48:51], v[184:187], v[144:147], a[48:51]
    ds_read_b64_tr_b16 a[166:167], v221 offset:15360
    v_mfma_f32_16x16x32_bf16 a[48:51], v[204:207], v[164:167], a[48:51]
    ds_read_b128 a[124:127], v219 offset:11264
    v_mfma_f32_16x16x32_bf16 a[52:55], v[208:211], v[164:167], a[52:55]
    buffer_load_dwordx4 v249, s[52:55], s33 offen lds
    v_mfma_f32_16x16x32_bf16 a[52:55], v[188:191], v[144:147], a[52:55]
    ds_read_b64_tr_b16 a[168:169], v220 offset:10304
    v_mfma_f32_16x16x32_bf16 a[56:59], v[192:195], v[144:147], a[56:59]
    ds_read_b64_tr_b16 a[170:171], v220 offset:15424
    v_mfma_f32_16x16x32_bf16 a[56:59], v[212:215], v[164:167], a[56:59]
    ds_read_b128 a[128:131], v219 offset:12288
    v_mfma_f32_16x16x32_bf16 a[76:79], v[212:215], v[168:171], a[76:79]
    ds_read_b64_tr_b16 a[172:173], v221 offset:10304
    v_mfma_f32_16x16x32_bf16 a[76:79], v[192:195], v[148:151], a[76:79]
    buffer_load_dwordx4 v250, s[52:55], s33 offen offset:1024 lds
    v_mfma_f32_16x16x32_bf16 a[72:75], v[188:191], v[148:151], a[72:75]
    ds_read_b64_tr_b16 a[174:175], v221 offset:15424
    v_mfma_f32_16x16x32_bf16 a[72:75], v[208:211], v[168:171], a[72:75]
    ds_read_b128 a[132:135], v219 offset:13312
    v_mfma_f32_16x16x32_bf16 a[68:71], v[204:207], v[168:171], a[68:71]
    ds_read_b64_tr_b16 a[176:177], v220 offset:10368
    v_mfma_f32_16x16x32_bf16 a[68:71], v[184:187], v[148:151], a[68:71]
    ds_read_b64_tr_b16 a[178:179], v220 offset:15488
    v_mfma_f32_16x16x32_bf16 a[64:67], v[180:183], v[148:151], a[64:67]
    buffer_load_dwordx4 v251, s[52:55], s33 offen offset:2048 lds
    v_mfma_f32_16x16x32_bf16 a[64:67], v[200:203], v[168:171], a[64:67]
    ds_read_b128 a[136:139], v219 offset:14336
    v_mfma_f32_16x16x32_bf16 a[60:63], v[196:199], v[168:171], a[60:63]
    v_mfma_f32_16x16x32_bf16 a[60:63], v[176:179], v[148:151], a[60:63]
    v_mfma_f32_16x16x32_bf16 a[80:83], v[176:179], v[152:155], a[80:83]
    v_mfma_f32_16x16x32_bf16 a[80:83], v[196:199], v[172:175], a[80:83]
    buffer_load_dwordx4 v252, s[52:55], s33 offen offset:3072 lds
    v_mfma_f32_16x16x32_bf16 a[84:87], v[200:203], v[172:175], a[84:87]
    s_add_u32 m0, s76, 147456
    v_mfma_f32_16x16x32_bf16 a[84:87], v[180:183], v[152:155], a[84:87]
    s_add_u32 s77, s77, 81920
    v_mfma_f32_16x16x32_bf16 a[88:91], v[184:187], v[152:155], a[88:91]
    v_mfma_f32_16x16x32_bf16 a[88:91], v[204:207], v[172:175], a[88:91]
    v_mfma_f32_16x16x32_bf16 a[92:95], v[208:211], v[172:175], a[92:95]
    buffer_load_dwordx4 v253, s[52:55], s33 offen lds
    v_mfma_f32_16x16x32_bf16 a[92:95], v[188:191], v[152:155], a[92:95]
    v_mfma_f32_16x16x32_bf16 a[96:99], v[192:195], v[152:155], a[96:99]
    s_waitcnt vmcnt(20) lgkmcnt(0)
    v_mfma_f32_16x16x32_bf16 a[96:99], v[212:215], v[172:175], a[96:99]

    s_barrier
    v_mfma_f32_16x16x32_bf16 a[0:3], a[140:143], a[100:103], a[0:3]
    s_add_u32 m0, s76, 0
    ds_read_b64_tr_b16 v[176:177], v223 offset:0
    v_mfma_f32_16x16x32_bf16 a[0:3], a[160:163], a[120:123], a[0:3]
    s_add_u32 s31, s79, s36
    buffer_load_dwordx4 v254, s[56:59], s78 offen sc1 lds
    v_mfma_f32_16x16x32_bf16 a[4:7], a[164:167], a[120:123], a[4:7]
    s_cmp_eq_u32 s31, 1
    ds_read_b64_tr_b16 v[178:179], v223 offset:5120
    v_mfma_f32_16x16x32_bf16 a[4:7], a[144:147], a[100:103], a[4:7]
    s_cselect_b32 s31, s81, 1879048192
    ds_read_b128 v[136:139], v222 offset:0
    v_mfma_f32_16x16x32_bf16 a[8:11], a[148:151], a[100:103], a[8:11]
    ds_read_b64_tr_b16 v[180:181], v224 offset:0
    v_mfma_f32_16x16x32_bf16 a[8:11], a[168:171], a[120:123], a[8:11]
    ds_read_b64_tr_b16 v[182:183], v224 offset:5120
    v_mfma_f32_16x16x32_bf16 a[12:15], a[172:175], a[120:123], a[12:15]
    buffer_load_dwordx4 v254, s[56:59], s78 offen offset:1024 sc1 lds
    v_mfma_f32_16x16x32_bf16 a[12:15], a[152:155], a[100:103], a[12:15]
    ds_read_b128 v[140:143], v222 offset:1024
    v_mfma_f32_16x16x32_bf16 a[16:19], a[156:159], a[100:103], a[16:19]
    ds_read_b64_tr_b16 v[184:185], v223 offset:64
    v_mfma_f32_16x16x32_bf16 a[16:19], a[176:179], a[120:123], a[16:19]
    ds_read_b64_tr_b16 v[186:187], v223 offset:5184
    v_mfma_f32_16x16x32_bf16 a[36:39], a[176:179], a[124:127], a[36:39]
    ds_read_b128 v[144:147], v222 offset:2048
    v_mfma_f32_16x16x32_bf16 a[36:39], a[156:159], a[104:107], a[36:39]
    buffer_load_dwordx4 v254, s[56:59], s78 offen offset:2048 sc1 lds
    v_mfma_f32_16x16x32_bf16 a[32:35], a[152:155], a[104:107], a[32:35]
    ds_read_b64_tr_b16 v[188:189], v224 offset:64
    v_mfma_f32_16x16x32_bf16 a[32:35], a[172:175], a[124:127], a[32:35]
    ds_read_b64_tr_b16 v[190:191], v224 offset:5184
    v_mfma_f32_16x16x32_bf16 a[28:31], a[168:171], a[124:127], a[28:31]
    ds_read_b128 v[148:151], v222 offset:3072
    v_mfma_f32_16x16x32_bf16 a[28:31], a[148:151], a[104:107], a[28:31]
    ds_read_b64_tr_b16 v[192:193], v223 offset:128
    v_mfma_f32_16x16x32_bf16 a[24:27], a[144:147], a[104:107], a[24:27]
    buffer_load_dwordx4 v254, s[56:59], s78 offen offset:3072 sc1 lds
    v_mfma_f32_16x16x32_bf16 a[24:27], a[164:167], a[124:127], a[24:27]
    s_add_u32 m0, s76, 4096
    ds_read_b64_tr_b16 v[194:195], v223 offset:5248
    v_mfma_f32_16x16x32_bf16 a[20:23], a[160:163], a[124:127], a[20:23]
    s_add_u32 s32, s78, 4096
    ds_read_b128 v[152:155], v222 offset:4096
    v_mfma_f32_16x16x32_bf16 a[20:23], a[140:143], a[104:107], a[20:23]
    s_add_u32 s78, s78, 20480
    ds_read_b64_tr_b16 v[196:197], v223 offset:10240
    v_mfma_f32_16x16x32_bf16 a[40:43], a[140:143], a[108:111], a[40:43]
    ds_read_b64_tr_b16 v[198:199], v223 offset:15360
    v_mfma_f32_16x16x32_bf16 a[40:43], a[160:163], a[128:131], a[40:43]
    buffer_load_dwordx4 v254, s[56:59], s32 offen sc1 lds
    v_mfma_f32_16x16x32_bf16 a[44:47], a[164:167], a[128:131], a[44:47]
    s_add_u32 m0, s76, 20480
    ds_read_b128 v[156:159], v222 offset:10240
    v_mfma_f32_16x16x32_bf16 a[44:47], a[144:147], a[108:111], a[44:47]
    s_mov_b32 s33, s77
    ds_read_b64_tr_b16 v[200:201], v224 offset:10240
    v_mfma_f32_16x16x32_bf16 a[48:51], a[148:151], a[108:111], a[48:51]
    ds_read_b64_tr_b16 v[202:203], v224 offset:15360
    v_mfma_f32_16x16x32_bf16 a[48:51], a[168:171], a[128:131], a[48:51]
    ds_read_b128 v[160:163], v222 offset:11264
    v_mfma_f32_16x16x32_bf16 a[52:55], a[172:175], a[128:131], a[52:55]
    buffer_load_dwordx4 v249, s[52:55], s33 offen lds
    v_mfma_f32_16x16x32_bf16 a[52:55], a[152:155], a[108:111], a[52:55]
    ds_read_b64_tr_b16 v[204:205], v223 offset:10304
    v_mfma_f32_16x16x32_bf16 a[56:59], a[156:159], a[108:111], a[56:59]
    ds_read_b64_tr_b16 v[206:207], v223 offset:15424
    v_mfma_f32_16x16x32_bf16 a[56:59], a[176:179], a[128:131], a[56:59]
    ds_read_b128 v[164:167], v222 offset:12288
    v_mfma_f32_16x16x32_bf16 a[76:79], a[176:179], a[132:135], a[76:79]
    ds_read_b64_tr_b16 v[208:209], v224 offset:10304
    v_mfma_f32_16x16x32_bf16 a[76:79], a[156:159], a[112:115], a[76:79]
    buffer_load_dwordx4 v250, s[52:55], s33 offen offset:1024 lds
    v_mfma_f32_16x16x32_bf16 a[72:75], a[152:155], a[112:115], a[72:75]
    ds_read_b64_tr_b16 v[210:211], v224 offset:15424
    v_mfma_f32_16x16x32_bf16 a[72:75], a[172:175], a[132:135], a[72:75]
    ds_read_b128 v[168:171], v222 offset:13312
    v_mfma_f32_16x16x32_bf16 a[68:71], a[168:171], a[132:135], a[68:71]
    ds_read_b64_tr_b16 v[212:213], v223 offset:10368
    v_mfma_f32_16x16x32_bf16 a[68:71], a[148:151], a[112:115], a[68:71]
    ds_read_b64_tr_b16 v[214:215], v223 offset:15488
    v_mfma_f32_16x16x32_bf16 a[64:67], a[144:147], a[112:115], a[64:67]
    buffer_load_dwordx4 v251, s[52:55], s33 offen offset:2048 lds
    v_mfma_f32_16x16x32_bf16 a[64:67], a[164:167], a[132:135], a[64:67]
    ds_read_b128 v[172:175], v222 offset:14336
    v_mfma_f32_16x16x32_bf16 a[60:63], a[160:163], a[132:135], a[60:63]
    v_mfma_f32_16x16x32_bf16 a[60:63], a[140:143], a[112:115], a[60:63]
    v_mfma_f32_16x16x32_bf16 a[80:83], a[140:143], a[116:119], a[80:83]
    v_mfma_f32_16x16x32_bf16 a[80:83], a[160:163], a[136:139], a[80:83]
    buffer_load_dwordx4 v252, s[52:55], s33 offen offset:3072 lds
    v_mfma_f32_16x16x32_bf16 a[84:87], a[164:167], a[136:139], a[84:87]
    s_add_u32 m0, s76, 24576
    v_mfma_f32_16x16x32_bf16 a[84:87], a[144:147], a[116:119], a[84:87]
    s_add_u32 s77, s77, 81920
    v_mfma_f32_16x16x32_bf16 a[88:91], a[148:151], a[116:119], a[88:91]
    v_mfma_f32_16x16x32_bf16 a[88:91], a[168:171], a[136:139], a[88:91]
    v_mfma_f32_16x16x32_bf16 a[92:95], a[172:175], a[136:139], a[92:95]
    buffer_load_dwordx4 v253, s[52:55], s33 offen lds
    v_mfma_f32_16x16x32_bf16 a[92:95], a[152:155], a[116:119], a[92:95]
    v_mfma_f32_16x16x32_bf16 a[96:99], a[156:159], a[116:119], a[96:99]
    s_waitcnt vmcnt(20) lgkmcnt(0)
    v_mfma_f32_16x16x32_bf16 a[96:99], a[176:179], a[136:139], a[96:99]

    s_barrier
    v_mfma_f32_16x16x32_bf16 a[0:3], v[176:179], v[136:139], a[0:3]
    s_add_u32 m0, s76, 40960
    ds_read_b64_tr_b16 a[140:141], v226 offset:0
    v_mfma_f32_16x16x32_bf16 a[0:3], v[196:199], v[156:159], a[0:3]
    s_lshl_b32 s30, s79, 4
    buffer_load_dwordx4 v254, s[56:59], s78 offen sc1 lds
    v_mfma_f32_16x16x32_bf16 a[4:7], v[200:203], v[156:159], a[4:7]
    s_add_u32 s30, s30, s36
    ds_read_b64_tr_b16 a[142:143], v226 offset:5120
    v_mfma_f32_16x16x32_bf16 a[4:7], v[180:183], v[136:139], a[4:7]
    s_cmp_eq_u32 s30, 18
    ds_read_b128 a[100:103], v225 offset:0
    v_mfma_f32_16x16x32_bf16 a[8:11], v[184:187], v[136:139], a[8:11]
    s_cselect_b32 s30, s49, 1879048192
    ds_read_b64_tr_b16 a[144:145], v227 offset:0
    v_mfma_f32_16x16x32_bf16 a[8:11], v[204:207], v[156:159], a[8:11]
    ds_read_b64_tr_b16 a[146:147], v227 offset:5120
    v_mfma_f32_16x16x32_bf16 a[12:15], v[208:211], v[156:159], a[12:15]
    buffer_load_dwordx4 v254, s[56:59], s78 offen offset:1024 sc1 lds
    v_mfma_f32_16x16x32_bf16 a[12:15], v[188:191], v[136:139], a[12:15]
    ds_read_b128 a[104:107], v225 offset:1024
    v_mfma_f32_16x16x32_bf16 a[16:19], v[192:195], v[136:139], a[16:19]
    ds_read_b64_tr_b16 a[148:149], v226 offset:64
    v_mfma_f32_16x16x32_bf16 a[16:19], v[212:215], v[156:159], a[16:19]
    ds_read_b64_tr_b16 a[150:151], v226 offset:5184
    v_mfma_f32_16x16x32_bf16 a[36:39], v[212:215], v[160:163], a[36:39]
    ds_read_b128 a[108:111], v225 offset:2048
    v_mfma_f32_16x16x32_bf16 a[36:39], v[192:195], v[140:143], a[36:39]
    buffer_load_dwordx4 v254, s[56:59], s78 offen offset:2048 sc1 lds
    v_mfma_f32_16x16x32_bf16 a[32:35], v[188:191], v[140:143], a[32:35]
    ds_read_b64_tr_b16 a[152:153], v227 offset:64
    v_mfma_f32_16x16x32_bf16 a[32:35], v[208:211], v[160:163], a[32:35]
    ds_read_b64_tr_b16 a[154:155], v227 offset:5184
    v_mfma_f32_16x16x32_bf16 a[28:31], v[204:207], v[160:163], a[28:31]
    ds_read_b128 a[112:115], v225 offset:3072
    v_mfma_f32_16x16x32_bf16 a[28:31], v[184:187], v[140:143], a[28:31]
    ds_read_b64_tr_b16 a[156:157], v226 offset:128
    v_mfma_f32_16x16x32_bf16 a[24:27], v[180:183], v[140:143], a[24:27]
    buffer_load_dwordx4 v254, s[56:59], s78 offen offset:3072 sc1 lds
    v_mfma_f32_16x16x32_bf16 a[24:27], v[200:203], v[160:163], a[24:27]
    s_add_u32 m0, s76, 45056
    ds_read_b64_tr_b16 a[158:159], v226 offset:5248
    v_mfma_f32_16x16x32_bf16 a[20:23], v[196:199], v[160:163], a[20:23]
    s_add_u32 s32, s78, 4096
    ds_read_b128 a[116:119], v225 offset:4096
    v_mfma_f32_16x16x32_bf16 a[20:23], v[176:179], v[140:143], a[20:23]
    s_add_u32 s78, s78, 20480
    ds_read_b64_tr_b16 a[160:161], v226 offset:10240
    v_mfma_f32_16x16x32_bf16 a[40:43], v[176:179], v[144:147], a[40:43]
    ds_read_b64_tr_b16 a[162:163], v226 offset:15360
    v_mfma_f32_16x16x32_bf16 a[40:43], v[196:199], v[164:167], a[40:43]
    buffer_load_dwordx4 v254, s[56:59], s32 offen sc1 lds
    v_mfma_f32_16x16x32_bf16 a[44:47], v[200:203], v[164:167], a[44:47]
    s_add_u32 m0, s76, 61440
    ds_read_b128 a[120:123], v225 offset:10240
    v_mfma_f32_16x16x32_bf16 a[44:47], v[180:183], v[144:147], a[44:47]
    s_mov_b32 s33, s77
    ds_read_b64_tr_b16 a[164:165], v227 offset:10240
    v_mfma_f32_16x16x32_bf16 a[48:51], v[184:187], v[144:147], a[48:51]
    ds_read_b64_tr_b16 a[166:167], v227 offset:15360
    v_mfma_f32_16x16x32_bf16 a[48:51], v[204:207], v[164:167], a[48:51]
    ds_read_b128 a[124:127], v225 offset:11264
    v_mfma_f32_16x16x32_bf16 a[52:55], v[208:211], v[164:167], a[52:55]
    buffer_load_dwordx4 v249, s[52:55], s33 offen lds
    v_mfma_f32_16x16x32_bf16 a[52:55], v[188:191], v[144:147], a[52:55]
    ds_read_b64_tr_b16 a[168:169], v226 offset:10304
    v_mfma_f32_16x16x32_bf16 a[56:59], v[192:195], v[144:147], a[56:59]
    ds_read_b64_tr_b16 a[170:171], v226 offset:15424
    v_mfma_f32_16x16x32_bf16 a[56:59], v[212:215], v[164:167], a[56:59]
    ds_read_b128 a[128:131], v225 offset:12288
    v_mfma_f32_16x16x32_bf16 a[76:79], v[212:215], v[168:171], a[76:79]
    ds_read_b64_tr_b16 a[172:173], v227 offset:10304
    v_mfma_f32_16x16x32_bf16 a[76:79], v[192:195], v[148:151], a[76:79]
    buffer_load_dwordx4 v250, s[52:55], s33 offen offset:1024 lds
    v_mfma_f32_16x16x32_bf16 a[72:75], v[188:191], v[148:151], a[72:75]
    ds_read_b64_tr_b16 a[174:175], v227 offset:15424
    v_mfma_f32_16x16x32_bf16 a[72:75], v[208:211], v[168:171], a[72:75]
    ds_read_b128 a[132:135], v225 offset:13312
    v_mfma_f32_16x16x32_bf16 a[68:71], v[204:207], v[168:171], a[68:71]
    ds_read_b64_tr_b16 a[176:177], v226 offset:10368
    v_mfma_f32_16x16x32_bf16 a[68:71], v[184:187], v[148:151], a[68:71]
    ds_read_b64_tr_b16 a[178:179], v226 offset:15488
    v_mfma_f32_16x16x32_bf16 a[64:67], v[180:183], v[148:151], a[64:67]
    buffer_load_dwordx4 v251, s[52:55], s33 offen offset:2048 lds
    v_mfma_f32_16x16x32_bf16 a[64:67], v[200:203], v[168:171], a[64:67]
    ds_read_b128 a[136:139], v225 offset:14336
    v_mfma_f32_16x16x32_bf16 a[60:63], v[196:199], v[168:171], a[60:63]
    v_mfma_f32_16x16x32_bf16 a[60:63], v[176:179], v[148:151], a[60:63]
    v_mfma_f32_16x16x32_bf16 a[80:83], v[176:179], v[152:155], a[80:83]
    v_mfma_f32_16x16x32_bf16 a[80:83], v[196:199], v[172:175], a[80:83]
    buffer_load_dwordx4 v252, s[52:55], s33 offen offset:3072 lds
    v_mfma_f32_16x16x32_bf16 a[84:87], v[200:203], v[172:175], a[84:87]
    s_add_u32 m0, s76, 65536
    v_mfma_f32_16x16x32_bf16 a[84:87], v[180:183], v[152:155], a[84:87]
    s_add_u32 s77, s77, 81920
    v_mfma_f32_16x16x32_bf16 a[88:91], v[184:187], v[152:155], a[88:91]
    v_mfma_f32_16x16x32_bf16 a[88:91], v[204:207], v[172:175], a[88:91]
    v_mfma_f32_16x16x32_bf16 a[92:95], v[208:211], v[172:175], a[92:95]
    buffer_load_dwordx4 v253, s[52:55], s33 offen lds
    v_mfma_f32_16x16x32_bf16 a[92:95], v[188:191], v[152:155], a[92:95]
    v_mfma_f32_16x16x32_bf16 a[96:99], v[192:195], v[152:155], a[96:99]
    s_waitcnt vmcnt(20) lgkmcnt(0)
    buffer_load_dword a255, v14, s[72:75], s30 offen
    v_mfma_f32_16x16x32_bf16 a[96:99], v[212:215], v[172:175], a[96:99]

    s_barrier
    v_mfma_f32_16x16x32_bf16 a[0:3], a[140:143], a[100:103], a[0:3]
    s_add_u32 m0, s76, 81920
    ds_read_b64_tr_b16 v[176:177], v217 offset:0
    v_mfma_f32_16x16x32_bf16 a[0:3], a[160:163], a[120:123], a[0:3]
    buffer_load_dwordx4 v254, s[56:59], s78 offen sc1 lds
    v_mfma_f32_16x16x32_bf16 a[4:7], a[164:167], a[120:123], a[4:7]
    ds_read_b64_tr_b16 v[178:179], v217 offset:5120
    v_mfma_f32_16x16x32_bf16 a[4:7], a[144:147], a[100:103], a[4:7]
    buffer_load_dword v255, off, s[68:71], s31 offset:128 sc1
    v_mfma_f32_16x16x32_bf16 a[8:11], a[148:151], a[100:103], a[8:11]
    ds_read_b128 v[136:139], v216 offset:0
    v_mfma_f32_16x16x32_bf16 a[8:11], a[168:171], a[120:123], a[8:11]
    ds_read_b64_tr_b16 v[180:181], v218 offset:0
    v_mfma_f32_16x16x32_bf16 a[12:15], a[172:175], a[120:123], a[12:15]
    buffer_load_dwordx4 v254, s[56:59], s78 offen offset:1024 sc1 lds
    v_mfma_f32_16x16x32_bf16 a[12:15], a[152:155], a[100:103], a[12:15]
    ds_read_b64_tr_b16 v[182:183], v218 offset:5120
    v_mfma_f32_16x16x32_bf16 a[16:19], a[156:159], a[100:103], a[16:19]
    ds_read_b128 v[140:143], v216 offset:1024
    v_mfma_f32_16x16x32_bf16 a[16:19], a[176:179], a[120:123], a[16:19]
    ds_read_b64_tr_b16 v[184:185], v217 offset:64
    v_mfma_f32_16x16x32_bf16 a[36:39], a[176:179], a[124:127], a[36:39]
    ds_read_b64_tr_b16 v[186:187], v217 offset:5184
    v_mfma_f32_16x16x32_bf16 a[36:39], a[156:159], a[104:107], a[36:39]
    buffer_load_dwordx4 v254, s[56:59], s78 offen offset:2048 sc1 lds
    v_mfma_f32_16x16x32_bf16 a[32:35], a[152:155], a[104:107], a[32:35]
    ds_read_b128 v[144:147], v216 offset:2048
    v_mfma_f32_16x16x32_bf16 a[32:35], a[172:175], a[124:127], a[32:35]
    ds_read_b64_tr_b16 v[188:189], v218 offset:64
    v_mfma_f32_16x16x32_bf16 a[28:31], a[168:171], a[124:127], a[28:31]
    ds_read_b64_tr_b16 v[190:191], v218 offset:5184
    v_mfma_f32_16x16x32_bf16 a[28:31], a[148:151], a[104:107], a[28:31]
    ds_read_b128 v[148:151], v216 offset:3072
    v_mfma_f32_16x16x32_bf16 a[24:27], a[144:147], a[104:107], a[24:27]
    buffer_load_dwordx4 v254, s[56:59], s78 offen offset:3072 sc1 lds
    v_mfma_f32_16x16x32_bf16 a[24:27], a[164:167], a[124:127], a[24:27]
    s_add_u32 m0, s76, 86016
    ds_read_b64_tr_b16 v[192:193], v217 offset:128
    v_mfma_f32_16x16x32_bf16 a[20:23], a[160:163], a[124:127], a[20:23]
    s_add_u32 s32, s78, 4096
    ds_read_b64_tr_b16 v[194:195], v217 offset:5248
    v_mfma_f32_16x16x32_bf16 a[20:23], a[140:143], a[104:107], a[20:23]
    s_add_u32 s78, s78, 20480
    ds_read_b128 v[152:155], v216 offset:4096
    v_mfma_f32_16x16x32_bf16 a[40:43], a[140:143], a[108:111], a[40:43]
    ds_read_b64_tr_b16 v[196:197], v217 offset:10240
    v_mfma_f32_16x16x32_bf16 a[40:43], a[160:163], a[128:131], a[40:43]
    buffer_load_dwordx4 v254, s[56:59], s32 offen sc1 lds
    v_mfma_f32_16x16x32_bf16 a[44:47], a[164:167], a[128:131], a[44:47]
    s_add_u32 m0, s76, 102400
    ds_read_b64_tr_b16 v[198:199], v217 offset:15360
    v_mfma_f32_16x16x32_bf16 a[44:47], a[144:147], a[108:111], a[44:47]
    s_mov_b32 s33, s77
    ds_read_b128 v[156:159], v216 offset:10240
    v_mfma_f32_16x16x32_bf16 a[48:51], a[148:151], a[108:111], a[48:51]
    ds_read_b64_tr_b16 v[200:201], v218 offset:10240
    v_mfma_f32_16x16x32_bf16 a[48:51], a[168:171], a[128:131], a[48:51]
    ds_read_b64_tr_b16 v[202:203], v218 offset:15360
    v_mfma_f32_16x16x32_bf16 a[52:55], a[172:175], a[128:131], a[52:55]
    buffer_load_dwordx4 v249, s[52:55], s33 offen lds
    v_mfma_f32_16x16x32_bf16 a[52:55], a[152:155], a[108:111], a[52:55]
    ds_read_b128 v[160:163], v216 offset:11264
    v_mfma_f32_16x16x32_bf16 a[56:59], a[156:159], a[108:111], a[56:59]
    ds_read_b64_tr_b16 v[204:205], v217 offset:10304
    v_mfma_f32_16x16x32_bf16 a[56:59], a[176:179], a[128:131], a[56:59]
    ds_read_b64_tr_b16 v[206:207], v217 offset:15424
    v_mfma_f32_16x16x32_bf16 a[76:79], a[176:179], a[132:135], a[76:79]
    ds_read_b128 v[164:167], v216 offset:12288
    v_mfma_f32_16x16x32_bf16 a[76:79], a[156:159], a[112:115], a[76:79]
    buffer_load_dwordx4 v250, s[52:55], s33 offen offset:1024 lds
    v_mfma_f32_16x16x32_bf16 a[72:75], a[152:155], a[112:115], a[72:75]
    ds_read_b64_tr_b16 v[208:209], v218 offset:10304
    v_mfma_f32_16x16x32_bf16 a[72:75], a[172:175], a[132:135], a[72:75]
    ds_read_b64_tr_b16 v[210:211], v218 offset:15424
    v_mfma_f32_16x16x32_bf16 a[68:71], a[168:171], a[132:135], a[68:71]
    ds_read_b128 v[168:171], v216 offset:13312
    v_mfma_f32_16x16x32_bf16 a[68:71], a[148:151], a[112:115], a[68:71]
    ds_read_b64_tr_b16 v[212:213], v217 offset:10368
    v_mfma_f32_16x16x32_bf16 a[64:67], a[144:147], a[112:115], a[64:67]
    buffer_load_dwordx4 v251, s[52:55], s33 offen offset:2048 lds
    v_mfma_f32_16x16x32_bf16 a[64:67], a[164:167], a[132:135], a[64:67]
    ds_read_b64_tr_b16 v[214:215], v217 offset:15488
    v_mfma_f32_16x16x32_bf16 a[60:63], a[160:163], a[132:135], a[60:63]
    ds_read_b128 v[172:175], v216 offset:14336
    v_mfma_f32_16x16x32_bf16 a[60:63], a[140:143], a[112:115], a[60:63]
    v_mfma_f32_16x16x32_bf16 a[80:83], a[140:143], a[116:119], a[80:83]
    v_mfma_f32_16x16x32_bf16 a[80:83], a[160:163], a[136:139], a[80:83]
    buffer_load_dwordx4 v252, s[52:55], s33 offen offset:3072 lds
    v_mfma_f32_16x16x32_bf16 a[84:87], a[164:167], a[136:139], a[84:87]
    s_add_u32 m0, s76, 106496
    v_mfma_f32_16x16x32_bf16 a[84:87], a[144:147], a[116:119], a[84:87]
    s_add_u32 s77, s77, 81920
    v_mfma_f32_16x16x32_bf16 a[88:91], a[148:151], a[116:119], a[88:91]
    v_mfma_f32_16x16x32_bf16 a[88:91], a[168:171], a[136:139], a[88:91]
    v_mfma_f32_16x16x32_bf16 a[92:95], a[172:175], a[136:139], a[92:95]
    s_sub_u32 s36, s36, 1
    buffer_load_dwordx4 v253, s[52:55], s33 offen lds
    v_mfma_f32_16x16x32_bf16 a[92:95], a[152:155], a[116:119], a[92:95]
    s_cmp_lg_u32 s36, 0
    v_mfma_f32_16x16x32_bf16 a[96:99], a[156:159], a[116:119], a[96:99]
    s_waitcnt vmcnt(20) lgkmcnt(0)
    v_mfma_f32_16x16x32_bf16 a[96:99], a[176:179], a[136:139], a[96:99]

    s_barrier
    s_cbranch_scc1 L_op
    s_cmp_ge_u32 s79, 1
    s_cbranch_scc1 L_exch
    s_cmp_eq_u32 s84, 0
    s_cselect_b32 s45, 48, 73
    s_mov_b32 s36, 6
    s_mul_i32 s77, s45, 81920
    s_mul_i32 s78, s45, 20480
    s_mov_b32 s79, 1

    s_waitcnt vmcnt(9)
    v_readfirstlane_b32 s43, v255
    s_mov_b32 s44, 0x80000
    L_chk4:
    s_and_b32 s43, s43, s86
    s_cmp_eq_u32 s43, s86
    s_cbranch_scc1 L_ok4
    s_sub_u32 s44, s44, 1
    s_cbranch_scc1 L_ok4
    buffer_load_dword v255, off, s[68:71], s81 offset:128 sc1
    s_waitcnt vmcnt(0)
    v_readfirstlane_b32 s43, v255
    s_branch L_chk4
    L_ok4:
    s_branch L_op
L_exch:
    s_cmp_eq_u32 s84, 0
    s_cbranch_scc0 L_x1
    v_mfma_f32_16x16x32_bf16 a[0:3], v[176:179], v[136:139], a[0:3]
    s_add_u32 m0, s76, 122880
    ds_read_b64_tr_b16 a[140:141], v220 offset:0
    v_mfma_f32_16x16x32_bf16 a[0:3], v[196:199], v[156:159], a[0:3]
    s_lshl_b32 s45, s82, 13
    buffer_load_dwordx4 v254, s[56:59], s78 offen sc1 lds
    v_mfma_f32_16x16x32_bf16 a[4:7], v[200:203], v[156:159], a[4:7]
    s_lshl_b32 s46, s83, 13
    ds_read_b64_tr_b16 a[142:143], v220 offset:5120
    v_mfma_f32_16x16x32_bf16 a[4:7], v[180:183], v[136:139], a[4:7]
    s_lshr_b32 s47, s82, 2
    ds_read_b128 a[100:103], v219 offset:0
    v_mfma_f32_16x16x32_bf16 a[8:11], v[184:187], v[136:139], a[8:11]
    s_lshl_b32 s47, s47, 7
    ds_read_b64_tr_b16 a[144:145], v221 offset:0
    v_mfma_f32_16x16x32_bf16 a[8:11], v[204:207], v[156:159], a[8:11]
    s_lshl_b32 s42, s24, 2
    ds_read_b64_tr_b16 a[146:147], v221 offset:5120
    v_mfma_f32_16x16x32_bf16 a[12:15], v[208:211], v[156:159], a[12:15]
    s_add_u32 s47, s47, s42
    buffer_load_dwordx4 v254, s[56:59], s78 offen offset:1024 sc1 lds
    v_mfma_f32_16x16x32_bf16 a[12:15], v[188:191], v[136:139], a[12:15]
    s_add_u32 s47, s47, 71303168
    ds_read_b128 a[104:107], v219 offset:1024
    v_mfma_f32_16x16x32_bf16 a[16:19], v[192:195], v[136:139], a[16:19]
    s_xor_b32 s42, s47, 128
    ds_read_b64_tr_b16 a[148:149], v220 offset:64
    v_mfma_f32_16x16x32_bf16 a[16:19], v[212:215], v[156:159], a[16:19]
    s_mov_b32 s86, 1
    ds_read_b64_tr_b16 a[150:151], v220 offset:5184
    v_mfma_f32_16x16x32_bf16 a[36:39], v[212:215], v[160:163], a[36:39]
    s_add_u32 s29, s45, 4096
    ds_read_b128 a[108:111], v219 offset:2048
    v_mfma_f32_16x16x32_bf16 a[36:39], v[192:195], v[140:143], a[36:39]
    s_add_u32 s34, s26, 81920
    buffer_load_dwordx4 v254, s[56:59], s78 offen offset:2048 sc1 lds
    v_mfma_f32_16x16x32_bf16 a[32:35], v[188:191], v[140:143], a[32:35]
    s_add_u32 s35, s34, 5632
    ds_read_b64_tr_b16 a[152:153], v221 offset:64
    v_mfma_f32_16x16x32_bf16 a[32:35], v[208:211], v[160:163], a[32:35]
    s_mov_b32 s37, 176
    ds_read_b64_tr_b16 a[154:155], v221 offset:5184
    v_mfma_f32_16x16x32_bf16 a[28:31], v[204:207], v[160:163], a[28:31]
    s_mov_b32 s40, 2560
    ds_read_b128 a[112:115], v219 offset:3072
    v_mfma_f32_16x16x32_bf16 a[28:31], v[184:187], v[140:143], a[28:31]
    ds_read_b64_tr_b16 a[156:157], v220 offset:128
    v_bfe_u32 v228, v254, 4, 4
    v_mfma_f32_16x16x32_bf16 a[24:27], v[180:183], v[140:143], a[24:27]
    buffer_load_dwordx4 v254, s[56:59], s78 offen offset:3072 sc1 lds
    v_mfma_f32_16x16x32_bf16 a[24:27], v[200:203], v[160:163], a[24:27]
    s_add_u32 m0, s76, 126976
    ds_read_b64_tr_b16 a[158:159], v220 offset:5248
    v_mul_u32_u24 v228, 176, v228
    v_mfma_f32_16x16x32_bf16 a[20:23], v[196:199], v[160:163], a[20:23]
    s_add_u32 s32, s78, 4096
    ds_read_b128 a[116:119], v219 offset:4096
    v_lshrrev_b32 v229, 8, v254
    v_mfma_f32_16x16x32_bf16 a[20:23], v[176:179], v[140:143], a[20:23]
    s_add_u32 s78, s78, 20480
    ds_read_b64_tr_b16 a[160:161], v220 offset:10240
    v_lshl_add_u32 v228, v229, 3, v228
    v_mfma_f32_16x16x32_bf16 a[40:43], v[176:179], v[144:147], a[40:43]
    ds_read_b64_tr_b16 a[162:163], v220 offset:15360
    v_add_u32 v0, s34, v228
    v_mfma_f32_16x16x32_bf16 a[40:43], v[196:199], v[164:167], a[40:43]
    buffer_load_dwordx4 v254, s[56:59], s32 offen sc1 lds
    v_mfma_f32_16x16x32_bf16 a[44:47], v[200:203], v[164:167], a[44:47]
    s_add_u32 m0, s76, 143360
    ds_read_b128 a[120:123], v219 offset:10240
    v_lshrrev_b32 v230, 4, v254
    v_mfma_f32_16x16x32_bf16 a[44:47], v[180:183], v[144:147], a[44:47]
    s_mov_b32 s33, s77
    ds_read_b64_tr_b16 a[164:165], v221 offset:10240
    v_add_u32 v228, 0, v230
    v_mfma_f32_16x16x32_bf16 a[48:51], v[184:187], v[144:147], a[48:51]
    ds_read_b64_tr_b16 a[166:167], v221 offset:15360
    v_mul_u32_u24 v229, 205, v228
    v_mfma_f32_16x16x32_bf16 a[48:51], v[204:207], v[164:167], a[48:51]
    ds_read_b128 a[124:127], v219 offset:11264
    v_lshrrev_b32 v229, 11, v229
    v_mfma_f32_16x16x32_bf16 a[52:55], v[208:211], v[164:167], a[52:55]
    buffer_load_dwordx4 v249, s[52:55], s33 offen lds
    v_mfma_f32_16x16x32_bf16 a[52:55], v[188:191], v[144:147], a[52:55]
    ds_read_b64_tr_b16 a[168:169], v220 offset:10304
    v_lshlrev_b32 v228, 4, v228
    v_mfma_f32_16x16x32_bf16 a[56:59], v[192:195], v[144:147], a[56:59]
    ds_read_b64_tr_b16 a[170:171], v220 offset:15424
    v_mul_u32_u24 v231, 16, v229
    v_mfma_f32_16x16x32_bf16 a[56:59], v[212:215], v[164:167], a[56:59]
    ds_read_b128 a[128:131], v219 offset:12288
    v_add3_u32 v1, v231, v228, s34
    v_mfma_f32_16x16x32_bf16 a[76:79], v[212:215], v[168:171], a[76:79]
    ds_read_b64_tr_b16 a[172:173], v221 offset:10304
    v_mul_u32_u24 v231, 2400, v229
    v_mfma_f32_16x16x32_bf16 a[76:79], v[192:195], v[148:151], a[76:79]
    buffer_load_dwordx4 v250, s[52:55], s33 offen offset:1024 lds
    v_mfma_f32_16x16x32_bf16 a[72:75], v[188:191], v[148:151], a[72:75]
    ds_read_b64_tr_b16 a[174:175], v221 offset:15424
    v_add_u32 v8, v231, v228
    v_mfma_f32_16x16x32_bf16 a[72:75], v[208:211], v[168:171], a[72:75]
    ds_read_b128 a[132:135], v219 offset:13312
    v_add_u32 v228, 64, v230
    v_mfma_f32_16x16x32_bf16 a[68:71], v[204:207], v[168:171], a[68:71]
    ds_read_b64_tr_b16 a[176:177], v220 offset:10368
    v_mul_u32_u24 v229, 205, v228
    v_mfma_f32_16x16x32_bf16 a[68:71], v[184:187], v[148:151], a[68:71]
    ds_read_b64_tr_b16 a[178:179], v220 offset:15488
    v_lshrrev_b32 v229, 11, v229
    v_mfma_f32_16x16x32_bf16 a[64:67], v[180:183], v[148:151], a[64:67]
    buffer_load_dwordx4 v251, s[52:55], s33 offen offset:2048 lds
    v_mfma_f32_16x16x32_bf16 a[64:67], v[200:203], v[168:171], a[64:67]
    ds_read_b128 a[136:139], v219 offset:14336
    v_lshlrev_b32 v228, 4, v228
    v_mfma_f32_16x16x32_bf16 a[60:63], v[196:199], v[168:171], a[60:63]
    v_mul_u32_u24 v231, 16, v229
    v_add3_u32 v2, v231, v228, s34
    v_mfma_f32_16x16x32_bf16 a[60:63], v[176:179], v[148:151], a[60:63]
    v_mul_u32_u24 v231, 2400, v229
    v_add_u32 v9, v231, v228
    v_mfma_f32_16x16x32_bf16 a[80:83], v[176:179], v[152:155], a[80:83]
    v_add_u32 v228, 128, v230
    v_mul_u32_u24 v229, 205, v228
    v_mfma_f32_16x16x32_bf16 a[80:83], v[196:199], v[172:175], a[80:83]
    buffer_load_dwordx4 v252, s[52:55], s33 offen offset:3072 lds
    v_mfma_f32_16x16x32_bf16 a[84:87], v[200:203], v[172:175], a[84:87]
    s_add_u32 m0, s76, 147456
    v_lshrrev_b32 v229, 11, v229
    v_lshlrev_b32 v228, 4, v228
    v_mfma_f32_16x16x32_bf16 a[84:87], v[180:183], v[152:155], a[84:87]
    s_add_u32 s77, s77, 81920
    v_mul_u32_u24 v231, 16, v229
    v_add3_u32 v3, v231, v228, s34
    v_mfma_f32_16x16x32_bf16 a[88:91], v[184:187], v[152:155], a[88:91]
    v_mul_u32_u24 v231, 2400, v229
    v_add_u32 v10, v231, v228
    v_mfma_f32_16x16x32_bf16 a[88:91], v[204:207], v[172:175], a[88:91]
    v_add_u32 v228, 192, v230
    v_mul_u32_u24 v229, 205, v228
    v_mfma_f32_16x16x32_bf16 a[92:95], v[208:211], v[172:175], a[92:95]
    buffer_load_dwordx4 v253, s[52:55], s33 offen lds
    v_mfma_f32_16x16x32_bf16 a[92:95], v[188:191], v[152:155], a[92:95]
    v_lshrrev_b32 v229, 11, v229
    v_lshlrev_b32 v228, 4, v228
    v_mfma_f32_16x16x32_bf16 a[96:99], v[192:195], v[152:155], a[96:99]
    s_waitcnt vmcnt(20) lgkmcnt(0)
    v_mul_u32_u24 v231, 16, v229
    v_add3_u32 v4, v231, v228, s34
    v_mfma_f32_16x16x32_bf16 a[96:99], v[212:215], v[172:175], a[96:99]

    s_barrier
    v_mfma_f32_16x16x32_bf16 a[0:3], a[140:143], a[100:103], a[0:3]
    ds_read_b64_tr_b16 v[176:177], v223 offset:0
    v_mul_u32_u24 v231, 2400, v229
    v_mfma_f32_16x16x32_bf16 a[0:3], a[160:163], a[120:123], a[0:3]
    ds_read_b64_tr_b16 v[178:179], v223 offset:5120
    v_add_u32 v11, v231, v228
    v_mfma_f32_16x16x32_bf16 a[4:7], a[164:167], a[120:123], a[4:7]
    ds_read_b128 v[136:139], v222 offset:0
    v_add_u32 v228, 256, v230
    v_mfma_f32_16x16x32_bf16 a[4:7], a[144:147], a[100:103], a[4:7]
    ds_read_b64_tr_b16 v[180:181], v224 offset:0
    v_mul_u32_u24 v229, 205, v228
    v_mfma_f32_16x16x32_bf16 a[8:11], a[148:151], a[100:103], a[8:11]
    ds_read_b64_tr_b16 v[182:183], v224 offset:5120
    v_lshrrev_b32 v229, 11, v229
    v_mfma_f32_16x16x32_bf16 a[8:11], a[168:171], a[120:123], a[8:11]
    ds_read_b128 v[140:143], v222 offset:1024
    v_lshlrev_b32 v228, 4, v228
    v_mfma_f32_16x16x32_bf16 a[12:15], a[172:175], a[120:123], a[12:15]
    ds_read_b64_tr_b16 v[184:185], v223 offset:64
    v_mul_u32_u24 v231, 16, v229
    v_mfma_f32_16x16x32_bf16 a[12:15], a[152:155], a[100:103], a[12:15]
    ds_read_b64_tr_b16 v[186:187], v223 offset:5184
    v_add3_u32 v5, v231, v228, s34
    v_mfma_f32_16x16x32_bf16 a[16:19], a[156:159], a[100:103], a[16:19]
    ds_read_b128 v[144:147], v222 offset:2048
    v_mul_u32_u24 v231, 2400, v229
    v_mfma_f32_16x16x32_bf16 a[16:19], a[176:179], a[120:123], a[16:19]
    ds_read_b64_tr_b16 v[188:189], v224 offset:64
    v_add_u32 v12, v231, v228
    v_mfma_f32_16x16x32_bf16 a[36:39], a[176:179], a[124:127], a[36:39]
    ds_read_b64_tr_b16 v[190:191], v224 offset:5184
    v_lshrrev_b32 v228, 6, v254
    v_mfma_f32_16x16x32_bf16 a[36:39], a[156:159], a[104:107], a[36:39]
    ds_read_b128 v[148:151], v222 offset:3072
    v_and_b32 v229, 48, v254
    v_mfma_f32_16x16x32_bf16 a[32:35], a[152:155], a[104:107], a[32:35]
    ds_read_b64_tr_b16 v[192:193], v223 offset:128
    v_mad_u32_u24 v231, v228, s37, v229
    v_mfma_f32_16x16x32_bf16 a[32:35], a[172:175], a[124:127], a[32:35]
    ds_read_b64_tr_b16 v[194:195], v223 offset:5248
    v_add_u32 v6, s35, v231
    v_mfma_f32_16x16x32_bf16 a[28:31], a[168:171], a[124:127], a[28:31]
    ds_read_b128 v[152:155], v222 offset:4096
    v_mad_u32_u24 v13, v228, s40, v229
    v_mfma_f32_16x16x32_bf16 a[28:31], a[148:151], a[104:107], a[28:31]
    ds_read_b64_tr_b16 v[196:197], v223 offset:10240
    v_mov_b32 v236, 1
    v_mfma_f32_16x16x32_bf16 a[24:27], a[144:147], a[104:107], a[24:27]
    ds_read_b64_tr_b16 v[198:199], v223 offset:15360
    v_mfma_f32_16x16x32_bf16 a[24:27], a[164:167], a[124:127], a[24:27]
    ds_read_b128 v[156:159], v222 offset:10240
    v_mfma_f32_16x16x32_bf16 a[20:23], a[160:163], a[124:127], a[20:23]
    ds_read_b64_tr_b16 v[200:201], v224 offset:10240
    v_mfma_f32_16x16x32_bf16 a[20:23], a[140:143], a[104:107], a[20:23]
    ds_read_b64_tr_b16 v[202:203], v224 offset:15360
    v_mfma_f32_16x16x32_bf16 a[40:43], a[140:143], a[108:111], a[40:43]
    ds_read_b128 v[160:163], v222 offset:11264
    v_mfma_f32_16x16x32_bf16 a[40:43], a[160:163], a[128:131], a[40:43]
    ds_read_b64_tr_b16 v[204:205], v223 offset:10304
    v_mfma_f32_16x16x32_bf16 a[44:47], a[164:167], a[128:131], a[44:47]
    ds_read_b64_tr_b16 v[206:207], v223 offset:15424
    v_mfma_f32_16x16x32_bf16 a[44:47], a[144:147], a[108:111], a[44:47]
    ds_read_b128 v[164:167], v222 offset:12288
    v_mfma_f32_16x16x32_bf16 a[48:51], a[148:151], a[108:111], a[48:51]
    ds_read_b64_tr_b16 v[208:209], v224 offset:10304
    v_mfma_f32_16x16x32_bf16 a[48:51], a[168:171], a[128:131], a[48:51]
    ds_read_b64_tr_b16 v[210:211], v224 offset:15424
    v_mfma_f32_16x16x32_bf16 a[52:55], a[172:175], a[128:131], a[52:55]
    ds_read_b128 v[168:171], v222 offset:13312
    v_mfma_f32_16x16x32_bf16 a[52:55], a[152:155], a[108:111], a[52:55]
    ds_read_b64_tr_b16 v[212:213], v223 offset:10368
    v_mfma_f32_16x16x32_bf16 a[56:59], a[156:159], a[108:111], a[56:59]
    ds_read_b64_tr_b16 v[214:215], v223 offset:15488
    v_mfma_f32_16x16x32_bf16 a[56:59], a[176:179], a[128:131], a[56:59]
    ds_read_b128 v[172:175], v222 offset:14336
    v_mfma_f32_16x16x32_bf16 a[76:79], a[176:179], a[132:135], a[76:79]
    v_mfma_f32_16x16x32_bf16 a[76:79], a[156:159], a[112:115], a[76:79]
    v_mfma_f32_16x16x32_bf16 a[72:75], a[152:155], a[112:115], a[72:75]
    v_mfma_f32_16x16x32_bf16 a[72:75], a[172:175], a[132:135], a[72:75]
    v_mfma_f32_16x16x32_bf16 a[68:71], a[168:171], a[132:135], a[68:71]
    v_mfma_f32_16x16x32_bf16 a[68:71], a[148:151], a[112:115], a[68:71]
    v_mfma_f32_16x16x32_bf16 a[64:67], a[144:147], a[112:115], a[64:67]
    v_mfma_f32_16x16x32_bf16 a[64:67], a[164:167], a[132:135], a[64:67]
    v_mfma_f32_16x16x32_bf16 a[60:63], a[160:163], a[132:135], a[60:63]
    v_mfma_f32_16x16x32_bf16 a[60:63], a[140:143], a[112:115], a[60:63]
    v_mfma_f32_16x16x32_bf16 a[80:83], a[140:143], a[116:119], a[80:83]
    v_mfma_f32_16x16x32_bf16 a[80:83], a[160:163], a[136:139], a[80:83]
    v_mfma_f32_16x16x32_bf16 a[84:87], a[164:167], a[136:139], a[84:87]
    v_mfma_f32_16x16x32_bf16 a[84:87], a[144:147], a[116:119], a[84:87]
    v_mfma_f32_16x16x32_bf16 a[88:91], a[148:151], a[116:119], a[88:91]
    v_mfma_f32_16x16x32_bf16 a[88:91], a[168:171], a[136:139], a[88:91]
    v_mfma_f32_16x16x32_bf16 a[92:95], a[172:175], a[136:139], a[92:95]
    v_mfma_f32_16x16x32_bf16 a[92:95], a[152:155], a[116:119], a[92:95]
    v_mfma_f32_16x16x32_bf16 a[96:99], a[156:159], a[116:119], a[96:99]
    s_waitcnt vmcnt(10) lgkmcnt(0)
    v_mfma_f32_16x16x32_bf16 a[96:99], a[176:179], a[136:139], a[96:99]

    s_barrier
    v_mfma_f32_16x16x32_bf16 a[0:3], v[176:179], v[136:139], a[0:3]
    ds_read_b64_tr_b16 a[140:141], v226 offset:0
    v_mfma_f32_16x16x32_bf16 a[0:3], v[196:199], v[156:159], a[0:3]
    ds_read_b64_tr_b16 a[142:143], v226 offset:5120
    v_mfma_f32_16x16x32_bf16 a[4:7], v[200:203], v[156:159], a[4:7]
    ds_read_b128 a[100:103], v225 offset:0
    v_mfma_f32_16x16x32_bf16 a[4:7], v[180:183], v[136:139], a[4:7]
    ds_read_b64_tr_b16 a[144:145], v227 offset:0
    v_mfma_f32_16x16x32_bf16 a[8:11], v[184:187], v[136:139], a[8:11]
    ds_read_b64_tr_b16 a[146:147], v227 offset:5120
    v_mfma_f32_16x16x32_bf16 a[8:11], v[204:207], v[156:159], a[8:11]
    ds_read_b128 a[104:107], v225 offset:1024
    v_mfma_f32_16x16x32_bf16 a[12:15], v[208:211], v[156:159], a[12:15]
    ds_read_b64_tr_b16 a[148:149], v226 offset:64
    v_mfma_f32_16x16x32_bf16 a[12:15], v[188:191], v[136:139], a[12:15]
    ds_read_b64_tr_b16 a[150:151], v226 offset:5184
    v_mfma_f32_16x16x32_bf16 a[16:19], v[192:195], v[136:139], a[16:19]
    ds_read_b128 a[108:111], v225 offset:2048
    v_mfma_f32_16x16x32_bf16 a[16:19], v[212:215], v[156:159], a[16:19]
    ds_read_b64_tr_b16 a[152:153], v227 offset:64
    v_mfma_f32_16x16x32_bf16 a[36:39], v[212:215], v[160:163], a[36:39]
    ds_read_b64_tr_b16 a[154:155], v227 offset:5184
    v_mfma_f32_16x16x32_bf16 a[36:39], v[192:195], v[140:143], a[36:39]
    ds_read_b128 a[112:115], v225 offset:3072
    v_mfma_f32_16x16x32_bf16 a[32:35], v[188:191], v[140:143], a[32:35]
    ds_read_b64_tr_b16 a[156:157], v226 offset:128
    v_mfma_f32_16x16x32_bf16 a[32:35], v[208:211], v[160:163], a[32:35]
    ds_read_b64_tr_b16 a[158:159], v226 offset:5248
    v_mfma_f32_16x16x32_bf16 a[28:31], v[204:207], v[160:163], a[28:31]
    ds_read_b128 a[116:119], v225 offset:4096
    v_mfma_f32_16x16x32_bf16 a[28:31], v[184:187], v[140:143], a[28:31]
    ds_read_b64_tr_b16 a[160:161], v226 offset:10240
    v_mfma_f32_16x16x32_bf16 a[24:27], v[180:183], v[140:143], a[24:27]
    ds_read_b64_tr_b16 a[162:163], v226 offset:15360
    v_mfma_f32_16x16x32_bf16 a[24:27], v[200:203], v[160:163], a[24:27]
    ds_read_b128 a[120:123], v225 offset:10240
    v_mfma_f32_16x16x32_bf16 a[20:23], v[196:199], v[160:163], a[20:23]
    ds_read_b64_tr_b16 a[164:165], v227 offset:10240
    v_mfma_f32_16x16x32_bf16 a[20:23], v[176:179], v[140:143], a[20:23]
    ds_read_b64_tr_b16 a[166:167], v227 offset:15360
    v_mfma_f32_16x16x32_bf16 a[40:43], v[176:179], v[144:147], a[40:43]
    ds_read_b128 a[124:127], v225 offset:11264
    v_mfma_f32_16x16x32_bf16 a[40:43], v[196:199], v[164:167], a[40:43]
    ds_read_b64_tr_b16 a[168:169], v226 offset:10304
    v_mfma_f32_16x16x32_bf16 a[44:47], v[200:203], v[164:167], a[44:47]
    ds_read_b64_tr_b16 a[170:171], v226 offset:15424
    v_mfma_f32_16x16x32_bf16 a[44:47], v[180:183], v[144:147], a[44:47]
    ds_read_b128 a[128:131], v225 offset:12288
    v_mfma_f32_16x16x32_bf16 a[48:51], v[184:187], v[144:147], a[48:51]
    ds_read_b64_tr_b16 a[172:173], v227 offset:10304
    v_mfma_f32_16x16x32_bf16 a[48:51], v[204:207], v[164:167], a[48:51]
    ds_read_b64_tr_b16 a[174:175], v227 offset:15424
    v_mfma_f32_16x16x32_bf16 a[52:55], v[208:211], v[164:167], a[52:55]
    ds_read_b128 a[132:135], v225 offset:13312
    v_mfma_f32_16x16x32_bf16 a[52:55], v[188:191], v[144:147], a[52:55]
    ds_read_b64_tr_b16 a[176:177], v226 offset:10368
    v_mfma_f32_16x16x32_bf16 a[56:59], v[192:195], v[144:147], a[56:59]
    ds_read_b64_tr_b16 a[178:179], v226 offset:15488
    v_mfma_f32_16x16x32_bf16 a[56:59], v[212:215], v[164:167], a[56:59]
    ds_read_b128 a[136:139], v225 offset:14336
    v_mfma_f32_16x16x32_bf16 a[76:79], v[212:215], v[168:171], a[76:79]
    v_mfma_f32_16x16x32_bf16 a[76:79], v[192:195], v[148:151], a[76:79]
    v_mfma_f32_16x16x32_bf16 a[72:75], v[188:191], v[148:151], a[72:75]
    v_mfma_f32_16x16x32_bf16 a[72:75], v[208:211], v[168:171], a[72:75]
    v_mfma_f32_16x16x32_bf16 a[68:71], v[204:207], v[168:171], a[68:71]
    v_mfma_f32_16x16x32_bf16 a[68:71], v[184:187], v[148:151], a[68:71]
    v_mfma_f32_16x16x32_bf16 a[64:67], v[180:183], v[148:151], a[64:67]
    v_mfma_f32_16x16x32_bf16 a[64:67], v[200:203], v[168:171], a[64:67]
    v_mfma_f32_16x16x32_bf16 a[60:63], v[196:199], v[168:171], a[60:63]
    v_mfma_f32_16x16x32_bf16 a[60:63], v[176:179], v[148:151], a[60:63]
    v_mfma_f32_16x16x32_bf16 a[80:83], v[176:179], v[152:155], a[80:83]
    v_mfma_f32_16x16x32_bf16 a[80:83], v[196:199], v[172:175], a[80:83]
    v_mfma_f32_16x16x32_bf16 a[84:87], v[200:203], v[172:175], a[84:87]
    v_mfma_f32_16x16x32_bf16 a[84:87], v[180:183], v[152:155], a[84:87]
    v_mfma_f32_16x16x32_bf16 a[88:91], v[184:187], v[152:155], a[88:91]
    v_mfma_f32_16x16x32_bf16 a[88:91], v[204:207], v[172:175], a[88:91]
    v_mfma_f32_16x16x32_bf16 a[92:95], v[208:211], v[172:175], a[92:95]
    v_mfma_f32_16x16x32_bf16 a[92:95], v[188:191], v[152:155], a[92:95]
    v_mfma_f32_16x16x32_bf16 a[96:99], v[192:195], v[152:155], a[96:99]
    s_waitcnt vmcnt(0) lgkmcnt(0)
    v_mfma_f32_16x16x32_bf16 a[96:99], v[212:215], v[172:175], a[96:99]

    s_barrier
    v_mfma_f32_16x16x32_bf16 a[48:51], a[148:151], a[108:111], a[48:51]
    ds_read_b64_tr_b16 v[176:177], v217 offset:0
    v_mfma_f32_16x16x32_bf16 a[48:51], a[168:171], a[128:131], a[48:51]
    ds_read_b64_tr_b16 v[178:179], v217 offset:5120
    v_mfma_f32_16x16x32_bf16 a[52:55], a[172:175], a[128:131], a[52:55]
    ds_read_b128 v[136:139], v216 offset:0
    v_mfma_f32_16x16x32_bf16 a[52:55], a[152:155], a[108:111], a[52:55]
    ds_read_b64_tr_b16 v[180:181], v218 offset:0
    v_mfma_f32_16x16x32_bf16 a[56:59], a[156:159], a[108:111], a[56:59]
    ds_read_b64_tr_b16 v[182:183], v218 offset:5120
    v_mfma_f32_16x16x32_bf16 a[56:59], a[176:179], a[128:131], a[56:59]
    ds_read_b128 v[140:143], v216 offset:1024
    v_mfma_f32_16x16x32_bf16 a[60:63], a[160:163], a[132:135], a[60:63]
    ds_read_b64_tr_b16 v[184:185], v217 offset:64
    v_mfma_f32_16x16x32_bf16 a[60:63], a[140:143], a[112:115], a[60:63]
    ds_read_b64_tr_b16 v[186:187], v217 offset:5184
    v_mfma_f32_16x16x32_bf16 a[64:67], a[144:147], a[112:115], a[64:67]
    ds_read_b128 v[144:147], v216 offset:2048
    v_mfma_f32_16x16x32_bf16 a[64:67], a[164:167], a[132:135], a[64:67]
    ds_read_b64_tr_b16 v[188:189], v218 offset:64
    v_mfma_f32_16x16x32_bf16 a[68:71], a[168:171], a[132:135], a[68:71]
    ds_read_b64_tr_b16 v[190:191], v218 offset:5184
    v_mfma_f32_16x16x32_bf16 a[68:71], a[148:151], a[112:115], a[68:71]
    ds_read_b128 v[148:151], v216 offset:3072
    v_mfma_f32_16x16x32_bf16 a[72:75], a[152:155], a[112:115], a[72:75]
    ds_read_b64_tr_b16 v[192:193], v217 offset:128
    v_mfma_f32_16x16x32_bf16 a[72:75], a[172:175], a[132:135], a[72:75]
    ds_read_b64_tr_b16 v[194:195], v217 offset:5248
    v_mfma_f32_16x16x32_bf16 a[76:79], a[176:179], a[132:135], a[76:79]
    ds_read_b128 v[152:155], v216 offset:4096
    v_mfma_f32_16x16x32_bf16 a[76:79], a[156:159], a[112:115], a[76:79]
    ds_read_b64_tr_b16 v[196:197], v217 offset:10240
    v_mfma_f32_16x16x32_bf16 a[80:83], a[140:143], a[116:119], a[80:83]
    ds_read_b64_tr_b16 v[198:199], v217 offset:15360
    v_mfma_f32_16x16x32_bf16 a[80:83], a[160:163], a[136:139], a[80:83]
    ds_read_b128 v[156:159], v216 offset:10240
    v_mfma_f32_16x16x32_bf16 a[84:87], a[164:167], a[136:139], a[84:87]
    ds_read_b64_tr_b16 v[200:201], v218 offset:10240
    v_mfma_f32_16x16x32_bf16 a[84:87], a[144:147], a[116:119], a[84:87]
    ds_read_b64_tr_b16 v[202:203], v218 offset:15360
    v_mfma_f32_16x16x32_bf16 a[88:91], a[148:151], a[116:119], a[88:91]
    ds_read_b128 v[160:163], v216 offset:11264
    v_mfma_f32_16x16x32_bf16 a[88:91], a[168:171], a[136:139], a[88:91]
    ds_read_b64_tr_b16 v[204:205], v217 offset:10304
    v_mfma_f32_16x16x32_bf16 a[92:95], a[172:175], a[136:139], a[92:95]
    ds_read_b64_tr_b16 v[206:207], v217 offset:15424
    v_mfma_f32_16x16x32_bf16 a[92:95], a[152:155], a[116:119], a[92:95]
    ds_read_b128 v[164:167], v216 offset:12288
    v_mfma_f32_16x16x32_bf16 a[96:99], a[156:159], a[116:119], a[96:99]
    ds_read_b64_tr_b16 v[208:209], v218 offset:10304
    v_mfma_f32_16x16x32_bf16 a[96:99], a[176:179], a[136:139], a[96:99]
    ds_read_b64_tr_b16 v[210:211], v218 offset:15424
    v_mfma_f32_16x16x32_bf16 a[0:3], a[160:163], a[120:123], a[0:3]
    ds_read_b128 v[168:171], v216 offset:13312
    v_mfma_f32_16x16x32_bf16 a[0:3], a[140:143], a[100:103], a[0:3]
    ds_read_b64_tr_b16 v[212:213], v217 offset:10368
    v_mfma_f32_16x16x32_bf16 a[4:7], a[144:147], a[100:103], a[4:7]
    ds_read_b64_tr_b16 v[214:215], v217 offset:15488
    v_mfma_f32_16x16x32_bf16 a[4:7], a[164:167], a[120:123], a[4:7]
    ds_read_b128 v[172:175], v216 offset:14336
    v_mfma_f32_16x16x32_bf16 a[8:11], a[168:171], a[120:123], a[8:11]
    v_mfma_f32_16x16x32_bf16 a[8:11], a[148:151], a[100:103], a[8:11]
    v_mfma_f32_16x16x32_bf16 a[12:15], a[152:155], a[100:103], a[12:15]
    v_mfma_f32_16x16x32_bf16 a[12:15], a[172:175], a[120:123], a[12:15]
    v_mfma_f32_16x16x32_bf16 a[16:19], a[176:179], a[120:123], a[16:19]
    v_mfma_f32_16x16x32_bf16 a[16:19], a[156:159], a[100:103], a[16:19]
    v_mfma_f32_16x16x32_bf16 a[20:23], a[140:143], a[104:107], a[20:23]
    v_mfma_f32_16x16x32_bf16 a[20:23], a[160:163], a[124:127], a[20:23]
    s_waitcnt lgkmcnt(0)
    v_mfma_f32_16x16x32_bf16 a[48:51], v[184:187], v[144:147], a[48:51]
    v_mfma_f32_16x16x32_bf16 a[48:51], v[204:207], v[164:167], a[48:51]
    v_mfma_f32_16x16x32_bf16 a[52:55], v[208:211], v[164:167], a[52:55]
    v_mfma_f32_16x16x32_bf16 a[52:55], v[188:191], v[144:147], a[52:55]
    v_mfma_f32_16x16x32_bf16 a[56:59], v[192:195], v[144:147], a[56:59]
    v_mfma_f32_16x16x32_bf16 a[56:59], v[212:215], v[164:167], a[56:59]
    v_mfma_f32_16x16x32_bf16 a[60:63], v[196:199], v[168:171], a[60:63]
    v_mfma_f32_16x16x32_bf16 a[60:63], v[176:179], v[148:151], a[60:63]
    v_mfma_f32_16x16x32_bf16 a[64:67], v[180:183], v[148:151], a[64:67]
    v_mfma_f32_16x16x32_bf16 a[64:67], v[200:203], v[168:171], a[64:67]
    v_accvgpr_read_b32 v16, a48
    v_accvgpr_read_b32 v17, a49
    v_mfma_f32_16x16x32_bf16 a[68:71], v[204:207], v[168:171], a[68:71]
    v_accvgpr_read_b32 v18, a50
    v_accvgpr_read_b32 v19, a51
    v_mfma_f32_16x16x32_bf16 a[68:71], v[184:187], v[148:151], a[68:71]
    v_accvgpr_read_b32 v20, a52
    v_accvgpr_read_b32 v21, a53
    v_mfma_f32_16x16x32_bf16 a[72:75], v[188:191], v[148:151], a[72:75]
    v_accvgpr_read_b32 v22, a54
    v_accvgpr_read_b32 v23, a55
    v_mfma_f32_16x16x32_bf16 a[72:75], v[208:211], v[168:171], a[72:75]
    v_cvt_pk_bf16_f32 v80, v16, v17
    v_cvt_pk_bf16_f32 v81, v18, v19
    v_mfma_f32_16x16x32_bf16 a[76:79], v[212:215], v[168:171], a[76:79]
    v_cvt_pk_bf16_f32 v82, v20, v21
    v_cvt_pk_bf16_f32 v83, v22, v23
    v_mfma_f32_16x16x32_bf16 a[76:79], v[192:195], v[148:151], a[76:79]
    buffer_store_dwordx4 v[80:83], v254, s[64:67], s45 offen offset:0 sc1
    v_mfma_f32_16x16x32_bf16 a[80:83], v[176:179], v[152:155], a[80:83]
    v_accvgpr_read_b32 v24, a56
    v_accvgpr_read_b32 v25, a57
    v_mfma_f32_16x16x32_bf16 a[80:83], v[196:199], v[172:175], a[80:83]
    v_accvgpr_read_b32 v26, a58
    v_accvgpr_read_b32 v27, a59
    v_mfma_f32_16x16x32_bf16 a[84:87], v[200:203], v[172:175], a[84:87]
    v_accvgpr_read_b32 v28, a60
    v_accvgpr_read_b32 v29, a61
    v_mfma_f32_16x16x32_bf16 a[84:87], v[180:183], v[152:155], a[84:87]
    v_accvgpr_read_b32 v30, a62
    v_accvgpr_read_b32 v31, a63
    v_mfma_f32_16x16x32_bf16 a[88:91], v[184:187], v[152:155], a[88:91]
    v_cvt_pk_bf16_f32 v84, v24, v25
    v_cvt_pk_bf16_f32 v85, v26, v27
    v_mfma_f32_16x16x32_bf16 a[88:91], v[204:207], v[172:175], a[88:91]
    v_cvt_pk_bf16_f32 v86, v28, v29
    v_cvt_pk_bf16_f32 v87, v30, v31
    v_mfma_f32_16x16x32_bf16 a[92:95], v[208:211], v[172:175], a[92:95]
    buffer_store_dwordx4 v[84:87], v254, s[64:67], s45 offen offset:1024 sc1
    v_mfma_f32_16x16x32_bf16 a[92:95], v[188:191], v[152:155], a[92:95]
    v_accvgpr_read_b32 v32, a64
    v_accvgpr_read_b32 v33, a65
    v_mfma_f32_16x16x32_bf16 a[96:99], v[192:195], v[152:155], a[96:99]
    v_accvgpr_read_b32 v34, a66
    v_accvgpr_read_b32 v35, a67
    v_mfma_f32_16x16x32_bf16 a[96:99], v[212:215], v[172:175], a[96:99]
    v_accvgpr_read_b32 v36, a68
    v_accvgpr_read_b32 v37, a69
    v_mfma_f32_16x16x32_bf16 a[0:3], v[176:179], v[136:139], a[0:3]
    v_accvgpr_read_b32 v38, a70
    v_accvgpr_read_b32 v39, a71
    v_mfma_f32_16x16x32_bf16 a[0:3], v[196:199], v[156:159], a[0:3]
    v_cvt_pk_bf16_f32 v88, v32, v33
    v_cvt_pk_bf16_f32 v89, v34, v35
    v_mfma_f32_16x16x32_bf16 a[4:7], v[180:183], v[136:139], a[4:7]
    v_cvt_pk_bf16_f32 v90, v36, v37
    v_cvt_pk_bf16_f32 v91, v38, v39
    v_mfma_f32_16x16x32_bf16 a[4:7], v[200:203], v[156:159], a[4:7]
    buffer_store_dwordx4 v[88:91], v254, s[64:67], s45 offen offset:2048 sc1
    v_mfma_f32_16x16x32_bf16 a[8:11], v[184:187], v[136:139], a[8:11]
    v_accvgpr_read_b32 v40, a72
    v_accvgpr_read_b32 v41, a73
    v_mfma_f32_16x16x32_bf16 a[8:11], v[204:207], v[156:159], a[8:11]
    v_accvgpr_read_b32 v42, a74
    v_accvgpr_read_b32 v43, a75
    v_mfma_f32_16x16x32_bf16 a[12:15], v[188:191], v[136:139], a[12:15]
    v_accvgpr_read_b32 v44, a76
    v_accvgpr_read_b32 v45, a77
    v_mfma_f32_16x16x32_bf16 a[12:15], v[208:211], v[156:159], a[12:15]
    v_accvgpr_read_b32 v46, a78
    v_accvgpr_read_b32 v47, a79
    v_mfma_f32_16x16x32_bf16 a[16:19], v[192:195], v[136:139], a[16:19]
    v_cvt_pk_bf16_f32 v92, v40, v41
    v_cvt_pk_bf16_f32 v93, v42, v43
    v_mfma_f32_16x16x32_bf16 a[16:19], v[212:215], v[156:159], a[16:19]
    v_cvt_pk_bf16_f32 v94, v44, v45
    v_cvt_pk_bf16_f32 v95, v46, v47
    v_mfma_f32_16x16x32_bf16 a[20:23], v[176:179], v[140:143], a[20:23]
    buffer_store_dwordx4 v[92:95], v254, s[64:67], s45 offen offset:3072 sc1
    v_mfma_f32_16x16x32_bf16 a[20:23], v[196:199], v[160:163], a[20:23]
    v_accvgpr_read_b32 v48, a80
    v_accvgpr_read_b32 v49, a81
    v_mfma_f32_16x16x32_bf16 a[24:27], a[144:147], a[104:107], a[24:27]
    v_accvgpr_read_b32 v50, a82
    v_accvgpr_read_b32 v51, a83
    v_mfma_f32_16x16x32_bf16 a[24:27], a[164:167], a[124:127], a[24:27]
    v_accvgpr_read_b32 v52, a84
    v_accvgpr_read_b32 v53, a85
    v_mfma_f32_16x16x32_bf16 a[24:27], v[180:183], v[140:143], a[24:27]
    v_accvgpr_read_b32 v54, a86
    v_accvgpr_read_b32 v55, a87
    v_mfma_f32_16x16x32_bf16 a[24:27], v[200:203], v[160:163], a[24:27]
    v_cvt_pk_bf16_f32 v96, v48, v49
    v_cvt_pk_bf16_f32 v97, v50, v51
    v_mfma_f32_16x16x32_bf16 a[28:31], a[148:151], a[104:107], a[28:31]
    v_cvt_pk_bf16_f32 v98, v52, v53
    v_cvt_pk_bf16_f32 v99, v54, v55
    v_mfma_f32_16x16x32_bf16 a[28:31], a[168:171], a[124:127], a[28:31]
    buffer_store_dwordx4 v[96:99], v254, s[64:67], s29 offen offset:0 sc1
    v_mfma_f32_16x16x32_bf16 a[28:31], v[184:187], v[140:143], a[28:31]
    v_accvgpr_read_b32 v56, a88
    v_accvgpr_read_b32 v57, a89
    v_mfma_f32_16x16x32_bf16 a[28:31], v[204:207], v[160:163], a[28:31]
    v_accvgpr_read_b32 v58, a90
    v_accvgpr_read_b32 v59, a91
    v_mfma_f32_16x16x32_bf16 a[32:35], a[152:155], a[104:107], a[32:35]
    v_accvgpr_read_b32 v60, a92
    v_accvgpr_read_b32 v61, a93
    v_mfma_f32_16x16x32_bf16 a[32:35], a[172:175], a[124:127], a[32:35]
    v_accvgpr_read_b32 v62, a94
    v_accvgpr_read_b32 v63, a95
    v_mfma_f32_16x16x32_bf16 a[32:35], v[188:191], v[140:143], a[32:35]
    v_cvt_pk_bf16_f32 v100, v56, v57
    v_cvt_pk_bf16_f32 v101, v58, v59
    v_mfma_f32_16x16x32_bf16 a[32:35], v[208:211], v[160:163], a[32:35]
    v_cvt_pk_bf16_f32 v102, v60, v61
    v_cvt_pk_bf16_f32 v103, v62, v63
    v_mfma_f32_16x16x32_bf16 a[36:39], a[156:159], a[104:107], a[36:39]
    buffer_store_dwordx4 v[100:103], v254, s[64:67], s29 offen offset:1024 sc1
    v_mfma_f32_16x16x32_bf16 a[36:39], a[176:179], a[124:127], a[36:39]
    v_accvgpr_read_b32 v64, a96
    v_accvgpr_read_b32 v65, a97
    v_mfma_f32_16x16x32_bf16 a[36:39], v[192:195], v[140:143], a[36:39]
    v_accvgpr_read_b32 v66, a98
    v_accvgpr_read_b32 v67, a99
    v_mfma_f32_16x16x32_bf16 a[36:39], v[212:215], v[160:163], a[36:39]
    v_cvt_pk_bf16_f32 v104, v64, v65
    v_cvt_pk_bf16_f32 v105, v66, v67
    v_mfma_f32_16x16x32_bf16 a[40:43], a[140:143], a[108:111], a[40:43]
    buffer_store_dwordx4 v[104:107], v254, s[64:67], s29 offen offset:2048 sc1
    v_mfma_f32_16x16x32_bf16 a[40:43], a[160:163], a[128:131], a[40:43]
    v_mfma_f32_16x16x32_bf16 a[40:43], v[176:179], v[144:147], a[40:43]
    v_mfma_f32_16x16x32_bf16 a[40:43], v[196:199], v[164:167], a[40:43]
    v_mfma_f32_16x16x32_bf16 a[44:47], a[144:147], a[108:111], a[44:47]
    v_mfma_f32_16x16x32_bf16 a[44:47], a[164:167], a[128:131], a[44:47]
    v_mfma_f32_16x16x32_bf16 a[44:47], v[180:183], v[144:147], a[44:47]
    v_mfma_f32_16x16x32_bf16 a[44:47], v[200:203], v[164:167], a[44:47]
    buffer_load_dword v255, off, s[64:67], s42 sc1
    v_accvgpr_read_b32 v16, a0
    v_accvgpr_read_b32 v17, a1
    v_accvgpr_read_b32 v18, a2
    v_accvgpr_read_b32 v19, a3
    v_accvgpr_read_b32 v20, a4
    v_accvgpr_read_b32 v21, a5
    v_accvgpr_read_b32 v22, a6
    v_accvgpr_read_b32 v23, a7
    v_accvgpr_read_b32 v24, a8
    v_accvgpr_read_b32 v25, a9
    v_accvgpr_read_b32 v26, a10
    v_accvgpr_read_b32 v27, a11
    v_accvgpr_read_b32 v28, a12
    v_accvgpr_read_b32 v29, a13
    v_accvgpr_read_b32 v30, a14
    v_accvgpr_read_b32 v31, a15
    v_accvgpr_read_b32 v32, a16
    v_accvgpr_read_b32 v33, a17
    v_accvgpr_read_b32 v34, a18
    v_accvgpr_read_b32 v35, a19
    v_accvgpr_read_b32 v36, a20
    v_accvgpr_read_b32 v37, a21
    v_accvgpr_read_b32 v38, a22
    v_accvgpr_read_b32 v39, a23
    v_accvgpr_read_b32 v40, a24
    v_accvgpr_read_b32 v41, a25
    v_accvgpr_read_b32 v42, a26
    v_accvgpr_read_b32 v43, a27
    v_accvgpr_read_b32 v44, a28
    v_accvgpr_read_b32 v45, a29
    v_accvgpr_read_b32 v46, a30
    v_accvgpr_read_b32 v47, a31
    v_accvgpr_read_b32 v48, a32
    v_accvgpr_read_b32 v49, a33
    v_accvgpr_read_b32 v50, a34
    v_accvgpr_read_b32 v51, a35
    v_accvgpr_read_b32 v52, a36
    v_accvgpr_read_b32 v53, a37
    v_accvgpr_read_b32 v54, a38
    v_accvgpr_read_b32 v55, a39
    v_accvgpr_read_b32 v56, a40
    v_accvgpr_read_b32 v57, a41
    v_accvgpr_read_b32 v58, a42
    v_accvgpr_read_b32 v59, a43
    v_accvgpr_read_b32 v60, a44
    v_accvgpr_read_b32 v61, a45
    v_accvgpr_read_b32 v62, a46
    v_accvgpr_read_b32 v63, a47
    s_waitcnt vmcnt(0)
    buffer_store_dword v236, off, s[64:67], s47 sc1
    v_readfirstlane_b32 s43, v255
    s_mov_b32 s44, 0x80000
    L_chk5:
    s_and_b32 s43, s43, s86
    s_cmp_eq_u32 s43, s86
    s_cbranch_scc1 L_ok5
    s_sub_u32 s44, s44, 1
    s_cbranch_scc1 L_ok5
    buffer_load_dword v255, off, s[64:67], s42 sc1
    s_waitcnt vmcnt(0)
    v_readfirstlane_b32 s43, v255
    s_branch L_chk5
    L_ok5:
    buffer_load_dwordx4 v[108:111], v254, s[64:67], s46 offen offset:0 sc1
    buffer_load_dwordx4 v[112:115], v254, s[64:67], s46 offen offset:1024 sc1
    buffer_load_dwordx4 v[116:119], v254, s[64:67], s46 offen offset:2048 sc1
    buffer_load_dwordx4 v[120:123], v254, s[64:67], s46 offen offset:3072 sc1
    s_add_u32 s46, s46, 4096
    buffer_load_dwordx4 v[124:127], v254, s[64:67], s46 offen offset:0 sc1
    buffer_load_dwordx4 v[128:131], v254, s[64:67], s46 offen offset:1024 sc1
    s_waitcnt vmcnt(5)
    v_lshlrev_b32 v228, 16, v108
    v_and_b32 v229, 0xffff0000, v108
    v_lshlrev_b32 v230, 16, v109
    v_and_b32 v231, 0xffff0000, v109
    v_pk_add_f32 v[16:17], v[16:17], v[228:229]
    v_pk_add_f32 v[18:19], v[18:19], v[230:231]
    v_cvt_pk_bf16_f32 v16, v16, v17
    v_cvt_pk_bf16_f32 v17, v18, v19
    ds_write_b64 v0, v[16:17] offset:0
    v_lshlrev_b32 v232, 16, v110
    v_and_b32 v233, 0xffff0000, v110
    v_lshlrev_b32 v234, 16, v111
    v_and_b32 v235, 0xffff0000, v111
    v_pk_add_f32 v[20:21], v[20:21], v[232:233]
    v_pk_add_f32 v[22:23], v[22:23], v[234:235]
    v_cvt_pk_bf16_f32 v20, v20, v21
    v_cvt_pk_bf16_f32 v21, v22, v23
    ds_write_b64 v0, v[20:21] offset:32
    s_waitcnt vmcnt(4)
    v_lshlrev_b32 v228, 16, v112
    v_and_b32 v229, 0xffff0000, v112
    v_lshlrev_b32 v230, 16, v113
    v_and_b32 v231, 0xffff0000, v113
    v_pk_add_f32 v[24:25], v[24:25], v[228:229]
    v_pk_add_f32 v[26:27], v[26:27], v[230:231]
    v_cvt_pk_bf16_f32 v24, v24, v25
    v_cvt_pk_bf16_f32 v25, v26, v27
    ds_write_b64 v0, v[24:25] offset:64
    v_lshlrev_b32 v232, 16, v114
    v_and_b32 v233, 0xffff0000, v114
    v_lshlrev_b32 v234, 16, v115
    v_and_b32 v235, 0xffff0000, v115
    v_pk_add_f32 v[28:29], v[28:29], v[232:233]
    v_pk_add_f32 v[30:31], v[30:31], v[234:235]
    v_cvt_pk_bf16_f32 v28, v28, v29
    v_cvt_pk_bf16_f32 v29, v30, v31
    ds_write_b64 v0, v[28:29] offset:96
    s_waitcnt vmcnt(3)
    v_lshlrev_b32 v228, 16, v116
    v_and_b32 v229, 0xffff0000, v116
    v_lshlrev_b32 v230, 16, v117
    v_and_b32 v231, 0xffff0000, v117
    v_pk_add_f32 v[32:33], v[32:33], v[228:229]
    v_pk_add_f32 v[34:35], v[34:35], v[230:231]
    v_cvt_pk_bf16_f32 v32, v32, v33
    v_cvt_pk_bf16_f32 v33, v34, v35
    ds_write_b64 v0, v[32:33] offset:128
    v_lshlrev_b32 v232, 16, v118
    v_and_b32 v233, 0xffff0000, v118
    v_lshlrev_b32 v234, 16, v119
    v_and_b32 v235, 0xffff0000, v119
    v_pk_add_f32 v[36:37], v[36:37], v[232:233]
    v_pk_add_f32 v[38:39], v[38:39], v[234:235]
    v_cvt_pk_bf16_f32 v36, v36, v37
    v_cvt_pk_bf16_f32 v37, v38, v39
    ds_write_b64 v0, v[36:37] offset:2816
    s_waitcnt vmcnt(2)
    v_lshlrev_b32 v228, 16, v120
    v_and_b32 v229, 0xffff0000, v120
    v_lshlrev_b32 v230, 16, v121
    v_and_b32 v231, 0xffff0000, v121
    v_pk_add_f32 v[40:41], v[40:41], v[228:229]
    v_pk_add_f32 v[42:43], v[42:43], v[230:231]
    v_cvt_pk_bf16_f32 v40, v40, v41
    v_cvt_pk_bf16_f32 v41, v42, v43
    ds_write_b64 v0, v[40:41] offset:2848
    v_lshlrev_b32 v232, 16, v122
    v_and_b32 v233, 0xffff0000, v122
    v_lshlrev_b32 v234, 16, v123
    v_and_b32 v235, 0xffff0000, v123
    v_pk_add_f32 v[44:45], v[44:45], v[232:233]
    v_pk_add_f32 v[46:47], v[46:47], v[234:235]
    v_cvt_pk_bf16_f32 v44, v44, v45
    v_cvt_pk_bf16_f32 v45, v46, v47
    ds_write_b64 v0, v[44:45] offset:2880
    s_waitcnt vmcnt(1)
    v_lshlrev_b32 v228, 16, v124
    v_and_b32 v229, 0xffff0000, v124
    v_lshlrev_b32 v230, 16, v125
    v_and_b32 v231, 0xffff0000, v125
    v_pk_add_f32 v[48:49], v[48:49], v[228:229]
    v_pk_add_f32 v[50:51], v[50:51], v[230:231]
    v_cvt_pk_bf16_f32 v48, v48, v49
    v_cvt_pk_bf16_f32 v49, v50, v51
    ds_write_b64 v0, v[48:49] offset:2912
    v_lshlrev_b32 v232, 16, v126
    v_and_b32 v233, 0xffff0000, v126
    v_lshlrev_b32 v234, 16, v127
    v_and_b32 v235, 0xffff0000, v127
    v_pk_add_f32 v[52:53], v[52:53], v[232:233]
    v_pk_add_f32 v[54:55], v[54:55], v[234:235]
    v_cvt_pk_bf16_f32 v52, v52, v53
    v_cvt_pk_bf16_f32 v53, v54, v55
    ds_write_b64 v0, v[52:53] offset:2944
    s_waitcnt vmcnt(0)
    v_lshlrev_b32 v228, 16, v128
    v_and_b32 v229, 0xffff0000, v128
    v_lshlrev_b32 v230, 16, v129
    v_and_b32 v231, 0xffff0000, v129
    v_pk_add_f32 v[56:57], v[56:57], v[228:229]
    v_pk_add_f32 v[58:59], v[58:59], v[230:231]
    v_cvt_pk_bf16_f32 v56, v56, v57
    v_cvt_pk_bf16_f32 v57, v58, v59
    ds_write_b64 v0, v[56:57] offset:5632
    v_lshlrev_b32 v232, 16, v130
    v_and_b32 v233, 0xffff0000, v130
    v_lshlrev_b32 v234, 16, v131
    v_and_b32 v235, 0xffff0000, v131
    v_pk_add_f32 v[60:61], v[60:61], v[232:233]
    v_pk_add_f32 v[62:63], v[62:63], v[234:235]
    v_cvt_pk_bf16_f32 v60, v60, v61
    v_cvt_pk_bf16_f32 v61, v62, v63
    ds_write_b64 v0, v[60:61] offset:5664
    s_waitcnt lgkmcnt(0)
    ds_read_b128 v[136:139], v1
    ds_read_b128 v[140:143], v2
    ds_read_b128 v[144:147], v3
    ds_read_b128 v[148:151], v4
    ds_read_b128 v[152:155], v5
    ds_read_b128 v[156:159], v6
    s_mov_b32 s45, 0
    s_mov_b32 s46, 81920
    s_waitcnt lgkmcnt(5)
    buffer_store_dwordx4 v[136:139], v8, s[60:63], s45 offen
    s_waitcnt lgkmcnt(4)
    buffer_store_dwordx4 v[140:143], v9, s[60:63], s45 offen
    s_waitcnt lgkmcnt(3)
    buffer_store_dwordx4 v[144:147], v10, s[60:63], s45 offen
    s_waitcnt lgkmcnt(2)
    buffer_store_dwordx4 v[148:151], v11, s[60:63], s45 offen
    s_waitcnt lgkmcnt(1)
    buffer_store_dwordx4 v[152:155], v12, s[60:63], s45 offen
    s_waitcnt lgkmcnt(0)
    buffer_store_dwordx4 v[156:159], v13, s[60:63], s46 offen
    s_branch L_fin
.p2align 3
L_x1:
    v_mfma_f32_16x16x32_bf16 a[0:3], v[176:179], v[136:139], a[0:3]
    s_lshl_b32 s45, s82, 13
    ds_read_b64_tr_b16 a[140:141], v220 offset:0
    v_mfma_f32_16x16x32_bf16 a[0:3], v[196:199], v[156:159], a[0:3]
    s_lshl_b32 s46, s83, 13
    ds_read_b64_tr_b16 a[142:143], v220 offset:5120
    v_mfma_f32_16x16x32_bf16 a[4:7], v[200:203], v[156:159], a[4:7]
    s_lshr_b32 s47, s82, 2
    ds_read_b128 a[100:103], v219 offset:0
    v_mfma_f32_16x16x32_bf16 a[4:7], v[180:183], v[136:139], a[4:7]
    s_lshl_b32 s47, s47, 7
    ds_read_b64_tr_b16 a[144:145], v221 offset:0
    v_mfma_f32_16x16x32_bf16 a[8:11], v[184:187], v[136:139], a[8:11]
    s_lshl_b32 s42, s24, 2
    ds_read_b64_tr_b16 a[146:147], v221 offset:5120
    v_mfma_f32_16x16x32_bf16 a[8:11], v[204:207], v[156:159], a[8:11]
    s_add_u32 s47, s47, s42
    ds_read_b128 a[104:107], v219 offset:1024
    v_mfma_f32_16x16x32_bf16 a[12:15], v[208:211], v[156:159], a[12:15]
    s_add_u32 s47, s47, 71303168
    ds_read_b64_tr_b16 a[148:149], v220 offset:64
    v_mfma_f32_16x16x32_bf16 a[12:15], v[188:191], v[136:139], a[12:15]
    s_xor_b32 s42, s47, 128
    ds_read_b64_tr_b16 a[150:151], v220 offset:5184
    v_mfma_f32_16x16x32_bf16 a[16:19], v[192:195], v[136:139], a[16:19]
    s_mov_b32 s86, 1
    ds_read_b128 a[108:111], v219 offset:2048
    v_mfma_f32_16x16x32_bf16 a[16:19], v[212:215], v[156:159], a[16:19]
    s_add_u32 s29, s45, 4096
    ds_read_b64_tr_b16 a[152:153], v221 offset:64
    v_mfma_f32_16x16x32_bf16 a[36:39], v[212:215], v[160:163], a[36:39]
    s_add_u32 s34, s26, 0
    ds_read_b64_tr_b16 a[154:155], v221 offset:5184
    v_mfma_f32_16x16x32_bf16 a[36:39], v[192:195], v[140:143], a[36:39]
    s_add_u32 s35, s34, 5696
    ds_read_b128 a[112:115], v219 offset:3072
    v_mfma_f32_16x16x32_bf16 a[32:35], v[188:191], v[140:143], a[32:35]
    s_mov_b32 s37, 176
    ds_read_b64_tr_b16 a[156:157], v220 offset:128
    v_mfma_f32_16x16x32_bf16 a[32:35], v[208:211], v[160:163], a[32:35]
    s_mov_b32 s40, 2560
    ds_read_b64_tr_b16 a[158:159], v220 offset:5248
    v_mfma_f32_16x16x32_bf16 a[28:31], v[204:207], v[160:163], a[28:31]
    ds_read_b128 a[116:119], v219 offset:4096
    v_bfe_u32 v228, v254, 4, 4
    v_mfma_f32_16x16x32_bf16 a[28:31], v[184:187], v[140:143], a[28:31]
    ds_read_b64_tr_b16 a[160:161], v220 offset:10240
    v_mul_u32_u24 v228, 176, v228
    v_mfma_f32_16x16x32_bf16 a[24:27], v[180:183], v[140:143], a[24:27]
    ds_read_b64_tr_b16 a[162:163], v220 offset:15360
    v_lshrrev_b32 v229, 8, v254
    v_mfma_f32_16x16x32_bf16 a[24:27], v[200:203], v[160:163], a[24:27]
    ds_read_b128 a[120:123], v219 offset:10240
    v_lshl_add_u32 v228, v229, 3, v228
    v_mfma_f32_16x16x32_bf16 a[20:23], v[196:199], v[160:163], a[20:23]
    ds_read_b64_tr_b16 a[164:165], v221 offset:10240
    v_add_u32 v0, s34, v228
    v_mfma_f32_16x16x32_bf16 a[20:23], v[176:179], v[140:143], a[20:23]
    ds_read_b64_tr_b16 a[166:167], v221 offset:15360
    v_lshrrev_b32 v230, 4, v254
    v_mfma_f32_16x16x32_bf16 a[40:43], v[176:179], v[144:147], a[40:43]
    ds_read_b128 a[124:127], v219 offset:11264
    v_add_u32 v228, 0, v230
    v_mfma_f32_16x16x32_bf16 a[40:43], v[196:199], v[164:167], a[40:43]
    ds_read_b64_tr_b16 a[168:169], v220 offset:10304
    v_mul_u32_u24 v229, 205, v228
    v_mfma_f32_16x16x32_bf16 a[44:47], v[200:203], v[164:167], a[44:47]
    ds_read_b64_tr_b16 a[170:171], v220 offset:15424
    v_lshrrev_b32 v229, 11, v229
    v_mfma_f32_16x16x32_bf16 a[44:47], v[180:183], v[144:147], a[44:47]
    ds_read_b128 a[128:131], v219 offset:12288
    v_lshlrev_b32 v228, 4, v228
    v_mfma_f32_16x16x32_bf16 a[48:51], v[184:187], v[144:147], a[48:51]
    ds_read_b64_tr_b16 a[172:173], v221 offset:10304
    v_mul_u32_u24 v231, 16, v229
    v_mfma_f32_16x16x32_bf16 a[48:51], v[204:207], v[164:167], a[48:51]
    ds_read_b64_tr_b16 a[174:175], v221 offset:15424
    v_add3_u32 v1, v231, v228, s34
    v_mfma_f32_16x16x32_bf16 a[52:55], v[208:211], v[164:167], a[52:55]
    ds_read_b128 a[132:135], v219 offset:13312
    v_mul_u32_u24 v231, 2400, v229
    v_mfma_f32_16x16x32_bf16 a[52:55], v[188:191], v[144:147], a[52:55]
    ds_read_b64_tr_b16 a[176:177], v220 offset:10368
    v_add_u32 v8, v231, v228
    v_mfma_f32_16x16x32_bf16 a[56:59], v[192:195], v[144:147], a[56:59]
    ds_read_b64_tr_b16 a[178:179], v220 offset:15488
    v_add_u32 v228, 64, v230
    v_mfma_f32_16x16x32_bf16 a[56:59], v[212:215], v[164:167], a[56:59]
    ds_read_b128 a[136:139], v219 offset:14336
    v_mul_u32_u24 v229, 205, v228
    v_mfma_f32_16x16x32_bf16 a[76:79], v[212:215], v[168:171], a[76:79]
    v_lshrrev_b32 v229, 11, v229
    v_lshlrev_b32 v228, 4, v228
    v_mfma_f32_16x16x32_bf16 a[76:79], v[192:195], v[148:151], a[76:79]
    v_mul_u32_u24 v231, 16, v229
    v_add3_u32 v2, v231, v228, s34
    v_mfma_f32_16x16x32_bf16 a[72:75], v[188:191], v[148:151], a[72:75]
    v_mul_u32_u24 v231, 2400, v229
    v_add_u32 v9, v231, v228
    v_mfma_f32_16x16x32_bf16 a[72:75], v[208:211], v[168:171], a[72:75]
    v_add_u32 v228, 128, v230
    v_mul_u32_u24 v229, 205, v228
    v_mfma_f32_16x16x32_bf16 a[68:71], v[204:207], v[168:171], a[68:71]
    v_lshrrev_b32 v229, 11, v229
    v_lshlrev_b32 v228, 4, v228
    v_mfma_f32_16x16x32_bf16 a[68:71], v[184:187], v[148:151], a[68:71]
    v_mul_u32_u24 v231, 16, v229
    v_add3_u32 v3, v231, v228, s34
    v_mfma_f32_16x16x32_bf16 a[64:67], v[180:183], v[148:151], a[64:67]
    v_mul_u32_u24 v231, 2400, v229
    v_add_u32 v10, v231, v228
    v_mfma_f32_16x16x32_bf16 a[64:67], v[200:203], v[168:171], a[64:67]
    v_add_u32 v228, 192, v230
    v_mul_u32_u24 v229, 205, v228
    v_mfma_f32_16x16x32_bf16 a[60:63], v[196:199], v[168:171], a[60:63]
    v_lshrrev_b32 v229, 11, v229
    v_lshlrev_b32 v228, 4, v228
    v_mfma_f32_16x16x32_bf16 a[60:63], v[176:179], v[148:151], a[60:63]
    v_mul_u32_u24 v231, 16, v229
    v_add3_u32 v4, v231, v228, s34
    v_mfma_f32_16x16x32_bf16 a[80:83], v[176:179], v[152:155], a[80:83]
    v_mul_u32_u24 v231, 2400, v229
    v_add_u32 v11, v231, v228
    v_mfma_f32_16x16x32_bf16 a[80:83], v[196:199], v[172:175], a[80:83]
    v_add_u32 v228, 256, v230
    v_mul_u32_u24 v229, 205, v228
    v_mfma_f32_16x16x32_bf16 a[84:87], v[200:203], v[172:175], a[84:87]
    v_lshrrev_b32 v229, 11, v229
    v_lshlrev_b32 v228, 4, v228
    v_mfma_f32_16x16x32_bf16 a[84:87], v[180:183], v[152:155], a[84:87]
    v_mul_u32_u24 v231, 16, v229
    v_add3_u32 v5, v231, v228, s34
    v_mfma_f32_16x16x32_bf16 a[88:91], v[184:187], v[152:155], a[88:91]
    v_mul_u32_u24 v231, 2400, v229
    v_add_u32 v12, v231, v228
    v_mfma_f32_16x16x32_bf16 a[88:91], v[204:207], v[172:175], a[88:91]
    v_lshrrev_b32 v228, 6, v254
    v_and_b32 v229, 48, v254
    v_mfma_f32_16x16x32_bf16 a[92:95], v[208:211], v[172:175], a[92:95]
    v_mad_u32_u24 v231, v228, s37, v229
    v_add_u32 v6, s35, v231
    v_mfma_f32_16x16x32_bf16 a[92:95], v[188:191], v[152:155], a[92:95]
    v_mad_u32_u24 v13, v228, s40, v229
    v_bfe_u32 v228, v254, 5, 4
    v_mfma_f32_16x16x32_bf16 a[96:99], v[192:195], v[152:155], a[96:99]
    s_waitcnt vmcnt(10) lgkmcnt(0)
    v_and_b32 v229, 16, v254
    v_mad_u32_u24 v231, v228, s37, v229
    v_mfma_f32_16x16x32_bf16 a[96:99], v[212:215], v[172:175], a[96:99]

    s_barrier
    v_mfma_f32_16x16x32_bf16 a[0:3], a[140:143], a[100:103], a[0:3]
    ds_read_b64_tr_b16 v[176:177], v223 offset:0
    v_add_u32 v7, s35, v231
    v_mfma_f32_16x16x32_bf16 a[0:3], a[160:163], a[120:123], a[0:3]
    ds_read_b64_tr_b16 v[178:179], v223 offset:5120
    v_mad_u32_u24 v231, v228, s40, v229
    v_mfma_f32_16x16x32_bf16 a[4:7], a[164:167], a[120:123], a[4:7]
    ds_read_b128 v[136:139], v222 offset:0
    v_lshrrev_b32 v229, 9, v254
    v_mfma_f32_16x16x32_bf16 a[4:7], a[144:147], a[100:103], a[4:7]
    ds_read_b64_tr_b16 v[180:181], v224 offset:0
    v_lshl_add_u32 v14, v229, 30, v231
    v_mfma_f32_16x16x32_bf16 a[8:11], a[148:151], a[100:103], a[8:11]
    ds_read_b64_tr_b16 v[182:183], v224 offset:5120
    v_mov_b32 v236, 1
    v_mfma_f32_16x16x32_bf16 a[8:11], a[168:171], a[120:123], a[8:11]
    ds_read_b128 v[140:143], v222 offset:1024
    v_mfma_f32_16x16x32_bf16 a[12:15], a[172:175], a[120:123], a[12:15]
    ds_read_b64_tr_b16 v[184:185], v223 offset:64
    v_mfma_f32_16x16x32_bf16 a[12:15], a[152:155], a[100:103], a[12:15]
    ds_read_b64_tr_b16 v[186:187], v223 offset:5184
    v_mfma_f32_16x16x32_bf16 a[16:19], a[156:159], a[100:103], a[16:19]
    ds_read_b128 v[144:147], v222 offset:2048
    v_mfma_f32_16x16x32_bf16 a[16:19], a[176:179], a[120:123], a[16:19]
    ds_read_b64_tr_b16 v[188:189], v224 offset:64
    v_mfma_f32_16x16x32_bf16 a[20:23], a[160:163], a[124:127], a[20:23]
    ds_read_b64_tr_b16 v[190:191], v224 offset:5184
    v_mfma_f32_16x16x32_bf16 a[20:23], a[140:143], a[104:107], a[20:23]
    ds_read_b128 v[148:151], v222 offset:3072
    v_mfma_f32_16x16x32_bf16 a[24:27], a[144:147], a[104:107], a[24:27]
    ds_read_b64_tr_b16 v[192:193], v223 offset:128
    v_mfma_f32_16x16x32_bf16 a[24:27], a[164:167], a[124:127], a[24:27]
    ds_read_b64_tr_b16 v[194:195], v223 offset:5248
    v_mfma_f32_16x16x32_bf16 a[28:31], a[168:171], a[124:127], a[28:31]
    ds_read_b128 v[152:155], v222 offset:4096
    v_mfma_f32_16x16x32_bf16 a[28:31], a[148:151], a[104:107], a[28:31]
    ds_read_b64_tr_b16 v[196:197], v223 offset:10240
    v_mfma_f32_16x16x32_bf16 a[32:35], a[152:155], a[104:107], a[32:35]
    ds_read_b64_tr_b16 v[198:199], v223 offset:15360
    v_mfma_f32_16x16x32_bf16 a[32:35], a[172:175], a[124:127], a[32:35]
    ds_read_b128 v[156:159], v222 offset:10240
    v_mfma_f32_16x16x32_bf16 a[36:39], a[176:179], a[124:127], a[36:39]
    ds_read_b64_tr_b16 v[200:201], v224 offset:10240
    v_mfma_f32_16x16x32_bf16 a[36:39], a[156:159], a[104:107], a[36:39]
    ds_read_b64_tr_b16 v[202:203], v224 offset:15360
    v_mfma_f32_16x16x32_bf16 a[40:43], a[140:143], a[108:111], a[40:43]
    ds_read_b128 v[160:163], v222 offset:11264
    v_mfma_f32_16x16x32_bf16 a[40:43], a[160:163], a[128:131], a[40:43]
    ds_read_b64_tr_b16 v[204:205], v223 offset:10304
    v_mfma_f32_16x16x32_bf16 a[44:47], a[164:167], a[128:131], a[44:47]
    ds_read_b64_tr_b16 v[206:207], v223 offset:15424
    v_mfma_f32_16x16x32_bf16 a[44:47], a[144:147], a[108:111], a[44:47]
    ds_read_b128 v[164:167], v222 offset:12288
    v_mfma_f32_16x16x32_bf16 a[48:51], a[148:151], a[108:111], a[48:51]
    ds_read_b64_tr_b16 v[208:209], v224 offset:10304
    v_mfma_f32_16x16x32_bf16 a[48:51], a[168:171], a[128:131], a[48:51]
    ds_read_b64_tr_b16 v[210:211], v224 offset:15424
    v_mfma_f32_16x16x32_bf16 a[52:55], a[172:175], a[128:131], a[52:55]
    ds_read_b128 v[168:171], v222 offset:13312
    v_mfma_f32_16x16x32_bf16 a[52:55], a[152:155], a[108:111], a[52:55]
    ds_read_b64_tr_b16 v[212:213], v223 offset:10368
    v_mfma_f32_16x16x32_bf16 a[56:59], a[156:159], a[108:111], a[56:59]
    ds_read_b64_tr_b16 v[214:215], v223 offset:15488
    v_mfma_f32_16x16x32_bf16 a[56:59], a[176:179], a[128:131], a[56:59]
    ds_read_b128 v[172:175], v222 offset:14336
    v_mfma_f32_16x16x32_bf16 a[60:63], a[160:163], a[132:135], a[60:63]
    v_mfma_f32_16x16x32_bf16 a[60:63], a[140:143], a[112:115], a[60:63]
    v_mfma_f32_16x16x32_bf16 a[64:67], a[144:147], a[112:115], a[64:67]
    v_mfma_f32_16x16x32_bf16 a[64:67], a[164:167], a[132:135], a[64:67]
    v_mfma_f32_16x16x32_bf16 a[68:71], a[168:171], a[132:135], a[68:71]
    v_mfma_f32_16x16x32_bf16 a[68:71], a[148:151], a[112:115], a[68:71]
    s_waitcnt lgkmcnt(0)
    v_mfma_f32_16x16x32_bf16 a[0:3], v[176:179], v[136:139], a[0:3]
    v_mfma_f32_16x16x32_bf16 a[0:3], v[196:199], v[156:159], a[0:3]
    v_mfma_f32_16x16x32_bf16 a[4:7], v[200:203], v[156:159], a[4:7]
    v_mfma_f32_16x16x32_bf16 a[4:7], v[180:183], v[136:139], a[4:7]
    v_mfma_f32_16x16x32_bf16 a[8:11], v[184:187], v[136:139], a[8:11]
    v_mfma_f32_16x16x32_bf16 a[8:11], v[204:207], v[156:159], a[8:11]
    v_mfma_f32_16x16x32_bf16 a[12:15], v[208:211], v[156:159], a[12:15]
    v_mfma_f32_16x16x32_bf16 a[12:15], v[188:191], v[136:139], a[12:15]
    v_mfma_f32_16x16x32_bf16 a[16:19], v[192:195], v[136:139], a[16:19]
    v_mfma_f32_16x16x32_bf16 a[16:19], v[212:215], v[156:159], a[16:19]
    v_accvgpr_read_b32 v16, a0
    v_accvgpr_read_b32 v17, a1
    v_mfma_f32_16x16x32_bf16 a[20:23], v[196:199], v[160:163], a[20:23]
    v_accvgpr_read_b32 v18, a2
    v_accvgpr_read_b32 v19, a3
    v_mfma_f32_16x16x32_bf16 a[20:23], v[176:179], v[140:143], a[20:23]
    v_accvgpr_read_b32 v20, a4
    v_accvgpr_read_b32 v21, a5
    v_mfma_f32_16x16x32_bf16 a[24:27], v[180:183], v[140:143], a[24:27]
    v_accvgpr_read_b32 v22, a6
    v_accvgpr_read_b32 v23, a7
    v_mfma_f32_16x16x32_bf16 a[24:27], v[200:203], v[160:163], a[24:27]
    v_cvt_pk_bf16_f32 v80, v16, v17
    v_cvt_pk_bf16_f32 v81, v18, v19
    v_mfma_f32_16x16x32_bf16 a[28:31], v[204:207], v[160:163], a[28:31]
    v_cvt_pk_bf16_f32 v82, v20, v21
    v_cvt_pk_bf16_f32 v83, v22, v23
    v_mfma_f32_16x16x32_bf16 a[28:31], v[184:187], v[140:143], a[28:31]
    buffer_store_dwordx4 v[80:83], v254, s[64:67], s45 offen offset:0 sc1
    v_mfma_f32_16x16x32_bf16 a[32:35], v[188:191], v[140:143], a[32:35]
    v_accvgpr_read_b32 v24, a8
    v_accvgpr_read_b32 v25, a9
    v_mfma_f32_16x16x32_bf16 a[32:35], v[208:211], v[160:163], a[32:35]
    v_accvgpr_read_b32 v26, a10
    v_accvgpr_read_b32 v27, a11
    v_mfma_f32_16x16x32_bf16 a[36:39], v[212:215], v[160:163], a[36:39]
    v_accvgpr_read_b32 v28, a12
    v_accvgpr_read_b32 v29, a13
    v_mfma_f32_16x16x32_bf16 a[36:39], v[192:195], v[140:143], a[36:39]
    v_accvgpr_read_b32 v30, a14
    v_accvgpr_read_b32 v31, a15
    v_mfma_f32_16x16x32_bf16 a[40:43], v[176:179], v[144:147], a[40:43]
    v_cvt_pk_bf16_f32 v84, v24, v25
    v_cvt_pk_bf16_f32 v85, v26, v27
    v_mfma_f32_16x16x32_bf16 a[40:43], v[196:199], v[164:167], a[40:43]
    v_cvt_pk_bf16_f32 v86, v28, v29
    v_cvt_pk_bf16_f32 v87, v30, v31
    v_mfma_f32_16x16x32_bf16 a[44:47], v[200:203], v[164:167], a[44:47]
    buffer_store_dwordx4 v[84:87], v254, s[64:67], s45 offen offset:1024 sc1
    v_mfma_f32_16x16x32_bf16 a[44:47], v[180:183], v[144:147], a[44:47]
    v_accvgpr_read_b32 v32, a16
    v_accvgpr_read_b32 v33, a17
    v_mfma_f32_16x16x32_bf16 a[48:51], v[184:187], v[144:147], a[48:51]
    v_accvgpr_read_b32 v34, a18
    v_accvgpr_read_b32 v35, a19
    v_mfma_f32_16x16x32_bf16 a[48:51], v[204:207], v[164:167], a[48:51]
    v_accvgpr_read_b32 v36, a20
    v_accvgpr_read_b32 v37, a21
    v_mfma_f32_16x16x32_bf16 a[52:55], v[188:191], v[144:147], a[52:55]
    v_accvgpr_read_b32 v38, a22
    v_accvgpr_read_b32 v39, a23
    v_mfma_f32_16x16x32_bf16 a[52:55], v[208:211], v[164:167], a[52:55]
    v_cvt_pk_bf16_f32 v88, v32, v33
    v_cvt_pk_bf16_f32 v89, v34, v35
    v_mfma_f32_16x16x32_bf16 a[56:59], v[192:195], v[144:147], a[56:59]
    v_cvt_pk_bf16_f32 v90, v36, v37
    v_cvt_pk_bf16_f32 v91, v38, v39
    v_mfma_f32_16x16x32_bf16 a[56:59], v[212:215], v[164:167], a[56:59]
    buffer_store_dwordx4 v[88:91], v254, s[64:67], s45 offen offset:2048 sc1
    v_mfma_f32_16x16x32_bf16 a[60:63], v[176:179], v[148:151], a[60:63]
    v_accvgpr_read_b32 v40, a24
    v_accvgpr_read_b32 v41, a25
    v_mfma_f32_16x16x32_bf16 a[60:63], v[196:199], v[168:171], a[60:63]
    v_accvgpr_read_b32 v42, a26
    v_accvgpr_read_b32 v43, a27
    v_mfma_f32_16x16x32_bf16 a[64:67], v[180:183], v[148:151], a[64:67]
    v_accvgpr_read_b32 v44, a28
    v_accvgpr_read_b32 v45, a29
    v_mfma_f32_16x16x32_bf16 a[64:67], v[200:203], v[168:171], a[64:67]
    v_accvgpr_read_b32 v46, a30
    v_accvgpr_read_b32 v47, a31
    v_mfma_f32_16x16x32_bf16 a[68:71], v[184:187], v[148:151], a[68:71]
    v_cvt_pk_bf16_f32 v92, v40, v41
    v_cvt_pk_bf16_f32 v93, v42, v43
    v_mfma_f32_16x16x32_bf16 a[68:71], v[204:207], v[168:171], a[68:71]
    v_cvt_pk_bf16_f32 v94, v44, v45
    v_cvt_pk_bf16_f32 v95, v46, v47
    v_mfma_f32_16x16x32_bf16 a[72:75], a[152:155], a[112:115], a[72:75]
    buffer_store_dwordx4 v[92:95], v254, s[64:67], s45 offen offset:3072 sc1
    v_mfma_f32_16x16x32_bf16 a[72:75], a[172:175], a[132:135], a[72:75]
    v_accvgpr_read_b32 v48, a32
    v_accvgpr_read_b32 v49, a33
    v_mfma_f32_16x16x32_bf16 a[72:75], v[188:191], v[148:151], a[72:75]
    v_accvgpr_read_b32 v50, a34
    v_accvgpr_read_b32 v51, a35
    v_mfma_f32_16x16x32_bf16 a[72:75], v[208:211], v[168:171], a[72:75]
    v_accvgpr_read_b32 v52, a36
    v_accvgpr_read_b32 v53, a37
    v_mfma_f32_16x16x32_bf16 a[76:79], a[156:159], a[112:115], a[76:79]
    v_accvgpr_read_b32 v54, a38
    v_accvgpr_read_b32 v55, a39
    v_mfma_f32_16x16x32_bf16 a[76:79], a[176:179], a[132:135], a[76:79]
    v_cvt_pk_bf16_f32 v96, v48, v49
    v_cvt_pk_bf16_f32 v97, v50, v51
    v_mfma_f32_16x16x32_bf16 a[76:79], v[192:195], v[148:151], a[76:79]
    v_cvt_pk_bf16_f32 v98, v52, v53
    v_cvt_pk_bf16_f32 v99, v54, v55
    v_mfma_f32_16x16x32_bf16 a[76:79], v[212:215], v[168:171], a[76:79]
    buffer_store_dwordx4 v[96:99], v254, s[64:67], s29 offen offset:0 sc1
    v_mfma_f32_16x16x32_bf16 a[80:83], a[140:143], a[116:119], a[80:83]
    v_accvgpr_read_b32 v56, a40
    v_accvgpr_read_b32 v57, a41
    v_mfma_f32_16x16x32_bf16 a[80:83], a[160:163], a[136:139], a[80:83]
    v_accvgpr_read_b32 v58, a42
    v_accvgpr_read_b32 v59, a43
    v_mfma_f32_16x16x32_bf16 a[80:83], v[176:179], v[152:155], a[80:83]
    v_accvgpr_read_b32 v60, a44
    v_accvgpr_read_b32 v61, a45
    v_mfma_f32_16x16x32_bf16 a[80:83], v[196:199], v[172:175], a[80:83]
    v_accvgpr_read_b32 v62, a46
    v_accvgpr_read_b32 v63, a47
    v_mfma_f32_16x16x32_bf16 a[84:87], a[144:147], a[116:119], a[84:87]
    v_cvt_pk_bf16_f32 v100, v56, v57
    v_cvt_pk_bf16_f32 v101, v58, v59
    v_mfma_f32_16x16x32_bf16 a[84:87], a[164:167], a[136:139], a[84:87]
    v_cvt_pk_bf16_f32 v102, v60, v61
    v_cvt_pk_bf16_f32 v103, v62, v63
    v_mfma_f32_16x16x32_bf16 a[84:87], v[180:183], v[152:155], a[84:87]
    buffer_store_dwordx4 v[100:103], v254, s[64:67], s29 offen offset:1024 sc1
    v_mfma_f32_16x16x32_bf16 a[84:87], v[200:203], v[172:175], a[84:87]
    v_mfma_f32_16x16x32_bf16 a[88:91], a[148:151], a[116:119], a[88:91]
    v_mfma_f32_16x16x32_bf16 a[88:91], a[168:171], a[136:139], a[88:91]
    v_mfma_f32_16x16x32_bf16 a[88:91], v[184:187], v[152:155], a[88:91]
    v_mfma_f32_16x16x32_bf16 a[88:91], v[204:207], v[172:175], a[88:91]
    v_mfma_f32_16x16x32_bf16 a[92:95], a[152:155], a[116:119], a[92:95]
    v_mfma_f32_16x16x32_bf16 a[92:95], a[172:175], a[136:139], a[92:95]
    v_mfma_f32_16x16x32_bf16 a[92:95], v[188:191], v[152:155], a[92:95]
    v_mfma_f32_16x16x32_bf16 a[92:95], v[208:211], v[172:175], a[92:95]
    v_mfma_f32_16x16x32_bf16 a[96:99], a[156:159], a[116:119], a[96:99]
    v_mfma_f32_16x16x32_bf16 a[96:99], a[176:179], a[136:139], a[96:99]
    v_mfma_f32_16x16x32_bf16 a[96:99], v[192:195], v[152:155], a[96:99]
    v_mfma_f32_16x16x32_bf16 a[96:99], v[212:215], v[172:175], a[96:99]
    buffer_load_dword v255, off, s[64:67], s42 sc1
    v_accvgpr_read_b32 v16, a48
    v_accvgpr_read_b32 v17, a49
    v_accvgpr_read_b32 v18, a50
    v_accvgpr_read_b32 v19, a51
    v_accvgpr_read_b32 v20, a52
    v_accvgpr_read_b32 v21, a53
    v_accvgpr_read_b32 v22, a54
    v_accvgpr_read_b32 v23, a55
    v_accvgpr_read_b32 v24, a56
    v_accvgpr_read_b32 v25, a57
    v_accvgpr_read_b32 v26, a58
    v_accvgpr_read_b32 v27, a59
    v_accvgpr_read_b32 v28, a60
    v_accvgpr_read_b32 v29, a61
    v_accvgpr_read_b32 v30, a62
    v_accvgpr_read_b32 v31, a63
    v_accvgpr_read_b32 v32, a64
    v_accvgpr_read_b32 v33, a65
    v_accvgpr_read_b32 v34, a66
    v_accvgpr_read_b32 v35, a67
    v_accvgpr_read_b32 v36, a68
    v_accvgpr_read_b32 v37, a69
    v_accvgpr_read_b32 v38, a70
    v_accvgpr_read_b32 v39, a71
    v_accvgpr_read_b32 v40, a72
    v_accvgpr_read_b32 v41, a73
    v_accvgpr_read_b32 v42, a74
    v_accvgpr_read_b32 v43, a75
    v_accvgpr_read_b32 v44, a76
    v_accvgpr_read_b32 v45, a77
    v_accvgpr_read_b32 v46, a78
    v_accvgpr_read_b32 v47, a79
    v_accvgpr_read_b32 v48, a80
    v_accvgpr_read_b32 v49, a81
    v_accvgpr_read_b32 v50, a82
    v_accvgpr_read_b32 v51, a83
    v_accvgpr_read_b32 v52, a84
    v_accvgpr_read_b32 v53, a85
    v_accvgpr_read_b32 v54, a86
    v_accvgpr_read_b32 v55, a87
    v_accvgpr_read_b32 v56, a88
    v_accvgpr_read_b32 v57, a89
    v_accvgpr_read_b32 v58, a90
    v_accvgpr_read_b32 v59, a91
    v_accvgpr_read_b32 v60, a92
    v_accvgpr_read_b32 v61, a93
    v_accvgpr_read_b32 v62, a94
    v_accvgpr_read_b32 v63, a95
    v_accvgpr_read_b32 v64, a96
    v_accvgpr_read_b32 v65, a97
    v_accvgpr_read_b32 v66, a98
    v_accvgpr_read_b32 v67, a99
    s_waitcnt vmcnt(0)
    buffer_store_dword v236, off, s[64:67], s47 sc1
    v_readfirstlane_b32 s43, v255
    s_mov_b32 s44, 0x80000
    L_chk6:
    s_and_b32 s43, s43, s86
    s_cmp_eq_u32 s43, s86
    s_cbranch_scc1 L_ok6
    s_sub_u32 s44, s44, 1
    s_cbranch_scc1 L_ok6
    buffer_load_dword v255, off, s[64:67], s42 sc1
    s_waitcnt vmcnt(0)
    v_readfirstlane_b32 s43, v255
    s_branch L_chk6
    L_ok6:
    buffer_load_dwordx4 v[108:111], v254, s[64:67], s46 offen offset:0 sc1
    buffer_load_dwordx4 v[112:115], v254, s[64:67], s46 offen offset:1024 sc1
    buffer_load_dwordx4 v[116:119], v254, s[64:67], s46 offen offset:2048 sc1
    buffer_load_dwordx4 v[120:123], v254, s[64:67], s46 offen offset:3072 sc1
    s_add_u32 s46, s46, 4096
    buffer_load_dwordx4 v[124:127], v254, s[64:67], s46 offen offset:0 sc1
    buffer_load_dwordx4 v[128:131], v254, s[64:67], s46 offen offset:1024 sc1
    buffer_load_dwordx4 v[132:135], v254, s[64:67], s46 offen offset:2048 sc1
    s_waitcnt vmcnt(6)
    v_lshlrev_b32 v228, 16, v108
    v_and_b32 v229, 0xffff0000, v108
    v_lshlrev_b32 v230, 16, v109
    v_and_b32 v231, 0xffff0000, v109
    v_pk_add_f32 v[16:17], v[16:17], v[228:229]
    v_pk_add_f32 v[18:19], v[18:19], v[230:231]
    v_cvt_pk_bf16_f32 v16, v16, v17
    v_cvt_pk_bf16_f32 v17, v18, v19
    ds_write_b64 v0, v[16:17] offset:5696
    v_lshlrev_b32 v232, 16, v110
    v_and_b32 v233, 0xffff0000, v110
    v_lshlrev_b32 v234, 16, v111
    v_and_b32 v235, 0xffff0000, v111
    v_pk_add_f32 v[20:21], v[20:21], v[232:233]
    v_pk_add_f32 v[22:23], v[22:23], v[234:235]
    v_cvt_pk_bf16_f32 v20, v20, v21
    v_cvt_pk_bf16_f32 v21, v22, v23
    ds_write_b64 v0, v[20:21] offset:5728
    s_waitcnt vmcnt(5)
    v_lshlrev_b32 v228, 16, v112
    v_and_b32 v229, 0xffff0000, v112
    v_lshlrev_b32 v230, 16, v113
    v_and_b32 v231, 0xffff0000, v113
    v_pk_add_f32 v[24:25], v[24:25], v[228:229]
    v_pk_add_f32 v[26:27], v[26:27], v[230:231]
    v_cvt_pk_bf16_f32 v24, v24, v25
    v_cvt_pk_bf16_f32 v25, v26, v27
    ds_write_b64 v0, v[24:25] offset:5760
    v_lshlrev_b32 v232, 16, v114
    v_and_b32 v233, 0xffff0000, v114
    v_lshlrev_b32 v234, 16, v115
    v_and_b32 v235, 0xffff0000, v115
    v_pk_add_f32 v[28:29], v[28:29], v[232:233]
    v_pk_add_f32 v[30:31], v[30:31], v[234:235]
    v_cvt_pk_bf16_f32 v28, v28, v29
    v_cvt_pk_bf16_f32 v29, v30, v31
    ds_write_b64 v0, v[28:29] offset:0
    s_waitcnt vmcnt(4)
    v_lshlrev_b32 v228, 16, v116
    v_and_b32 v229, 0xffff0000, v116
    v_lshlrev_b32 v230, 16, v117
    v_and_b32 v231, 0xffff0000, v117
    v_pk_add_f32 v[32:33], v[32:33], v[228:229]
    v_pk_add_f32 v[34:35], v[34:35], v[230:231]
    v_cvt_pk_bf16_f32 v32, v32, v33
    v_cvt_pk_bf16_f32 v33, v34, v35
    ds_write_b64 v0, v[32:33] offset:32
    v_lshlrev_b32 v232, 16, v118
    v_and_b32 v233, 0xffff0000, v118
    v_lshlrev_b32 v234, 16, v119
    v_and_b32 v235, 0xffff0000, v119
    v_pk_add_f32 v[36:37], v[36:37], v[232:233]
    v_pk_add_f32 v[38:39], v[38:39], v[234:235]
    v_cvt_pk_bf16_f32 v36, v36, v37
    v_cvt_pk_bf16_f32 v37, v38, v39
    ds_write_b64 v0, v[36:37] offset:64
    s_waitcnt vmcnt(3)
    v_lshlrev_b32 v228, 16, v120
    v_and_b32 v229, 0xffff0000, v120
    v_lshlrev_b32 v230, 16, v121
    v_and_b32 v231, 0xffff0000, v121
    v_pk_add_f32 v[40:41], v[40:41], v[228:229]
    v_pk_add_f32 v[42:43], v[42:43], v[230:231]
    v_cvt_pk_bf16_f32 v40, v40, v41
    v_cvt_pk_bf16_f32 v41, v42, v43
    ds_write_b64 v0, v[40:41] offset:96
    v_lshlrev_b32 v232, 16, v122
    v_and_b32 v233, 0xffff0000, v122
    v_lshlrev_b32 v234, 16, v123
    v_and_b32 v235, 0xffff0000, v123
    v_pk_add_f32 v[44:45], v[44:45], v[232:233]
    v_pk_add_f32 v[46:47], v[46:47], v[234:235]
    v_cvt_pk_bf16_f32 v44, v44, v45
    v_cvt_pk_bf16_f32 v45, v46, v47
    ds_write_b64 v0, v[44:45] offset:128
    s_waitcnt vmcnt(2)
    v_lshlrev_b32 v228, 16, v124
    v_and_b32 v229, 0xffff0000, v124
    v_lshlrev_b32 v230, 16, v125
    v_and_b32 v231, 0xffff0000, v125
    v_pk_add_f32 v[48:49], v[48:49], v[228:229]
    v_pk_add_f32 v[50:51], v[50:51], v[230:231]
    v_cvt_pk_bf16_f32 v48, v48, v49
    v_cvt_pk_bf16_f32 v49, v50, v51
    ds_write_b64 v0, v[48:49] offset:2816
    v_lshlrev_b32 v232, 16, v126
    v_and_b32 v233, 0xffff0000, v126
    v_lshlrev_b32 v234, 16, v127
    v_and_b32 v235, 0xffff0000, v127
    v_pk_add_f32 v[52:53], v[52:53], v[232:233]
    v_pk_add_f32 v[54:55], v[54:55], v[234:235]
    v_cvt_pk_bf16_f32 v52, v52, v53
    v_cvt_pk_bf16_f32 v53, v54, v55
    ds_write_b64 v0, v[52:53] offset:2848
    s_waitcnt vmcnt(1)
    v_lshlrev_b32 v228, 16, v128
    v_and_b32 v229, 0xffff0000, v128
    v_lshlrev_b32 v230, 16, v129
    v_and_b32 v231, 0xffff0000, v129
    v_pk_add_f32 v[56:57], v[56:57], v[228:229]
    v_pk_add_f32 v[58:59], v[58:59], v[230:231]
    v_cvt_pk_bf16_f32 v56, v56, v57
    v_cvt_pk_bf16_f32 v57, v58, v59
    ds_write_b64 v0, v[56:57] offset:2880
    v_lshlrev_b32 v232, 16, v130
    v_and_b32 v233, 0xffff0000, v130
    v_lshlrev_b32 v234, 16, v131
    v_and_b32 v235, 0xffff0000, v131
    v_pk_add_f32 v[60:61], v[60:61], v[232:233]
    v_pk_add_f32 v[62:63], v[62:63], v[234:235]
    v_cvt_pk_bf16_f32 v60, v60, v61
    v_cvt_pk_bf16_f32 v61, v62, v63
    ds_write_b64 v0, v[60:61] offset:2912
    s_waitcnt vmcnt(0)
    v_lshlrev_b32 v228, 16, v132
    v_and_b32 v229, 0xffff0000, v132
    v_lshlrev_b32 v230, 16, v133
    v_and_b32 v231, 0xffff0000, v133
    v_pk_add_f32 v[64:65], v[64:65], v[228:229]
    v_pk_add_f32 v[66:67], v[66:67], v[230:231]
    v_cvt_pk_bf16_f32 v64, v64, v65
    v_cvt_pk_bf16_f32 v65, v66, v67
    ds_write_b64 v0, v[64:65] offset:2944
    s_waitcnt lgkmcnt(0)
    ds_read_b128 v[136:139], v1
    ds_read_b128 v[140:143], v2
    ds_read_b128 v[144:147], v3
    ds_read_b128 v[148:151], v4
    ds_read_b128 v[152:155], v5
    ds_read_b128 v[156:159], v6
    ds_read_b128 v[160:163], v7 offset:64
    s_mov_b32 s45, 122880
    s_mov_b32 s46, 81984
    s_waitcnt lgkmcnt(6)
    buffer_store_dwordx4 v[136:139], v8, s[60:63], s45 offen
    s_waitcnt lgkmcnt(5)
    buffer_store_dwordx4 v[140:143], v9, s[60:63], s45 offen
    s_waitcnt lgkmcnt(4)
    buffer_store_dwordx4 v[144:147], v10, s[60:63], s45 offen
    s_waitcnt lgkmcnt(3)
    buffer_store_dwordx4 v[148:151], v11, s[60:63], s45 offen
    s_waitcnt lgkmcnt(2)
    buffer_store_dwordx4 v[152:155], v12, s[60:63], s45 offen
    s_waitcnt lgkmcnt(1)
    buffer_store_dwordx4 v[156:159], v13, s[60:63], s46 offen
    s_waitcnt lgkmcnt(0)
    buffer_store_dwordx4 v[160:163], v14, s[60:63], s46 offen offset:64
    s_branch L_fin
    L_slow:
    v_bfe_u32 v136, v254, 4, 4
    v_lshrrev_b32 v137, 8, v254
    v_mul_u32_u24 v241, 384, v136
    v_and_b32 v138, 1, v137
    v_lshl_add_u32 v241, v138, 5, v241
    v_lshrrev_b32 v138, 1, v137
    v_lshl_add_u32 v241, v138, 4, v241
    v_mul_u32_u24 v242, 1536, v137
    v_lshl_add_u32 v242, v136, 1, v242
    s_mov_b32 s45, 0

    v_mov_b32 v236, 0xff800000
    v_mov_b32 v244, 0
    v_mov_b32 v237, 0xff800000
    v_mov_b32 v245, 0
    v_mov_b32 v238, 0xff800000
    v_mov_b32 v246, 0
    v_mov_b32 v239, 0xff800000
    v_mov_b32 v247, 0
    v_mov_b32 v240, 0xff800000
    v_mov_b32 v248, 0
    v_mov_b32 v232, 0
    v_mov_b32 v233, 0
    v_mov_b32 v234, 0
    v_mov_b32 v235, 0
L_slow1:
    buffer_load_dwordx4 v[196:199], v241, s[12:15], s45 offen offset:0
    buffer_load_dwordx4 v[200:203], v241, s[12:15], s45 offen offset:64
    buffer_load_dwordx4 v[204:207], v241, s[12:15], s45 offen offset:128
    buffer_load_dwordx4 v[208:211], v241, s[12:15], s45 offen offset:192
    buffer_load_dwordx4 v[212:215], v241, s[12:15], s45 offen offset:256
    buffer_load_dwordx4 v[216:219], v241, s[12:15], s45 offen offset:320
    s_waitcnt vmcnt(0)
    v_mfma_f32_16x16x32_bf16 v[136:139], v[196:199], v[16:19], 0
    v_mfma_f32_16x16x32_bf16 v[136:139], v[200:203], v[36:39], v[136:139]
    v_mfma_f32_16x16x32_bf16 v[136:139], v[204:207], v[56:59], v[136:139]
    v_mfma_f32_16x16x32_bf16 v[136:139], v[208:211], v[76:79], v[136:139]
    v_mfma_f32_16x16x32_bf16 v[136:139], v[212:215], v[96:99], v[136:139]
    v_mfma_f32_16x16x32_bf16 v[136:139], v[216:219], v[116:119], v[136:139]
    v_mfma_f32_16x16x32_bf16 v[140:143], v[216:219], v[120:123], 0
    v_mfma_f32_16x16x32_bf16 v[140:143], v[212:215], v[100:103], v[140:143]
    v_mfma_f32_16x16x32_bf16 v[140:143], v[208:211], v[80:83], v[140:143]
    v_mfma_f32_16x16x32_bf16 v[140:143], v[204:207], v[60:63], v[140:143]
    v_mfma_f32_16x16x32_bf16 v[140:143], v[200:203], v[40:43], v[140:143]
    v_mfma_f32_16x16x32_bf16 v[140:143], v[196:199], v[20:23], v[140:143]
    v_mfma_f32_16x16x32_bf16 v[144:147], v[196:199], v[24:27], 0
    v_mfma_f32_16x16x32_bf16 v[144:147], v[200:203], v[44:47], v[144:147]
    v_mfma_f32_16x16x32_bf16 v[144:147], v[204:207], v[64:67], v[144:147]
    v_mfma_f32_16x16x32_bf16 v[144:147], v[208:211], v[84:87], v[144:147]
    v_mfma_f32_16x16x32_bf16 v[144:147], v[212:215], v[104:107], v[144:147]
    v_mfma_f32_16x16x32_bf16 v[144:147], v[216:219], v[124:127], v[144:147]
    v_mfma_f32_16x16x32_bf16 v[148:151], v[216:219], v[128:131], 0
    v_mfma_f32_16x16x32_bf16 v[148:151], v[212:215], v[108:111], v[148:151]
    v_mfma_f32_16x16x32_bf16 v[148:151], v[208:211], v[88:91], v[148:151]
    v_mfma_f32_16x16x32_bf16 v[148:151], v[204:207], v[68:71], v[148:151]
    v_mfma_f32_16x16x32_bf16 v[148:151], v[200:203], v[48:51], v[148:151]
    v_mfma_f32_16x16x32_bf16 v[148:151], v[196:199], v[28:31], v[148:151]
    v_mfma_f32_16x16x32_bf16 v[152:155], v[196:199], v[32:35], 0
    v_mfma_f32_16x16x32_bf16 v[152:155], v[200:203], v[52:55], v[152:155]
    v_mfma_f32_16x16x32_bf16 v[152:155], v[204:207], v[72:75], v[152:155]
    v_mfma_f32_16x16x32_bf16 v[152:155], v[208:211], v[92:95], v[152:155]
    v_mfma_f32_16x16x32_bf16 v[152:155], v[212:215], v[112:115], v[152:155]
    v_mfma_f32_16x16x32_bf16 v[152:155], v[216:219], v[132:135], v[152:155]
    s_nop 7
    v_max3_f32 v236, v236, v136, v137
    v_max3_f32 v236, v236, v138, v139
    v_max3_f32 v237, v237, v140, v141
    v_max3_f32 v237, v237, v142, v143
    v_max3_f32 v238, v238, v144, v145
    v_max3_f32 v238, v238, v146, v147
    v_max3_f32 v239, v239, v148, v149
    v_max3_f32 v239, v239, v150, v151
    v_max3_f32 v240, v240, v152, v153
    v_max3_f32 v240, v240, v154, v155
    s_add_u32 s45, s45, 6144
    s_cmp_lt_u32 s45, 196608
    s_cbranch_scc1 L_slow1
    v_mov_b32 v136, v236
    v_mov_b32 v137, v237
    v_mov_b32 v138, v238
    v_mov_b32 v139, v239
    v_mov_b32 v140, v240
    s_nop 0
    v_permlane32_swap_b32 v136, v236
    v_permlane32_swap_b32 v137, v237
    v_permlane32_swap_b32 v138, v238
    v_permlane32_swap_b32 v139, v239
    v_permlane32_swap_b32 v140, v240
    s_nop 0
    v_max_f32 v236, v236, v136
    v_max_f32 v237, v237, v137
    v_max_f32 v238, v238, v138
    v_max_f32 v239, v239, v139
    v_max_f32 v240, v240, v140
    v_mov_b32 v136, v236
    v_mov_b32 v137, v237
    v_mov_b32 v138, v238
    v_mov_b32 v139, v239
    v_mov_b32 v140, v240
    s_nop 0
    v_permlane16_swap_b32 v136, v236
    v_permlane16_swap_b32 v137, v237
    v_permlane16_swap_b32 v138, v238
    v_permlane16_swap_b32 v139, v239
    v_permlane16_swap_b32 v140, v240
    s_nop 0
    v_max_f32 v236, v236, v136
    v_max_f32 v237, v237, v137
    v_max_f32 v238, v238, v138
    v_max_f32 v239, v239, v139
    v_max_f32 v240, v240, v140
    v_mfma_f32_16x16x32_bf16 a[0:3], v[232:235], v[232:235], 0
    v_mfma_f32_16x16x32_bf16 a[4:7], v[232:235], v[232:235], 0
    v_mfma_f32_16x16x32_bf16 a[8:11], v[232:235], v[232:235], 0
    v_mfma_f32_16x16x32_bf16 a[12:15], v[232:235], v[232:235], 0
    v_mfma_f32_16x16x32_bf16 a[16:19], v[232:235], v[232:235], 0
    v_mfma_f32_16x16x32_bf16 a[20:23], v[232:235], v[232:235], 0
    v_mfma_f32_16x16x32_bf16 a[24:27], v[232:235], v[232:235], 0
    v_mfma_f32_16x16x32_bf16 a[28:31], v[232:235], v[232:235], 0
    v_mfma_f32_16x16x32_bf16 a[32:35], v[232:235], v[232:235], 0
    v_mfma_f32_16x16x32_bf16 a[36:39], v[232:235], v[232:235], 0
    v_mfma_f32_16x16x32_bf16 a[40:43], v[232:235], v[232:235], 0
    v_mfma_f32_16x16x32_bf16 a[44:47], v[232:235], v[232:235], 0
    v_mfma_f32_16x16x32_bf16 a[48:51], v[232:235], v[232:235], 0
    v_mfma_f32_16x16x32_bf16 a[52:55], v[232:235], v[232:235], 0
    v_mfma_f32_16x16x32_bf16 a[56:59], v[232:235], v[232:235], 0
    v_mfma_f32_16x16x32_bf16 a[60:63], v[232:235], v[232:235], 0
    v_mfma_f32_16x16x32_bf16 a[64:67], v[232:235], v[232:235], 0
    v_mfma_f32_16x16x32_bf16 a[68:71], v[232:235], v[232:235], 0
    v_mfma_f32_16x16x32_bf16 a[72:75], v[232:235], v[232:235], 0
    v_mfma_f32_16x16x32_bf16 a[76:79], v[232:235], v[232:235], 0
    v_mfma_f32_16x16x32_bf16 a[80:83], v[232:235], v[232:235], 0
    v_mfma_f32_16x16x32_bf16 a[84:87], v[232:235], v[232:235], 0
    v_mfma_f32_16x16x32_bf16 a[88:91], v[232:235], v[232:235], 0
    v_mfma_f32_16x16x32_bf16 a[92:95], v[232:235], v[232:235], 0
    v_mfma_f32_16x16x32_bf16 a[96:99], v[232:235], v[232:235], 0
    v_mfma_f32_16x16x32_bf16 a[100:103], v[232:235], v[232:235], 0
    v_mfma_f32_16x16x32_bf16 a[104:107], v[232:235], v[232:235], 0
    v_mfma_f32_16x16x32_bf16 a[108:111], v[232:235], v[232:235], 0
    v_mfma_f32_16x16x32_bf16 a[112:115], v[232:235], v[232:235], 0
    v_mfma_f32_16x16x32_bf16 a[116:119], v[232:235], v[232:235], 0
    v_mfma_f32_16x16x32_bf16 a[120:123], v[232:235], v[232:235], 0
    v_mfma_f32_16x16x32_bf16 a[124:127], v[232:235], v[232:235], 0
    v_mfma_f32_16x16x32_bf16 a[128:131], v[232:235], v[232:235], 0
    v_mfma_f32_16x16x32_bf16 a[132:135], v[232:235], v[232:235], 0
    v_mfma_f32_16x16x32_bf16 a[136:139], v[232:235], v[232:235], 0
    v_mfma_f32_16x16x32_bf16 a[140:143], v[232:235], v[232:235], 0
    v_mfma_f32_16x16x32_bf16 a[144:147], v[232:235], v[232:235], 0
    v_mfma_f32_16x16x32_bf16 a[148:151], v[232:235], v[232:235], 0
    v_mfma_f32_16x16x32_bf16 a[152:155], v[232:235], v[232:235], 0
    v_mfma_f32_16x16x32_bf16 a[156:159], v[232:235], v[232:235], 0
    v_mfma_f32_16x16x32_bf16 a[160:163], v[232:235], v[232:235], 0
    v_mfma_f32_16x16x32_bf16 a[164:167], v[232:235], v[232:235], 0
    v_mfma_f32_16x16x32_bf16 a[168:171], v[232:235], v[232:235], 0
    v_mfma_f32_16x16x32_bf16 a[172:175], v[232:235], v[232:235], 0
    v_mfma_f32_16x16x32_bf16 a[176:179], v[232:235], v[232:235], 0
    v_mfma_f32_16x16x32_bf16 a[180:183], v[232:235], v[232:235], 0
    v_mfma_f32_16x16x32_bf16 a[184:187], v[232:235], v[232:235], 0
    v_mfma_f32_16x16x32_bf16 a[188:191], v[232:235], v[232:235], 0
    v_mfma_f32_16x16x32_bf16 a[192:195], v[232:235], v[232:235], 0
    v_mfma_f32_16x16x32_bf16 a[196:199], v[232:235], v[232:235], 0
    v_mfma_f32_16x16x32_bf16 a[200:203], v[232:235], v[232:235], 0
    v_mfma_f32_16x16x32_bf16 a[204:207], v[232:235], v[232:235], 0
    v_mfma_f32_16x16x32_bf16 a[208:211], v[232:235], v[232:235], 0
    v_mfma_f32_16x16x32_bf16 a[212:215], v[232:235], v[232:235], 0
    v_mfma_f32_16x16x32_bf16 a[216:219], v[232:235], v[232:235], 0
    v_mfma_f32_16x16x32_bf16 a[220:223], v[232:235], v[232:235], 0
    v_mfma_f32_16x16x32_bf16 a[224:227], v[232:235], v[232:235], 0
    v_mfma_f32_16x16x32_bf16 a[228:231], v[232:235], v[232:235], 0
    v_mfma_f32_16x16x32_bf16 a[232:235], v[232:235], v[232:235], 0
    v_mfma_f32_16x16x32_bf16 a[236:239], v[232:235], v[232:235], 0
    s_mov_b32 s45, 0
L_slow2:
    s_add_u32 s46, s45, 6144
    buffer_load_dwordx4 v[196:199], v241, s[12:15], s45 offen offset:0
    buffer_load_dwordx4 v[200:203], v241, s[12:15], s45 offen offset:64
    buffer_load_dwordx4 v[204:207], v241, s[12:15], s45 offen offset:128
    buffer_load_dwordx4 v[208:211], v241, s[12:15], s45 offen offset:192
    buffer_load_dwordx4 v[212:215], v241, s[12:15], s45 offen offset:256
    buffer_load_dwordx4 v[216:219], v241, s[12:15], s45 offen offset:320
    s_waitcnt vmcnt(0)
    v_mfma_f32_16x16x32_bf16 v[136:139], v[196:199], v[16:19], 0
    v_mfma_f32_16x16x32_bf16 v[136:139], v[200:203], v[36:39], v[136:139]
    v_mfma_f32_16x16x32_bf16 v[136:139], v[204:207], v[56:59], v[136:139]
    v_mfma_f32_16x16x32_bf16 v[136:139], v[208:211], v[76:79], v[136:139]
    v_mfma_f32_16x16x32_bf16 v[136:139], v[212:215], v[96:99], v[136:139]
    v_mfma_f32_16x16x32_bf16 v[136:139], v[216:219], v[116:119], v[136:139]
    v_mfma_f32_16x16x32_bf16 v[140:143], v[216:219], v[120:123], 0
    v_mfma_f32_16x16x32_bf16 v[140:143], v[212:215], v[100:103], v[140:143]
    v_mfma_f32_16x16x32_bf16 v[140:143], v[208:211], v[80:83], v[140:143]
    v_mfma_f32_16x16x32_bf16 v[140:143], v[204:207], v[60:63], v[140:143]
    v_mfma_f32_16x16x32_bf16 v[140:143], v[200:203], v[40:43], v[140:143]
    v_mfma_f32_16x16x32_bf16 v[140:143], v[196:199], v[20:23], v[140:143]
    v_mfma_f32_16x16x32_bf16 v[144:147], v[196:199], v[24:27], 0
    v_mfma_f32_16x16x32_bf16 v[144:147], v[200:203], v[44:47], v[144:147]
    v_mfma_f32_16x16x32_bf16 v[144:147], v[204:207], v[64:67], v[144:147]
    v_mfma_f32_16x16x32_bf16 v[144:147], v[208:211], v[84:87], v[144:147]
    v_mfma_f32_16x16x32_bf16 v[144:147], v[212:215], v[104:107], v[144:147]
    v_mfma_f32_16x16x32_bf16 v[144:147], v[216:219], v[124:127], v[144:147]
    v_mfma_f32_16x16x32_bf16 v[148:151], v[216:219], v[128:131], 0
    v_mfma_f32_16x16x32_bf16 v[148:151], v[212:215], v[108:111], v[148:151]
    v_mfma_f32_16x16x32_bf16 v[148:151], v[208:211], v[88:91], v[148:151]
    v_mfma_f32_16x16x32_bf16 v[148:151], v[204:207], v[68:71], v[148:151]
    v_mfma_f32_16x16x32_bf16 v[148:151], v[200:203], v[48:51], v[148:151]
    v_mfma_f32_16x16x32_bf16 v[148:151], v[196:199], v[28:31], v[148:151]
    v_mfma_f32_16x16x32_bf16 v[152:155], v[196:199], v[32:35], 0
    v_mfma_f32_16x16x32_bf16 v[152:155], v[200:203], v[52:55], v[152:155]
    v_mfma_f32_16x16x32_bf16 v[152:155], v[204:207], v[72:75], v[152:155]
    v_mfma_f32_16x16x32_bf16 v[152:155], v[208:211], v[92:95], v[152:155]
    v_mfma_f32_16x16x32_bf16 v[152:155], v[212:215], v[112:115], v[152:155]
    v_mfma_f32_16x16x32_bf16 v[152:155], v[216:219], v[132:135], v[152:155]
    buffer_load_dwordx4 v[196:199], v241, s[12:15], s46 offen offset:0
    buffer_load_dwordx4 v[200:203], v241, s[12:15], s46 offen offset:64
    buffer_load_dwordx4 v[204:207], v241, s[12:15], s46 offen offset:128
    buffer_load_dwordx4 v[208:211], v241, s[12:15], s46 offen offset:192
    buffer_load_dwordx4 v[212:215], v241, s[12:15], s46 offen offset:256
    buffer_load_dwordx4 v[216:219], v241, s[12:15], s46 offen offset:320
    s_waitcnt vmcnt(0)
    v_mfma_f32_16x16x32_bf16 v[156:159], v[196:199], v[16:19], 0
    v_mfma_f32_16x16x32_bf16 v[156:159], v[200:203], v[36:39], v[156:159]
    v_mfma_f32_16x16x32_bf16 v[156:159], v[204:207], v[56:59], v[156:159]
    v_mfma_f32_16x16x32_bf16 v[156:159], v[208:211], v[76:79], v[156:159]
    v_mfma_f32_16x16x32_bf16 v[156:159], v[212:215], v[96:99], v[156:159]
    v_mfma_f32_16x16x32_bf16 v[156:159], v[216:219], v[116:119], v[156:159]
    v_mfma_f32_16x16x32_bf16 v[160:163], v[216:219], v[120:123], 0
    v_mfma_f32_16x16x32_bf16 v[160:163], v[212:215], v[100:103], v[160:163]
    v_mfma_f32_16x16x32_bf16 v[160:163], v[208:211], v[80:83], v[160:163]
    v_mfma_f32_16x16x32_bf16 v[160:163], v[204:207], v[60:63], v[160:163]
    v_mfma_f32_16x16x32_bf16 v[160:163], v[200:203], v[40:43], v[160:163]
    v_mfma_f32_16x16x32_bf16 v[160:163], v[196:199], v[20:23], v[160:163]
    v_mfma_f32_16x16x32_bf16 v[164:167], v[196:199], v[24:27], 0
    v_mfma_f32_16x16x32_bf16 v[164:167], v[200:203], v[44:47], v[164:167]
    v_mfma_f32_16x16x32_bf16 v[164:167], v[204:207], v[64:67], v[164:167]
    v_mfma_f32_16x16x32_bf16 v[164:167], v[208:211], v[84:87], v[164:167]
    v_mfma_f32_16x16x32_bf16 v[164:167], v[212:215], v[104:107], v[164:167]
    v_mfma_f32_16x16x32_bf16 v[164:167], v[216:219], v[124:127], v[164:167]
    v_mfma_f32_16x16x32_bf16 v[168:171], v[216:219], v[128:131], 0
    v_mfma_f32_16x16x32_bf16 v[168:171], v[212:215], v[108:111], v[168:171]
    v_mfma_f32_16x16x32_bf16 v[168:171], v[208:211], v[88:91], v[168:171]
    v_mfma_f32_16x16x32_bf16 v[168:171], v[204:207], v[68:71], v[168:171]
    v_mfma_f32_16x16x32_bf16 v[168:171], v[200:203], v[48:51], v[168:171]
    v_mfma_f32_16x16x32_bf16 v[168:171], v[196:199], v[28:31], v[168:171]
    v_mfma_f32_16x16x32_bf16 v[172:175], v[196:199], v[32:35], 0
    v_mfma_f32_16x16x32_bf16 v[172:175], v[200:203], v[52:55], v[172:175]
    v_mfma_f32_16x16x32_bf16 v[172:175], v[204:207], v[72:75], v[172:175]
    v_mfma_f32_16x16x32_bf16 v[172:175], v[208:211], v[92:95], v[172:175]
    v_mfma_f32_16x16x32_bf16 v[172:175], v[212:215], v[112:115], v[172:175]
    v_mfma_f32_16x16x32_bf16 v[172:175], v[216:219], v[132:135], v[172:175]
    s_nop 7
    v_sub_f32 v136, v136, v236
    v_sub_f32 v137, v137, v236
    v_sub_f32 v138, v138, v236
    v_sub_f32 v139, v139, v236
    v_exp_f32 v136, v136
    v_exp_f32 v137, v137
    v_exp_f32 v138, v138
    v_exp_f32 v139, v139
    s_nop 0
    v_add_f32 v244, v244, v136
    v_add_f32 v244, v244, v137
    v_add_f32 v244, v244, v138
    v_add_f32 v244, v244, v139
    v_cvt_pk_bf16_f32 v176, v136, v137
    v_cvt_pk_bf16_f32 v177, v138, v139
    v_sub_f32 v140, v140, v237
    v_sub_f32 v141, v141, v237
    v_sub_f32 v142, v142, v237
    v_sub_f32 v143, v143, v237
    v_exp_f32 v140, v140
    v_exp_f32 v141, v141
    v_exp_f32 v142, v142
    v_exp_f32 v143, v143
    s_nop 0
    v_add_f32 v245, v245, v140
    v_add_f32 v245, v245, v141
    v_add_f32 v245, v245, v142
    v_add_f32 v245, v245, v143
    v_cvt_pk_bf16_f32 v180, v140, v141
    v_cvt_pk_bf16_f32 v181, v142, v143
    v_sub_f32 v144, v144, v238
    v_sub_f32 v145, v145, v238
    v_sub_f32 v146, v146, v238
    v_sub_f32 v147, v147, v238
    v_exp_f32 v144, v144
    v_exp_f32 v145, v145
    v_exp_f32 v146, v146
    v_exp_f32 v147, v147
    s_nop 0
    v_add_f32 v246, v246, v144
    v_add_f32 v246, v246, v145
    v_add_f32 v246, v246, v146
    v_add_f32 v246, v246, v147
    v_cvt_pk_bf16_f32 v184, v144, v145
    v_cvt_pk_bf16_f32 v185, v146, v147
    v_sub_f32 v148, v148, v239
    v_sub_f32 v149, v149, v239
    v_sub_f32 v150, v150, v239
    v_sub_f32 v151, v151, v239
    v_exp_f32 v148, v148
    v_exp_f32 v149, v149
    v_exp_f32 v150, v150
    v_exp_f32 v151, v151
    s_nop 0
    v_add_f32 v247, v247, v148
    v_add_f32 v247, v247, v149
    v_add_f32 v247, v247, v150
    v_add_f32 v247, v247, v151
    v_cvt_pk_bf16_f32 v188, v148, v149
    v_cvt_pk_bf16_f32 v189, v150, v151
    v_sub_f32 v152, v152, v240
    v_sub_f32 v153, v153, v240
    v_sub_f32 v154, v154, v240
    v_sub_f32 v155, v155, v240
    v_exp_f32 v152, v152
    v_exp_f32 v153, v153
    v_exp_f32 v154, v154
    v_exp_f32 v155, v155
    s_nop 0
    v_add_f32 v248, v248, v152
    v_add_f32 v248, v248, v153
    v_add_f32 v248, v248, v154
    v_add_f32 v248, v248, v155
    v_cvt_pk_bf16_f32 v192, v152, v153
    v_cvt_pk_bf16_f32 v193, v154, v155
    v_sub_f32 v156, v156, v236
    v_sub_f32 v157, v157, v236
    v_sub_f32 v158, v158, v236
    v_sub_f32 v159, v159, v236
    v_exp_f32 v156, v156
    v_exp_f32 v157, v157
    v_exp_f32 v158, v158
    v_exp_f32 v159, v159
    s_nop 0
    v_add_f32 v244, v244, v156
    v_add_f32 v244, v244, v157
    v_add_f32 v244, v244, v158
    v_add_f32 v244, v244, v159
    v_cvt_pk_bf16_f32 v178, v156, v157
    v_cvt_pk_bf16_f32 v179, v158, v159
    v_sub_f32 v160, v160, v237
    v_sub_f32 v161, v161, v237
    v_sub_f32 v162, v162, v237
    v_sub_f32 v163, v163, v237
    v_exp_f32 v160, v160
    v_exp_f32 v161, v161
    v_exp_f32 v162, v162
    v_exp_f32 v163, v163
    s_nop 0
    v_add_f32 v245, v245, v160
    v_add_f32 v245, v245, v161
    v_add_f32 v245, v245, v162
    v_add_f32 v245, v245, v163
    v_cvt_pk_bf16_f32 v182, v160, v161
    v_cvt_pk_bf16_f32 v183, v162, v163
    v_sub_f32 v164, v164, v238
    v_sub_f32 v165, v165, v238
    v_sub_f32 v166, v166, v238
    v_sub_f32 v167, v167, v238
    v_exp_f32 v164, v164
    v_exp_f32 v165, v165
    v_exp_f32 v166, v166
    v_exp_f32 v167, v167
    s_nop 0
    v_add_f32 v246, v246, v164
    v_add_f32 v246, v246, v165
    v_add_f32 v246, v246, v166
    v_add_f32 v246, v246, v167
    v_cvt_pk_bf16_f32 v186, v164, v165
    v_cvt_pk_bf16_f32 v187, v166, v167
    v_sub_f32 v168, v168, v239
    v_sub_f32 v169, v169, v239
    v_sub_f32 v170, v170, v239
    v_sub_f32 v171, v171, v239
    v_exp_f32 v168, v168
    v_exp_f32 v169, v169
    v_exp_f32 v170, v170
    v_exp_f32 v171, v171
    s_nop 0
    v_add_f32 v247, v247, v168
    v_add_f32 v247, v247, v169
    v_add_f32 v247, v247, v170
    v_add_f32 v247, v247, v171
    v_cvt_pk_bf16_f32 v190, v168, v169
    v_cvt_pk_bf16_f32 v191, v170, v171
    v_sub_f32 v172, v172, v240
    v_sub_f32 v173, v173, v240
    v_sub_f32 v174, v174, v240
    v_sub_f32 v175, v175, v240
    v_exp_f32 v172, v172
    v_exp_f32 v173, v173
    v_exp_f32 v174, v174
    v_exp_f32 v175, v175
    s_nop 0
    v_add_f32 v248, v248, v172
    v_add_f32 v248, v248, v173
    v_add_f32 v248, v248, v174
    v_add_f32 v248, v248, v175
    v_cvt_pk_bf16_f32 v194, v172, v173
    v_cvt_pk_bf16_f32 v195, v174, v175
    buffer_load_ushort v196, v242, s[16:19], s45 offen offset:0
    buffer_load_ushort v197, v242, s[16:19], s45 offen offset:384
    buffer_load_ushort v198, v242, s[16:19], s45 offen offset:768
    buffer_load_ushort v199, v242, s[16:19], s45 offen offset:1152
    buffer_load_ushort v200, v242, s[16:19], s46 offen offset:0
    buffer_load_ushort v201, v242, s[16:19], s46 offen offset:384
    buffer_load_ushort v202, v242, s[16:19], s46 offen offset:768
    buffer_load_ushort v203, v242, s[16:19], s46 offen offset:1152
    buffer_load_ushort v204, v242, s[16:19], s45 offen offset:32
    buffer_load_ushort v205, v242, s[16:19], s45 offen offset:416
    buffer_load_ushort v206, v242, s[16:19], s45 offen offset:800
    buffer_load_ushort v207, v242, s[16:19], s45 offen offset:1184
    buffer_load_ushort v208, v242, s[16:19], s46 offen offset:32
    buffer_load_ushort v209, v242, s[16:19], s46 offen offset:416
    buffer_load_ushort v210, v242, s[16:19], s46 offen offset:800
    buffer_load_ushort v211, v242, s[16:19], s46 offen offset:1184
    buffer_load_ushort v212, v242, s[16:19], s45 offen offset:64
    buffer_load_ushort v213, v242, s[16:19], s45 offen offset:448
    buffer_load_ushort v214, v242, s[16:19], s45 offen offset:832
    buffer_load_ushort v215, v242, s[16:19], s45 offen offset:1216
    buffer_load_ushort v216, v242, s[16:19], s46 offen offset:64
    buffer_load_ushort v217, v242, s[16:19], s46 offen offset:448
    buffer_load_ushort v218, v242, s[16:19], s46 offen offset:832
    buffer_load_ushort v219, v242, s[16:19], s46 offen offset:1216
    s_waitcnt vmcnt(0)
    v_lshl_or_b32 v220, v197, 16, v196
    v_lshl_or_b32 v221, v199, 16, v198
    v_lshl_or_b32 v222, v201, 16, v200
    v_lshl_or_b32 v223, v203, 16, v202
    v_lshl_or_b32 v224, v205, 16, v204
    v_lshl_or_b32 v225, v207, 16, v206
    v_lshl_or_b32 v226, v209, 16, v208
    v_lshl_or_b32 v227, v211, 16, v210
    v_lshl_or_b32 v228, v213, 16, v212
    v_lshl_or_b32 v229, v215, 16, v214
    v_lshl_or_b32 v230, v217, 16, v216
    v_lshl_or_b32 v231, v219, 16, v218
    s_nop 1
    v_mfma_f32_16x16x32_bf16 a[0:3], v[220:223], v[176:179], a[0:3]
    v_mfma_f32_16x16x32_bf16 a[4:7], v[220:223], v[180:183], a[4:7]
    v_mfma_f32_16x16x32_bf16 a[8:11], v[220:223], v[184:187], a[8:11]
    v_mfma_f32_16x16x32_bf16 a[12:15], v[220:223], v[188:191], a[12:15]
    v_mfma_f32_16x16x32_bf16 a[16:19], v[220:223], v[192:195], a[16:19]
    v_mfma_f32_16x16x32_bf16 a[20:23], v[224:227], v[176:179], a[20:23]
    v_mfma_f32_16x16x32_bf16 a[24:27], v[224:227], v[180:183], a[24:27]
    v_mfma_f32_16x16x32_bf16 a[28:31], v[224:227], v[184:187], a[28:31]
    v_mfma_f32_16x16x32_bf16 a[32:35], v[224:227], v[188:191], a[32:35]
    v_mfma_f32_16x16x32_bf16 a[36:39], v[224:227], v[192:195], a[36:39]
    v_mfma_f32_16x16x32_bf16 a[40:43], v[228:231], v[176:179], a[40:43]
    v_mfma_f32_16x16x32_bf16 a[44:47], v[228:231], v[180:183], a[44:47]
    v_mfma_f32_16x16x32_bf16 a[48:51], v[228:231], v[184:187], a[48:51]
    v_mfma_f32_16x16x32_bf16 a[52:55], v[228:231], v[188:191], a[52:55]
    v_mfma_f32_16x16x32_bf16 a[56:59], v[228:231], v[192:195], a[56:59]
    buffer_load_ushort v196, v242, s[16:19], s45 offen offset:96
    buffer_load_ushort v197, v242, s[16:19], s45 offen offset:480
    buffer_load_ushort v198, v242, s[16:19], s45 offen offset:864
    buffer_load_ushort v199, v242, s[16:19], s45 offen offset:1248
    buffer_load_ushort v200, v242, s[16:19], s46 offen offset:96
    buffer_load_ushort v201, v242, s[16:19], s46 offen offset:480
    buffer_load_ushort v202, v242, s[16:19], s46 offen offset:864
    buffer_load_ushort v203, v242, s[16:19], s46 offen offset:1248
    buffer_load_ushort v204, v242, s[16:19], s45 offen offset:128
    buffer_load_ushort v205, v242, s[16:19], s45 offen offset:512
    buffer_load_ushort v206, v242, s[16:19], s45 offen offset:896
    buffer_load_ushort v207, v242, s[16:19], s45 offen offset:1280
    buffer_load_ushort v208, v242, s[16:19], s46 offen offset:128
    buffer_load_ushort v209, v242, s[16:19], s46 offen offset:512
    buffer_load_ushort v210, v242, s[16:19], s46 offen offset:896
    buffer_load_ushort v211, v242, s[16:19], s46 offen offset:1280
    buffer_load_ushort v212, v242, s[16:19], s45 offen offset:160
    buffer_load_ushort v213, v242, s[16:19], s45 offen offset:544
    buffer_load_ushort v214, v242, s[16:19], s45 offen offset:928
    buffer_load_ushort v215, v242, s[16:19], s45 offen offset:1312
    buffer_load_ushort v216, v242, s[16:19], s46 offen offset:160
    buffer_load_ushort v217, v242, s[16:19], s46 offen offset:544
    buffer_load_ushort v218, v242, s[16:19], s46 offen offset:928
    buffer_load_ushort v219, v242, s[16:19], s46 offen offset:1312
    s_waitcnt vmcnt(0)
    v_lshl_or_b32 v220, v197, 16, v196
    v_lshl_or_b32 v221, v199, 16, v198
    v_lshl_or_b32 v222, v201, 16, v200
    v_lshl_or_b32 v223, v203, 16, v202
    v_lshl_or_b32 v224, v205, 16, v204
    v_lshl_or_b32 v225, v207, 16, v206
    v_lshl_or_b32 v226, v209, 16, v208
    v_lshl_or_b32 v227, v211, 16, v210
    v_lshl_or_b32 v228, v213, 16, v212
    v_lshl_or_b32 v229, v215, 16, v214
    v_lshl_or_b32 v230, v217, 16, v216
    v_lshl_or_b32 v231, v219, 16, v218
    s_nop 1
    v_mfma_f32_16x16x32_bf16 a[60:63], v[220:223], v[176:179], a[60:63]
    v_mfma_f32_16x16x32_bf16 a[64:67], v[220:223], v[180:183], a[64:67]
    v_mfma_f32_16x16x32_bf16 a[68:71], v[220:223], v[184:187], a[68:71]
    v_mfma_f32_16x16x32_bf16 a[72:75], v[220:223], v[188:191], a[72:75]
    v_mfma_f32_16x16x32_bf16 a[76:79], v[220:223], v[192:195], a[76:79]
    v_mfma_f32_16x16x32_bf16 a[80:83], v[224:227], v[176:179], a[80:83]
    v_mfma_f32_16x16x32_bf16 a[84:87], v[224:227], v[180:183], a[84:87]
    v_mfma_f32_16x16x32_bf16 a[88:91], v[224:227], v[184:187], a[88:91]
    v_mfma_f32_16x16x32_bf16 a[92:95], v[224:227], v[188:191], a[92:95]
    v_mfma_f32_16x16x32_bf16 a[96:99], v[224:227], v[192:195], a[96:99]
    v_mfma_f32_16x16x32_bf16 a[100:103], v[228:231], v[176:179], a[100:103]
    v_mfma_f32_16x16x32_bf16 a[104:107], v[228:231], v[180:183], a[104:107]
    v_mfma_f32_16x16x32_bf16 a[108:111], v[228:231], v[184:187], a[108:111]
    v_mfma_f32_16x16x32_bf16 a[112:115], v[228:231], v[188:191], a[112:115]
    v_mfma_f32_16x16x32_bf16 a[116:119], v[228:231], v[192:195], a[116:119]
    buffer_load_ushort v196, v242, s[16:19], s45 offen offset:192
    buffer_load_ushort v197, v242, s[16:19], s45 offen offset:576
    buffer_load_ushort v198, v242, s[16:19], s45 offen offset:960
    buffer_load_ushort v199, v242, s[16:19], s45 offen offset:1344
    buffer_load_ushort v200, v242, s[16:19], s46 offen offset:192
    buffer_load_ushort v201, v242, s[16:19], s46 offen offset:576
    buffer_load_ushort v202, v242, s[16:19], s46 offen offset:960
    buffer_load_ushort v203, v242, s[16:19], s46 offen offset:1344
    buffer_load_ushort v204, v242, s[16:19], s45 offen offset:224
    buffer_load_ushort v205, v242, s[16:19], s45 offen offset:608
    buffer_load_ushort v206, v242, s[16:19], s45 offen offset:992
    buffer_load_ushort v207, v242, s[16:19], s45 offen offset:1376
    buffer_load_ushort v208, v242, s[16:19], s46 offen offset:224
    buffer_load_ushort v209, v242, s[16:19], s46 offen offset:608
    buffer_load_ushort v210, v242, s[16:19], s46 offen offset:992
    buffer_load_ushort v211, v242, s[16:19], s46 offen offset:1376
    buffer_load_ushort v212, v242, s[16:19], s45 offen offset:256
    buffer_load_ushort v213, v242, s[16:19], s45 offen offset:640
    buffer_load_ushort v214, v242, s[16:19], s45 offen offset:1024
    buffer_load_ushort v215, v242, s[16:19], s45 offen offset:1408
    buffer_load_ushort v216, v242, s[16:19], s46 offen offset:256
    buffer_load_ushort v217, v242, s[16:19], s46 offen offset:640
    buffer_load_ushort v218, v242, s[16:19], s46 offen offset:1024
    buffer_load_ushort v219, v242, s[16:19], s46 offen offset:1408
    s_waitcnt vmcnt(0)
    v_lshl_or_b32 v220, v197, 16, v196
    v_lshl_or_b32 v221, v199, 16, v198
    v_lshl_or_b32 v222, v201, 16, v200
    v_lshl_or_b32 v223, v203, 16, v202
    v_lshl_or_b32 v224, v205, 16, v204
    v_lshl_or_b32 v225, v207, 16, v206
    v_lshl_or_b32 v226, v209, 16, v208
    v_lshl_or_b32 v227, v211, 16, v210
    v_lshl_or_b32 v228, v213, 16, v212
    v_lshl_or_b32 v229, v215, 16, v214
    v_lshl_or_b32 v230, v217, 16, v216
    v_lshl_or_b32 v231, v219, 16, v218
    s_nop 1
    v_mfma_f32_16x16x32_bf16 a[120:123], v[220:223], v[176:179], a[120:123]
    v_mfma_f32_16x16x32_bf16 a[124:127], v[220:223], v[180:183], a[124:127]
    v_mfma_f32_16x16x32_bf16 a[128:131], v[220:223], v[184:187], a[128:131]
    v_mfma_f32_16x16x32_bf16 a[132:135], v[220:223], v[188:191], a[132:135]
    v_mfma_f32_16x16x32_bf16 a[136:139], v[220:223], v[192:195], a[136:139]
    v_mfma_f32_16x16x32_bf16 a[140:143], v[224:227], v[176:179], a[140:143]
    v_mfma_f32_16x16x32_bf16 a[144:147], v[224:227], v[180:183], a[144:147]
    v_mfma_f32_16x16x32_bf16 a[148:151], v[224:227], v[184:187], a[148:151]
    v_mfma_f32_16x16x32_bf16 a[152:155], v[224:227], v[188:191], a[152:155]
    v_mfma_f32_16x16x32_bf16 a[156:159], v[224:227], v[192:195], a[156:159]
    v_mfma_f32_16x16x32_bf16 a[160:163], v[228:231], v[176:179], a[160:163]
    v_mfma_f32_16x16x32_bf16 a[164:167], v[228:231], v[180:183], a[164:167]
    v_mfma_f32_16x16x32_bf16 a[168:171], v[228:231], v[184:187], a[168:171]
    v_mfma_f32_16x16x32_bf16 a[172:175], v[228:231], v[188:191], a[172:175]
    v_mfma_f32_16x16x32_bf16 a[176:179], v[228:231], v[192:195], a[176:179]
    buffer_load_ushort v196, v242, s[16:19], s45 offen offset:288
    buffer_load_ushort v197, v242, s[16:19], s45 offen offset:672
    buffer_load_ushort v198, v242, s[16:19], s45 offen offset:1056
    buffer_load_ushort v199, v242, s[16:19], s45 offen offset:1440
    buffer_load_ushort v200, v242, s[16:19], s46 offen offset:288
    buffer_load_ushort v201, v242, s[16:19], s46 offen offset:672
    buffer_load_ushort v202, v242, s[16:19], s46 offen offset:1056
    buffer_load_ushort v203, v242, s[16:19], s46 offen offset:1440
    buffer_load_ushort v204, v242, s[16:19], s45 offen offset:320
    buffer_load_ushort v205, v242, s[16:19], s45 offen offset:704
    buffer_load_ushort v206, v242, s[16:19], s45 offen offset:1088
    buffer_load_ushort v207, v242, s[16:19], s45 offen offset:1472
    buffer_load_ushort v208, v242, s[16:19], s46 offen offset:320
    buffer_load_ushort v209, v242, s[16:19], s46 offen offset:704
    buffer_load_ushort v210, v242, s[16:19], s46 offen offset:1088
    buffer_load_ushort v211, v242, s[16:19], s46 offen offset:1472
    buffer_load_ushort v212, v242, s[16:19], s45 offen offset:352
    buffer_load_ushort v213, v242, s[16:19], s45 offen offset:736
    buffer_load_ushort v214, v242, s[16:19], s45 offen offset:1120
    buffer_load_ushort v215, v242, s[16:19], s45 offen offset:1504
    buffer_load_ushort v216, v242, s[16:19], s46 offen offset:352
    buffer_load_ushort v217, v242, s[16:19], s46 offen offset:736
    buffer_load_ushort v218, v242, s[16:19], s46 offen offset:1120
    buffer_load_ushort v219, v242, s[16:19], s46 offen offset:1504
    s_waitcnt vmcnt(0)
    v_lshl_or_b32 v220, v197, 16, v196
    v_lshl_or_b32 v221, v199, 16, v198
    v_lshl_or_b32 v222, v201, 16, v200
    v_lshl_or_b32 v223, v203, 16, v202
    v_lshl_or_b32 v224, v205, 16, v204
    v_lshl_or_b32 v225, v207, 16, v206
    v_lshl_or_b32 v226, v209, 16, v208
    v_lshl_or_b32 v227, v211, 16, v210
    v_lshl_or_b32 v228, v213, 16, v212
    v_lshl_or_b32 v229, v215, 16, v214
    v_lshl_or_b32 v230, v217, 16, v216
    v_lshl_or_b32 v231, v219, 16, v218
    s_nop 1
    v_mfma_f32_16x16x32_bf16 a[180:183], v[220:223], v[176:179], a[180:183]
    v_mfma_f32_16x16x32_bf16 a[184:187], v[220:223], v[180:183], a[184:187]
    v_mfma_f32_16x16x32_bf16 a[188:191], v[220:223], v[184:187], a[188:191]
    v_mfma_f32_16x16x32_bf16 a[192:195], v[220:223], v[188:191], a[192:195]
    v_mfma_f32_16x16x32_bf16 a[196:199], v[220:223], v[192:195], a[196:199]
    v_mfma_f32_16x16x32_bf16 a[200:203], v[224:227], v[176:179], a[200:203]
    v_mfma_f32_16x16x32_bf16 a[204:207], v[224:227], v[180:183], a[204:207]
    v_mfma_f32_16x16x32_bf16 a[208:211], v[224:227], v[184:187], a[208:211]
    v_mfma_f32_16x16x32_bf16 a[212:215], v[224:227], v[188:191], a[212:215]
    v_mfma_f32_16x16x32_bf16 a[216:219], v[224:227], v[192:195], a[216:219]
    v_mfma_f32_16x16x32_bf16 a[220:223], v[228:231], v[176:179], a[220:223]
    v_mfma_f32_16x16x32_bf16 a[224:227], v[228:231], v[180:183], a[224:227]
    v_mfma_f32_16x16x32_bf16 a[228:231], v[228:231], v[184:187], a[228:231]
    v_mfma_f32_16x16x32_bf16 a[232:235], v[228:231], v[188:191], a[232:235]
    v_mfma_f32_16x16x32_bf16 a[236:239], v[228:231], v[192:195], a[236:239]
    s_add_u32 s45, s45, 12288
    s_cmp_lt_u32 s45, 196608
    s_cbranch_scc1 L_slow2
    v_mov_b32 v136, v244
    v_mov_b32 v137, v245
    v_mov_b32 v138, v246
    v_mov_b32 v139, v247
    v_mov_b32 v140, v248
    s_nop 0
    v_permlane32_swap_b32 v136, v244
    v_permlane32_swap_b32 v137, v245
    v_permlane32_swap_b32 v138, v246
    v_permlane32_swap_b32 v139, v247
    v_permlane32_swap_b32 v140, v248
    s_nop 0
    v_add_f32 v244, v244, v136
    v_add_f32 v245, v245, v137
    v_add_f32 v246, v246, v138
    v_add_f32 v247, v247, v139
    v_add_f32 v248, v248, v140
    v_mov_b32 v136, v244
    v_mov_b32 v137, v245
    v_mov_b32 v138, v246
    v_mov_b32 v139, v247
    v_mov_b32 v140, v248
    s_nop 0
    v_permlane16_swap_b32 v136, v244
    v_permlane16_swap_b32 v137, v245
    v_permlane16_swap_b32 v138, v246
    v_permlane16_swap_b32 v139, v247
    v_permlane16_swap_b32 v140, v248
    s_nop 0
    v_add_f32 v244, v244, v136
    v_add_f32 v245, v245, v137
    v_add_f32 v246, v246, v138
    v_add_f32 v247, v247, v139
    v_add_f32 v248, v248, v140
    s_cmp_eq_u32 s28, 1
    s_cbranch_scc1 L_backQ
    s_branch L_backO
L_fin:
L_end:
    s_endpgm
.section .rodata,"a"
.p2align 6
.amdhsa_kernel concat_heads__gqa_block_cached__mha_block_cached__near_ridge_kernel
  .amdhsa_next_free_vgpr 512
  .amdhsa_next_free_sgpr 102
  .amdhsa_accum_offset 256
  .amdhsa_group_segment_fixed_size 0
  .amdhsa_kernarg_size 104
  .amdhsa_user_sgpr_count 2
  .amdhsa_user_sgpr_kernarg_segment_ptr 1
  .amdhsa_system_sgpr_workgroup_id_x 1
  .amdhsa_float_denorm_mode_32 3
.end_amdhsa_kernel
```
